```python
import torch

def _softmax(x, axis=-1):
    return torch.softmax(x, dim=axis)

def _gelu(x):
    return torch.nn.functional.gelu(x, approximate='tanh')

def _silu(x):
    return torch.nn.functional.silu(x)

def _sigmoid(x):
    return torch.sigmoid(x)

def _layernorm(x, axis=-1, eps=1e-05):
    m = x.mean(dim=axis, keepdim=True)
    v = x.var(dim=axis, keepdim=True, unbiased=False)
    return (x - m) / torch.sqrt(v + eps)

def _scatter_add(tgt, idx, src, axis=0):
    return tgt.clone().index_add_(axis, idx, src)

def _segment_sum(src, seg, n):
    out = torch.zeros((n,) + src.shape[1:], dtype=src.dtype)
    return out.index_add_(0, seg, src)

def _pad(x, pw):
    flat = tuple((v for pair in reversed(pw) for v in pair))
    return torch.nn.functional.pad(x, flat)
kernel_name = 'adaLN_cond__mha_block_cached__moe_arch_mod__prompt'

def setup_inputs():

    _w = lambda a: (lambda t: t.to(torch.bfloat16) if t.is_floating_point() else t)(torch.as_tensor(a))

    def _A_setup():
        B, Sq, D = (1, 2048, 1024)
        H, Sk, Dh = (32, 2048, 128)
        return {'x': _w((lambda *s: torch.randn(*s, dtype=torch.bfloat16) * 0.1)(B, Sq, D)), 'k_cache': _w((lambda *s: torch.randn(*s, dtype=torch.bfloat16) * 0.8)(B, H, Sk, Dh)), 'v_cache': _w((lambda *s: torch.randn(*s, dtype=torch.bfloat16) * 0.8)(B, H, Sk, Dh)), 'wq': _w((lambda *s: torch.randn(*s, dtype=torch.bfloat16) * 0.8)(D, H * Dh) * D ** (-0.5)), 'wo': _w((lambda *s: torch.randn(*s, dtype=torch.bfloat16) * 0.8)(H * Dh, D) * (H * Dh) ** (-0.5))}
    _A_in = _A_setup()

    def _B_setup():
        B, S, D, F, C = (1, 2048, 1024, 3584, 2)
        return {'x': _w((lambda *s: torch.randn(*s, dtype=torch.bfloat16) * 0.1)(B, S, D)), 'w_r': _w((lambda *s: torch.randn(*s, dtype=torch.bfloat16) * 3.2)(D)), 'w_gate': _w((lambda *s: torch.randn(*s, dtype=torch.bfloat16) * 0.2)(D, F)), 'w_up': _w((lambda *s: torch.randn(*s, dtype=torch.bfloat16) * 0.2)(D, F)), 'w_down': _w((lambda *s: torch.randn(*s, dtype=torch.bfloat16) * 0.2)(F, D))}
    _B_in = _B_setup()
    return {'A_x': _A_in['x'], 'A_k_cache': _A_in['k_cache'], 'A_v_cache': _A_in['v_cache'], 'A_wq': _A_in['wq'], 'A_wo': _A_in['wo'], 'B_x': _B_in['x'], 'B_w_r': _B_in['w_r'], 'B_w_gate': _B_in['w_gate'], 'B_w_up': _B_in['w_up'], 'B_w_down': _B_in['w_down'], 'c': _w((lambda *s: torch.randn(*s, dtype=torch.bfloat16) * 0.2)(1, 1024) * 8.0), 'w_mod': _w((lambda *s: torch.randn(*s, dtype=torch.bfloat16) * 0.2)(1024, 6 * 1024) * 1024 ** (-0.5) * 8.0)}

def reference(A_x, A_k_cache, A_v_cache, A_wq, A_wo, B_x, B_w_r, B_w_gate, B_w_up, B_w_down, c, w_mod):

    def _A_ref(x, k_cache, v_cache, wq, wo):
        B, Sq, D = x.shape
        H, Dh = (32, 128)
        q = (lambda x, *d: x.permute(*d))((x @ wq).reshape(B, Sq, H, Dh), 0, 2, 1, 3)
        scores = torch.einsum('bhqd,bhkd->bhqk', q, k_cache) * Dh ** (-0.5)
        p = _softmax(scores, axis=-1)
        o = torch.einsum('bhqk,bhkd->bhqd', p, v_cache)
        return (lambda x, *d: x.permute(*d))(o, 0, 2, 1, 3).reshape(B, Sq, H * Dh) @ wo

    def _B_ref(x, w_r, w_gate, w_up, w_down):
        B, S, D = x.shape
        C = 2
        r = x @ w_r
        idx = torch.argsort(-r, axis=-1)[:, :C]
        idx_e = (lambda x, n, axis: torch.repeat_interleave(x, n, dim=axis))(idx.reshape(B, C, 1), D, axis=2)
        x_sel = (lambda x, i, axis: torch.take_along_dim(x, i, dim=axis))(x, idx_e, axis=1)
        g = _silu(x_sel @ w_gate)
        u = x_sel @ w_up
        y = g * u @ w_down
        r_sel = _sigmoid((lambda x, i, axis: torch.take_along_dim(x, i, dim=axis))(r, idx, axis=1))
        y = y * r_sel.reshape(B, C, 1)
        b_off = (torch.arange(B) * S).reshape(B, 1)
        flat_idx = (idx + b_off).reshape(B * C)
        zero = (x * 0.0).reshape(B * S, D)
        upd = _scatter_add(zero, flat_idx, y.reshape(B * C, D), axis=0)
        return x + upd.reshape(B, S, D)
    x = A_x
    mod = (_silu(c) @ w_mod).reshape(c.shape[0], 6, 1, -1)
    sa, ca, ga, sb, cb, gb = (mod[:, 0].clone(), mod[:, 1].clone(), mod[:, 2].clone(), mod[:, 3].clone(), mod[:, 4].clone(), mod[:, 5].clone())
    h = _layernorm(x, axis=-1) * (1 + ca) + sa
    x = x + ga * _A_ref(h, A_k_cache, A_v_cache, A_wq, A_wo)
    h = _layernorm(x, axis=-1) * (1 + cb) + sb
    x = x + gb * _B_ref(h, B_w_r, B_w_gate, B_w_up, B_w_down)
    return x
```

```asm
; @launch grid=(256,1,1) block=(256,1,1) lds=161344
.amdgcn_target "amdgcn-amd-amdhsa--gfx950"
.text
.globl adaLN_cond__mha_block_cached__moe_arch_mod__prompt_kernel
.p2align 8
.type adaLN_cond__mha_block_cached__moe_arch_mod__prompt_kernel,@function
adaLN_cond__mha_block_cached__moe_arch_mod__prompt_kernel:
    s_cmp_lt_u32 s2, 256
    s_cbranch_scc1 L_go_1
    s_endpgm
L_go_1:
    s_load_dwordx16 s[68:83], s[0:1], 0
    s_load_dwordx8 s[84:91], s[0:1], 64
    s_load_dwordx4 s[92:95], s[0:1], 96
    s_load_dwordx2 s[96:97], s[0:1], 112
    v_lshrrev_b32 v10, 6, v0
    s_getpc_b64 s[50:51]
L_pc_2:
    s_lshr_b32 s44, s2, 3
    s_lshl_b32 s44, s44, 4
    v_and_b32 v216, 3, v0
    v_lshl_add_u32 v216, v10, 2, v216
    v_add_u32 v216, s44, v216
    v_lshlrev_b32 v216, 7, v216
    v_min_u32 v216, L_code_hi-L_code_lo-4, v216
    v_add_u32 v216, L_code_lo-L_pc_2, v216
    v_mov_b32 v217, s51
    v_add_co_u32 v216, vcc, s50, v216
    s_nop 1
    v_addc_co_u32 v217, vcc, 0, v217, vcc
    global_load_dword v218, v[216:217], off
L_code_lo:
    v_and_b32 v11, 63, v0
    v_readfirstlane_b32 s3, v10
    v_lshlrev_b32 v1, 4, v11
    v_lshrrev_b32 v12, 4, v11
    v_and_b32 v13, 15, v11
    s_lshr_b32 s53, s2, 5
    s_lshl_b32 s54, s53, 2
    s_add_u32 s54, s54, s3
    s_mul_i32 s61, s3, 4224
    s_add_u32 s62, s61, 67584
    s_and_b32 s44, s2, 7
    s_bfe_u32 s45, s2, 0x20003
    s_lshl_b32 s59, s53, 3
    s_add_u32 s59, s59, s44
    s_lshl_b32 s59, s59, 2
    s_add_u32 s59, s59, s45
    s_lshl_b32 s44, s44, 2
    s_lshr_b32 s52, 0x73625140, s44
    s_and_b32 s52, s52, 7
    s_lshl_b32 s52, s52, 2
    s_add_u32 s52, s52, s45
    s_and_b32 s58, s2, 1
    s_and_b32 s57, s2, 4
    s_add_u32 s57, s57, s45
    s_lshl_b32 s57, s57, 1
    s_add_u32 s57, s57, s58
    s_bfe_u32 s44, s2, 0x10001
    s_lshl_b32 s56, s53, 1
    s_add_u32 s56, s56, s44
    s_lshl_b32 s55, s56, 4
    s_add_u32 s55, s55, s57
    s_lshl_b32 s56, s56, 2
    s_add_u32 s56, s56, s3
    s_getreg_b32 s43, hwreg(HW_REG_XCC_ID, 0, 1)
    s_and_b32 s44, s2, 6
    s_or_b32 s44, s44, s43
    s_lshl_b32 s44, s44, 2
    s_lshr_b32 s52, 0x73625140, s44
    s_and_b32 s52, s52, 7
    s_lshl_b32 s52, s52, 2
    s_add_u32 s52, s52, s45
    v_and_b32 v208, 7, v0
    v_lshrrev_b32 v96, 3, v11
    v_lshl_add_u32 v96, v10, 5, v96
    v_lshlrev_b32 v96, 4, v96
    v_lshl_add_u32 v14, v208, 11, v96
    v_lshlrev_b32 v211, 24, v11
    s_and_b32 s47, s2, 7
    s_lshl_b32 s44, s47, 3
    s_lshr_b32 s45, s2, 3
    s_add_u32 s50, s44, s45
    s_add_u32 s44, s44, 56
    s_cmp_lt_u32 s2, 64
    s_cselect_b32 s44, 0, s44
    s_cselect_b32 s63, 2, 3
    s_cselect_b32 s64, 3, 7
    s_cselect_b32 s65, 0, 1
    s_add_u32 s50, s50, s44
    s_and_b32 s65, s65, s50
    s_sub_u32 s51, s50, s65
    s_lshl_b32 s51, s51, 6
    s_lshl_b32 s65, s65, 5
    v_lshrrev_b32 v97, s63, v0
    v_add_u32 v97, s65, v97
    v_and_b32 v99, s64, v0
    v_mul_u32_u24 v215, 196608, v97
    v_lshl_add_u32 v215, v99, 4, v215
    v_lshlrev_b32 v97, 5, v97
    s_sub_u32 s44, s45, 8
    s_lshl_b32 s44, s44, 2
    s_add_u32 s44, s44, s3
    s_sub_u32 s63, s44, 64
    s_cmp_ge_u32 s2, 192
    s_cselect_b32 s63, s63, 0
    s_cselect_b32 s64, 6, 5
    s_add_u32 s44, s44, s63
    s_mul_i32 s44, s44, 98304
    s_lshl_b32 s47, s47, 9
    s_add_u32 s44, s44, s47
    s_cmp_lt_u32 s2, 64
    s_cselect_b32 s66, 16777216, s44
    v_and_b32 v98, 3, v0
    v_lshrrev_b32 v100, 2, v11
    v_mul_u32_u24 v100, 12288, v100
    v_lshl_add_u32 v100, v98, 7, v100
    v_lshrrev_b32 v101, s64, v11
    v_lshl_add_u32 v100, v101, 24, v100
    v_mov_b32 v210, 45056
    s_lshl_b32 s46, s59, 14
    s_mov_b32 s38, 12582912
    s_mov_b32 s39, 0x20000
    s_mov_b32 s22, 2048
    s_mov_b32 s23, 0x20000
    s_mov_b32 s18, 16384
    s_mov_b32 s19, 0x20000
    s_mov_b32 s6, 16777216
    s_mov_b32 s7, 0x20000
    s_waitcnt lgkmcnt(0)
    s_mov_b32 s36, s90
    s_and_b32 s37, s91, 0xffff
    buffer_load_dword v212, v100, s[36:39], s66 offen
    s_mov_b32 s20, s88
    s_and_b32 s21, s89, 0xffff
    buffer_load_dwordx4 v[32:35], v97, s[20:23], 0 offen offset:0
    buffer_load_dwordx4 v[36:39], v97, s[20:23], 0 offen offset:16
    s_mov_b32 s4, s96
    s_and_b32 s5, s97, 0xffff
    buffer_load_dword v210, v210, s[4:7], 0 offen sc1
    s_add_u32 s16, s68, s46
    s_addc_u32 s17, s69, 0
    s_and_b32 s17, s17, 0xffff
    buffer_load_dwordx4 v[16:19], v14, s[16:19], 0 offen offset:0
    buffer_load_dwordx4 v[20:23], v14, s[16:19], 0 offen offset:128
    buffer_load_dwordx4 v[24:27], v14, s[16:19], 0 offen offset:256
    buffer_load_dwordx4 v[28:31], v14, s[16:19], 0 offen offset:384
    s_cmp_ge_u32 s2, 192
    s_cbranch_scc1 L_roleC_4
    s_cmp_ge_u32 s2, 64
    s_cbranch_scc1 L_roleBC_3
    buffer_load_dwordx4 v[144:147], v215, s[36:39], s51 offen
    s_add_u32 s51, s51, 12288
    buffer_load_dwordx4 v[148:151], v215, s[36:39], s51 offen
    s_add_u32 s51, s51, 12288
    buffer_load_dwordx4 v[152:155], v215, s[36:39], s51 offen
    s_add_u32 s51, s51, 12288
    v_lshrrev_b32 v4, 2, v11
    v_mul_u32_u24 v4, 1056, v4
    v_and_b32 v3, 3, v11
    v_lshl_add_u32 v4, v3, 3, v4
    v_add_u32 v4, 67584, v4
    v_lshl_add_u32 v231, v3, 3, v4
    v_bfe_u32 v3, v11, 2, 1
    v_mul_u32_u24 v3, 24, v3
    v_sub_u32 v231, v231, v3
    v_lshrrev_b32 v2, 1, v12
    v_lshlrev_b32 v2, 5, v2
    v_and_b32 v3, 1, v12
    v_lshl_add_u32 v2, v3, 2, v2
    v_lshl_add_u32 v2, v10, 3, v2
    v_lshlrev_b32 v2, 13, v2
    v_lshl_add_u32 v2, v13, 4, v2
    s_lshl_b32 s44, s52, 8
    s_mov_b32 s65, 0
    s_add_u32 s8, s74, s44
    s_addc_u32 s9, s75, 0
    s_and_b32 s9, s9, 0xffff
    s_mov_b32 s10, 8380672
    s_mov_b32 s11, 0x20000
    v_lshrrev_b32 v252, 1, v11
    v_lshlrev_b32 v252, 13, v252
    v_and_b32 v3, 1, v11
    v_lshl_add_u32 v252, v3, 7, v252
    v_lshrrev_b32 v3, 4, v11
    v_lshl_add_u32 v252, v3, 24, v252
    s_lshl_b32 s67, s54, 16
    v_accvgpr_write_b32 a0, 0
    v_accvgpr_write_b32 a1, 0
    v_accvgpr_write_b32 a2, 0
    v_accvgpr_write_b32 a3, 0
    v_accvgpr_write_b32 a4, 0
    v_accvgpr_write_b32 a5, 0
    v_accvgpr_write_b32 a6, 0
    v_accvgpr_write_b32 a7, 0
    v_accvgpr_write_b32 a8, 0
    v_accvgpr_write_b32 a9, 0
    v_accvgpr_write_b32 a10, 0
    v_accvgpr_write_b32 a11, 0
    v_accvgpr_write_b32 a12, 0
    v_accvgpr_write_b32 a13, 0
    buffer_load_dwordx4 v[156:159], v215, s[36:39], s51 offen
    s_add_u32 s51, s51, 12288
    v_accvgpr_write_b32 a14, 0
    v_accvgpr_write_b32 a15, 0
    v_accvgpr_write_b32 a16, 0
    v_accvgpr_write_b32 a17, 0
    v_accvgpr_write_b32 a18, 0
    v_accvgpr_write_b32 a19, 0
    v_accvgpr_write_b32 a20, 0
    v_accvgpr_write_b32 a21, 0
    v_accvgpr_write_b32 a22, 0
    v_accvgpr_write_b32 a23, 0
    v_accvgpr_write_b32 a24, 0
    v_accvgpr_write_b32 a25, 0
    v_accvgpr_write_b32 a26, 0
    v_accvgpr_write_b32 a27, 0
    v_accvgpr_write_b32 a28, 0
    v_accvgpr_write_b32 a29, 0
    v_accvgpr_write_b32 a30, 0
    v_accvgpr_write_b32 a31, 0
    v_accvgpr_write_b32 a32, 0
    v_accvgpr_write_b32 a33, 0
    v_accvgpr_write_b32 a34, 0
    v_accvgpr_write_b32 a35, 0
    v_accvgpr_write_b32 a36, 0
    v_accvgpr_write_b32 a37, 0
    v_accvgpr_write_b32 a38, 0
    v_accvgpr_write_b32 a39, 0
    v_accvgpr_write_b32 a40, 0
    v_accvgpr_write_b32 a41, 0
    v_accvgpr_write_b32 a42, 0
    v_accvgpr_write_b32 a43, 0
    v_accvgpr_write_b32 a44, 0
    v_accvgpr_write_b32 a45, 0
    v_accvgpr_write_b32 a46, 0
    v_accvgpr_write_b32 a47, 0
    v_accvgpr_write_b32 a48, 0
    v_accvgpr_write_b32 a49, 0
    v_accvgpr_write_b32 a50, 0
    v_accvgpr_write_b32 a51, 0
    v_accvgpr_write_b32 a52, 0
    v_accvgpr_write_b32 a53, 0
    v_accvgpr_write_b32 a54, 0
    v_accvgpr_write_b32 a55, 0
    v_accvgpr_write_b32 a56, 0
    v_accvgpr_write_b32 a57, 0
    buffer_load_dwordx4 v[160:163], v215, s[36:39], s51 offen
    s_add_u32 s51, s51, 12288
    v_accvgpr_write_b32 a58, 0
    v_accvgpr_write_b32 a59, 0
    v_accvgpr_write_b32 a60, 0
    v_accvgpr_write_b32 a61, 0
    v_accvgpr_write_b32 a62, 0
    v_accvgpr_write_b32 a63, 0
    v_accvgpr_write_b32 a64, 0
    v_accvgpr_write_b32 a65, 0
    v_accvgpr_write_b32 a66, 0
    v_accvgpr_write_b32 a67, 0
    v_accvgpr_write_b32 a68, 0
    v_accvgpr_write_b32 a69, 0
    v_accvgpr_write_b32 a70, 0
    v_accvgpr_write_b32 a71, 0
    v_accvgpr_write_b32 a72, 0
    v_accvgpr_write_b32 a73, 0
    v_accvgpr_write_b32 a74, 0
    v_accvgpr_write_b32 a75, 0
    v_accvgpr_write_b32 a76, 0
    v_accvgpr_write_b32 a77, 0
    v_accvgpr_write_b32 a78, 0
    v_accvgpr_write_b32 a79, 0
    v_accvgpr_write_b32 a80, 0
    v_accvgpr_write_b32 a81, 0
    v_accvgpr_write_b32 a82, 0
    v_accvgpr_write_b32 a83, 0
    v_accvgpr_write_b32 a84, 0
    v_accvgpr_write_b32 a85, 0
    v_accvgpr_write_b32 a86, 0
    v_accvgpr_write_b32 a87, 0
    v_accvgpr_write_b32 a88, 0
    v_accvgpr_write_b32 a89, 0
    v_accvgpr_write_b32 a90, 0
    v_accvgpr_write_b32 a91, 0
    v_accvgpr_write_b32 a92, 0
    v_accvgpr_write_b32 a93, 0
    v_accvgpr_write_b32 a94, 0
    v_accvgpr_write_b32 a95, 0
    v_accvgpr_write_b32 a96, 0
    v_accvgpr_write_b32 a97, 0
    v_accvgpr_write_b32 a98, 0
    v_accvgpr_write_b32 a99, 0
    v_accvgpr_write_b32 a100, 0
    v_accvgpr_write_b32 a101, 0
    buffer_load_dwordx4 v[164:167], v215, s[36:39], s51 offen
    s_add_u32 s51, s51, 12288
    v_accvgpr_write_b32 a102, 0
    v_accvgpr_write_b32 a103, 0
    v_accvgpr_write_b32 a104, 0
    v_accvgpr_write_b32 a105, 0
    v_accvgpr_write_b32 a106, 0
    v_accvgpr_write_b32 a107, 0
    v_accvgpr_write_b32 a108, 0
    v_accvgpr_write_b32 a109, 0
    v_accvgpr_write_b32 a110, 0
    v_accvgpr_write_b32 a111, 0
    v_accvgpr_write_b32 a112, 0
    v_accvgpr_write_b32 a113, 0
    v_accvgpr_write_b32 a114, 0
    v_accvgpr_write_b32 a115, 0
    v_accvgpr_write_b32 a116, 0
    v_accvgpr_write_b32 a117, 0
    v_accvgpr_write_b32 a118, 0
    v_accvgpr_write_b32 a119, 0
    v_accvgpr_write_b32 a120, 0
    v_accvgpr_write_b32 a121, 0
    v_accvgpr_write_b32 a122, 0
    v_accvgpr_write_b32 a123, 0
    v_accvgpr_write_b32 a124, 0
    v_accvgpr_write_b32 a125, 0
    v_accvgpr_write_b32 a126, 0
    v_accvgpr_write_b32 a127, 0
    v_accvgpr_write_b32 a128, 0
    v_accvgpr_write_b32 a129, 0
    v_accvgpr_write_b32 a130, 0
    v_accvgpr_write_b32 a131, 0
    v_accvgpr_write_b32 a132, 0
    v_accvgpr_write_b32 a133, 0
    v_accvgpr_write_b32 a134, 0
    v_accvgpr_write_b32 a135, 0
    v_accvgpr_write_b32 a136, 0
    v_accvgpr_write_b32 a137, 0
    v_accvgpr_write_b32 a138, 0
    v_accvgpr_write_b32 a139, 0
    v_accvgpr_write_b32 a140, 0
    v_accvgpr_write_b32 a141, 0
    v_accvgpr_write_b32 a142, 0
    v_accvgpr_write_b32 a143, 0
    s_waitcnt vmcnt(10)
    v_readfirstlane_b32 s60, v210
    buffer_load_dwordx4 v[168:171], v215, s[36:39], s51 offen
    s_add_u32 s51, s51, 12288
    s_nop 3
    s_mul_i32 s60, s60, 0x9e3779b1
    s_add_u32 s60, s60, 0x7f4a7c15
    s_lshr_b32 s42, s2, 1
    s_lshl_b32 s42, s42, 7
    s_add_u32 s42, s42, 458752
    s_add_u32 s41, s60, s43
    v_mov_b32 v222, s41
    s_and_b32 s41, s2, 1
    v_xor_b32 v223, 0xc0, v0
    v_or_b32 v223, s41, v223
    v_min_u32 v223, 64, v223
    v_lshlrev_b32 v223, 24, v223
    buffer_store_dword v222, v223, s[4:7], s42 offen sc1
    s_waitcnt vmcnt(12)
    v_lshlrev_b32 v40, 16, v32
    v_and_b32 v41, 0xffff0000, v32
    v_lshlrev_b32 v42, 16, v33
    v_and_b32 v43, 0xffff0000, v33
    v_lshlrev_b32 v44, 16, v34
    v_and_b32 v45, 0xffff0000, v34
    v_lshlrev_b32 v46, 16, v35
    v_and_b32 v47, 0xffff0000, v35
    v_lshlrev_b32 v48, 16, v36
    v_and_b32 v49, 0xffff0000, v36
    v_lshlrev_b32 v50, 16, v37
    v_and_b32 v51, 0xffff0000, v37
    v_lshlrev_b32 v52, 16, v38
    v_and_b32 v53, 0xffff0000, v38
    v_lshlrev_b32 v54, 16, v39
    v_and_b32 v55, 0xffff0000, v39
    v_mul_f32 v112, 0xbfb8aa3b, v40
    v_mul_f32 v113, 0xbfb8aa3b, v41
    v_mul_f32 v114, 0xbfb8aa3b, v42
    v_mul_f32 v115, 0xbfb8aa3b, v43
    v_mul_f32 v116, 0xbfb8aa3b, v44
    v_mul_f32 v117, 0xbfb8aa3b, v45
    v_mul_f32 v118, 0xbfb8aa3b, v46
    v_mul_f32 v119, 0xbfb8aa3b, v47
    v_mul_f32 v120, 0xbfb8aa3b, v48
    v_mul_f32 v121, 0xbfb8aa3b, v49
    v_mul_f32 v122, 0xbfb8aa3b, v50
    v_mul_f32 v123, 0xbfb8aa3b, v51
    v_mul_f32 v124, 0xbfb8aa3b, v52
    buffer_load_dwordx4 v[172:175], v215, s[36:39], s51 offen
    s_add_u32 s51, s51, 12288
    v_mul_f32 v125, 0xbfb8aa3b, v53
    v_mul_f32 v126, 0xbfb8aa3b, v54
    v_mul_f32 v127, 0xbfb8aa3b, v55
    v_exp_f32 v112, v112
    v_exp_f32 v113, v113
    v_exp_f32 v114, v114
    v_exp_f32 v115, v115
    v_exp_f32 v116, v116
    v_exp_f32 v117, v117
    v_exp_f32 v118, v118
    v_exp_f32 v119, v119
    v_exp_f32 v120, v120
    v_exp_f32 v121, v121
    v_exp_f32 v122, v122
    v_exp_f32 v123, v123
    v_exp_f32 v124, v124
    v_exp_f32 v125, v125
    v_exp_f32 v126, v126
    v_exp_f32 v127, v127
    v_pk_add_f32 v[112:113], v[112:113], 1.0 op_sel_hi:[1,0]
    v_pk_add_f32 v[114:115], v[114:115], 1.0 op_sel_hi:[1,0]
    v_pk_add_f32 v[116:117], v[116:117], 1.0 op_sel_hi:[1,0]
    v_pk_add_f32 v[118:119], v[118:119], 1.0 op_sel_hi:[1,0]
    v_pk_add_f32 v[120:121], v[120:121], 1.0 op_sel_hi:[1,0]
    v_pk_add_f32 v[122:123], v[122:123], 1.0 op_sel_hi:[1,0]
    v_pk_add_f32 v[124:125], v[124:125], 1.0 op_sel_hi:[1,0]
    v_pk_add_f32 v[126:127], v[126:127], 1.0 op_sel_hi:[1,0]
    v_rcp_f32 v112, v112
    v_rcp_f32 v113, v113
    v_rcp_f32 v114, v114
    v_rcp_f32 v115, v115
    v_rcp_f32 v116, v116
    v_rcp_f32 v117, v117
    v_rcp_f32 v118, v118
    v_rcp_f32 v119, v119
    v_rcp_f32 v120, v120
    v_rcp_f32 v121, v121
    v_rcp_f32 v122, v122
    v_rcp_f32 v123, v123
    v_rcp_f32 v124, v124
    v_rcp_f32 v125, v125
    v_rcp_f32 v126, v126
    v_rcp_f32 v127, v127
    v_pk_mul_f32 v[40:41], v[40:41], v[112:113]
    buffer_load_dwordx4 v[176:179], v215, s[36:39], s51 offen
    s_add_u32 s51, s51, 12288
    v_pk_mul_f32 v[42:43], v[42:43], v[114:115]
    v_pk_mul_f32 v[44:45], v[44:45], v[116:117]
    v_pk_mul_f32 v[46:47], v[46:47], v[118:119]
    v_pk_mul_f32 v[48:49], v[48:49], v[120:121]
    v_pk_mul_f32 v[50:51], v[50:51], v[122:123]
    v_pk_mul_f32 v[52:53], v[52:53], v[124:125]
    v_pk_mul_f32 v[54:55], v[54:55], v[126:127]
    v_cvt_pk_bf16_f32 v41, v40, v41
    v_lshlrev_b32 v40, 16, v41
    v_and_b32 v41, 0xffff0000, v41
    v_cvt_pk_bf16_f32 v43, v42, v43
    v_lshlrev_b32 v42, 16, v43
    v_and_b32 v43, 0xffff0000, v43
    v_cvt_pk_bf16_f32 v45, v44, v45
    v_lshlrev_b32 v44, 16, v45
    v_and_b32 v45, 0xffff0000, v45
    v_cvt_pk_bf16_f32 v47, v46, v47
    v_lshlrev_b32 v46, 16, v47
    v_and_b32 v47, 0xffff0000, v47
    v_cvt_pk_bf16_f32 v49, v48, v49
    v_lshlrev_b32 v48, 16, v49
    v_and_b32 v49, 0xffff0000, v49
    v_cvt_pk_bf16_f32 v51, v50, v51
    v_lshlrev_b32 v50, 16, v51
    v_and_b32 v51, 0xffff0000, v51
    v_cvt_pk_bf16_f32 v53, v52, v53
    v_lshlrev_b32 v52, 16, v53
    v_and_b32 v53, 0xffff0000, v53
    v_cvt_pk_bf16_f32 v55, v54, v55
    v_lshlrev_b32 v54, 16, v55
    v_and_b32 v55, 0xffff0000, v55
    s_waitcnt vmcnt(10)
    v_lshlrev_b32 v64, 16, v16
    v_and_b32 v65, 0xffff0000, v16
    v_lshlrev_b32 v66, 16, v17
    v_and_b32 v67, 0xffff0000, v17
    v_lshlrev_b32 v68, 16, v18
    v_and_b32 v69, 0xffff0000, v18
    v_lshlrev_b32 v70, 16, v19
    v_and_b32 v71, 0xffff0000, v19
    v_lshlrev_b32 v72, 16, v20
    v_and_b32 v73, 0xffff0000, v20
    v_lshlrev_b32 v74, 16, v21
    v_and_b32 v75, 0xffff0000, v21
    buffer_load_dwordx4 v[180:183], v215, s[36:39], s51 offen
    s_add_u32 s51, s51, 12288
    v_lshlrev_b32 v76, 16, v22
    v_and_b32 v77, 0xffff0000, v22
    v_lshlrev_b32 v78, 16, v23
    v_and_b32 v79, 0xffff0000, v23
    v_lshlrev_b32 v80, 16, v24
    v_and_b32 v81, 0xffff0000, v24
    v_lshlrev_b32 v82, 16, v25
    v_and_b32 v83, 0xffff0000, v25
    v_lshlrev_b32 v84, 16, v26
    v_and_b32 v85, 0xffff0000, v26
    v_lshlrev_b32 v86, 16, v27
    v_and_b32 v87, 0xffff0000, v27
    v_lshlrev_b32 v88, 16, v28
    v_and_b32 v89, 0xffff0000, v28
    v_lshlrev_b32 v90, 16, v29
    v_and_b32 v91, 0xffff0000, v29
    v_lshlrev_b32 v92, 16, v30
    v_and_b32 v93, 0xffff0000, v30
    v_lshlrev_b32 v94, 16, v31
    v_and_b32 v95, 0xffff0000, v31
    v_pk_add_f32 v[96:97], v[64:65], v[66:67]
    v_pk_add_f32 v[96:97], v[96:97], v[68:69]
    v_pk_add_f32 v[96:97], v[96:97], v[70:71]
    v_pk_add_f32 v[96:97], v[96:97], v[72:73]
    v_pk_add_f32 v[96:97], v[96:97], v[74:75]
    v_pk_add_f32 v[96:97], v[96:97], v[76:77]
    v_pk_add_f32 v[96:97], v[96:97], v[78:79]
    v_pk_add_f32 v[96:97], v[96:97], v[80:81]
    v_pk_add_f32 v[96:97], v[96:97], v[82:83]
    v_pk_add_f32 v[96:97], v[96:97], v[84:85]
    v_pk_add_f32 v[96:97], v[96:97], v[86:87]
    v_pk_add_f32 v[96:97], v[96:97], v[88:89]
    v_pk_add_f32 v[96:97], v[96:97], v[90:91]
    v_pk_add_f32 v[96:97], v[96:97], v[92:93]
    v_pk_add_f32 v[96:97], v[96:97], v[94:95]
    v_add_f32 v96, v96, v97
    s_nop 1
    v_add_f32_dpp v96, v96, v96 row_ror:8 row_mask:0xf bank_mask:0xf
    v_mov_b32 v97, v96
    s_nop 1
    v_permlane16_swap_b32 v96, v97
    v_add_f32 v96, v96, v97
    v_mov_b32 v97, v96
    s_nop 1
    buffer_load_dwordx4 v[184:187], v215, s[36:39], s51 offen
    s_add_u32 s51, s51, 12288
    v_permlane32_swap_b32 v96, v97
    v_add_f32 v96, v96, v97
    v_mul_f32 v96, 0xbb800000, v96
    v_pk_add_f32 v[112:113], v[64:65], v[96:97] op_sel_hi:[1,0]
    v_pk_mul_f32 v[98:99], v[112:113], v[112:113]
    v_pk_add_f32 v[112:113], v[66:67], v[96:97] op_sel_hi:[1,0]
    v_pk_fma_f32 v[98:99], v[112:113], v[112:113], v[98:99]
    v_pk_add_f32 v[112:113], v[68:69], v[96:97] op_sel_hi:[1,0]
    v_pk_fma_f32 v[98:99], v[112:113], v[112:113], v[98:99]
    v_pk_add_f32 v[112:113], v[70:71], v[96:97] op_sel_hi:[1,0]
    v_pk_fma_f32 v[98:99], v[112:113], v[112:113], v[98:99]
    v_pk_add_f32 v[112:113], v[72:73], v[96:97] op_sel_hi:[1,0]
    v_pk_fma_f32 v[98:99], v[112:113], v[112:113], v[98:99]
    v_pk_add_f32 v[112:113], v[74:75], v[96:97] op_sel_hi:[1,0]
    v_pk_fma_f32 v[98:99], v[112:113], v[112:113], v[98:99]
    v_pk_add_f32 v[112:113], v[76:77], v[96:97] op_sel_hi:[1,0]
    v_pk_fma_f32 v[98:99], v[112:113], v[112:113], v[98:99]
    v_pk_add_f32 v[112:113], v[78:79], v[96:97] op_sel_hi:[1,0]
    v_pk_fma_f32 v[98:99], v[112:113], v[112:113], v[98:99]
    v_pk_add_f32 v[112:113], v[80:81], v[96:97] op_sel_hi:[1,0]
    v_pk_fma_f32 v[98:99], v[112:113], v[112:113], v[98:99]
    v_pk_add_f32 v[112:113], v[82:83], v[96:97] op_sel_hi:[1,0]
    v_pk_fma_f32 v[98:99], v[112:113], v[112:113], v[98:99]
    v_pk_add_f32 v[112:113], v[84:85], v[96:97] op_sel_hi:[1,0]
    v_pk_fma_f32 v[98:99], v[112:113], v[112:113], v[98:99]
    v_pk_add_f32 v[112:113], v[86:87], v[96:97] op_sel_hi:[1,0]
    v_pk_fma_f32 v[98:99], v[112:113], v[112:113], v[98:99]
    v_pk_add_f32 v[112:113], v[88:89], v[96:97] op_sel_hi:[1,0]
    v_pk_fma_f32 v[98:99], v[112:113], v[112:113], v[98:99]
    v_pk_add_f32 v[112:113], v[90:91], v[96:97] op_sel_hi:[1,0]
    v_pk_fma_f32 v[98:99], v[112:113], v[112:113], v[98:99]
    v_pk_add_f32 v[112:113], v[92:93], v[96:97] op_sel_hi:[1,0]
    v_pk_fma_f32 v[98:99], v[112:113], v[112:113], v[98:99]
    v_pk_add_f32 v[112:113], v[94:95], v[96:97] op_sel_hi:[1,0]
    v_pk_fma_f32 v[98:99], v[112:113], v[112:113], v[98:99]
    v_add_f32 v97, v98, v99
    s_nop 1
    v_add_f32_dpp v97, v97, v97 row_ror:8 row_mask:0xf bank_mask:0xf
    v_mov_b32 v98, v97
    s_nop 1
    v_permlane16_swap_b32 v97, v98
    v_add_f32 v97, v97, v98
    v_mov_b32 v98, v97
    s_nop 1
    buffer_load_dwordx4 v[188:191], v215, s[36:39], s51 offen
    s_add_u32 s51, s51, 12288
    v_permlane32_swap_b32 v97, v98
    v_add_f32 v97, v97, v98
    v_lshlrev_b32 v99, 5, v208
    v_lshl_add_u32 v98, v10, 3, v99
    ds_write_b64 v98, v[96:97]
    s_waitcnt vmcnt(12)
    v_lshlrev_b32 v100, 16, v144
    v_and_b32 v101, 0xffff0000, v144
    v_pk_mul_f32 v[56:57], v[100:101], v[40:41] op_sel_hi:[1,0]
    v_lshlrev_b32 v102, 16, v145
    v_and_b32 v103, 0xffff0000, v145
    v_pk_mul_f32 v[58:59], v[102:103], v[40:41] op_sel_hi:[1,0]
    v_lshlrev_b32 v100, 16, v146
    v_and_b32 v101, 0xffff0000, v146
    v_pk_mul_f32 v[60:61], v[100:101], v[40:41] op_sel_hi:[1,0]
    v_lshlrev_b32 v102, 16, v147
    v_and_b32 v103, 0xffff0000, v147
    v_pk_mul_f32 v[62:63], v[102:103], v[40:41] op_sel_hi:[1,0]
    s_waitcnt vmcnt(11)
    v_lshlrev_b32 v100, 16, v148
    v_and_b32 v101, 0xffff0000, v148
    v_pk_fma_f32 v[56:57], v[100:101], v[40:41], v[56:57] op_sel:[0,1,0] op_sel_hi:[1,1,1]
    v_lshlrev_b32 v102, 16, v149
    v_and_b32 v103, 0xffff0000, v149
    v_pk_fma_f32 v[58:59], v[102:103], v[40:41], v[58:59] op_sel:[0,1,0] op_sel_hi:[1,1,1]
    v_lshlrev_b32 v100, 16, v150
    v_and_b32 v101, 0xffff0000, v150
    v_pk_fma_f32 v[60:61], v[100:101], v[40:41], v[60:61] op_sel:[0,1,0] op_sel_hi:[1,1,1]
    v_lshlrev_b32 v102, 16, v151
    v_and_b32 v103, 0xffff0000, v151
    v_pk_fma_f32 v[62:63], v[102:103], v[40:41], v[62:63] op_sel:[0,1,0] op_sel_hi:[1,1,1]
    s_waitcnt vmcnt(10)
    v_lshlrev_b32 v100, 16, v152
    v_and_b32 v101, 0xffff0000, v152
    v_pk_fma_f32 v[56:57], v[100:101], v[42:43], v[56:57] op_sel_hi:[1,0,1]
    v_lshlrev_b32 v102, 16, v153
    v_and_b32 v103, 0xffff0000, v153
    v_pk_fma_f32 v[58:59], v[102:103], v[42:43], v[58:59] op_sel_hi:[1,0,1]
    v_lshlrev_b32 v100, 16, v154
    v_and_b32 v101, 0xffff0000, v154
    v_pk_fma_f32 v[60:61], v[100:101], v[42:43], v[60:61] op_sel_hi:[1,0,1]
    v_lshlrev_b32 v102, 16, v155
    v_and_b32 v103, 0xffff0000, v155
    v_pk_fma_f32 v[62:63], v[102:103], v[42:43], v[62:63] op_sel_hi:[1,0,1]
    buffer_load_dwordx4 v[192:195], v215, s[36:39], s51 offen
    s_add_u32 s51, s51, 12288
    s_waitcnt vmcnt(10)
    v_lshlrev_b32 v100, 16, v156
    v_and_b32 v101, 0xffff0000, v156
    v_pk_fma_f32 v[56:57], v[100:101], v[42:43], v[56:57] op_sel:[0,1,0] op_sel_hi:[1,1,1]
    v_lshlrev_b32 v102, 16, v157
    v_and_b32 v103, 0xffff0000, v157
    v_pk_fma_f32 v[58:59], v[102:103], v[42:43], v[58:59] op_sel:[0,1,0] op_sel_hi:[1,1,1]
    v_lshlrev_b32 v100, 16, v158
    v_and_b32 v101, 0xffff0000, v158
    v_pk_fma_f32 v[60:61], v[100:101], v[42:43], v[60:61] op_sel:[0,1,0] op_sel_hi:[1,1,1]
    v_lshlrev_b32 v102, 16, v159
    v_and_b32 v103, 0xffff0000, v159
    v_pk_fma_f32 v[62:63], v[102:103], v[42:43], v[62:63] op_sel:[0,1,0] op_sel_hi:[1,1,1]
    s_waitcnt vmcnt(9)
    v_lshlrev_b32 v100, 16, v160
    v_and_b32 v101, 0xffff0000, v160
    v_pk_fma_f32 v[56:57], v[100:101], v[44:45], v[56:57] op_sel_hi:[1,0,1]
    v_lshlrev_b32 v102, 16, v161
    v_and_b32 v103, 0xffff0000, v161
    v_pk_fma_f32 v[58:59], v[102:103], v[44:45], v[58:59] op_sel_hi:[1,0,1]
    v_lshlrev_b32 v100, 16, v162
    v_and_b32 v101, 0xffff0000, v162
    v_pk_fma_f32 v[60:61], v[100:101], v[44:45], v[60:61] op_sel_hi:[1,0,1]
    v_lshlrev_b32 v102, 16, v163
    v_and_b32 v103, 0xffff0000, v163
    v_pk_fma_f32 v[62:63], v[102:103], v[44:45], v[62:63] op_sel_hi:[1,0,1]
    s_waitcnt vmcnt(8)
    v_lshlrev_b32 v100, 16, v164
    v_and_b32 v101, 0xffff0000, v164
    v_pk_fma_f32 v[56:57], v[100:101], v[44:45], v[56:57] op_sel:[0,1,0] op_sel_hi:[1,1,1]
    v_lshlrev_b32 v102, 16, v165
    v_and_b32 v103, 0xffff0000, v165
    v_pk_fma_f32 v[58:59], v[102:103], v[44:45], v[58:59] op_sel:[0,1,0] op_sel_hi:[1,1,1]
    v_lshlrev_b32 v100, 16, v166
    v_and_b32 v101, 0xffff0000, v166
    v_pk_fma_f32 v[60:61], v[100:101], v[44:45], v[60:61] op_sel:[0,1,0] op_sel_hi:[1,1,1]
    v_lshlrev_b32 v102, 16, v167
    v_and_b32 v103, 0xffff0000, v167
    v_pk_fma_f32 v[62:63], v[102:103], v[44:45], v[62:63] op_sel:[0,1,0] op_sel_hi:[1,1,1]
    s_waitcnt vmcnt(7)
    v_lshlrev_b32 v100, 16, v168
    v_and_b32 v101, 0xffff0000, v168
    v_pk_fma_f32 v[56:57], v[100:101], v[46:47], v[56:57] op_sel_hi:[1,0,1]
    v_lshlrev_b32 v102, 16, v169
    buffer_load_dwordx4 v[196:199], v215, s[36:39], s51 offen
    s_add_u32 s51, s51, 12288
    v_and_b32 v103, 0xffff0000, v169
    v_pk_fma_f32 v[58:59], v[102:103], v[46:47], v[58:59] op_sel_hi:[1,0,1]
    v_lshlrev_b32 v100, 16, v170
    v_and_b32 v101, 0xffff0000, v170
    v_pk_fma_f32 v[60:61], v[100:101], v[46:47], v[60:61] op_sel_hi:[1,0,1]
    v_lshlrev_b32 v102, 16, v171
    v_and_b32 v103, 0xffff0000, v171
    v_pk_fma_f32 v[62:63], v[102:103], v[46:47], v[62:63] op_sel_hi:[1,0,1]
    s_waitcnt vmcnt(6)
    v_lshlrev_b32 v100, 16, v172
    v_and_b32 v101, 0xffff0000, v172
    v_pk_fma_f32 v[56:57], v[100:101], v[46:47], v[56:57] op_sel:[0,1,0] op_sel_hi:[1,1,1]
    v_lshlrev_b32 v102, 16, v173
    v_and_b32 v103, 0xffff0000, v173
    v_pk_fma_f32 v[58:59], v[102:103], v[46:47], v[58:59] op_sel:[0,1,0] op_sel_hi:[1,1,1]
    v_lshlrev_b32 v100, 16, v174
    v_and_b32 v101, 0xffff0000, v174
    v_pk_fma_f32 v[60:61], v[100:101], v[46:47], v[60:61] op_sel:[0,1,0] op_sel_hi:[1,1,1]
    v_lshlrev_b32 v102, 16, v175
    v_and_b32 v103, 0xffff0000, v175
    v_pk_fma_f32 v[62:63], v[102:103], v[46:47], v[62:63] op_sel:[0,1,0] op_sel_hi:[1,1,1]
    s_waitcnt vmcnt(5)
    v_lshlrev_b32 v100, 16, v176
    v_and_b32 v101, 0xffff0000, v176
    v_pk_fma_f32 v[56:57], v[100:101], v[48:49], v[56:57] op_sel_hi:[1,0,1]
    v_lshlrev_b32 v102, 16, v177
    v_and_b32 v103, 0xffff0000, v177
    v_pk_fma_f32 v[58:59], v[102:103], v[48:49], v[58:59] op_sel_hi:[1,0,1]
    v_lshlrev_b32 v100, 16, v178
    v_and_b32 v101, 0xffff0000, v178
    v_pk_fma_f32 v[60:61], v[100:101], v[48:49], v[60:61] op_sel_hi:[1,0,1]
    v_lshlrev_b32 v102, 16, v179
    v_and_b32 v103, 0xffff0000, v179
    v_pk_fma_f32 v[62:63], v[102:103], v[48:49], v[62:63] op_sel_hi:[1,0,1]
    s_waitcnt vmcnt(4)
    v_lshlrev_b32 v100, 16, v180
    v_and_b32 v101, 0xffff0000, v180
    v_pk_fma_f32 v[56:57], v[100:101], v[48:49], v[56:57] op_sel:[0,1,0] op_sel_hi:[1,1,1]
    v_lshlrev_b32 v102, 16, v181
    v_and_b32 v103, 0xffff0000, v181
    v_pk_fma_f32 v[58:59], v[102:103], v[48:49], v[58:59] op_sel:[0,1,0] op_sel_hi:[1,1,1]
    v_lshlrev_b32 v100, 16, v182
    v_and_b32 v101, 0xffff0000, v182
    v_pk_fma_f32 v[60:61], v[100:101], v[48:49], v[60:61] op_sel:[0,1,0] op_sel_hi:[1,1,1]
    buffer_load_dwordx4 v[200:203], v215, s[36:39], s51 offen
    s_add_u32 s51, s51, 12288
    v_lshlrev_b32 v102, 16, v183
    v_and_b32 v103, 0xffff0000, v183
    v_pk_fma_f32 v[62:63], v[102:103], v[48:49], v[62:63] op_sel:[0,1,0] op_sel_hi:[1,1,1]
    s_waitcnt vmcnt(4)
    v_lshlrev_b32 v100, 16, v184
    v_and_b32 v101, 0xffff0000, v184
    v_pk_fma_f32 v[56:57], v[100:101], v[50:51], v[56:57] op_sel_hi:[1,0,1]
    v_lshlrev_b32 v102, 16, v185
    v_and_b32 v103, 0xffff0000, v185
    v_pk_fma_f32 v[58:59], v[102:103], v[50:51], v[58:59] op_sel_hi:[1,0,1]
    v_lshlrev_b32 v100, 16, v186
    v_and_b32 v101, 0xffff0000, v186
    v_pk_fma_f32 v[60:61], v[100:101], v[50:51], v[60:61] op_sel_hi:[1,0,1]
    v_lshlrev_b32 v102, 16, v187
    v_and_b32 v103, 0xffff0000, v187
    v_pk_fma_f32 v[62:63], v[102:103], v[50:51], v[62:63] op_sel_hi:[1,0,1]
    buffer_load_dwordx4 v[204:207], v215, s[36:39], s51 offen
    s_waitcnt vmcnt(4)
    v_lshlrev_b32 v100, 16, v188
    v_and_b32 v101, 0xffff0000, v188
    v_pk_fma_f32 v[56:57], v[100:101], v[50:51], v[56:57] op_sel:[0,1,0] op_sel_hi:[1,1,1]
    v_lshlrev_b32 v102, 16, v189
    v_and_b32 v103, 0xffff0000, v189
    v_pk_fma_f32 v[58:59], v[102:103], v[50:51], v[58:59] op_sel:[0,1,0] op_sel_hi:[1,1,1]
    v_lshlrev_b32 v100, 16, v190
    v_and_b32 v101, 0xffff0000, v190
    v_pk_fma_f32 v[60:61], v[100:101], v[50:51], v[60:61] op_sel:[0,1,0] op_sel_hi:[1,1,1]
    v_lshlrev_b32 v102, 16, v191
    v_and_b32 v103, 0xffff0000, v191
    v_pk_fma_f32 v[62:63], v[102:103], v[50:51], v[62:63] op_sel:[0,1,0] op_sel_hi:[1,1,1]
    s_waitcnt vmcnt(3)
    v_lshlrev_b32 v100, 16, v192
    v_and_b32 v101, 0xffff0000, v192
    v_pk_fma_f32 v[56:57], v[100:101], v[52:53], v[56:57] op_sel_hi:[1,0,1]
    v_lshlrev_b32 v102, 16, v193
    v_and_b32 v103, 0xffff0000, v193
    v_pk_fma_f32 v[58:59], v[102:103], v[52:53], v[58:59] op_sel_hi:[1,0,1]
    v_lshlrev_b32 v100, 16, v194
    v_and_b32 v101, 0xffff0000, v194
    v_pk_fma_f32 v[60:61], v[100:101], v[52:53], v[60:61] op_sel_hi:[1,0,1]
    v_lshlrev_b32 v102, 16, v195
    v_and_b32 v103, 0xffff0000, v195
    v_pk_fma_f32 v[62:63], v[102:103], v[52:53], v[62:63] op_sel_hi:[1,0,1]
    s_waitcnt vmcnt(2)
    v_lshlrev_b32 v100, 16, v196
    v_and_b32 v101, 0xffff0000, v196
    v_pk_fma_f32 v[56:57], v[100:101], v[52:53], v[56:57] op_sel:[0,1,0] op_sel_hi:[1,1,1]
    v_lshlrev_b32 v102, 16, v197
    v_and_b32 v103, 0xffff0000, v197
    v_pk_fma_f32 v[58:59], v[102:103], v[52:53], v[58:59] op_sel:[0,1,0] op_sel_hi:[1,1,1]
    v_lshlrev_b32 v100, 16, v198
    v_and_b32 v101, 0xffff0000, v198
    v_pk_fma_f32 v[60:61], v[100:101], v[52:53], v[60:61] op_sel:[0,1,0] op_sel_hi:[1,1,1]
    v_lshlrev_b32 v102, 16, v199
    v_and_b32 v103, 0xffff0000, v199
    v_pk_fma_f32 v[62:63], v[102:103], v[52:53], v[62:63] op_sel:[0,1,0] op_sel_hi:[1,1,1]
    s_waitcnt vmcnt(1)
    v_lshlrev_b32 v100, 16, v200
    v_and_b32 v101, 0xffff0000, v200
    v_pk_fma_f32 v[56:57], v[100:101], v[54:55], v[56:57] op_sel_hi:[1,0,1]
    v_lshlrev_b32 v102, 16, v201
    v_and_b32 v103, 0xffff0000, v201
    v_pk_fma_f32 v[58:59], v[102:103], v[54:55], v[58:59] op_sel_hi:[1,0,1]
    v_lshlrev_b32 v100, 16, v202
    v_and_b32 v101, 0xffff0000, v202
    v_pk_fma_f32 v[60:61], v[100:101], v[54:55], v[60:61] op_sel_hi:[1,0,1]
    v_lshlrev_b32 v102, 16, v203
    v_and_b32 v103, 0xffff0000, v203
    v_pk_fma_f32 v[62:63], v[102:103], v[54:55], v[62:63] op_sel_hi:[1,0,1]
    s_waitcnt vmcnt(0)
    v_lshlrev_b32 v100, 16, v204
    v_and_b32 v101, 0xffff0000, v204
    v_pk_fma_f32 v[56:57], v[100:101], v[54:55], v[56:57] op_sel:[0,1,0] op_sel_hi:[1,1,1]
    v_lshlrev_b32 v102, 16, v205
    v_and_b32 v103, 0xffff0000, v205
    v_pk_fma_f32 v[58:59], v[102:103], v[54:55], v[58:59] op_sel:[0,1,0] op_sel_hi:[1,1,1]
    v_lshlrev_b32 v100, 16, v206
    v_and_b32 v101, 0xffff0000, v206
    v_pk_fma_f32 v[60:61], v[100:101], v[54:55], v[60:61] op_sel:[0,1,0] op_sel_hi:[1,1,1]
    v_lshlrev_b32 v102, 16, v207
    v_and_b32 v103, 0xffff0000, v207
    v_pk_fma_f32 v[62:63], v[102:103], v[54:55], v[62:63] op_sel:[0,1,0] op_sel_hi:[1,1,1]
    s_nop 1
    v_add_f32_dpp v56, v56, v56 row_ror:8 row_mask:0xf bank_mask:0xf
    v_add_f32_dpp v57, v57, v57 row_ror:8 row_mask:0xf bank_mask:0xf
    v_add_f32_dpp v58, v58, v58 row_ror:8 row_mask:0xf bank_mask:0xf
    v_add_f32_dpp v59, v59, v59 row_ror:8 row_mask:0xf bank_mask:0xf
    v_add_f32_dpp v60, v60, v60 row_ror:8 row_mask:0xf bank_mask:0xf
    v_add_f32_dpp v61, v61, v61 row_ror:8 row_mask:0xf bank_mask:0xf
    v_add_f32_dpp v62, v62, v62 row_ror:8 row_mask:0xf bank_mask:0xf
    v_add_f32_dpp v63, v63, v63 row_ror:8 row_mask:0xf bank_mask:0xf
    v_add_f32_dpp v56, v56, v56 row_ror:4 row_mask:0xf bank_mask:0xf
    v_add_f32_dpp v57, v57, v57 row_ror:4 row_mask:0xf bank_mask:0xf
    v_add_f32_dpp v58, v58, v58 row_ror:4 row_mask:0xf bank_mask:0xf
    v_add_f32_dpp v59, v59, v59 row_ror:4 row_mask:0xf bank_mask:0xf
    v_add_f32_dpp v60, v60, v60 row_ror:4 row_mask:0xf bank_mask:0xf
    v_add_f32_dpp v61, v61, v61 row_ror:4 row_mask:0xf bank_mask:0xf
    v_add_f32_dpp v62, v62, v62 row_ror:4 row_mask:0xf bank_mask:0xf
    v_add_f32_dpp v63, v63, v63 row_ror:4 row_mask:0xf bank_mask:0xf
    v_lshrrev_b32 v100, 4, v0
    v_lshlrev_b32 v100, 7, v100
    v_and_b32 v101, 3, v0
    v_lshl_add_u32 v100, v101, 5, v100
    ds_write_b128 v100, v[56:59] offset:1024
    ds_write_b128 v100, v[60:63] offset:1040
    s_waitcnt lgkmcnt(0)
    s_barrier
    s_cmp_lg_u32 s3, 0
    s_cbranch_scc1 L_join_5
    v_lshlrev_b32 v100, 9, v12
    v_lshl_add_u32 v100, v13, 3, v100
    ds_read_b64 v[56:57], v100 offset:1024
    ds_read_b64 v[58:59], v100 offset:1152
    ds_read_b64 v[60:61], v100 offset:1280
    ds_read_b64 v[62:63], v100 offset:1408
    v_lshlrev_b32 v102, 24, v12
    s_waitcnt lgkmcnt(0)
    v_pk_add_f32 v[56:57], v[56:57], v[58:59]
    v_pk_add_f32 v[60:61], v[60:61], v[62:63]
    v_pk_add_f32 v[56:57], v[56:57], v[60:61]
    v_mov_b32 v58, v56
    v_mov_b32 v59, v57
    s_nop 0
    v_permlane16_swap_b32 v56, v58
    v_permlane16_swap_b32 v57, v59
    v_add_f32 v56, v56, v58
    v_add_f32 v57, v57, v59
    v_mov_b32 v58, v56
    v_mov_b32 v59, v57
    s_nop 0
    v_permlane32_swap_b32 v56, v58
    v_permlane32_swap_b32 v57, v59
    v_add_f32 v56, v56, v58
    v_add_f32 v57, v57, v59
    v_cvt_pk_bf16_f32 v60, v56, v57
    s_cmp_ge_u32 s50, 32
    s_cselect_b32 s44, 1.0, 0
    s_mov_b32 s45, s44
    v_lshlrev_b32 v56, 16, v60
    v_and_b32 v57, 0xffff0000, v60
    v_pk_add_f32 v[56:57], v[56:57], s[44:45]
    v_mul_f32 v56, 0x3d800000, v56
    v_mul_f32 v57, 0x3d800000, v57
    v_lshl_add_u32 v102, v13, 3, v102
    v_cvt_pk_bf16_f32 v58, v56, v57
    v_mov_b32 v59, s60
    s_lshl_b32 s44, s50, 7
    s_add_u32 s44, s44, 16384
    buffer_store_dwordx2 v[58:59], v102, s[4:7], s44 offen sc1
    s_branch L_join_5
L_roleBC_3:
    buffer_load_dwordx4 v[144:147], v215, s[36:39], s51 offen
    s_add_u32 s51, s51, 12288
    buffer_load_dwordx4 v[148:151], v215, s[36:39], s51 offen
    s_add_u32 s51, s51, 12288
    buffer_load_dwordx4 v[152:155], v215, s[36:39], s51 offen
    s_add_u32 s51, s51, 12288
    v_lshrrev_b32 v4, 2, v11
    v_mul_u32_u24 v4, 1056, v4
    v_and_b32 v3, 3, v11
    v_lshl_add_u32 v4, v3, 3, v4
    v_add_u32 v4, 67584, v4
    v_lshl_add_u32 v231, v3, 3, v4
    v_bfe_u32 v3, v11, 2, 1
    v_mul_u32_u24 v3, 24, v3
    v_sub_u32 v231, v231, v3
    v_lshrrev_b32 v2, 1, v12
    v_lshlrev_b32 v2, 5, v2
    v_and_b32 v3, 1, v12
    v_lshl_add_u32 v2, v3, 2, v2
    v_lshl_add_u32 v2, v10, 3, v2
    v_lshlrev_b32 v2, 13, v2
    v_lshl_add_u32 v2, v13, 4, v2
    s_lshl_b32 s44, s52, 8
    s_mov_b32 s65, 0
    s_add_u32 s8, s74, s44
    s_addc_u32 s9, s75, 0
    s_and_b32 s9, s9, 0xffff
    s_mov_b32 s10, 8380672
    s_mov_b32 s11, 0x20000
    v_lshrrev_b32 v252, 1, v11
    v_lshlrev_b32 v252, 13, v252
    v_and_b32 v3, 1, v11
    v_lshl_add_u32 v252, v3, 7, v252
    v_lshrrev_b32 v3, 4, v11
    v_lshl_add_u32 v252, v3, 24, v252
    s_lshl_b32 s67, s54, 16
    v_accvgpr_write_b32 a0, 0
    v_accvgpr_write_b32 a1, 0
    v_accvgpr_write_b32 a2, 0
    v_accvgpr_write_b32 a3, 0
    v_accvgpr_write_b32 a4, 0
    v_accvgpr_write_b32 a5, 0
    v_accvgpr_write_b32 a6, 0
    v_accvgpr_write_b32 a7, 0
    v_accvgpr_write_b32 a8, 0
    v_accvgpr_write_b32 a9, 0
    v_accvgpr_write_b32 a10, 0
    v_accvgpr_write_b32 a11, 0
    v_accvgpr_write_b32 a12, 0
    v_accvgpr_write_b32 a13, 0
    buffer_load_dwordx4 v[156:159], v215, s[36:39], s51 offen
    s_add_u32 s51, s51, 12288
    v_accvgpr_write_b32 a14, 0
    v_accvgpr_write_b32 a15, 0
    v_accvgpr_write_b32 a16, 0
    v_accvgpr_write_b32 a17, 0
    v_accvgpr_write_b32 a18, 0
    v_accvgpr_write_b32 a19, 0
    v_accvgpr_write_b32 a20, 0
    v_accvgpr_write_b32 a21, 0
    v_accvgpr_write_b32 a22, 0
    v_accvgpr_write_b32 a23, 0
    v_accvgpr_write_b32 a24, 0
    v_accvgpr_write_b32 a25, 0
    v_accvgpr_write_b32 a26, 0
    v_accvgpr_write_b32 a27, 0
    v_accvgpr_write_b32 a28, 0
    v_accvgpr_write_b32 a29, 0
    v_accvgpr_write_b32 a30, 0
    v_accvgpr_write_b32 a31, 0
    v_accvgpr_write_b32 a32, 0
    v_accvgpr_write_b32 a33, 0
    v_accvgpr_write_b32 a34, 0
    v_accvgpr_write_b32 a35, 0
    v_accvgpr_write_b32 a36, 0
    v_accvgpr_write_b32 a37, 0
    v_accvgpr_write_b32 a38, 0
    v_accvgpr_write_b32 a39, 0
    v_accvgpr_write_b32 a40, 0
    v_accvgpr_write_b32 a41, 0
    v_accvgpr_write_b32 a42, 0
    v_accvgpr_write_b32 a43, 0
    v_accvgpr_write_b32 a44, 0
    v_accvgpr_write_b32 a45, 0
    v_accvgpr_write_b32 a46, 0
    v_accvgpr_write_b32 a47, 0
    v_accvgpr_write_b32 a48, 0
    v_accvgpr_write_b32 a49, 0
    v_accvgpr_write_b32 a50, 0
    v_accvgpr_write_b32 a51, 0
    v_accvgpr_write_b32 a52, 0
    v_accvgpr_write_b32 a53, 0
    v_accvgpr_write_b32 a54, 0
    v_accvgpr_write_b32 a55, 0
    v_accvgpr_write_b32 a56, 0
    v_accvgpr_write_b32 a57, 0
    buffer_load_dwordx4 v[160:163], v215, s[36:39], s51 offen
    s_add_u32 s51, s51, 12288
    v_accvgpr_write_b32 a58, 0
    v_accvgpr_write_b32 a59, 0
    v_accvgpr_write_b32 a60, 0
    v_accvgpr_write_b32 a61, 0
    v_accvgpr_write_b32 a62, 0
    v_accvgpr_write_b32 a63, 0
    v_accvgpr_write_b32 a64, 0
    v_accvgpr_write_b32 a65, 0
    v_accvgpr_write_b32 a66, 0
    v_accvgpr_write_b32 a67, 0
    v_accvgpr_write_b32 a68, 0
    v_accvgpr_write_b32 a69, 0
    v_accvgpr_write_b32 a70, 0
    v_accvgpr_write_b32 a71, 0
    v_accvgpr_write_b32 a72, 0
    v_accvgpr_write_b32 a73, 0
    v_accvgpr_write_b32 a74, 0
    v_accvgpr_write_b32 a75, 0
    v_accvgpr_write_b32 a76, 0
    v_accvgpr_write_b32 a77, 0
    v_accvgpr_write_b32 a78, 0
    v_accvgpr_write_b32 a79, 0
    v_accvgpr_write_b32 a80, 0
    v_accvgpr_write_b32 a81, 0
    v_accvgpr_write_b32 a82, 0
    v_accvgpr_write_b32 a83, 0
    v_accvgpr_write_b32 a84, 0
    v_accvgpr_write_b32 a85, 0
    v_accvgpr_write_b32 a86, 0
    v_accvgpr_write_b32 a87, 0
    v_accvgpr_write_b32 a88, 0
    v_accvgpr_write_b32 a89, 0
    v_accvgpr_write_b32 a90, 0
    v_accvgpr_write_b32 a91, 0
    v_accvgpr_write_b32 a92, 0
    v_accvgpr_write_b32 a93, 0
    v_accvgpr_write_b32 a94, 0
    v_accvgpr_write_b32 a95, 0
    v_accvgpr_write_b32 a96, 0
    v_accvgpr_write_b32 a97, 0
    v_accvgpr_write_b32 a98, 0
    v_accvgpr_write_b32 a99, 0
    v_accvgpr_write_b32 a100, 0
    v_accvgpr_write_b32 a101, 0
    buffer_load_dwordx4 v[164:167], v215, s[36:39], s51 offen
    s_add_u32 s51, s51, 12288
    v_accvgpr_write_b32 a102, 0
    v_accvgpr_write_b32 a103, 0
    v_accvgpr_write_b32 a104, 0
    v_accvgpr_write_b32 a105, 0
    v_accvgpr_write_b32 a106, 0
    v_accvgpr_write_b32 a107, 0
    v_accvgpr_write_b32 a108, 0
    v_accvgpr_write_b32 a109, 0
    v_accvgpr_write_b32 a110, 0
    v_accvgpr_write_b32 a111, 0
    v_accvgpr_write_b32 a112, 0
    v_accvgpr_write_b32 a113, 0
    v_accvgpr_write_b32 a114, 0
    v_accvgpr_write_b32 a115, 0
    v_accvgpr_write_b32 a116, 0
    v_accvgpr_write_b32 a117, 0
    v_accvgpr_write_b32 a118, 0
    v_accvgpr_write_b32 a119, 0
    v_accvgpr_write_b32 a120, 0
    v_accvgpr_write_b32 a121, 0
    v_accvgpr_write_b32 a122, 0
    v_accvgpr_write_b32 a123, 0
    v_accvgpr_write_b32 a124, 0
    v_accvgpr_write_b32 a125, 0
    v_accvgpr_write_b32 a126, 0
    v_accvgpr_write_b32 a127, 0
    v_accvgpr_write_b32 a128, 0
    v_accvgpr_write_b32 a129, 0
    v_accvgpr_write_b32 a130, 0
    v_accvgpr_write_b32 a131, 0
    v_accvgpr_write_b32 a132, 0
    v_accvgpr_write_b32 a133, 0
    v_accvgpr_write_b32 a134, 0
    v_accvgpr_write_b32 a135, 0
    v_accvgpr_write_b32 a136, 0
    v_accvgpr_write_b32 a137, 0
    v_accvgpr_write_b32 a138, 0
    v_accvgpr_write_b32 a139, 0
    v_accvgpr_write_b32 a140, 0
    v_accvgpr_write_b32 a141, 0
    v_accvgpr_write_b32 a142, 0
    v_accvgpr_write_b32 a143, 0
    s_waitcnt vmcnt(6)
    v_readfirstlane_b32 s60, v210
    buffer_load_dwordx4 v[168:171], v215, s[36:39], s51 offen
    s_add_u32 s51, s51, 12288
    s_nop 3
    s_mul_i32 s60, s60, 0x9e3779b1
    s_add_u32 s60, s60, 0x7f4a7c15
    s_lshr_b32 s42, s2, 1
    s_lshl_b32 s42, s42, 7
    s_add_u32 s42, s42, 458752
    s_add_u32 s41, s60, s43
    v_mov_b32 v222, s41
    s_and_b32 s41, s2, 1
    v_xor_b32 v223, 0xc0, v0
    v_or_b32 v223, s41, v223
    v_min_u32 v223, 64, v223
    v_lshlrev_b32 v223, 24, v223
    buffer_store_dword v222, v223, s[4:7], s42 offen sc1
    s_waitcnt vmcnt(8)
    v_lshlrev_b32 v64, 16, v16
    v_and_b32 v65, 0xffff0000, v16
    v_lshlrev_b32 v66, 16, v17
    v_and_b32 v67, 0xffff0000, v17
    v_lshlrev_b32 v68, 16, v18
    v_and_b32 v69, 0xffff0000, v18
    v_lshlrev_b32 v70, 16, v19
    v_and_b32 v71, 0xffff0000, v19
    v_lshlrev_b32 v72, 16, v20
    v_and_b32 v73, 0xffff0000, v20
    v_lshlrev_b32 v74, 16, v21
    v_and_b32 v75, 0xffff0000, v21
    v_lshlrev_b32 v76, 16, v22
    v_and_b32 v77, 0xffff0000, v22
    v_lshlrev_b32 v78, 16, v23
    v_and_b32 v79, 0xffff0000, v23
    v_lshlrev_b32 v80, 16, v24
    v_and_b32 v81, 0xffff0000, v24
    v_lshlrev_b32 v82, 16, v25
    v_and_b32 v83, 0xffff0000, v25
    v_lshlrev_b32 v84, 16, v26
    v_and_b32 v85, 0xffff0000, v26
    v_lshlrev_b32 v86, 16, v27
    v_and_b32 v87, 0xffff0000, v27
    v_lshlrev_b32 v88, 16, v28
    v_and_b32 v89, 0xffff0000, v28
    v_lshlrev_b32 v90, 16, v29
    v_and_b32 v91, 0xffff0000, v29
    v_lshlrev_b32 v92, 16, v30
    buffer_load_dwordx4 v[172:175], v215, s[36:39], s51 offen
    s_add_u32 s51, s51, 12288
    v_and_b32 v93, 0xffff0000, v30
    v_lshlrev_b32 v94, 16, v31
    v_and_b32 v95, 0xffff0000, v31
    v_pk_add_f32 v[96:97], v[64:65], v[66:67]
    v_pk_add_f32 v[96:97], v[96:97], v[68:69]
    v_pk_add_f32 v[96:97], v[96:97], v[70:71]
    v_pk_add_f32 v[96:97], v[96:97], v[72:73]
    v_pk_add_f32 v[96:97], v[96:97], v[74:75]
    v_pk_add_f32 v[96:97], v[96:97], v[76:77]
    v_pk_add_f32 v[96:97], v[96:97], v[78:79]
    v_pk_add_f32 v[96:97], v[96:97], v[80:81]
    v_pk_add_f32 v[96:97], v[96:97], v[82:83]
    v_pk_add_f32 v[96:97], v[96:97], v[84:85]
    v_pk_add_f32 v[96:97], v[96:97], v[86:87]
    v_pk_add_f32 v[96:97], v[96:97], v[88:89]
    v_pk_add_f32 v[96:97], v[96:97], v[90:91]
    v_pk_add_f32 v[96:97], v[96:97], v[92:93]
    v_pk_add_f32 v[96:97], v[96:97], v[94:95]
    v_add_f32 v96, v96, v97
    s_nop 1
    v_add_f32_dpp v96, v96, v96 row_ror:8 row_mask:0xf bank_mask:0xf
    v_mov_b32 v97, v96
    s_nop 1
    v_permlane16_swap_b32 v96, v97
    v_add_f32 v96, v96, v97
    v_mov_b32 v97, v96
    s_nop 1
    v_permlane32_swap_b32 v96, v97
    v_add_f32 v96, v96, v97
    v_mul_f32 v96, 0xbb800000, v96
    v_pk_add_f32 v[112:113], v[64:65], v[96:97] op_sel_hi:[1,0]
    v_pk_mul_f32 v[98:99], v[112:113], v[112:113]
    v_pk_add_f32 v[112:113], v[66:67], v[96:97] op_sel_hi:[1,0]
    v_pk_fma_f32 v[98:99], v[112:113], v[112:113], v[98:99]
    v_pk_add_f32 v[112:113], v[68:69], v[96:97] op_sel_hi:[1,0]
    v_pk_fma_f32 v[98:99], v[112:113], v[112:113], v[98:99]
    v_pk_add_f32 v[112:113], v[70:71], v[96:97] op_sel_hi:[1,0]
    v_pk_fma_f32 v[98:99], v[112:113], v[112:113], v[98:99]
    v_pk_add_f32 v[112:113], v[72:73], v[96:97] op_sel_hi:[1,0]
    v_pk_fma_f32 v[98:99], v[112:113], v[112:113], v[98:99]
    v_pk_add_f32 v[112:113], v[74:75], v[96:97] op_sel_hi:[1,0]
    v_pk_fma_f32 v[98:99], v[112:113], v[112:113], v[98:99]
    v_pk_add_f32 v[112:113], v[76:77], v[96:97] op_sel_hi:[1,0]
    v_pk_fma_f32 v[98:99], v[112:113], v[112:113], v[98:99]
    buffer_load_dwordx4 v[176:179], v215, s[36:39], s51 offen
    s_add_u32 s51, s51, 12288
    v_pk_add_f32 v[112:113], v[78:79], v[96:97] op_sel_hi:[1,0]
    v_pk_fma_f32 v[98:99], v[112:113], v[112:113], v[98:99]
    v_pk_add_f32 v[112:113], v[80:81], v[96:97] op_sel_hi:[1,0]
    v_pk_fma_f32 v[98:99], v[112:113], v[112:113], v[98:99]
    v_pk_add_f32 v[112:113], v[82:83], v[96:97] op_sel_hi:[1,0]
    v_pk_fma_f32 v[98:99], v[112:113], v[112:113], v[98:99]
    v_pk_add_f32 v[112:113], v[84:85], v[96:97] op_sel_hi:[1,0]
    v_pk_fma_f32 v[98:99], v[112:113], v[112:113], v[98:99]
    v_pk_add_f32 v[112:113], v[86:87], v[96:97] op_sel_hi:[1,0]
    v_pk_fma_f32 v[98:99], v[112:113], v[112:113], v[98:99]
    v_pk_add_f32 v[112:113], v[88:89], v[96:97] op_sel_hi:[1,0]
    v_pk_fma_f32 v[98:99], v[112:113], v[112:113], v[98:99]
    v_pk_add_f32 v[112:113], v[90:91], v[96:97] op_sel_hi:[1,0]
    v_pk_fma_f32 v[98:99], v[112:113], v[112:113], v[98:99]
    v_pk_add_f32 v[112:113], v[92:93], v[96:97] op_sel_hi:[1,0]
    v_pk_fma_f32 v[98:99], v[112:113], v[112:113], v[98:99]
    v_pk_add_f32 v[112:113], v[94:95], v[96:97] op_sel_hi:[1,0]
    v_pk_fma_f32 v[98:99], v[112:113], v[112:113], v[98:99]
    v_add_f32 v97, v98, v99
    s_nop 1
    v_add_f32_dpp v97, v97, v97 row_ror:8 row_mask:0xf bank_mask:0xf
    v_mov_b32 v98, v97
    s_nop 1
    v_permlane16_swap_b32 v97, v98
    v_add_f32 v97, v97, v98
    v_mov_b32 v98, v97
    s_nop 1
    v_permlane32_swap_b32 v97, v98
    v_add_f32 v97, v97, v98
    v_lshlrev_b32 v99, 5, v208
    v_lshl_add_u32 v98, v10, 3, v99
    ds_write_b64 v98, v[96:97]
    s_waitcnt vmcnt(14)
    v_lshlrev_b32 v40, 16, v32
    v_and_b32 v41, 0xffff0000, v32
    v_lshlrev_b32 v42, 16, v33
    v_and_b32 v43, 0xffff0000, v33
    v_lshlrev_b32 v44, 16, v34
    v_and_b32 v45, 0xffff0000, v34
    v_lshlrev_b32 v46, 16, v35
    v_and_b32 v47, 0xffff0000, v35
    v_lshlrev_b32 v48, 16, v36
    v_and_b32 v49, 0xffff0000, v36
    v_lshlrev_b32 v50, 16, v37
    buffer_load_dwordx4 v[180:183], v215, s[36:39], s51 offen
    s_add_u32 s51, s51, 12288
    v_and_b32 v51, 0xffff0000, v37
    v_lshlrev_b32 v52, 16, v38
    v_and_b32 v53, 0xffff0000, v38
    v_lshlrev_b32 v54, 16, v39
    v_and_b32 v55, 0xffff0000, v39
    v_mul_f32 v112, 0xbfb8aa3b, v40
    v_mul_f32 v113, 0xbfb8aa3b, v41
    v_mul_f32 v114, 0xbfb8aa3b, v42
    v_mul_f32 v115, 0xbfb8aa3b, v43
    v_mul_f32 v116, 0xbfb8aa3b, v44
    v_mul_f32 v117, 0xbfb8aa3b, v45
    v_mul_f32 v118, 0xbfb8aa3b, v46
    v_mul_f32 v119, 0xbfb8aa3b, v47
    v_mul_f32 v120, 0xbfb8aa3b, v48
    v_mul_f32 v121, 0xbfb8aa3b, v49
    v_mul_f32 v122, 0xbfb8aa3b, v50
    v_mul_f32 v123, 0xbfb8aa3b, v51
    v_mul_f32 v124, 0xbfb8aa3b, v52
    v_mul_f32 v125, 0xbfb8aa3b, v53
    v_mul_f32 v126, 0xbfb8aa3b, v54
    v_mul_f32 v127, 0xbfb8aa3b, v55
    v_exp_f32 v112, v112
    v_exp_f32 v113, v113
    v_exp_f32 v114, v114
    v_exp_f32 v115, v115
    v_exp_f32 v116, v116
    v_exp_f32 v117, v117
    v_exp_f32 v118, v118
    v_exp_f32 v119, v119
    v_exp_f32 v120, v120
    v_exp_f32 v121, v121
    v_exp_f32 v122, v122
    v_exp_f32 v123, v123
    v_exp_f32 v124, v124
    v_exp_f32 v125, v125
    v_exp_f32 v126, v126
    v_exp_f32 v127, v127
    v_pk_add_f32 v[112:113], v[112:113], 1.0 op_sel_hi:[1,0]
    v_pk_add_f32 v[114:115], v[114:115], 1.0 op_sel_hi:[1,0]
    v_pk_add_f32 v[116:117], v[116:117], 1.0 op_sel_hi:[1,0]
    v_pk_add_f32 v[118:119], v[118:119], 1.0 op_sel_hi:[1,0]
    v_pk_add_f32 v[120:121], v[120:121], 1.0 op_sel_hi:[1,0]
    v_pk_add_f32 v[122:123], v[122:123], 1.0 op_sel_hi:[1,0]
    v_pk_add_f32 v[124:125], v[124:125], 1.0 op_sel_hi:[1,0]
    buffer_load_dwordx4 v[184:187], v215, s[36:39], s51 offen
    s_add_u32 s51, s51, 12288
    v_pk_add_f32 v[126:127], v[126:127], 1.0 op_sel_hi:[1,0]
    v_rcp_f32 v112, v112
    v_rcp_f32 v113, v113
    v_rcp_f32 v114, v114
    v_rcp_f32 v115, v115
    v_rcp_f32 v116, v116
    v_rcp_f32 v117, v117
    v_rcp_f32 v118, v118
    v_rcp_f32 v119, v119
    v_rcp_f32 v120, v120
    v_rcp_f32 v121, v121
    v_rcp_f32 v122, v122
    v_rcp_f32 v123, v123
    v_rcp_f32 v124, v124
    v_rcp_f32 v125, v125
    v_rcp_f32 v126, v126
    v_rcp_f32 v127, v127
    v_pk_mul_f32 v[40:41], v[40:41], v[112:113]
    v_pk_mul_f32 v[42:43], v[42:43], v[114:115]
    v_pk_mul_f32 v[44:45], v[44:45], v[116:117]
    v_pk_mul_f32 v[46:47], v[46:47], v[118:119]
    v_pk_mul_f32 v[48:49], v[48:49], v[120:121]
    v_pk_mul_f32 v[50:51], v[50:51], v[122:123]
    v_pk_mul_f32 v[52:53], v[52:53], v[124:125]
    v_pk_mul_f32 v[54:55], v[54:55], v[126:127]
    v_cvt_pk_bf16_f32 v41, v40, v41
    v_lshlrev_b32 v40, 16, v41
    v_and_b32 v41, 0xffff0000, v41
    v_cvt_pk_bf16_f32 v43, v42, v43
    v_lshlrev_b32 v42, 16, v43
    v_and_b32 v43, 0xffff0000, v43
    v_cvt_pk_bf16_f32 v45, v44, v45
    v_lshlrev_b32 v44, 16, v45
    v_and_b32 v45, 0xffff0000, v45
    v_cvt_pk_bf16_f32 v47, v46, v47
    v_lshlrev_b32 v46, 16, v47
    v_and_b32 v47, 0xffff0000, v47
    v_cvt_pk_bf16_f32 v49, v48, v49
    v_lshlrev_b32 v48, 16, v49
    v_and_b32 v49, 0xffff0000, v49
    v_cvt_pk_bf16_f32 v51, v50, v51
    v_lshlrev_b32 v50, 16, v51
    v_and_b32 v51, 0xffff0000, v51
    v_cvt_pk_bf16_f32 v53, v52, v53
    buffer_load_dwordx4 v[188:191], v215, s[36:39], s51 offen
    s_add_u32 s51, s51, 12288
    v_lshlrev_b32 v52, 16, v53
    v_and_b32 v53, 0xffff0000, v53
    v_cvt_pk_bf16_f32 v55, v54, v55
    v_lshlrev_b32 v54, 16, v55
    v_and_b32 v55, 0xffff0000, v55
    s_waitcnt lgkmcnt(0)
    s_barrier
    ds_read_b128 v[112:115], v99
    ds_read_b128 v[116:119], v99 offset:16
    s_waitcnt lgkmcnt(0)
    v_pk_add_f32 v[96:97], v[112:113], v[114:115]
    v_pk_add_f32 v[98:99], v[116:117], v[118:119]
    v_pk_add_f32 v[96:97], v[96:97], v[98:99]
    v_mul_f32 v96, 0x3e800000, v96
    v_sub_f32 v98, v112, v96
    v_mul_f32 v99, v98, v98
    v_sub_f32 v98, v114, v96
    v_fmac_f32 v99, v98, v98
    v_sub_f32 v98, v116, v96
    v_fmac_f32 v99, v98, v98
    v_sub_f32 v98, v118, v96
    v_fmac_f32 v99, v98, v98
    v_fmac_f32 v97, 0x43800000, v99
    v_mul_f32 v97, 0x3a800000, v97
    v_cvt_pk_bf16_f32 v97, v96, v97
    v_lshlrev_b32 v96, 16, v97
    v_and_b32 v97, 0xffff0000, v97
    v_add_f32 v97, 0x3727c5ac, v97
    v_cvt_pk_bf16_f32 v97, v97, v97
    v_lshlrev_b32 v97, 16, v97
    v_sqrt_f32 v97, v97
    s_nop 0
    v_cvt_pk_bf16_f32 v97, v97, v97
    v_lshlrev_b32 v97, 16, v97
    v_rcp_f32 v97, v97
    s_nop 0
    v_pk_add_f32 v[64:65], v[64:65], v[96:97] op_sel_hi:[1,0]
    v_cvt_pk_bf16_f32 v65, v64, v65
    v_lshlrev_b32 v64, 16, v65
    v_and_b32 v65, 0xffff0000, v65
    v_pk_mul_f32 v[64:65], v[64:65], v[96:97] op_sel:[0,1] op_sel_hi:[1,1]
    v_cvt_pk_bf16_f32 v65, v64, v65
    v_lshlrev_b32 v64, 16, v65
    v_and_b32 v65, 0xffff0000, v65
    buffer_load_dwordx4 v[192:195], v215, s[36:39], s51 offen
    s_add_u32 s51, s51, 12288
    v_pk_add_f32 v[66:67], v[66:67], v[96:97] op_sel_hi:[1,0]
    v_cvt_pk_bf16_f32 v67, v66, v67
    v_lshlrev_b32 v66, 16, v67
    v_and_b32 v67, 0xffff0000, v67
    v_pk_mul_f32 v[66:67], v[66:67], v[96:97] op_sel:[0,1] op_sel_hi:[1,1]
    v_cvt_pk_bf16_f32 v67, v66, v67
    v_lshlrev_b32 v66, 16, v67
    v_and_b32 v67, 0xffff0000, v67
    v_pk_add_f32 v[68:69], v[68:69], v[96:97] op_sel_hi:[1,0]
    v_cvt_pk_bf16_f32 v69, v68, v69
    v_lshlrev_b32 v68, 16, v69
    v_and_b32 v69, 0xffff0000, v69
    v_pk_mul_f32 v[68:69], v[68:69], v[96:97] op_sel:[0,1] op_sel_hi:[1,1]
    v_cvt_pk_bf16_f32 v69, v68, v69
    v_lshlrev_b32 v68, 16, v69
    v_and_b32 v69, 0xffff0000, v69
    v_pk_add_f32 v[70:71], v[70:71], v[96:97] op_sel_hi:[1,0]
    v_cvt_pk_bf16_f32 v71, v70, v71
    v_lshlrev_b32 v70, 16, v71
    v_and_b32 v71, 0xffff0000, v71
    v_pk_mul_f32 v[70:71], v[70:71], v[96:97] op_sel:[0,1] op_sel_hi:[1,1]
    v_cvt_pk_bf16_f32 v71, v70, v71
    v_lshlrev_b32 v70, 16, v71
    v_and_b32 v71, 0xffff0000, v71
    v_pk_add_f32 v[72:73], v[72:73], v[96:97] op_sel_hi:[1,0]
    v_cvt_pk_bf16_f32 v73, v72, v73
    v_lshlrev_b32 v72, 16, v73
    v_and_b32 v73, 0xffff0000, v73
    v_pk_mul_f32 v[72:73], v[72:73], v[96:97] op_sel:[0,1] op_sel_hi:[1,1]
    v_cvt_pk_bf16_f32 v73, v72, v73
    v_lshlrev_b32 v72, 16, v73
    v_and_b32 v73, 0xffff0000, v73
    v_pk_add_f32 v[74:75], v[74:75], v[96:97] op_sel_hi:[1,0]
    v_cvt_pk_bf16_f32 v75, v74, v75
    v_lshlrev_b32 v74, 16, v75
    v_and_b32 v75, 0xffff0000, v75
    v_pk_mul_f32 v[74:75], v[74:75], v[96:97] op_sel:[0,1] op_sel_hi:[1,1]
    v_cvt_pk_bf16_f32 v75, v74, v75
    v_lshlrev_b32 v74, 16, v75
    v_and_b32 v75, 0xffff0000, v75
    v_pk_add_f32 v[76:77], v[76:77], v[96:97] op_sel_hi:[1,0]
    v_cvt_pk_bf16_f32 v77, v76, v77
    v_lshlrev_b32 v76, 16, v77
    v_and_b32 v77, 0xffff0000, v77
    buffer_load_dwordx4 v[196:199], v215, s[36:39], s51 offen
    s_add_u32 s51, s51, 12288
    v_pk_mul_f32 v[76:77], v[76:77], v[96:97] op_sel:[0,1] op_sel_hi:[1,1]
    v_cvt_pk_bf16_f32 v77, v76, v77
    v_lshlrev_b32 v76, 16, v77
    v_and_b32 v77, 0xffff0000, v77
    v_pk_add_f32 v[78:79], v[78:79], v[96:97] op_sel_hi:[1,0]
    v_cvt_pk_bf16_f32 v79, v78, v79
    v_lshlrev_b32 v78, 16, v79
    v_and_b32 v79, 0xffff0000, v79
    v_pk_mul_f32 v[78:79], v[78:79], v[96:97] op_sel:[0,1] op_sel_hi:[1,1]
    v_cvt_pk_bf16_f32 v79, v78, v79
    v_lshlrev_b32 v78, 16, v79
    v_and_b32 v79, 0xffff0000, v79
    v_pk_add_f32 v[80:81], v[80:81], v[96:97] op_sel_hi:[1,0]
    v_cvt_pk_bf16_f32 v81, v80, v81
    v_lshlrev_b32 v80, 16, v81
    v_and_b32 v81, 0xffff0000, v81
    v_pk_mul_f32 v[80:81], v[80:81], v[96:97] op_sel:[0,1] op_sel_hi:[1,1]
    v_cvt_pk_bf16_f32 v81, v80, v81
    v_lshlrev_b32 v80, 16, v81
    v_and_b32 v81, 0xffff0000, v81
    v_pk_add_f32 v[82:83], v[82:83], v[96:97] op_sel_hi:[1,0]
    v_cvt_pk_bf16_f32 v83, v82, v83
    v_lshlrev_b32 v82, 16, v83
    v_and_b32 v83, 0xffff0000, v83
    v_pk_mul_f32 v[82:83], v[82:83], v[96:97] op_sel:[0,1] op_sel_hi:[1,1]
    v_cvt_pk_bf16_f32 v83, v82, v83
    v_lshlrev_b32 v82, 16, v83
    v_and_b32 v83, 0xffff0000, v83
    v_pk_add_f32 v[84:85], v[84:85], v[96:97] op_sel_hi:[1,0]
    v_cvt_pk_bf16_f32 v85, v84, v85
    v_lshlrev_b32 v84, 16, v85
    v_and_b32 v85, 0xffff0000, v85
    v_pk_mul_f32 v[84:85], v[84:85], v[96:97] op_sel:[0,1] op_sel_hi:[1,1]
    v_cvt_pk_bf16_f32 v85, v84, v85
    v_lshlrev_b32 v84, 16, v85
    v_and_b32 v85, 0xffff0000, v85
    v_pk_add_f32 v[86:87], v[86:87], v[96:97] op_sel_hi:[1,0]
    v_cvt_pk_bf16_f32 v87, v86, v87
    v_lshlrev_b32 v86, 16, v87
    v_and_b32 v87, 0xffff0000, v87
    v_pk_mul_f32 v[86:87], v[86:87], v[96:97] op_sel:[0,1] op_sel_hi:[1,1]
    v_cvt_pk_bf16_f32 v87, v86, v87
    v_lshlrev_b32 v86, 16, v87
    v_and_b32 v87, 0xffff0000, v87
    buffer_load_dwordx4 v[200:203], v215, s[36:39], s51 offen
    s_add_u32 s51, s51, 12288
    v_pk_add_f32 v[88:89], v[88:89], v[96:97] op_sel_hi:[1,0]
    v_cvt_pk_bf16_f32 v89, v88, v89
    v_lshlrev_b32 v88, 16, v89
    v_and_b32 v89, 0xffff0000, v89
    v_pk_mul_f32 v[88:89], v[88:89], v[96:97] op_sel:[0,1] op_sel_hi:[1,1]
    v_cvt_pk_bf16_f32 v89, v88, v89
    v_lshlrev_b32 v88, 16, v89
    v_and_b32 v89, 0xffff0000, v89
    v_pk_add_f32 v[90:91], v[90:91], v[96:97] op_sel_hi:[1,0]
    v_cvt_pk_bf16_f32 v91, v90, v91
    v_lshlrev_b32 v90, 16, v91
    v_and_b32 v91, 0xffff0000, v91
    v_pk_mul_f32 v[90:91], v[90:91], v[96:97] op_sel:[0,1] op_sel_hi:[1,1]
    v_cvt_pk_bf16_f32 v91, v90, v91
    v_lshlrev_b32 v90, 16, v91
    v_and_b32 v91, 0xffff0000, v91
    v_pk_add_f32 v[92:93], v[92:93], v[96:97] op_sel_hi:[1,0]
    v_cvt_pk_bf16_f32 v93, v92, v93
    v_lshlrev_b32 v92, 16, v93
    v_and_b32 v93, 0xffff0000, v93
    v_pk_mul_f32 v[92:93], v[92:93], v[96:97] op_sel:[0,1] op_sel_hi:[1,1]
    v_cvt_pk_bf16_f32 v93, v92, v93
    v_lshlrev_b32 v92, 16, v93
    v_and_b32 v93, 0xffff0000, v93
    v_pk_add_f32 v[94:95], v[94:95], v[96:97] op_sel_hi:[1,0]
    v_cvt_pk_bf16_f32 v95, v94, v95
    v_lshlrev_b32 v94, 16, v95
    v_and_b32 v95, 0xffff0000, v95
    v_pk_mul_f32 v[94:95], v[94:95], v[96:97] op_sel:[0,1] op_sel_hi:[1,1]
    v_cvt_pk_bf16_f32 v95, v94, v95
    v_lshlrev_b32 v94, 16, v95
    v_and_b32 v95, 0xffff0000, v95
    s_waitcnt vmcnt(15)
    v_lshlrev_b32 v100, 16, v144
    v_and_b32 v101, 0xffff0000, v144
    v_pk_mul_f32 v[56:57], v[100:101], v[40:41] op_sel_hi:[1,0]
    v_lshlrev_b32 v102, 16, v145
    v_and_b32 v103, 0xffff0000, v145
    v_pk_mul_f32 v[58:59], v[102:103], v[40:41] op_sel_hi:[1,0]
    v_lshlrev_b32 v100, 16, v146
    v_and_b32 v101, 0xffff0000, v146
    v_pk_mul_f32 v[60:61], v[100:101], v[40:41] op_sel_hi:[1,0]
    v_lshlrev_b32 v102, 16, v147
    v_and_b32 v103, 0xffff0000, v147
    buffer_load_dwordx4 v[204:207], v215, s[36:39], s51 offen
    v_pk_mul_f32 v[62:63], v[102:103], v[40:41] op_sel_hi:[1,0]
    s_waitcnt vmcnt(15)
    v_lshlrev_b32 v100, 16, v148
    v_and_b32 v101, 0xffff0000, v148
    v_pk_fma_f32 v[56:57], v[100:101], v[40:41], v[56:57] op_sel:[0,1,0] op_sel_hi:[1,1,1]
    v_lshlrev_b32 v102, 16, v149
    v_and_b32 v103, 0xffff0000, v149
    v_pk_fma_f32 v[58:59], v[102:103], v[40:41], v[58:59] op_sel:[0,1,0] op_sel_hi:[1,1,1]
    v_lshlrev_b32 v100, 16, v150
    v_and_b32 v101, 0xffff0000, v150
    v_pk_fma_f32 v[60:61], v[100:101], v[40:41], v[60:61] op_sel:[0,1,0] op_sel_hi:[1,1,1]
    v_lshlrev_b32 v102, 16, v151
    v_and_b32 v103, 0xffff0000, v151
    v_pk_fma_f32 v[62:63], v[102:103], v[40:41], v[62:63] op_sel:[0,1,0] op_sel_hi:[1,1,1]
    s_waitcnt vmcnt(14)
    v_lshlrev_b32 v100, 16, v152
    v_and_b32 v101, 0xffff0000, v152
    v_pk_fma_f32 v[56:57], v[100:101], v[42:43], v[56:57] op_sel_hi:[1,0,1]
    v_lshlrev_b32 v102, 16, v153
    v_and_b32 v103, 0xffff0000, v153
    v_pk_fma_f32 v[58:59], v[102:103], v[42:43], v[58:59] op_sel_hi:[1,0,1]
    v_lshlrev_b32 v100, 16, v154
    v_and_b32 v101, 0xffff0000, v154
    v_pk_fma_f32 v[60:61], v[100:101], v[42:43], v[60:61] op_sel_hi:[1,0,1]
    v_lshlrev_b32 v102, 16, v155
    v_and_b32 v103, 0xffff0000, v155
    v_pk_fma_f32 v[62:63], v[102:103], v[42:43], v[62:63] op_sel_hi:[1,0,1]
    s_waitcnt vmcnt(13)
    v_lshlrev_b32 v100, 16, v156
    v_and_b32 v101, 0xffff0000, v156
    v_pk_fma_f32 v[56:57], v[100:101], v[42:43], v[56:57] op_sel:[0,1,0] op_sel_hi:[1,1,1]
    v_lshlrev_b32 v102, 16, v157
    v_and_b32 v103, 0xffff0000, v157
    v_pk_fma_f32 v[58:59], v[102:103], v[42:43], v[58:59] op_sel:[0,1,0] op_sel_hi:[1,1,1]
    v_lshlrev_b32 v100, 16, v158
    v_and_b32 v101, 0xffff0000, v158
    v_pk_fma_f32 v[60:61], v[100:101], v[42:43], v[60:61] op_sel:[0,1,0] op_sel_hi:[1,1,1]
    v_lshlrev_b32 v102, 16, v159
    v_and_b32 v103, 0xffff0000, v159
    v_pk_fma_f32 v[62:63], v[102:103], v[42:43], v[62:63] op_sel:[0,1,0] op_sel_hi:[1,1,1]
    s_waitcnt vmcnt(12)
    v_lshlrev_b32 v100, 16, v160
    v_and_b32 v101, 0xffff0000, v160
    v_pk_fma_f32 v[56:57], v[100:101], v[44:45], v[56:57] op_sel_hi:[1,0,1]
    v_lshlrev_b32 v102, 16, v161
    v_and_b32 v103, 0xffff0000, v161
    v_pk_fma_f32 v[58:59], v[102:103], v[44:45], v[58:59] op_sel_hi:[1,0,1]
    v_lshlrev_b32 v100, 16, v162
    v_and_b32 v101, 0xffff0000, v162
    v_pk_fma_f32 v[60:61], v[100:101], v[44:45], v[60:61] op_sel_hi:[1,0,1]
    v_lshlrev_b32 v102, 16, v163
    v_and_b32 v103, 0xffff0000, v163
    v_pk_fma_f32 v[62:63], v[102:103], v[44:45], v[62:63] op_sel_hi:[1,0,1]
    s_waitcnt vmcnt(11)
    v_lshlrev_b32 v100, 16, v164
    v_and_b32 v101, 0xffff0000, v164
    v_pk_fma_f32 v[56:57], v[100:101], v[44:45], v[56:57] op_sel:[0,1,0] op_sel_hi:[1,1,1]
    v_lshlrev_b32 v102, 16, v165
    v_and_b32 v103, 0xffff0000, v165
    v_pk_fma_f32 v[58:59], v[102:103], v[44:45], v[58:59] op_sel:[0,1,0] op_sel_hi:[1,1,1]
    v_lshlrev_b32 v100, 16, v166
    v_and_b32 v101, 0xffff0000, v166
    v_pk_fma_f32 v[60:61], v[100:101], v[44:45], v[60:61] op_sel:[0,1,0] op_sel_hi:[1,1,1]
    v_lshlrev_b32 v102, 16, v167
    v_and_b32 v103, 0xffff0000, v167
    v_pk_fma_f32 v[62:63], v[102:103], v[44:45], v[62:63] op_sel:[0,1,0] op_sel_hi:[1,1,1]
    s_waitcnt vmcnt(10)
    v_lshlrev_b32 v100, 16, v168
    v_and_b32 v101, 0xffff0000, v168
    v_pk_fma_f32 v[56:57], v[100:101], v[46:47], v[56:57] op_sel_hi:[1,0,1]
    v_lshlrev_b32 v102, 16, v169
    v_and_b32 v103, 0xffff0000, v169
    v_pk_fma_f32 v[58:59], v[102:103], v[46:47], v[58:59] op_sel_hi:[1,0,1]
    v_lshlrev_b32 v100, 16, v170
    v_and_b32 v101, 0xffff0000, v170
    v_pk_fma_f32 v[60:61], v[100:101], v[46:47], v[60:61] op_sel_hi:[1,0,1]
    v_lshlrev_b32 v102, 16, v171
    v_and_b32 v103, 0xffff0000, v171
    v_pk_fma_f32 v[62:63], v[102:103], v[46:47], v[62:63] op_sel_hi:[1,0,1]
    s_waitcnt vmcnt(8)
    v_lshlrev_b32 v100, 16, v172
    v_and_b32 v101, 0xffff0000, v172
    v_pk_fma_f32 v[56:57], v[100:101], v[46:47], v[56:57] op_sel:[0,1,0] op_sel_hi:[1,1,1]
    v_lshlrev_b32 v102, 16, v173
    v_and_b32 v103, 0xffff0000, v173
    v_pk_fma_f32 v[58:59], v[102:103], v[46:47], v[58:59] op_sel:[0,1,0] op_sel_hi:[1,1,1]
    v_lshlrev_b32 v100, 16, v174
    v_and_b32 v101, 0xffff0000, v174
    v_pk_fma_f32 v[60:61], v[100:101], v[46:47], v[60:61] op_sel:[0,1,0] op_sel_hi:[1,1,1]
    v_lshlrev_b32 v102, 16, v175
    v_and_b32 v103, 0xffff0000, v175
    v_pk_fma_f32 v[62:63], v[102:103], v[46:47], v[62:63] op_sel:[0,1,0] op_sel_hi:[1,1,1]
    s_waitcnt vmcnt(7)
    v_lshlrev_b32 v100, 16, v176
    v_and_b32 v101, 0xffff0000, v176
    v_pk_fma_f32 v[56:57], v[100:101], v[48:49], v[56:57] op_sel_hi:[1,0,1]
    v_lshlrev_b32 v102, 16, v177
    v_and_b32 v103, 0xffff0000, v177
    v_pk_fma_f32 v[58:59], v[102:103], v[48:49], v[58:59] op_sel_hi:[1,0,1]
    v_lshlrev_b32 v100, 16, v178
    v_and_b32 v101, 0xffff0000, v178
    v_pk_fma_f32 v[60:61], v[100:101], v[48:49], v[60:61] op_sel_hi:[1,0,1]
    v_lshlrev_b32 v102, 16, v179
    v_and_b32 v103, 0xffff0000, v179
    v_pk_fma_f32 v[62:63], v[102:103], v[48:49], v[62:63] op_sel_hi:[1,0,1]
    s_waitcnt vmcnt(6)
    v_lshlrev_b32 v100, 16, v180
    v_and_b32 v101, 0xffff0000, v180
    v_pk_fma_f32 v[56:57], v[100:101], v[48:49], v[56:57] op_sel:[0,1,0] op_sel_hi:[1,1,1]
    v_lshlrev_b32 v102, 16, v181
    v_and_b32 v103, 0xffff0000, v181
    v_pk_fma_f32 v[58:59], v[102:103], v[48:49], v[58:59] op_sel:[0,1,0] op_sel_hi:[1,1,1]
    v_lshlrev_b32 v100, 16, v182
    v_and_b32 v101, 0xffff0000, v182
    v_pk_fma_f32 v[60:61], v[100:101], v[48:49], v[60:61] op_sel:[0,1,0] op_sel_hi:[1,1,1]
    v_lshlrev_b32 v102, 16, v183
    v_and_b32 v103, 0xffff0000, v183
    v_pk_fma_f32 v[62:63], v[102:103], v[48:49], v[62:63] op_sel:[0,1,0] op_sel_hi:[1,1,1]
    s_waitcnt vmcnt(5)
    v_lshlrev_b32 v100, 16, v184
    v_and_b32 v101, 0xffff0000, v184
    v_pk_fma_f32 v[56:57], v[100:101], v[50:51], v[56:57] op_sel_hi:[1,0,1]
    v_lshlrev_b32 v102, 16, v185
    v_and_b32 v103, 0xffff0000, v185
    v_pk_fma_f32 v[58:59], v[102:103], v[50:51], v[58:59] op_sel_hi:[1,0,1]
    v_lshlrev_b32 v100, 16, v186
    v_and_b32 v101, 0xffff0000, v186
    v_pk_fma_f32 v[60:61], v[100:101], v[50:51], v[60:61] op_sel_hi:[1,0,1]
    v_lshlrev_b32 v102, 16, v187
    v_and_b32 v103, 0xffff0000, v187
    v_pk_fma_f32 v[62:63], v[102:103], v[50:51], v[62:63] op_sel_hi:[1,0,1]
    s_waitcnt vmcnt(4)
    v_lshlrev_b32 v100, 16, v188
    v_and_b32 v101, 0xffff0000, v188
    v_pk_fma_f32 v[56:57], v[100:101], v[50:51], v[56:57] op_sel:[0,1,0] op_sel_hi:[1,1,1]
    v_lshlrev_b32 v102, 16, v189
    v_and_b32 v103, 0xffff0000, v189
    v_pk_fma_f32 v[58:59], v[102:103], v[50:51], v[58:59] op_sel:[0,1,0] op_sel_hi:[1,1,1]
    v_lshlrev_b32 v100, 16, v190
    v_and_b32 v101, 0xffff0000, v190
    v_pk_fma_f32 v[60:61], v[100:101], v[50:51], v[60:61] op_sel:[0,1,0] op_sel_hi:[1,1,1]
    v_lshlrev_b32 v102, 16, v191
    v_and_b32 v103, 0xffff0000, v191
    v_pk_fma_f32 v[62:63], v[102:103], v[50:51], v[62:63] op_sel:[0,1,0] op_sel_hi:[1,1,1]
    s_waitcnt vmcnt(3)
    v_lshlrev_b32 v100, 16, v192
    v_and_b32 v101, 0xffff0000, v192
    v_pk_fma_f32 v[56:57], v[100:101], v[52:53], v[56:57] op_sel_hi:[1,0,1]
    v_lshlrev_b32 v102, 16, v193
    v_and_b32 v103, 0xffff0000, v193
    v_pk_fma_f32 v[58:59], v[102:103], v[52:53], v[58:59] op_sel_hi:[1,0,1]
    v_lshlrev_b32 v100, 16, v194
    v_and_b32 v101, 0xffff0000, v194
    v_pk_fma_f32 v[60:61], v[100:101], v[52:53], v[60:61] op_sel_hi:[1,0,1]
    v_lshlrev_b32 v102, 16, v195
    v_and_b32 v103, 0xffff0000, v195
    v_pk_fma_f32 v[62:63], v[102:103], v[52:53], v[62:63] op_sel_hi:[1,0,1]
    s_waitcnt vmcnt(2)
    v_lshlrev_b32 v100, 16, v196
    v_and_b32 v101, 0xffff0000, v196
    v_pk_fma_f32 v[56:57], v[100:101], v[52:53], v[56:57] op_sel:[0,1,0] op_sel_hi:[1,1,1]
    v_lshlrev_b32 v102, 16, v197
    v_and_b32 v103, 0xffff0000, v197
    v_pk_fma_f32 v[58:59], v[102:103], v[52:53], v[58:59] op_sel:[0,1,0] op_sel_hi:[1,1,1]
    v_lshlrev_b32 v100, 16, v198
    v_and_b32 v101, 0xffff0000, v198
    v_pk_fma_f32 v[60:61], v[100:101], v[52:53], v[60:61] op_sel:[0,1,0] op_sel_hi:[1,1,1]
    v_lshlrev_b32 v102, 16, v199
    v_and_b32 v103, 0xffff0000, v199
    v_pk_fma_f32 v[62:63], v[102:103], v[52:53], v[62:63] op_sel:[0,1,0] op_sel_hi:[1,1,1]
    s_waitcnt vmcnt(1)
    v_lshlrev_b32 v100, 16, v200
    v_and_b32 v101, 0xffff0000, v200
    v_pk_fma_f32 v[56:57], v[100:101], v[54:55], v[56:57] op_sel_hi:[1,0,1]
    v_lshlrev_b32 v102, 16, v201
    v_and_b32 v103, 0xffff0000, v201
    v_pk_fma_f32 v[58:59], v[102:103], v[54:55], v[58:59] op_sel_hi:[1,0,1]
    v_lshlrev_b32 v100, 16, v202
    v_and_b32 v101, 0xffff0000, v202
    v_pk_fma_f32 v[60:61], v[100:101], v[54:55], v[60:61] op_sel_hi:[1,0,1]
    v_lshlrev_b32 v102, 16, v203
    v_and_b32 v103, 0xffff0000, v203
    v_pk_fma_f32 v[62:63], v[102:103], v[54:55], v[62:63] op_sel_hi:[1,0,1]
    s_waitcnt vmcnt(0)
    v_lshlrev_b32 v100, 16, v204
    v_and_b32 v101, 0xffff0000, v204
    v_pk_fma_f32 v[56:57], v[100:101], v[54:55], v[56:57] op_sel:[0,1,0] op_sel_hi:[1,1,1]
    v_lshlrev_b32 v102, 16, v205
    v_and_b32 v103, 0xffff0000, v205
    v_pk_fma_f32 v[58:59], v[102:103], v[54:55], v[58:59] op_sel:[0,1,0] op_sel_hi:[1,1,1]
    v_lshlrev_b32 v100, 16, v206
    v_and_b32 v101, 0xffff0000, v206
    v_pk_fma_f32 v[60:61], v[100:101], v[54:55], v[60:61] op_sel:[0,1,0] op_sel_hi:[1,1,1]
    v_lshlrev_b32 v102, 16, v207
    v_and_b32 v103, 0xffff0000, v207
    v_pk_fma_f32 v[62:63], v[102:103], v[54:55], v[62:63] op_sel:[0,1,0] op_sel_hi:[1,1,1]
    s_nop 1
    v_add_f32_dpp v56, v56, v56 row_ror:8 row_mask:0xf bank_mask:0xf
    v_add_f32_dpp v57, v57, v57 row_ror:8 row_mask:0xf bank_mask:0xf
    v_add_f32_dpp v58, v58, v58 row_ror:8 row_mask:0xf bank_mask:0xf
    v_add_f32_dpp v59, v59, v59 row_ror:8 row_mask:0xf bank_mask:0xf
    v_add_f32_dpp v60, v60, v60 row_ror:8 row_mask:0xf bank_mask:0xf
    v_add_f32_dpp v61, v61, v61 row_ror:8 row_mask:0xf bank_mask:0xf
    v_add_f32_dpp v62, v62, v62 row_ror:8 row_mask:0xf bank_mask:0xf
    v_add_f32_dpp v63, v63, v63 row_ror:8 row_mask:0xf bank_mask:0xf
    v_lshrrev_b32 v100, 4, v0
    v_lshlrev_b32 v100, 8, v100
    v_and_b32 v101, 7, v0
    v_lshl_add_u32 v100, v101, 5, v100
    ds_write_b128 v100, v[56:59] offset:1024
    ds_write_b128 v100, v[60:63] offset:1040
    s_waitcnt lgkmcnt(0)
    s_barrier
    s_cmp_lg_u32 s3, 0
    s_cbranch_scc1 L_join_6
    v_lshlrev_b32 v100, 10, v12
    v_lshl_add_u32 v100, v13, 4, v100
    ds_read_b128 v[144:147], v100 offset:1024
    ds_read_b128 v[148:151], v100 offset:1280
    ds_read_b128 v[152:155], v100 offset:1536
    ds_read_b128 v[156:159], v100 offset:1792
    v_lshlrev_b32 v102, 24, v12
    v_lshl_add_u32 v102, v13, 4, v102
    s_and_b32 s44, s50, 1
    s_lshl_b32 s44, s44, 14
    s_lshr_b32 s45, s50, 1
    s_lshl_b32 s45, s45, 8
    s_add_u32 s44, s44, s45
    s_add_u32 s44, s44, 385024
    s_waitcnt lgkmcnt(0)
    v_pk_add_f32 v[144:145], v[144:145], v[148:149]
    v_pk_add_f32 v[152:153], v[152:153], v[156:157]
    v_pk_add_f32 v[144:145], v[144:145], v[152:153]
    v_pk_add_f32 v[146:147], v[146:147], v[150:151]
    v_pk_add_f32 v[154:155], v[154:155], v[158:159]
    v_pk_add_f32 v[146:147], v[146:147], v[154:155]
    v_mov_b32 v148, v144
    v_mov_b32 v149, v145
    v_mov_b32 v150, v146
    v_mov_b32 v151, v147
    v_permlane16_swap_b32 v144, v148
    v_permlane16_swap_b32 v145, v149
    v_permlane16_swap_b32 v146, v150
    v_permlane16_swap_b32 v147, v151
    v_add_f32 v144, v144, v148
    v_add_f32 v145, v145, v149
    v_add_f32 v146, v146, v150
    v_add_f32 v147, v147, v151
    v_mov_b32 v148, v144
    v_mov_b32 v149, v145
    v_mov_b32 v150, v146
    v_mov_b32 v151, v147
    v_permlane32_swap_b32 v144, v148
    v_permlane32_swap_b32 v145, v149
    v_permlane32_swap_b32 v146, v150
    v_permlane32_swap_b32 v147, v151
    v_add_f32 v144, v144, v148
    v_add_f32 v145, v145, v149
    v_add_f32 v146, v146, v150
    v_add_f32 v147, v147, v151
    buffer_store_dwordx4 v[144:147], v102, s[4:7], s44 offen sc1
    s_branch L_join_6
L_roleC_4:
    s_lshr_b32 s44, s2, 3
    s_sub_u32 s44, s44, 24
    s_lshl_b32 s44, s44, 2
    s_add_u32 s44, s44, s3
    s_mul_i32 s44, s44, 393216
    s_lshl_b32 s47, s47, 1
    s_add_u32 s44, s44, s47
    s_add_u32 s44, s44, 4480
    v_and_b32 v101, 31, v11
    v_mul_u32_u24 v101, 12288, v101
    v_and_b32 v102, 0, v11
    v_lshl_add_u32 v101, v102, 1, v101
    buffer_load_dword v213, v101, s[36:39], s44 offen
    v_lshrrev_b32 v4, 2, v11
    v_mul_u32_u24 v4, 1056, v4
    v_and_b32 v3, 3, v11
    v_lshl_add_u32 v4, v3, 3, v4
    v_add_u32 v4, 67584, v4
    v_lshl_add_u32 v231, v3, 3, v4
    v_bfe_u32 v3, v11, 2, 1
    v_mul_u32_u24 v3, 24, v3
    v_sub_u32 v231, v231, v3
    v_lshrrev_b32 v2, 1, v12
    v_lshlrev_b32 v2, 5, v2
    v_and_b32 v3, 1, v12
    v_lshl_add_u32 v2, v3, 2, v2
    v_lshl_add_u32 v2, v10, 3, v2
    v_lshlrev_b32 v2, 13, v2
    v_lshl_add_u32 v2, v13, 4, v2
    s_lshl_b32 s44, s52, 8
    s_mov_b32 s65, 0
    s_add_u32 s8, s74, s44
    s_addc_u32 s9, s75, 0
    s_and_b32 s9, s9, 0xffff
    s_mov_b32 s10, 8380672
    s_mov_b32 s11, 0x20000
    v_lshrrev_b32 v252, 1, v11
    v_lshlrev_b32 v252, 13, v252
    v_and_b32 v3, 1, v11
    v_lshl_add_u32 v252, v3, 7, v252
    v_lshrrev_b32 v3, 4, v11
    v_lshl_add_u32 v252, v3, 24, v252
    s_lshl_b32 s67, s54, 16
    s_bfe_u32 s44, s2, 0x20003
    s_cmp_eq_u32 s44, 1
    s_mov_b32 s46, 135270404
    s_cselect_b32 s46, 117506056, s46
    s_cmp_eq_u32 s44, 2
    s_cselect_b32 s46, 1799, s46
    s_cmp_eq_u32 s44, 3
    s_cselect_b32 s46, 2097156, s46
    s_lshl_b32 s44, s44, 2
    s_add_u32 s44, s44, s3
    s_min_u32 s44, s44, 14
    s_lshl_b32 s44, s44, 3
    s_load_dwordx2 s[28:29], s[0:1], s44
    s_lshl_b32 s45, s3, 3
    s_lshr_b32 s46, s46, s45
    s_and_b32 s46, s46, 0xff
    s_lshl_b32 s46, s46, 20
    s_sub_u32 s46, s46, 1048572
    s_cselect_b32 s30, 0, s46
    s_mov_b32 s31, 0x20000
    v_lshlrev_b32 v101, 20, v11
    s_waitcnt lgkmcnt(0)
    s_and_b32 s29, s29, 0xffff
    buffer_load_dword v221, v101, s[28:31], 0 offen
    s_sub_u32 s44, s54, 24
    s_lshl_b32 s44, s44, 18
    v_lshrrev_b32 v101, 1, v11
    v_lshlrev_b32 v101, 13, v101
    v_and_b32 v102, 1, v11
    v_lshl_add_u32 v101, v102, 7, v101
    buffer_load_dword v214, v101, s[8:11], s44 offen
    v_accvgpr_write_b32 a0, 0
    v_accvgpr_write_b32 a1, 0
    v_accvgpr_write_b32 a2, 0
    v_accvgpr_write_b32 a3, 0
    v_accvgpr_write_b32 a4, 0
    v_accvgpr_write_b32 a5, 0
    v_accvgpr_write_b32 a6, 0
    v_accvgpr_write_b32 a7, 0
    v_accvgpr_write_b32 a8, 0
    v_accvgpr_write_b32 a9, 0
    v_accvgpr_write_b32 a10, 0
    v_accvgpr_write_b32 a11, 0
    v_accvgpr_write_b32 a12, 0
    v_accvgpr_write_b32 a13, 0
    v_accvgpr_write_b32 a14, 0
    v_accvgpr_write_b32 a15, 0
    v_accvgpr_write_b32 a16, 0
    v_accvgpr_write_b32 a17, 0
    v_accvgpr_write_b32 a18, 0
    v_accvgpr_write_b32 a19, 0
    v_accvgpr_write_b32 a20, 0
    v_accvgpr_write_b32 a21, 0
    v_accvgpr_write_b32 a22, 0
    v_accvgpr_write_b32 a23, 0
    v_accvgpr_write_b32 a24, 0
    v_accvgpr_write_b32 a25, 0
    v_accvgpr_write_b32 a26, 0
    v_accvgpr_write_b32 a27, 0
    v_accvgpr_write_b32 a28, 0
    v_accvgpr_write_b32 a29, 0
    v_accvgpr_write_b32 a30, 0
    v_accvgpr_write_b32 a31, 0
    v_accvgpr_write_b32 a32, 0
    v_accvgpr_write_b32 a33, 0
    v_accvgpr_write_b32 a34, 0
    v_accvgpr_write_b32 a35, 0
    v_accvgpr_write_b32 a36, 0
    v_accvgpr_write_b32 a37, 0
    v_accvgpr_write_b32 a38, 0
    v_accvgpr_write_b32 a39, 0
    v_accvgpr_write_b32 a40, 0
    v_accvgpr_write_b32 a41, 0
    v_accvgpr_write_b32 a42, 0
    v_accvgpr_write_b32 a43, 0
    v_accvgpr_write_b32 a44, 0
    v_accvgpr_write_b32 a45, 0
    v_accvgpr_write_b32 a46, 0
    v_accvgpr_write_b32 a47, 0
    v_accvgpr_write_b32 a48, 0
    v_accvgpr_write_b32 a49, 0
    v_accvgpr_write_b32 a50, 0
    v_accvgpr_write_b32 a51, 0
    v_accvgpr_write_b32 a52, 0
    v_accvgpr_write_b32 a53, 0
    v_accvgpr_write_b32 a54, 0
    v_accvgpr_write_b32 a55, 0
    v_accvgpr_write_b32 a56, 0
    v_accvgpr_write_b32 a57, 0
    v_accvgpr_write_b32 a58, 0
    v_accvgpr_write_b32 a59, 0
    v_accvgpr_write_b32 a60, 0
    v_accvgpr_write_b32 a61, 0
    v_accvgpr_write_b32 a62, 0
    v_accvgpr_write_b32 a63, 0
    v_accvgpr_write_b32 a64, 0
    v_accvgpr_write_b32 a65, 0
    v_accvgpr_write_b32 a66, 0
    v_accvgpr_write_b32 a67, 0
    v_accvgpr_write_b32 a68, 0
    v_accvgpr_write_b32 a69, 0
    v_accvgpr_write_b32 a70, 0
    v_accvgpr_write_b32 a71, 0
    v_accvgpr_write_b32 a72, 0
    v_accvgpr_write_b32 a73, 0
    v_accvgpr_write_b32 a74, 0
    v_accvgpr_write_b32 a75, 0
    v_accvgpr_write_b32 a76, 0
    v_accvgpr_write_b32 a77, 0
    v_accvgpr_write_b32 a78, 0
    v_accvgpr_write_b32 a79, 0
    v_accvgpr_write_b32 a80, 0
    v_accvgpr_write_b32 a81, 0
    v_accvgpr_write_b32 a82, 0
    v_accvgpr_write_b32 a83, 0
    v_accvgpr_write_b32 a84, 0
    v_accvgpr_write_b32 a85, 0
    v_accvgpr_write_b32 a86, 0
    v_accvgpr_write_b32 a87, 0
    v_accvgpr_write_b32 a88, 0
    v_accvgpr_write_b32 a89, 0
    v_accvgpr_write_b32 a90, 0
    v_accvgpr_write_b32 a91, 0
    v_accvgpr_write_b32 a92, 0
    v_accvgpr_write_b32 a93, 0
    v_accvgpr_write_b32 a94, 0
    v_accvgpr_write_b32 a95, 0
    v_accvgpr_write_b32 a96, 0
    v_accvgpr_write_b32 a97, 0
    v_accvgpr_write_b32 a98, 0
    v_accvgpr_write_b32 a99, 0
    v_accvgpr_write_b32 a100, 0
    v_accvgpr_write_b32 a101, 0
    v_accvgpr_write_b32 a102, 0
    v_accvgpr_write_b32 a103, 0
    v_accvgpr_write_b32 a104, 0
    v_accvgpr_write_b32 a105, 0
    v_accvgpr_write_b32 a106, 0
    v_accvgpr_write_b32 a107, 0
    v_accvgpr_write_b32 a108, 0
    v_accvgpr_write_b32 a109, 0
    v_accvgpr_write_b32 a110, 0
    v_accvgpr_write_b32 a111, 0
    v_accvgpr_write_b32 a112, 0
    v_accvgpr_write_b32 a113, 0
    v_accvgpr_write_b32 a114, 0
    v_accvgpr_write_b32 a115, 0
    v_accvgpr_write_b32 a116, 0
    v_accvgpr_write_b32 a117, 0
    v_accvgpr_write_b32 a118, 0
    v_accvgpr_write_b32 a119, 0
    v_accvgpr_write_b32 a120, 0
    v_accvgpr_write_b32 a121, 0
    v_accvgpr_write_b32 a122, 0
    v_accvgpr_write_b32 a123, 0
    v_accvgpr_write_b32 a124, 0
    v_accvgpr_write_b32 a125, 0
    v_accvgpr_write_b32 a126, 0
    v_accvgpr_write_b32 a127, 0
    v_accvgpr_write_b32 a128, 0
    v_accvgpr_write_b32 a129, 0
    v_accvgpr_write_b32 a130, 0
    v_accvgpr_write_b32 a131, 0
    v_accvgpr_write_b32 a132, 0
    v_accvgpr_write_b32 a133, 0
    v_accvgpr_write_b32 a134, 0
    v_accvgpr_write_b32 a135, 0
    v_accvgpr_write_b32 a136, 0
    v_accvgpr_write_b32 a137, 0
    v_accvgpr_write_b32 a138, 0
    v_accvgpr_write_b32 a139, 0
    v_accvgpr_write_b32 a140, 0
    v_accvgpr_write_b32 a141, 0
    v_accvgpr_write_b32 a142, 0
    v_accvgpr_write_b32 a143, 0
    s_waitcnt vmcnt(3)
    v_readfirstlane_b32 s60, v210
    s_nop 3
    s_mul_i32 s60, s60, 0x9e3779b1
    s_add_u32 s60, s60, 0x7f4a7c15
    s_lshr_b32 s42, s2, 1
    s_lshl_b32 s42, s42, 7
    s_add_u32 s42, s42, 458752
    s_add_u32 s41, s60, s43
    v_mov_b32 v222, s41
    s_and_b32 s41, s2, 1
    v_xor_b32 v223, 0xc0, v0
    v_or_b32 v223, s41, v223
    v_min_u32 v223, 64, v223
    v_lshlrev_b32 v223, 24, v223
    buffer_store_dword v222, v223, s[4:7], s42 offen sc1
    s_waitcnt vmcnt(4)
    v_lshlrev_b32 v64, 16, v16
    v_and_b32 v65, 0xffff0000, v16
    v_lshlrev_b32 v66, 16, v17
    v_and_b32 v67, 0xffff0000, v17
    v_lshlrev_b32 v68, 16, v18
    v_and_b32 v69, 0xffff0000, v18
    v_lshlrev_b32 v70, 16, v19
    v_and_b32 v71, 0xffff0000, v19
    v_lshlrev_b32 v72, 16, v20
    v_and_b32 v73, 0xffff0000, v20
    v_lshlrev_b32 v74, 16, v21
    v_and_b32 v75, 0xffff0000, v21
    v_lshlrev_b32 v76, 16, v22
    v_and_b32 v77, 0xffff0000, v22
    v_lshlrev_b32 v78, 16, v23
    v_and_b32 v79, 0xffff0000, v23
    v_lshlrev_b32 v80, 16, v24
    v_and_b32 v81, 0xffff0000, v24
    v_lshlrev_b32 v82, 16, v25
    v_and_b32 v83, 0xffff0000, v25
    v_lshlrev_b32 v84, 16, v26
    v_and_b32 v85, 0xffff0000, v26
    v_lshlrev_b32 v86, 16, v27
    v_and_b32 v87, 0xffff0000, v27
    v_lshlrev_b32 v88, 16, v28
    v_and_b32 v89, 0xffff0000, v28
    v_lshlrev_b32 v90, 16, v29
    v_and_b32 v91, 0xffff0000, v29
    v_lshlrev_b32 v92, 16, v30
    v_and_b32 v93, 0xffff0000, v30
    v_lshlrev_b32 v94, 16, v31
    v_and_b32 v95, 0xffff0000, v31
    v_pk_add_f32 v[96:97], v[64:65], v[66:67]
    v_pk_add_f32 v[96:97], v[96:97], v[68:69]
    v_pk_add_f32 v[96:97], v[96:97], v[70:71]
    v_pk_add_f32 v[96:97], v[96:97], v[72:73]
    v_pk_add_f32 v[96:97], v[96:97], v[74:75]
    v_pk_add_f32 v[96:97], v[96:97], v[76:77]
    v_pk_add_f32 v[96:97], v[96:97], v[78:79]
    v_pk_add_f32 v[96:97], v[96:97], v[80:81]
    v_pk_add_f32 v[96:97], v[96:97], v[82:83]
    v_pk_add_f32 v[96:97], v[96:97], v[84:85]
    v_pk_add_f32 v[96:97], v[96:97], v[86:87]
    v_pk_add_f32 v[96:97], v[96:97], v[88:89]
    v_pk_add_f32 v[96:97], v[96:97], v[90:91]
    v_pk_add_f32 v[96:97], v[96:97], v[92:93]
    v_pk_add_f32 v[96:97], v[96:97], v[94:95]
    v_add_f32 v96, v96, v97
    s_nop 1
    v_add_f32_dpp v96, v96, v96 row_ror:8 row_mask:0xf bank_mask:0xf
    v_mov_b32 v97, v96
    s_nop 1
    v_permlane16_swap_b32 v96, v97
    v_add_f32 v96, v96, v97
    v_mov_b32 v97, v96
    s_nop 1
    v_permlane32_swap_b32 v96, v97
    v_add_f32 v96, v96, v97
    v_mul_f32 v96, 0xbb800000, v96
    v_pk_add_f32 v[112:113], v[64:65], v[96:97] op_sel_hi:[1,0]
    v_pk_mul_f32 v[98:99], v[112:113], v[112:113]
    v_pk_add_f32 v[112:113], v[66:67], v[96:97] op_sel_hi:[1,0]
    v_pk_fma_f32 v[98:99], v[112:113], v[112:113], v[98:99]
    v_pk_add_f32 v[112:113], v[68:69], v[96:97] op_sel_hi:[1,0]
    v_pk_fma_f32 v[98:99], v[112:113], v[112:113], v[98:99]
    v_pk_add_f32 v[112:113], v[70:71], v[96:97] op_sel_hi:[1,0]
    v_pk_fma_f32 v[98:99], v[112:113], v[112:113], v[98:99]
    v_pk_add_f32 v[112:113], v[72:73], v[96:97] op_sel_hi:[1,0]
    v_pk_fma_f32 v[98:99], v[112:113], v[112:113], v[98:99]
    v_pk_add_f32 v[112:113], v[74:75], v[96:97] op_sel_hi:[1,0]
    v_pk_fma_f32 v[98:99], v[112:113], v[112:113], v[98:99]
    v_pk_add_f32 v[112:113], v[76:77], v[96:97] op_sel_hi:[1,0]
    v_pk_fma_f32 v[98:99], v[112:113], v[112:113], v[98:99]
    v_pk_add_f32 v[112:113], v[78:79], v[96:97] op_sel_hi:[1,0]
    v_pk_fma_f32 v[98:99], v[112:113], v[112:113], v[98:99]
    v_pk_add_f32 v[112:113], v[80:81], v[96:97] op_sel_hi:[1,0]
    v_pk_fma_f32 v[98:99], v[112:113], v[112:113], v[98:99]
    v_pk_add_f32 v[112:113], v[82:83], v[96:97] op_sel_hi:[1,0]
    v_pk_fma_f32 v[98:99], v[112:113], v[112:113], v[98:99]
    v_pk_add_f32 v[112:113], v[84:85], v[96:97] op_sel_hi:[1,0]
    v_pk_fma_f32 v[98:99], v[112:113], v[112:113], v[98:99]
    v_pk_add_f32 v[112:113], v[86:87], v[96:97] op_sel_hi:[1,0]
    v_pk_fma_f32 v[98:99], v[112:113], v[112:113], v[98:99]
    v_pk_add_f32 v[112:113], v[88:89], v[96:97] op_sel_hi:[1,0]
    v_pk_fma_f32 v[98:99], v[112:113], v[112:113], v[98:99]
    v_pk_add_f32 v[112:113], v[90:91], v[96:97] op_sel_hi:[1,0]
    v_pk_fma_f32 v[98:99], v[112:113], v[112:113], v[98:99]
    v_pk_add_f32 v[112:113], v[92:93], v[96:97] op_sel_hi:[1,0]
    v_pk_fma_f32 v[98:99], v[112:113], v[112:113], v[98:99]
    v_pk_add_f32 v[112:113], v[94:95], v[96:97] op_sel_hi:[1,0]
    v_pk_fma_f32 v[98:99], v[112:113], v[112:113], v[98:99]
    v_add_f32 v97, v98, v99
    s_nop 1
    v_add_f32_dpp v97, v97, v97 row_ror:8 row_mask:0xf bank_mask:0xf
    v_mov_b32 v98, v97
    s_nop 1
    v_permlane16_swap_b32 v97, v98
    v_add_f32 v97, v97, v98
    v_mov_b32 v98, v97
    s_nop 1
    v_permlane32_swap_b32 v97, v98
    v_add_f32 v97, v97, v98
    v_lshlrev_b32 v99, 5, v208
    v_lshl_add_u32 v98, v10, 3, v99
    ds_write_b64 v98, v[96:97]
    s_waitcnt lgkmcnt(0)
    s_barrier
L_join_5:
    ds_read_b128 v[112:115], v99
    ds_read_b128 v[116:119], v99 offset:16
    s_waitcnt lgkmcnt(0)
    v_pk_add_f32 v[96:97], v[112:113], v[114:115]
    v_pk_add_f32 v[98:99], v[116:117], v[118:119]
    v_pk_add_f32 v[96:97], v[96:97], v[98:99]
    v_mul_f32 v96, 0x3e800000, v96
    v_sub_f32 v98, v112, v96
    v_mul_f32 v99, v98, v98
    v_sub_f32 v98, v114, v96
    v_fmac_f32 v99, v98, v98
    v_sub_f32 v98, v116, v96
    v_fmac_f32 v99, v98, v98
    v_sub_f32 v98, v118, v96
    v_fmac_f32 v99, v98, v98
    v_fmac_f32 v97, 0x43800000, v99
    v_mul_f32 v97, 0x3a800000, v97
    v_cvt_pk_bf16_f32 v97, v96, v97
    v_lshlrev_b32 v96, 16, v97
    v_and_b32 v97, 0xffff0000, v97
    v_add_f32 v97, 0x3727c5ac, v97
    v_cvt_pk_bf16_f32 v97, v97, v97
    v_lshlrev_b32 v97, 16, v97
    v_sqrt_f32 v97, v97
    s_nop 0
    v_cvt_pk_bf16_f32 v97, v97, v97
    v_lshlrev_b32 v97, 16, v97
    v_rcp_f32 v97, v97
    s_nop 0
    v_pk_add_f32 v[64:65], v[64:65], v[96:97] op_sel_hi:[1,0]
    v_cvt_pk_bf16_f32 v65, v64, v65
    v_lshlrev_b32 v64, 16, v65
    v_and_b32 v65, 0xffff0000, v65
    v_pk_mul_f32 v[64:65], v[64:65], v[96:97] op_sel:[0,1] op_sel_hi:[1,1]
    v_cvt_pk_bf16_f32 v65, v64, v65
    v_lshlrev_b32 v64, 16, v65
    v_and_b32 v65, 0xffff0000, v65
    v_pk_add_f32 v[66:67], v[66:67], v[96:97] op_sel_hi:[1,0]
    v_cvt_pk_bf16_f32 v67, v66, v67
    v_lshlrev_b32 v66, 16, v67
    v_and_b32 v67, 0xffff0000, v67
    v_pk_mul_f32 v[66:67], v[66:67], v[96:97] op_sel:[0,1] op_sel_hi:[1,1]
    v_cvt_pk_bf16_f32 v67, v66, v67
    v_lshlrev_b32 v66, 16, v67
    v_and_b32 v67, 0xffff0000, v67
    v_pk_add_f32 v[68:69], v[68:69], v[96:97] op_sel_hi:[1,0]
    v_cvt_pk_bf16_f32 v69, v68, v69
    v_lshlrev_b32 v68, 16, v69
    v_and_b32 v69, 0xffff0000, v69
    v_pk_mul_f32 v[68:69], v[68:69], v[96:97] op_sel:[0,1] op_sel_hi:[1,1]
    v_cvt_pk_bf16_f32 v69, v68, v69
    v_lshlrev_b32 v68, 16, v69
    v_and_b32 v69, 0xffff0000, v69
    v_pk_add_f32 v[70:71], v[70:71], v[96:97] op_sel_hi:[1,0]
    v_cvt_pk_bf16_f32 v71, v70, v71
    v_lshlrev_b32 v70, 16, v71
    v_and_b32 v71, 0xffff0000, v71
    v_pk_mul_f32 v[70:71], v[70:71], v[96:97] op_sel:[0,1] op_sel_hi:[1,1]
    v_cvt_pk_bf16_f32 v71, v70, v71
    v_lshlrev_b32 v70, 16, v71
    v_and_b32 v71, 0xffff0000, v71
    v_pk_add_f32 v[72:73], v[72:73], v[96:97] op_sel_hi:[1,0]
    v_cvt_pk_bf16_f32 v73, v72, v73
    v_lshlrev_b32 v72, 16, v73
    v_and_b32 v73, 0xffff0000, v73
    v_pk_mul_f32 v[72:73], v[72:73], v[96:97] op_sel:[0,1] op_sel_hi:[1,1]
    v_cvt_pk_bf16_f32 v73, v72, v73
    v_lshlrev_b32 v72, 16, v73
    v_and_b32 v73, 0xffff0000, v73
    v_pk_add_f32 v[74:75], v[74:75], v[96:97] op_sel_hi:[1,0]
    v_cvt_pk_bf16_f32 v75, v74, v75
    v_lshlrev_b32 v74, 16, v75
    v_and_b32 v75, 0xffff0000, v75
    v_pk_mul_f32 v[74:75], v[74:75], v[96:97] op_sel:[0,1] op_sel_hi:[1,1]
    v_cvt_pk_bf16_f32 v75, v74, v75
    v_lshlrev_b32 v74, 16, v75
    v_and_b32 v75, 0xffff0000, v75
    v_pk_add_f32 v[76:77], v[76:77], v[96:97] op_sel_hi:[1,0]
    v_cvt_pk_bf16_f32 v77, v76, v77
    v_lshlrev_b32 v76, 16, v77
    v_and_b32 v77, 0xffff0000, v77
    v_pk_mul_f32 v[76:77], v[76:77], v[96:97] op_sel:[0,1] op_sel_hi:[1,1]
    v_cvt_pk_bf16_f32 v77, v76, v77
    v_lshlrev_b32 v76, 16, v77
    v_and_b32 v77, 0xffff0000, v77
    v_pk_add_f32 v[78:79], v[78:79], v[96:97] op_sel_hi:[1,0]
    v_cvt_pk_bf16_f32 v79, v78, v79
    v_lshlrev_b32 v78, 16, v79
    v_and_b32 v79, 0xffff0000, v79
    v_pk_mul_f32 v[78:79], v[78:79], v[96:97] op_sel:[0,1] op_sel_hi:[1,1]
    v_cvt_pk_bf16_f32 v79, v78, v79
    v_lshlrev_b32 v78, 16, v79
    v_and_b32 v79, 0xffff0000, v79
    v_pk_add_f32 v[80:81], v[80:81], v[96:97] op_sel_hi:[1,0]
    v_cvt_pk_bf16_f32 v81, v80, v81
    v_lshlrev_b32 v80, 16, v81
    v_and_b32 v81, 0xffff0000, v81
    v_pk_mul_f32 v[80:81], v[80:81], v[96:97] op_sel:[0,1] op_sel_hi:[1,1]
    v_cvt_pk_bf16_f32 v81, v80, v81
    v_lshlrev_b32 v80, 16, v81
    v_and_b32 v81, 0xffff0000, v81
    v_pk_add_f32 v[82:83], v[82:83], v[96:97] op_sel_hi:[1,0]
    v_cvt_pk_bf16_f32 v83, v82, v83
    v_lshlrev_b32 v82, 16, v83
    v_and_b32 v83, 0xffff0000, v83
    v_pk_mul_f32 v[82:83], v[82:83], v[96:97] op_sel:[0,1] op_sel_hi:[1,1]
    v_cvt_pk_bf16_f32 v83, v82, v83
    v_lshlrev_b32 v82, 16, v83
    v_and_b32 v83, 0xffff0000, v83
    v_pk_add_f32 v[84:85], v[84:85], v[96:97] op_sel_hi:[1,0]
    v_cvt_pk_bf16_f32 v85, v84, v85
    v_lshlrev_b32 v84, 16, v85
    v_and_b32 v85, 0xffff0000, v85
    v_pk_mul_f32 v[84:85], v[84:85], v[96:97] op_sel:[0,1] op_sel_hi:[1,1]
    v_cvt_pk_bf16_f32 v85, v84, v85
    v_lshlrev_b32 v84, 16, v85
    v_and_b32 v85, 0xffff0000, v85
    v_pk_add_f32 v[86:87], v[86:87], v[96:97] op_sel_hi:[1,0]
    v_cvt_pk_bf16_f32 v87, v86, v87
    v_lshlrev_b32 v86, 16, v87
    v_and_b32 v87, 0xffff0000, v87
    v_pk_mul_f32 v[86:87], v[86:87], v[96:97] op_sel:[0,1] op_sel_hi:[1,1]
    v_cvt_pk_bf16_f32 v87, v86, v87
    v_lshlrev_b32 v86, 16, v87
    v_and_b32 v87, 0xffff0000, v87
    v_pk_add_f32 v[88:89], v[88:89], v[96:97] op_sel_hi:[1,0]
    v_cvt_pk_bf16_f32 v89, v88, v89
    v_lshlrev_b32 v88, 16, v89
    v_and_b32 v89, 0xffff0000, v89
    v_pk_mul_f32 v[88:89], v[88:89], v[96:97] op_sel:[0,1] op_sel_hi:[1,1]
    v_cvt_pk_bf16_f32 v89, v88, v89
    v_lshlrev_b32 v88, 16, v89
    v_and_b32 v89, 0xffff0000, v89
    v_pk_add_f32 v[90:91], v[90:91], v[96:97] op_sel_hi:[1,0]
    v_cvt_pk_bf16_f32 v91, v90, v91
    v_lshlrev_b32 v90, 16, v91
    v_and_b32 v91, 0xffff0000, v91
    v_pk_mul_f32 v[90:91], v[90:91], v[96:97] op_sel:[0,1] op_sel_hi:[1,1]
    v_cvt_pk_bf16_f32 v91, v90, v91
    v_lshlrev_b32 v90, 16, v91
    v_and_b32 v91, 0xffff0000, v91
    v_pk_add_f32 v[92:93], v[92:93], v[96:97] op_sel_hi:[1,0]
    v_cvt_pk_bf16_f32 v93, v92, v93
    v_lshlrev_b32 v92, 16, v93
    v_and_b32 v93, 0xffff0000, v93
    v_pk_mul_f32 v[92:93], v[92:93], v[96:97] op_sel:[0,1] op_sel_hi:[1,1]
    v_cvt_pk_bf16_f32 v93, v92, v93
    v_lshlrev_b32 v92, 16, v93
    v_and_b32 v93, 0xffff0000, v93
    v_pk_add_f32 v[94:95], v[94:95], v[96:97] op_sel_hi:[1,0]
    v_cvt_pk_bf16_f32 v95, v94, v95
    v_lshlrev_b32 v94, 16, v95
    v_and_b32 v95, 0xffff0000, v95
    v_pk_mul_f32 v[94:95], v[94:95], v[96:97] op_sel:[0,1] op_sel_hi:[1,1]
    v_cvt_pk_bf16_f32 v95, v94, v95
    v_lshlrev_b32 v94, 16, v95
    v_and_b32 v95, 0xffff0000, v95
L_join_6:
    v_lshlrev_b32 v96, 3, v11
    v_lshl_add_u32 v96, v10, 10, v96
    v_add_u32 v96, 8192, v96
    v_lshrrev_b32 v98, 3, v11
    v_lshlrev_b32 v97, 4, v98
    v_lshl_add_u32 v97, v10, 10, v97
    v_lshl_add_u32 v98, v10, 5, v98
    v_lshlrev_b32 v98, 8, v98
    v_lshl_add_u32 v98, v208, 4, v98
    v_mov_b32 v210, s60
    s_lshr_b32 s46, s59, 1
    s_lshl_b32 s46, s46, 15
    s_and_b32 s47, s59, 1
    s_lshl_b32 s47, s47, 7
    s_add_u32 s46, s46, s47
    s_add_u32 s46, s46, 4194304
    s_add_u32 s47, s46, 4096
    s_lshl_b32 s44, s3, 10
    s_add_u32 s44, s44, 16384
    s_add_u32 s45, s44, 4096
    s_mov_b32 s48, 0
L_poll_7:
    buffer_load_dwordx4 v[16:19], v1, s[4:7], s44 offen sc1
    buffer_load_dwordx4 v[20:23], v1, s[4:7], s45 offen sc1
    buffer_load_dword v222, off, s[4:7], s42 sc1
    s_waitcnt vmcnt(0)
    v_xor_b32 v100, s60, v17
    v_xor_b32 v101, s60, v19
    v_or_b32 v100, v100, v101
    v_xor_b32 v101, s60, v21
    v_or_b32 v100, v100, v101
    v_xor_b32 v101, s60, v23
    v_or_b32 v100, v100, v101
    v_subrev_u32 v222, s60, v222
    v_lshrrev_b32 v101, 1, v222
    v_or_b32 v100, v100, v101
    v_cmp_ne_u32 vcc, 0, v100
    s_add_u32 s48, s48, 1
    s_cbranch_vccz L_gotmod_8
    s_cmp_lt_u32 s48, 65536
    s_cbranch_scc1 L_poll_7
L_gotmod_8:
    ds_write2_b32 v96, v16, v18 offset0:0 offset1:1
    ds_write2_b32 v96, v20, v22 offset0:128 offset1:129
    s_waitcnt lgkmcnt(0)
    ds_read_b128 v[128:131], v97 offset:8704
    ds_read_b128 v[112:115], v97 offset:8192
    ds_read_b128 v[132:135], v97 offset:8832
    ds_read_b128 v[116:119], v97 offset:8320
    ds_read_b128 v[136:139], v97 offset:8960
    ds_read_b128 v[120:123], v97 offset:8448
    ds_read_b128 v[140:143], v97 offset:9088
    ds_read_b128 v[124:127], v97 offset:8576
    s_lshl_b32 s44, s59, 2
    s_add_u32 s44, s44, s3
    s_lshl_b32 s44, s44, 7
    s_add_u32 s44, s44, 131072
    s_lshl_b32 s45, s54, 12
    s_add_u32 s45, s45, 131072
    v_and_b32 v212, 28, v11
    v_lshl_add_u32 v212, v212, 7, s45
    s_waitcnt lgkmcnt(6)
    v_lshlrev_b32 v102, 16, v128
    v_and_b32 v103, 0xffff0000, v128
    v_pk_mul_f32 v[64:65], v[64:65], v[102:103]
    v_cvt_pk_bf16_f32 v65, v64, v65
    v_lshlrev_b32 v64, 16, v65
    v_and_b32 v65, 0xffff0000, v65
    v_lshlrev_b32 v102, 16, v112
    v_and_b32 v103, 0xffff0000, v112
    v_pk_add_f32 v[64:65], v[64:65], v[102:103]
    v_cvt_pk_bf16_f32 v112, v64, v65
    v_lshlrev_b32 v102, 16, v129
    v_and_b32 v103, 0xffff0000, v129
    v_pk_mul_f32 v[66:67], v[66:67], v[102:103]
    v_cvt_pk_bf16_f32 v67, v66, v67
    v_lshlrev_b32 v66, 16, v67
    v_and_b32 v67, 0xffff0000, v67
    v_lshlrev_b32 v102, 16, v113
    v_and_b32 v103, 0xffff0000, v113
    v_pk_add_f32 v[66:67], v[66:67], v[102:103]
    v_cvt_pk_bf16_f32 v113, v66, v67
    v_lshlrev_b32 v102, 16, v130
    v_and_b32 v103, 0xffff0000, v130
    v_pk_mul_f32 v[68:69], v[68:69], v[102:103]
    v_cvt_pk_bf16_f32 v69, v68, v69
    v_lshlrev_b32 v68, 16, v69
    v_and_b32 v69, 0xffff0000, v69
    v_lshlrev_b32 v102, 16, v114
    v_and_b32 v103, 0xffff0000, v114
    v_pk_add_f32 v[68:69], v[68:69], v[102:103]
    v_cvt_pk_bf16_f32 v114, v68, v69
    v_lshlrev_b32 v102, 16, v131
    v_and_b32 v103, 0xffff0000, v131
    v_pk_mul_f32 v[70:71], v[70:71], v[102:103]
    v_cvt_pk_bf16_f32 v71, v70, v71
    v_lshlrev_b32 v70, 16, v71
    v_and_b32 v71, 0xffff0000, v71
    v_lshlrev_b32 v102, 16, v115
    v_and_b32 v103, 0xffff0000, v115
    v_pk_add_f32 v[70:71], v[70:71], v[102:103]
    v_cvt_pk_bf16_f32 v115, v70, v71
    buffer_store_dwordx4 v[112:115], v98, s[4:7], s46 offen offset:0 sc1
    s_waitcnt lgkmcnt(4)
    v_lshlrev_b32 v102, 16, v132
    v_and_b32 v103, 0xffff0000, v132
    v_pk_mul_f32 v[72:73], v[72:73], v[102:103]
    v_cvt_pk_bf16_f32 v73, v72, v73
    v_lshlrev_b32 v72, 16, v73
    v_and_b32 v73, 0xffff0000, v73
    v_lshlrev_b32 v102, 16, v116
    v_and_b32 v103, 0xffff0000, v116
    v_pk_add_f32 v[72:73], v[72:73], v[102:103]
    v_cvt_pk_bf16_f32 v116, v72, v73
    v_lshlrev_b32 v102, 16, v133
    v_and_b32 v103, 0xffff0000, v133
    v_pk_mul_f32 v[74:75], v[74:75], v[102:103]
    v_cvt_pk_bf16_f32 v75, v74, v75
    v_lshlrev_b32 v74, 16, v75
    v_and_b32 v75, 0xffff0000, v75
    v_lshlrev_b32 v102, 16, v117
    v_and_b32 v103, 0xffff0000, v117
    v_pk_add_f32 v[74:75], v[74:75], v[102:103]
    v_cvt_pk_bf16_f32 v117, v74, v75
    v_lshlrev_b32 v102, 16, v134
    v_and_b32 v103, 0xffff0000, v134
    v_pk_mul_f32 v[76:77], v[76:77], v[102:103]
    v_cvt_pk_bf16_f32 v77, v76, v77
    v_lshlrev_b32 v76, 16, v77
    v_and_b32 v77, 0xffff0000, v77
    v_lshlrev_b32 v102, 16, v118
    v_and_b32 v103, 0xffff0000, v118
    v_pk_add_f32 v[76:77], v[76:77], v[102:103]
    v_cvt_pk_bf16_f32 v118, v76, v77
    v_lshlrev_b32 v102, 16, v135
    v_and_b32 v103, 0xffff0000, v135
    v_pk_mul_f32 v[78:79], v[78:79], v[102:103]
    v_cvt_pk_bf16_f32 v79, v78, v79
    v_lshlrev_b32 v78, 16, v79
    v_and_b32 v79, 0xffff0000, v79
    v_lshlrev_b32 v102, 16, v119
    v_and_b32 v103, 0xffff0000, v119
    v_pk_add_f32 v[78:79], v[78:79], v[102:103]
    v_cvt_pk_bf16_f32 v119, v78, v79
    buffer_store_dwordx4 v[116:119], v98, s[4:7], s46 offen offset:2048 sc1
    s_waitcnt lgkmcnt(2)
    v_lshlrev_b32 v102, 16, v136
    v_and_b32 v103, 0xffff0000, v136
    v_pk_mul_f32 v[80:81], v[80:81], v[102:103]
    v_cvt_pk_bf16_f32 v81, v80, v81
    v_lshlrev_b32 v80, 16, v81
    v_and_b32 v81, 0xffff0000, v81
    v_lshlrev_b32 v102, 16, v120
    v_and_b32 v103, 0xffff0000, v120
    v_pk_add_f32 v[80:81], v[80:81], v[102:103]
    v_cvt_pk_bf16_f32 v120, v80, v81
    v_lshlrev_b32 v102, 16, v137
    v_and_b32 v103, 0xffff0000, v137
    v_pk_mul_f32 v[82:83], v[82:83], v[102:103]
    v_cvt_pk_bf16_f32 v83, v82, v83
    v_lshlrev_b32 v82, 16, v83
    v_and_b32 v83, 0xffff0000, v83
    v_lshlrev_b32 v102, 16, v121
    v_and_b32 v103, 0xffff0000, v121
    v_pk_add_f32 v[82:83], v[82:83], v[102:103]
    v_cvt_pk_bf16_f32 v121, v82, v83
    v_lshlrev_b32 v102, 16, v138
    v_and_b32 v103, 0xffff0000, v138
    v_pk_mul_f32 v[84:85], v[84:85], v[102:103]
    v_cvt_pk_bf16_f32 v85, v84, v85
    v_lshlrev_b32 v84, 16, v85
    v_and_b32 v85, 0xffff0000, v85
    v_lshlrev_b32 v102, 16, v122
    v_and_b32 v103, 0xffff0000, v122
    v_pk_add_f32 v[84:85], v[84:85], v[102:103]
    v_cvt_pk_bf16_f32 v122, v84, v85
    v_lshlrev_b32 v102, 16, v139
    v_and_b32 v103, 0xffff0000, v139
    v_pk_mul_f32 v[86:87], v[86:87], v[102:103]
    v_cvt_pk_bf16_f32 v87, v86, v87
    v_lshlrev_b32 v86, 16, v87
    v_and_b32 v87, 0xffff0000, v87
    v_lshlrev_b32 v102, 16, v123
    v_and_b32 v103, 0xffff0000, v123
    v_pk_add_f32 v[86:87], v[86:87], v[102:103]
    v_cvt_pk_bf16_f32 v123, v86, v87
    buffer_store_dwordx4 v[120:123], v98, s[4:7], s47 offen offset:0 sc1
    s_waitcnt lgkmcnt(0)
    v_lshlrev_b32 v102, 16, v140
    v_and_b32 v103, 0xffff0000, v140
    v_pk_mul_f32 v[88:89], v[88:89], v[102:103]
    v_cvt_pk_bf16_f32 v89, v88, v89
    v_lshlrev_b32 v88, 16, v89
    v_and_b32 v89, 0xffff0000, v89
    v_lshlrev_b32 v102, 16, v124
    v_and_b32 v103, 0xffff0000, v124
    v_pk_add_f32 v[88:89], v[88:89], v[102:103]
    v_cvt_pk_bf16_f32 v124, v88, v89
    v_lshlrev_b32 v102, 16, v141
    v_and_b32 v103, 0xffff0000, v141
    v_pk_mul_f32 v[90:91], v[90:91], v[102:103]
    v_cvt_pk_bf16_f32 v91, v90, v91
    v_lshlrev_b32 v90, 16, v91
    v_and_b32 v91, 0xffff0000, v91
    v_lshlrev_b32 v102, 16, v125
    v_and_b32 v103, 0xffff0000, v125
    v_pk_add_f32 v[90:91], v[90:91], v[102:103]
    v_cvt_pk_bf16_f32 v125, v90, v91
    v_lshlrev_b32 v102, 16, v142
    v_and_b32 v103, 0xffff0000, v142
    v_pk_mul_f32 v[92:93], v[92:93], v[102:103]
    v_cvt_pk_bf16_f32 v93, v92, v93
    v_lshlrev_b32 v92, 16, v93
    v_and_b32 v93, 0xffff0000, v93
    v_lshlrev_b32 v102, 16, v126
    v_and_b32 v103, 0xffff0000, v126
    v_pk_add_f32 v[92:93], v[92:93], v[102:103]
    v_cvt_pk_bf16_f32 v126, v92, v93
    v_lshlrev_b32 v102, 16, v143
    v_and_b32 v103, 0xffff0000, v143
    v_pk_mul_f32 v[94:95], v[94:95], v[102:103]
    v_cvt_pk_bf16_f32 v95, v94, v95
    v_lshlrev_b32 v94, 16, v95
    v_and_b32 v95, 0xffff0000, v95
    v_lshlrev_b32 v102, 16, v127
    v_and_b32 v103, 0xffff0000, v127
    v_pk_add_f32 v[94:95], v[94:95], v[102:103]
    v_cvt_pk_bf16_f32 v127, v94, v95
    buffer_store_dwordx4 v[124:127], v98, s[4:7], s47 offen offset:2048 sc1
    v_readfirstlane_b32 s41, v222
    s_mov_b32 s42, s44
    s_nop 2
    s_and_b32 s41, s41, 1
    s_xor_b32 s2, s2, s41
    s_and_b32 s44, s2, 7
    s_bfe_u32 s45, s2, 0x20003
    s_lshl_b32 s59, s53, 3
    s_add_u32 s59, s59, s44
    s_lshl_b32 s59, s59, 2
    s_add_u32 s59, s59, s45
    s_lshl_b32 s44, s44, 2
    s_lshr_b32 s52, 0x73625140, s44
    s_and_b32 s52, s52, 7
    s_lshl_b32 s52, s52, 2
    s_add_u32 s52, s52, s45
    s_and_b32 s58, s2, 1
    s_and_b32 s57, s2, 4
    s_add_u32 s57, s57, s45
    s_lshl_b32 s57, s57, 1
    s_add_u32 s57, s57, s58
    s_bfe_u32 s44, s2, 0x10001
    s_lshl_b32 s56, s53, 1
    s_add_u32 s56, s56, s44
    s_lshl_b32 s55, s56, 4
    s_add_u32 s55, s55, s57
    s_lshl_b32 s56, s56, 2
    s_add_u32 s56, s56, s3
    s_lshl_b32 s44, s52, 8
    s_add_u32 s8, s74, s44
    s_addc_u32 s9, s75, 0
    s_and_b32 s9, s9, 0xffff
    s_mov_b32 s10, 8380672
    s_mov_b32 s11, 0x20000
    s_mov_b32 s44, s42
    s_add_u32 m0, s61, 67584
    s_nop 0
    buffer_load_dwordx4 v2, s[8:11], s65 offen  lds
    s_add_u32 s65, s65, 8192
    s_add_u32 m0, s61, 68616
    s_nop 0
    buffer_load_dwordx4 v2, s[8:11], s65 offen  lds
    s_add_u32 s65, s65, 8192
    s_add_u32 m0, s61, 69696
    s_nop 0
    buffer_load_dwordx4 v2, s[8:11], s65 offen  lds
    s_add_u32 s65, s65, 8192
    s_add_u32 m0, s61, 70728
    s_nop 0
    buffer_load_dwordx4 v2, s[8:11], s65 offen  lds
    s_add_u32 s65, s65, 499712
    v_lshrrev_b32 v211, 5, v0
    v_lshlrev_b32 v211, 24, v211
    v_lshl_add_u32 v211, v11, 2, v211
    s_waitcnt vmcnt(4)
    s_barrier
    buffer_store_dword v210, v211, s[4:7], s44 offen sc1
    s_add_u32 m0, s61, 84480
    s_nop 0
    buffer_load_dwordx4 v2, s[8:11], s65 offen  lds
    s_add_u32 s65, s65, 8192
    s_add_u32 m0, s61, 85512
    s_nop 0
    buffer_load_dwordx4 v2, s[8:11], s65 offen  lds
    s_add_u32 s65, s65, 8192
    s_add_u32 m0, s61, 86592
    s_nop 0
    buffer_load_dwordx4 v2, s[8:11], s65 offen  lds
    s_add_u32 s65, s65, 8192
    s_add_u32 m0, s61, 87624
    s_nop 0
    buffer_load_dwordx4 v2, s[8:11], s65 offen  lds
    s_add_u32 s65, s65, 499712
    s_add_u32 m0, s61, 101376
    s_nop 0
    buffer_load_dwordx4 v2, s[8:11], s65 offen  lds
    s_add_u32 s65, s65, 8192
    s_add_u32 m0, s61, 102408
    s_nop 0
    buffer_load_dwordx4 v2, s[8:11], s65 offen  lds
    s_add_u32 s65, s65, 8192
    s_add_u32 m0, s61, 103488
    s_nop 0
    buffer_load_dwordx4 v2, s[8:11], s65 offen  lds
    s_add_u32 s65, s65, 8192
    s_add_u32 m0, s61, 104520
    s_nop 0
    buffer_load_dwordx4 v2, s[8:11], s65 offen  lds
    s_add_u32 s65, s65, 499712
    s_add_u32 m0, s61, 118272
    s_nop 0
    buffer_load_dwordx4 v2, s[8:11], s65 offen  lds
    s_add_u32 s65, s65, 8192
    s_add_u32 s67, s67, 2097152
    buffer_load_dword v253, v252, s[8:11], s67 offen
    s_add_u32 s67, s67, 2097152
    s_sub_u32 s44, s2, 64
    s_cmp_lt_u32 s44, 128
    s_cselect_b32 s44, 0, 16777216
    s_add_u32 s44, s44, 65536
    s_lshl_b32 s50, s50, 7
    s_add_u32 s50, s44, s50
    buffer_store_dword v210, v211, s[4:7], s50 offen sc1
    buffer_load_dword v213, v212, s[4:7], 0 offen sc1
    v_lshl_add_u32 v3, v10, 12, v1
    v_mul_u32_u24 v5, 1056, v13
    v_lshl_add_u32 v5, v12, 4, v5
    s_mov_b32 s63, 0
    s_mov_b32 s64, 0
    s_lshl_b32 s44, s52, 19
    s_lshl_b32 s45, s54, 14
    s_add_u32 s45, s45, s44
    s_add_u32 s45, s45, 16777216
    s_add_u32 s16, s70, s44
    s_addc_u32 s17, s71, 0
    s_and_b32 s17, s17, 0xffff
    s_mov_b32 s18, 524288
    s_mov_b32 s19, 0x20000
    s_add_u32 s20, s72, s44
    s_addc_u32 s21, s73, 0
    s_and_b32 s21, s21, 0xffff
    s_mov_b32 s22, 524288
    s_mov_b32 s23, 0x20000
    s_add_u32 s24, s96, s45
    s_addc_u32 s25, s97, 0
    s_and_b32 s25, s25, 0xffff
    s_mov_b32 s26, 16384
    s_mov_b32 s27, 0x20000
    v_and_b32 v14, 1, v11
    v_mul_u32_u24 v15, 0xaaaa, v14
    v_add_u32 v15, 0x4444, v15
    v_lshl_add_u32 v228, v15, 16, v15
    v_lshrrev_b32 v15, 1, v11
    v_mul_u32_u24 v248, 7168, v15
    v_lshl_add_u32 v248, v14, 4, v248
    v_lshrrev_b32 v15, 1, v11
    v_lshlrev_b32 v249, 11, v15
    v_and_b32 v15, 1, v11
    v_lshl_add_u32 v249, v15, 7, v249
    v_lshrrev_b32 v15, 4, v11
    v_lshl_add_u32 v249, v15, 24, v249
    s_lshl_b32 s44, s55, 15
    s_mul_i32 s45, s3, 7168
    s_add_u32 s44, s44, s45
    s_add_u32 s44, s44, 8388608
    v_add_u32 v251, s44, v1
    s_xor_b32 s45, s59, 4
    s_min_u32 s45, s45, 223
    s_lshl_b32 s45, s45, 15
    s_cmp_lt_u32 s2, 224
    s_cselect_b32 s46, 32768, 0
    s_add_u32 s36, s86, s45
    s_addc_u32 s37, s87, 0
    s_and_b32 s37, s37, 0xffff
    s_mov_b32 s38, s46
    s_mov_b32 s39, 0x20000
    s_lshl_b32 s45, s57, 8
    s_add_u32 s45, s45, 73728
    v_bfe_u32 v229, v11, 1, 2
    v_lshlrev_b32 v229, 12, v229
    v_and_b32 v14, 1, v11
    v_lshl_add_u32 v229, v14, 7, v229
    v_add_u32 v229, s45, v229
    v_and_b32 v254, 3, v11
    v_lshlrev_b32 v254, 7, v254
    s_mul_i32 s47, s54, 512
    v_add_u32 v6, 0, v1
    v_add_u32 v7, 32768, v1
    v_add_u32 v8, 65536, v1
    v_add_u32 v9, 98304, v1
    s_lshl_b32 s44, s54, 17
    s_add_u32 s44, s44, 4194304
    s_mov_b32 s66, 0
    s_add_u32 s12, s96, s44
    s_addc_u32 s13, s97, 0
    s_and_b32 s13, s13, 0xffff
    s_mov_b32 s14, 131072
    s_mov_b32 s15, 0x20000
    v_lshrrev_b32 v15, 3, v11
    v_and_b32 v14, 7, v11
    v_lshlrev_b32 v14, 4, v14
    v_lshl_add_u32 v14, v15, 11, v14
    v_lshlrev_b32 v15, 12, v12
    v_lshl_add_u32 v15, v13, 4, v15
    s_lshl_b32 s44, s57, 7
    s_lshl_b32 s45, s56, 16
    s_add_u32 s45, s45, s44
    s_add_u32 s28, s68, s45
    s_addc_u32 s29, s69, 0
    s_and_b32 s29, s29, 0xffff
    s_mov_b32 s30, 63616
    s_mov_b32 s31, 0x20000
    s_add_u32 s32, s80, s44
    s_addc_u32 s33, s81, 0
    s_and_b32 s33, s33, 0xffff
    s_mov_b32 s34, 128
    s_mov_b32 s35, 0x20000
    s_lshl_b32 s45, s57, 8
    s_add_u32 s45, s45, 393216
    s_mul_i32 s44, s3, 6528
    s_add_u32 s44, s44, 135232
    s_mov_b32 s46, 0
    s_mov_b32 s48, 0
    s_waitcnt vmcnt(0)
    s_branch L_chk_12
L_poll_10:
    buffer_load_dword v213, v212, s[4:7], 0 offen sc1
    s_waitcnt vmcnt(0)
L_chk_12:
    v_cmp_ne_u32 vcc, s60, v213
    s_add_u32 s48, s48, 1
    s_cbranch_vccz L_goth_11
    s_cmp_lt_u32 s48, 65536
    s_cbranch_scc1 L_poll_10
L_goth_11:
    buffer_load_dwordx4 v[160:163], v6, s[12:15], s66 offen offset:0 sc1
    buffer_load_dwordx4 v[164:167], v6, s[12:15], s66 offen offset:1024 sc1
    buffer_load_dwordx4 v[168:171], v7, s[12:15], s66 offen offset:0 sc1
    buffer_load_dwordx4 v[172:175], v7, s[12:15], s66 offen offset:1024 sc1
    buffer_load_dwordx4 v[176:179], v8, s[12:15], s66 offen offset:0 sc1
    buffer_load_dwordx4 v[180:183], v8, s[12:15], s66 offen offset:1024 sc1
    buffer_load_dwordx4 v[184:187], v9, s[12:15], s66 offen offset:0 sc1
    buffer_load_dwordx4 v[188:191], v9, s[12:15], s66 offen offset:1024 sc1
    s_add_u32 s66, s66, 2048
    s_waitcnt lgkmcnt(0)
    s_barrier
    v_mov_b64 v[16:17], 0
    v_mov_b64 v[18:19], 0
    v_mov_b64 v[20:21], 0
    v_mov_b64 v[22:23], 0
    v_mov_b64 v[24:25], 0
    v_mov_b64 v[26:27], 0
    v_mov_b64 v[28:29], 0
    v_mov_b64 v[30:31], 0
    v_mov_b64 v[32:33], 0
    v_mov_b64 v[34:35], 0
    v_mov_b64 v[36:37], 0
    v_mov_b64 v[38:39], 0
    v_mov_b64 v[40:41], 0
    v_mov_b64 v[42:43], 0
    v_mov_b64 v[44:45], 0
    v_mov_b64 v[46:47], 0
    v_mov_b64 v[48:49], 0
    v_mov_b64 v[50:51], 0
    v_mov_b64 v[52:53], 0
    v_mov_b64 v[54:55], 0
    v_mov_b64 v[56:57], 0
    v_mov_b64 v[58:59], 0
    v_mov_b64 v[60:61], 0
    v_mov_b64 v[62:63], 0
    v_mov_b64 v[64:65], 0
    v_mov_b64 v[66:67], 0
    v_mov_b64 v[68:69], 0
    v_mov_b64 v[70:71], 0
    v_mov_b64 v[72:73], 0
    v_mov_b64 v[74:75], 0
    v_mov_b64 v[76:77], 0
    v_mov_b64 v[78:79], 0
    v_mov_b64 v[80:81], 0
    v_mov_b64 v[82:83], 0
    v_mov_b64 v[84:85], 0
    v_mov_b64 v[86:87], 0
    v_mov_b64 v[88:89], 0
    v_mov_b64 v[90:91], 0
    v_mov_b64 v[92:93], 0
    v_mov_b64 v[94:95], 0
    v_mov_b64 v[96:97], 0
    v_mov_b64 v[98:99], 0
    v_mov_b64 v[100:101], 0
    v_mov_b64 v[102:103], 0
    v_mov_b64 v[104:105], 0
    v_mov_b64 v[106:107], 0
    v_mov_b64 v[108:109], 0
    v_mov_b64 v[110:111], 0
    v_mov_b64 v[112:113], 0
    v_mov_b64 v[114:115], 0
    v_mov_b64 v[116:117], 0
    v_mov_b64 v[118:119], 0
    v_mov_b64 v[120:121], 0
    v_mov_b64 v[122:123], 0
    v_mov_b64 v[124:125], 0
    v_mov_b64 v[126:127], 0
    v_mov_b64 v[128:129], 0
    v_mov_b64 v[130:131], 0
    v_mov_b64 v[132:133], 0
    v_mov_b64 v[134:135], 0
    v_mov_b64 v[136:137], 0
    v_mov_b64 v[138:139], 0
    v_mov_b64 v[140:141], 0
    v_mov_b64 v[142:143], 0
    ds_read_b64_tr_b16 v[144:145], v231 offset:0
    ds_read_b64_tr_b16 v[146:147], v231 offset:256
    ds_read_b64_tr_b16 v[148:149], v231 offset:512
    ds_read_b64_tr_b16 v[150:151], v231 offset:768
    buffer_load_dwordx4 v[192:195], v6, s[12:15], s66 offen offset:0 sc1
    buffer_load_dwordx4 v[196:199], v6, s[12:15], s66 offen offset:1024 sc1
    buffer_load_dwordx4 v[200:203], v7, s[12:15], s66 offen offset:0 sc1
    buffer_load_dwordx4 v[204:207], v7, s[12:15], s66 offen offset:1024 sc1
    buffer_load_dwordx4 v[208:211], v8, s[12:15], s66 offen offset:0 sc1
    buffer_load_dwordx4 v[212:215], v8, s[12:15], s66 offen offset:1024 sc1
    buffer_load_dwordx4 v[216:219], v9, s[12:15], s66 offen offset:0 sc1
    buffer_load_dwordx4 v[220:223], v9, s[12:15], s66 offen offset:1024 sc1
    s_add_u32 s66, s66, 2048
    s_waitcnt vmcnt(8) lgkmcnt(0)
    s_mov_b32 s49, 0
L_qproj_13:
    v_mfma_f32_16x16x32_bf16 v[16:19], v[144:147], v[160:163], v[16:19]
    ds_read_b64_tr_b16 v[152:153], v231 offset:8
    ds_read_b64_tr_b16 v[154:155], v231 offset:264
    v_mfma_f32_16x16x32_bf16 v[16:19], v[148:151], v[164:167], v[16:19]
    ds_read_b64_tr_b16 v[156:157], v231 offset:520
    ds_read_b64_tr_b16 v[158:159], v231 offset:776
    v_mfma_f32_16x16x32_bf16 v[48:51], v[148:151], v[172:175], v[48:51]
    v_mfma_f32_16x16x32_bf16 v[48:51], v[144:147], v[168:171], v[48:51]
    buffer_load_dwordx4 v[232:235], v6, s[12:15], s66 offen offset:0 sc1
    v_mfma_f32_16x16x32_bf16 v[80:83], v[144:147], v[176:179], v[80:83]
    v_mfma_f32_16x16x32_bf16 v[80:83], v[148:151], v[180:183], v[80:83]
    buffer_load_dword v253, v252, s[8:11], s67 offen
    v_mfma_f32_16x16x32_bf16 v[112:115], v[148:151], v[188:191], v[112:115]
    s_add_u32 s67, s67, 2097152
    v_mfma_f32_16x16x32_bf16 v[112:115], v[144:147], v[184:187], v[112:115]
    s_waitcnt lgkmcnt(0)
    v_mfma_f32_16x16x32_bf16 v[116:119], v[156:159], v[188:191], v[116:119]
    ds_read_b64_tr_b16 v[144:145], v231 offset:64
    ds_read_b64_tr_b16 v[146:147], v231 offset:320
    v_mfma_f32_16x16x32_bf16 v[116:119], v[152:155], v[184:187], v[116:119]
    ds_read_b64_tr_b16 v[148:149], v231 offset:576
    ds_read_b64_tr_b16 v[150:151], v231 offset:832
    v_mfma_f32_16x16x32_bf16 v[84:87], v[152:155], v[176:179], v[84:87]
    v_mfma_f32_16x16x32_bf16 v[84:87], v[156:159], v[180:183], v[84:87]
    buffer_load_dwordx4 v[236:239], v6, s[12:15], s66 offen offset:1024 sc1
    v_mfma_f32_16x16x32_bf16 v[52:55], v[156:159], v[172:175], v[52:55]
    s_add_u32 m0, s61, 119304
    v_mfma_f32_16x16x32_bf16 v[52:55], v[152:155], v[168:171], v[52:55]
    buffer_load_dwordx4 v2, s[8:11], s65 offen  lds
    v_mfma_f32_16x16x32_bf16 v[20:23], v[152:155], v[160:163], v[20:23]
    s_add_u32 s65, s65, 8192
    v_mfma_f32_16x16x32_bf16 v[20:23], v[156:159], v[164:167], v[20:23]
    s_waitcnt lgkmcnt(0)
    v_mfma_f32_16x16x32_bf16 v[24:27], v[144:147], v[160:163], v[24:27]
    ds_read_b64_tr_b16 v[152:153], v231 offset:72
    ds_read_b64_tr_b16 v[154:155], v231 offset:328
    v_mfma_f32_16x16x32_bf16 v[24:27], v[148:151], v[164:167], v[24:27]
    ds_read_b64_tr_b16 v[156:157], v231 offset:584
    ds_read_b64_tr_b16 v[158:159], v231 offset:840
    v_mfma_f32_16x16x32_bf16 v[56:59], v[148:151], v[172:175], v[56:59]
    v_mfma_f32_16x16x32_bf16 v[56:59], v[144:147], v[168:171], v[56:59]
    buffer_load_dwordx4 v[240:243], v7, s[12:15], s66 offen offset:0 sc1
    v_mfma_f32_16x16x32_bf16 v[88:91], v[144:147], v[176:179], v[88:91]
    v_mfma_f32_16x16x32_bf16 v[88:91], v[148:151], v[180:183], v[88:91]
    v_mfma_f32_16x16x32_bf16 v[120:123], v[148:151], v[188:191], v[120:123]
    v_mfma_f32_16x16x32_bf16 v[120:123], v[144:147], v[184:187], v[120:123]
    s_waitcnt lgkmcnt(0)
    v_mfma_f32_16x16x32_bf16 v[124:127], v[156:159], v[188:191], v[124:127]
    ds_read_b64_tr_b16 v[144:145], v231 offset:128
    ds_read_b64_tr_b16 v[146:147], v231 offset:384
    v_mfma_f32_16x16x32_bf16 v[124:127], v[152:155], v[184:187], v[124:127]
    ds_read_b64_tr_b16 v[148:149], v231 offset:640
    ds_read_b64_tr_b16 v[150:151], v231 offset:896
    v_mfma_f32_16x16x32_bf16 v[92:95], v[152:155], v[176:179], v[92:95]
    v_mfma_f32_16x16x32_bf16 v[92:95], v[156:159], v[180:183], v[92:95]
    buffer_load_dwordx4 v[244:247], v7, s[12:15], s66 offen offset:1024 sc1
    v_mfma_f32_16x16x32_bf16 v[60:63], v[156:159], v[172:175], v[60:63]
    s_add_u32 m0, s61, 120384
    v_mfma_f32_16x16x32_bf16 v[60:63], v[152:155], v[168:171], v[60:63]
    buffer_load_dwordx4 v2, s[8:11], s65 offen  lds
    v_mfma_f32_16x16x32_bf16 v[28:31], v[152:155], v[160:163], v[28:31]
    s_add_u32 s65, s65, 8192
    v_mfma_f32_16x16x32_bf16 v[28:31], v[156:159], v[164:167], v[28:31]
    s_waitcnt lgkmcnt(0)
    v_mfma_f32_16x16x32_bf16 v[32:35], v[144:147], v[160:163], v[32:35]
    ds_read_b64_tr_b16 v[152:153], v231 offset:136
    ds_read_b64_tr_b16 v[154:155], v231 offset:392
    v_mfma_f32_16x16x32_bf16 v[32:35], v[148:151], v[164:167], v[32:35]
    ds_read_b64_tr_b16 v[156:157], v231 offset:648
    ds_read_b64_tr_b16 v[158:159], v231 offset:904
    v_mfma_f32_16x16x32_bf16 v[64:67], v[148:151], v[172:175], v[64:67]
    v_mfma_f32_16x16x32_bf16 v[64:67], v[144:147], v[168:171], v[64:67]
    buffer_load_dwordx4 a[144:147], v8, s[12:15], s66 offen offset:0 sc1
    v_mfma_f32_16x16x32_bf16 v[96:99], v[144:147], v[176:179], v[96:99]
    v_mfma_f32_16x16x32_bf16 v[96:99], v[148:151], v[180:183], v[96:99]
    v_mfma_f32_16x16x32_bf16 v[128:131], v[148:151], v[188:191], v[128:131]
    v_mfma_f32_16x16x32_bf16 v[128:131], v[144:147], v[184:187], v[128:131]
    s_waitcnt lgkmcnt(0)
    v_mfma_f32_16x16x32_bf16 v[132:135], v[156:159], v[188:191], v[132:135]
    ds_read_b64_tr_b16 v[144:145], v231 offset:192
    ds_read_b64_tr_b16 v[146:147], v231 offset:448
    v_mfma_f32_16x16x32_bf16 v[132:135], v[152:155], v[184:187], v[132:135]
    ds_read_b64_tr_b16 v[148:149], v231 offset:704
    ds_read_b64_tr_b16 v[150:151], v231 offset:960
    v_mfma_f32_16x16x32_bf16 v[100:103], v[152:155], v[176:179], v[100:103]
    v_mfma_f32_16x16x32_bf16 v[100:103], v[156:159], v[180:183], v[100:103]
    buffer_load_dwordx4 a[148:151], v8, s[12:15], s66 offen offset:1024 sc1
    v_mfma_f32_16x16x32_bf16 v[68:71], v[156:159], v[172:175], v[68:71]
    s_add_u32 m0, s61, 121416
    v_mfma_f32_16x16x32_bf16 v[68:71], v[152:155], v[168:171], v[68:71]
    buffer_load_dwordx4 v2, s[8:11], s65 offen  lds
    v_mfma_f32_16x16x32_bf16 v[36:39], v[152:155], v[160:163], v[36:39]
    s_add_u32 s65, s65, 499712
    v_mfma_f32_16x16x32_bf16 v[36:39], v[156:159], v[164:167], v[36:39]
    s_waitcnt lgkmcnt(0)
    v_mfma_f32_16x16x32_bf16 v[40:43], v[144:147], v[160:163], v[40:43]
    ds_read_b64_tr_b16 v[152:153], v231 offset:200
    ds_read_b64_tr_b16 v[154:155], v231 offset:456
    v_mfma_f32_16x16x32_bf16 v[40:43], v[148:151], v[164:167], v[40:43]
    ds_read_b64_tr_b16 v[156:157], v231 offset:712
    ds_read_b64_tr_b16 v[158:159], v231 offset:968
    v_mfma_f32_16x16x32_bf16 v[72:75], v[148:151], v[172:175], v[72:75]
    v_mfma_f32_16x16x32_bf16 v[72:75], v[144:147], v[168:171], v[72:75]
    buffer_load_dwordx4 a[152:155], v9, s[12:15], s66 offen offset:0 sc1
    v_mfma_f32_16x16x32_bf16 v[104:107], v[144:147], v[176:179], v[104:107]
    v_mfma_f32_16x16x32_bf16 v[104:107], v[148:151], v[180:183], v[104:107]
    v_mfma_f32_16x16x32_bf16 v[136:139], v[148:151], v[188:191], v[136:139]
    v_mfma_f32_16x16x32_bf16 v[136:139], v[144:147], v[184:187], v[136:139]
    s_waitcnt vmcnt(11) lgkmcnt(0)
    s_barrier
    v_mfma_f32_16x16x32_bf16 v[140:143], v[156:159], v[188:191], v[140:143]
    ds_read_b64_tr_b16 v[144:145], v231 offset:16896
    ds_read_b64_tr_b16 v[146:147], v231 offset:17152
    v_mfma_f32_16x16x32_bf16 v[140:143], v[152:155], v[184:187], v[140:143]
    ds_read_b64_tr_b16 v[148:149], v231 offset:17408
    ds_read_b64_tr_b16 v[150:151], v231 offset:17664
    v_mfma_f32_16x16x32_bf16 v[108:111], v[152:155], v[176:179], v[108:111]
    v_mfma_f32_16x16x32_bf16 v[108:111], v[156:159], v[180:183], v[108:111]
    buffer_load_dwordx4 a[156:159], v9, s[12:15], s66 offen offset:1024 sc1
    v_mfma_f32_16x16x32_bf16 v[76:79], v[156:159], v[172:175], v[76:79]
    s_add_u32 m0, s61, 67584
    s_add_u32 s66, s66, 2048
    v_mfma_f32_16x16x32_bf16 v[76:79], v[152:155], v[168:171], v[76:79]
    buffer_load_dwordx4 v2, s[8:11], s65 offen  lds
    v_mfma_f32_16x16x32_bf16 v[44:47], v[152:155], v[160:163], v[44:47]
    s_add_u32 s65, s65, 8192
    v_mfma_f32_16x16x32_bf16 v[44:47], v[156:159], v[164:167], v[44:47]
    s_waitcnt lgkmcnt(0)
    v_mfma_f32_16x16x32_bf16 v[16:19], v[144:147], v[192:195], v[16:19]
    ds_read_b64_tr_b16 v[152:153], v231 offset:16904
    ds_read_b64_tr_b16 v[154:155], v231 offset:17160
    v_mfma_f32_16x16x32_bf16 v[16:19], v[148:151], v[196:199], v[16:19]
    ds_read_b64_tr_b16 v[156:157], v231 offset:17416
    ds_read_b64_tr_b16 v[158:159], v231 offset:17672
    v_mfma_f32_16x16x32_bf16 v[48:51], v[148:151], v[204:207], v[48:51]
    v_mfma_f32_16x16x32_bf16 v[48:51], v[144:147], v[200:203], v[48:51]
    buffer_load_dwordx4 a[160:163], v6, s[12:15], s66 offen offset:0 sc1
    v_mfma_f32_16x16x32_bf16 v[80:83], v[144:147], v[208:211], v[80:83]
    v_mfma_f32_16x16x32_bf16 v[80:83], v[148:151], v[212:215], v[80:83]
    v_mfma_f32_16x16x32_bf16 v[112:115], v[148:151], v[220:223], v[112:115]
    v_mfma_f32_16x16x32_bf16 v[112:115], v[144:147], v[216:219], v[112:115]
    s_waitcnt lgkmcnt(0)
    v_mfma_f32_16x16x32_bf16 v[116:119], v[156:159], v[220:223], v[116:119]
    ds_read_b64_tr_b16 v[144:145], v231 offset:16960
    ds_read_b64_tr_b16 v[146:147], v231 offset:17216
    v_mfma_f32_16x16x32_bf16 v[116:119], v[152:155], v[216:219], v[116:119]
    ds_read_b64_tr_b16 v[148:149], v231 offset:17472
    ds_read_b64_tr_b16 v[150:151], v231 offset:17728
    v_mfma_f32_16x16x32_bf16 v[84:87], v[152:155], v[208:211], v[84:87]
    v_mfma_f32_16x16x32_bf16 v[84:87], v[156:159], v[212:215], v[84:87]
    buffer_load_dwordx4 a[164:167], v6, s[12:15], s66 offen offset:1024 sc1
    v_mfma_f32_16x16x32_bf16 v[52:55], v[156:159], v[204:207], v[52:55]
    s_add_u32 m0, s61, 68616
    v_mfma_f32_16x16x32_bf16 v[52:55], v[152:155], v[200:203], v[52:55]
    buffer_load_dwordx4 v2, s[8:11], s65 offen  lds
    v_mfma_f32_16x16x32_bf16 v[20:23], v[152:155], v[192:195], v[20:23]
    s_add_u32 s65, s65, 8192
    v_mfma_f32_16x16x32_bf16 v[20:23], v[156:159], v[196:199], v[20:23]
    s_waitcnt lgkmcnt(0)
    v_mfma_f32_16x16x32_bf16 v[24:27], v[144:147], v[192:195], v[24:27]
    ds_read_b64_tr_b16 v[152:153], v231 offset:16968
    ds_read_b64_tr_b16 v[154:155], v231 offset:17224
    v_mfma_f32_16x16x32_bf16 v[24:27], v[148:151], v[196:199], v[24:27]
    ds_read_b64_tr_b16 v[156:157], v231 offset:17480
    ds_read_b64_tr_b16 v[158:159], v231 offset:17736
    v_mfma_f32_16x16x32_bf16 v[56:59], v[148:151], v[204:207], v[56:59]
    v_mfma_f32_16x16x32_bf16 v[56:59], v[144:147], v[200:203], v[56:59]
    buffer_load_dwordx4 a[168:171], v7, s[12:15], s66 offen offset:0 sc1
    v_mfma_f32_16x16x32_bf16 v[88:91], v[144:147], v[208:211], v[88:91]
    v_mfma_f32_16x16x32_bf16 v[88:91], v[148:151], v[212:215], v[88:91]
    v_mfma_f32_16x16x32_bf16 v[120:123], v[148:151], v[220:223], v[120:123]
    v_mfma_f32_16x16x32_bf16 v[120:123], v[144:147], v[216:219], v[120:123]
    s_waitcnt lgkmcnt(0)
    v_mfma_f32_16x16x32_bf16 v[124:127], v[156:159], v[220:223], v[124:127]
    ds_read_b64_tr_b16 v[144:145], v231 offset:17024
    ds_read_b64_tr_b16 v[146:147], v231 offset:17280
    v_mfma_f32_16x16x32_bf16 v[124:127], v[152:155], v[216:219], v[124:127]
    ds_read_b64_tr_b16 v[148:149], v231 offset:17536
    ds_read_b64_tr_b16 v[150:151], v231 offset:17792
    v_mfma_f32_16x16x32_bf16 v[92:95], v[152:155], v[208:211], v[92:95]
    v_mfma_f32_16x16x32_bf16 v[92:95], v[156:159], v[212:215], v[92:95]
    buffer_load_dwordx4 a[172:175], v7, s[12:15], s66 offen offset:1024 sc1
    v_mfma_f32_16x16x32_bf16 v[60:63], v[156:159], v[204:207], v[60:63]
    s_add_u32 m0, s61, 69696
    v_mfma_f32_16x16x32_bf16 v[60:63], v[152:155], v[200:203], v[60:63]
    buffer_load_dwordx4 v2, s[8:11], s65 offen  lds
    v_mfma_f32_16x16x32_bf16 v[28:31], v[152:155], v[192:195], v[28:31]
    s_add_u32 s65, s65, 8192
    v_mfma_f32_16x16x32_bf16 v[28:31], v[156:159], v[196:199], v[28:31]
    s_waitcnt lgkmcnt(0)
    v_mfma_f32_16x16x32_bf16 v[32:35], v[144:147], v[192:195], v[32:35]
    ds_read_b64_tr_b16 v[152:153], v231 offset:17032
    ds_read_b64_tr_b16 v[154:155], v231 offset:17288
    v_mfma_f32_16x16x32_bf16 v[32:35], v[148:151], v[196:199], v[32:35]
    ds_read_b64_tr_b16 v[156:157], v231 offset:17544
    ds_read_b64_tr_b16 v[158:159], v231 offset:17800
    v_mfma_f32_16x16x32_bf16 v[64:67], v[148:151], v[204:207], v[64:67]
    v_mfma_f32_16x16x32_bf16 v[64:67], v[144:147], v[200:203], v[64:67]
    buffer_load_dwordx4 a[176:179], v8, s[12:15], s66 offen offset:0 sc1
    v_mfma_f32_16x16x32_bf16 v[96:99], v[144:147], v[208:211], v[96:99]
    v_mfma_f32_16x16x32_bf16 v[96:99], v[148:151], v[212:215], v[96:99]
    v_mfma_f32_16x16x32_bf16 v[128:131], v[148:151], v[220:223], v[128:131]
    v_mfma_f32_16x16x32_bf16 v[128:131], v[144:147], v[216:219], v[128:131]
    s_waitcnt lgkmcnt(0)
    v_mfma_f32_16x16x32_bf16 v[132:135], v[156:159], v[220:223], v[132:135]
    ds_read_b64_tr_b16 v[144:145], v231 offset:17088
    ds_read_b64_tr_b16 v[146:147], v231 offset:17344
    v_mfma_f32_16x16x32_bf16 v[132:135], v[152:155], v[216:219], v[132:135]
    ds_read_b64_tr_b16 v[148:149], v231 offset:17600
    ds_read_b64_tr_b16 v[150:151], v231 offset:17856
    v_mfma_f32_16x16x32_bf16 v[100:103], v[152:155], v[208:211], v[100:103]
    v_mfma_f32_16x16x32_bf16 v[100:103], v[156:159], v[212:215], v[100:103]
    buffer_load_dwordx4 a[180:183], v8, s[12:15], s66 offen offset:1024 sc1
    v_mfma_f32_16x16x32_bf16 v[68:71], v[156:159], v[204:207], v[68:71]
    s_add_u32 m0, s61, 70728
    v_mfma_f32_16x16x32_bf16 v[68:71], v[152:155], v[200:203], v[68:71]
    buffer_load_dwordx4 v2, s[8:11], s65 offen  lds
    v_mfma_f32_16x16x32_bf16 v[36:39], v[152:155], v[192:195], v[36:39]
    s_add_u32 s65, s65, 499712
    v_mfma_f32_16x16x32_bf16 v[36:39], v[156:159], v[196:199], v[36:39]
    s_waitcnt lgkmcnt(0)
    v_mfma_f32_16x16x32_bf16 v[40:43], v[144:147], v[192:195], v[40:43]
    ds_read_b64_tr_b16 v[152:153], v231 offset:17096
    ds_read_b64_tr_b16 v[154:155], v231 offset:17352
    v_mfma_f32_16x16x32_bf16 v[40:43], v[148:151], v[196:199], v[40:43]
    ds_read_b64_tr_b16 v[156:157], v231 offset:17608
    ds_read_b64_tr_b16 v[158:159], v231 offset:17864
    v_mfma_f32_16x16x32_bf16 v[72:75], v[148:151], v[204:207], v[72:75]
    v_mfma_f32_16x16x32_bf16 v[72:75], v[144:147], v[200:203], v[72:75]
    buffer_load_dwordx4 a[184:187], v9, s[12:15], s66 offen offset:0 sc1
    v_mfma_f32_16x16x32_bf16 v[104:107], v[144:147], v[208:211], v[104:107]
    v_mfma_f32_16x16x32_bf16 v[104:107], v[148:151], v[212:215], v[104:107]
    v_mfma_f32_16x16x32_bf16 v[136:139], v[148:151], v[220:223], v[136:139]
    v_mfma_f32_16x16x32_bf16 v[136:139], v[144:147], v[216:219], v[136:139]
    s_waitcnt vmcnt(11) lgkmcnt(0)
    s_barrier
    v_mfma_f32_16x16x32_bf16 v[140:143], v[156:159], v[220:223], v[140:143]
    ds_read_b64_tr_b16 v[144:145], v231 offset:33792
    ds_read_b64_tr_b16 v[146:147], v231 offset:34048
    v_mfma_f32_16x16x32_bf16 v[140:143], v[152:155], v[216:219], v[140:143]
    ds_read_b64_tr_b16 v[148:149], v231 offset:34304
    ds_read_b64_tr_b16 v[150:151], v231 offset:34560
    v_mfma_f32_16x16x32_bf16 v[108:111], v[152:155], v[208:211], v[108:111]
    v_mfma_f32_16x16x32_bf16 v[108:111], v[156:159], v[212:215], v[108:111]
    buffer_load_dwordx4 a[188:191], v9, s[12:15], s66 offen offset:1024 sc1
    v_mfma_f32_16x16x32_bf16 v[76:79], v[156:159], v[204:207], v[76:79]
    s_add_u32 m0, s61, 84480
    s_add_u32 s66, s66, 2048
    v_mfma_f32_16x16x32_bf16 v[76:79], v[152:155], v[200:203], v[76:79]
    buffer_load_dwordx4 v2, s[8:11], s65 offen  lds
    v_mfma_f32_16x16x32_bf16 v[44:47], v[152:155], v[192:195], v[44:47]
    s_add_u32 s65, s65, 8192
    v_mfma_f32_16x16x32_bf16 v[44:47], v[156:159], v[196:199], v[44:47]
    s_waitcnt lgkmcnt(0)
    v_mfma_f32_16x16x32_bf16 v[16:19], v[144:147], v[232:235], v[16:19]
    ds_read_b64_tr_b16 v[152:153], v231 offset:33800
    ds_read_b64_tr_b16 v[154:155], v231 offset:34056
    v_mfma_f32_16x16x32_bf16 v[16:19], v[148:151], v[236:239], v[16:19]
    ds_read_b64_tr_b16 v[156:157], v231 offset:34312
    ds_read_b64_tr_b16 v[158:159], v231 offset:34568
    v_mfma_f32_16x16x32_bf16 v[48:51], v[148:151], v[244:247], v[48:51]
    v_mfma_f32_16x16x32_bf16 v[48:51], v[144:147], v[240:243], v[48:51]
    buffer_load_dwordx4 v[160:163], v6, s[12:15], s66 offen offset:0 sc1
    v_mfma_f32_16x16x32_bf16 v[80:83], v[144:147], a[144:147], v[80:83]
    v_mfma_f32_16x16x32_bf16 v[80:83], v[148:151], a[148:151], v[80:83]
    buffer_load_dword v253, v254, s[16:19], s47 offen
    v_mfma_f32_16x16x32_bf16 v[112:115], v[148:151], a[156:159], v[112:115]
    v_mfma_f32_16x16x32_bf16 v[112:115], v[144:147], a[152:155], v[112:115]
    s_waitcnt lgkmcnt(0)
    v_mfma_f32_16x16x32_bf16 v[116:119], v[156:159], a[156:159], v[116:119]
    ds_read_b64_tr_b16 v[144:145], v231 offset:33856
    ds_read_b64_tr_b16 v[146:147], v231 offset:34112
    v_mfma_f32_16x16x32_bf16 v[116:119], v[152:155], a[152:155], v[116:119]
    ds_read_b64_tr_b16 v[148:149], v231 offset:34368
    ds_read_b64_tr_b16 v[150:151], v231 offset:34624
    v_mfma_f32_16x16x32_bf16 v[84:87], v[152:155], a[144:147], v[84:87]
    v_mfma_f32_16x16x32_bf16 v[84:87], v[156:159], a[148:151], v[84:87]
    buffer_load_dwordx4 v[164:167], v6, s[12:15], s66 offen offset:1024 sc1
    v_mfma_f32_16x16x32_bf16 v[52:55], v[156:159], v[244:247], v[52:55]
    s_add_u32 m0, s61, 85512
    v_mfma_f32_16x16x32_bf16 v[52:55], v[152:155], v[240:243], v[52:55]
    buffer_load_dwordx4 v2, s[8:11], s65 offen  lds
    v_mfma_f32_16x16x32_bf16 v[20:23], v[152:155], v[232:235], v[20:23]
    s_add_u32 s65, s65, 8192
    v_mfma_f32_16x16x32_bf16 v[20:23], v[156:159], v[236:239], v[20:23]
    s_waitcnt lgkmcnt(0)
    v_mfma_f32_16x16x32_bf16 v[24:27], v[144:147], v[232:235], v[24:27]
    ds_read_b64_tr_b16 v[152:153], v231 offset:33864
    ds_read_b64_tr_b16 v[154:155], v231 offset:34120
    v_mfma_f32_16x16x32_bf16 v[24:27], v[148:151], v[236:239], v[24:27]
    ds_read_b64_tr_b16 v[156:157], v231 offset:34376
    ds_read_b64_tr_b16 v[158:159], v231 offset:34632
    v_mfma_f32_16x16x32_bf16 v[56:59], v[148:151], v[244:247], v[56:59]
    v_mfma_f32_16x16x32_bf16 v[56:59], v[144:147], v[240:243], v[56:59]
    buffer_load_dwordx4 v[168:171], v7, s[12:15], s66 offen offset:0 sc1
    v_mfma_f32_16x16x32_bf16 v[88:91], v[144:147], a[144:147], v[88:91]
    v_mfma_f32_16x16x32_bf16 v[88:91], v[148:151], a[148:151], v[88:91]
    buffer_load_dword v230, v254, s[20:23], s47 offen
    v_mfma_f32_16x16x32_bf16 v[120:123], v[148:151], a[156:159], v[120:123]
    s_add_u32 s47, s47, 16384
    v_mfma_f32_16x16x32_bf16 v[120:123], v[144:147], a[152:155], v[120:123]
    s_waitcnt lgkmcnt(0)
    v_mfma_f32_16x16x32_bf16 v[124:127], v[156:159], a[156:159], v[124:127]
    ds_read_b64_tr_b16 v[144:145], v231 offset:33920
    ds_read_b64_tr_b16 v[146:147], v231 offset:34176
    v_mfma_f32_16x16x32_bf16 v[124:127], v[152:155], a[152:155], v[124:127]
    ds_read_b64_tr_b16 v[148:149], v231 offset:34432
    ds_read_b64_tr_b16 v[150:151], v231 offset:34688
    v_mfma_f32_16x16x32_bf16 v[92:95], v[152:155], a[144:147], v[92:95]
    v_mfma_f32_16x16x32_bf16 v[92:95], v[156:159], a[148:151], v[92:95]
    buffer_load_dwordx4 v[172:175], v7, s[12:15], s66 offen offset:1024 sc1
    v_mfma_f32_16x16x32_bf16 v[60:63], v[156:159], v[244:247], v[60:63]
    s_add_u32 m0, s61, 86592
    v_mfma_f32_16x16x32_bf16 v[60:63], v[152:155], v[240:243], v[60:63]
    buffer_load_dwordx4 v2, s[8:11], s65 offen  lds
    v_mfma_f32_16x16x32_bf16 v[28:31], v[152:155], v[232:235], v[28:31]
    s_add_u32 s65, s65, 8192
    v_mfma_f32_16x16x32_bf16 v[28:31], v[156:159], v[236:239], v[28:31]
    s_waitcnt lgkmcnt(0)
    v_mfma_f32_16x16x32_bf16 v[32:35], v[144:147], v[232:235], v[32:35]
    ds_read_b64_tr_b16 v[152:153], v231 offset:33928
    ds_read_b64_tr_b16 v[154:155], v231 offset:34184
    v_mfma_f32_16x16x32_bf16 v[32:35], v[148:151], v[236:239], v[32:35]
    ds_read_b64_tr_b16 v[156:157], v231 offset:34440
    ds_read_b64_tr_b16 v[158:159], v231 offset:34696
    v_mfma_f32_16x16x32_bf16 v[64:67], v[148:151], v[244:247], v[64:67]
    v_mfma_f32_16x16x32_bf16 v[64:67], v[144:147], v[240:243], v[64:67]
    buffer_load_dwordx4 v[176:179], v8, s[12:15], s66 offen offset:0 sc1
    v_mfma_f32_16x16x32_bf16 v[96:99], v[144:147], a[144:147], v[96:99]
    v_mfma_f32_16x16x32_bf16 v[96:99], v[148:151], a[148:151], v[96:99]
    v_mfma_f32_16x16x32_bf16 v[128:131], v[148:151], a[156:159], v[128:131]
    v_mfma_f32_16x16x32_bf16 v[128:131], v[144:147], a[152:155], v[128:131]
    s_waitcnt lgkmcnt(0)
    v_mfma_f32_16x16x32_bf16 v[132:135], v[156:159], a[156:159], v[132:135]
    ds_read_b64_tr_b16 v[144:145], v231 offset:33984
    ds_read_b64_tr_b16 v[146:147], v231 offset:34240
    v_mfma_f32_16x16x32_bf16 v[132:135], v[152:155], a[152:155], v[132:135]
    ds_read_b64_tr_b16 v[148:149], v231 offset:34496
    ds_read_b64_tr_b16 v[150:151], v231 offset:34752
    v_mfma_f32_16x16x32_bf16 v[100:103], v[152:155], a[144:147], v[100:103]
    v_mfma_f32_16x16x32_bf16 v[100:103], v[156:159], a[148:151], v[100:103]
    buffer_load_dwordx4 v[180:183], v8, s[12:15], s66 offen offset:1024 sc1
    v_mfma_f32_16x16x32_bf16 v[68:71], v[156:159], v[244:247], v[68:71]
    s_add_u32 m0, s61, 87624
    v_mfma_f32_16x16x32_bf16 v[68:71], v[152:155], v[240:243], v[68:71]
    buffer_load_dwordx4 v2, s[8:11], s65 offen  lds
    v_mfma_f32_16x16x32_bf16 v[36:39], v[152:155], v[232:235], v[36:39]
    s_add_u32 s65, s65, 499712
    v_mfma_f32_16x16x32_bf16 v[36:39], v[156:159], v[236:239], v[36:39]
    s_waitcnt lgkmcnt(0)
    v_mfma_f32_16x16x32_bf16 v[40:43], v[144:147], v[232:235], v[40:43]
    ds_read_b64_tr_b16 v[152:153], v231 offset:33992
    ds_read_b64_tr_b16 v[154:155], v231 offset:34248
    v_mfma_f32_16x16x32_bf16 v[40:43], v[148:151], v[236:239], v[40:43]
    ds_read_b64_tr_b16 v[156:157], v231 offset:34504
    ds_read_b64_tr_b16 v[158:159], v231 offset:34760
    v_mfma_f32_16x16x32_bf16 v[72:75], v[148:151], v[244:247], v[72:75]
    v_mfma_f32_16x16x32_bf16 v[72:75], v[144:147], v[240:243], v[72:75]
    buffer_load_dwordx4 v[184:187], v9, s[12:15], s66 offen offset:0 sc1
    v_mfma_f32_16x16x32_bf16 v[104:107], v[144:147], a[144:147], v[104:107]
    v_mfma_f32_16x16x32_bf16 v[104:107], v[148:151], a[148:151], v[104:107]
    v_mfma_f32_16x16x32_bf16 v[136:139], v[148:151], a[156:159], v[136:139]
    v_mfma_f32_16x16x32_bf16 v[136:139], v[144:147], a[152:155], v[136:139]
    s_waitcnt vmcnt(13) lgkmcnt(0)
    s_barrier
    v_mfma_f32_16x16x32_bf16 v[140:143], v[156:159], a[156:159], v[140:143]
    ds_read_b64_tr_b16 v[144:145], v231 offset:50688
    ds_read_b64_tr_b16 v[146:147], v231 offset:50944
    v_mfma_f32_16x16x32_bf16 v[140:143], v[152:155], a[152:155], v[140:143]
    ds_read_b64_tr_b16 v[148:149], v231 offset:51200
    ds_read_b64_tr_b16 v[150:151], v231 offset:51456
    v_mfma_f32_16x16x32_bf16 v[108:111], v[152:155], a[144:147], v[108:111]
    v_mfma_f32_16x16x32_bf16 v[108:111], v[156:159], a[148:151], v[108:111]
    buffer_load_dwordx4 v[188:191], v9, s[12:15], s66 offen offset:1024 sc1
    v_mfma_f32_16x16x32_bf16 v[76:79], v[156:159], v[244:247], v[76:79]
    s_add_u32 m0, s61, 101376
    s_add_u32 s66, s66, 2048
    v_mfma_f32_16x16x32_bf16 v[76:79], v[152:155], v[240:243], v[76:79]
    buffer_load_dwordx4 v2, s[8:11], s65 offen  lds
    v_mfma_f32_16x16x32_bf16 v[44:47], v[152:155], v[232:235], v[44:47]
    s_add_u32 s65, s65, 8192
    v_mfma_f32_16x16x32_bf16 v[44:47], v[156:159], v[236:239], v[44:47]
    s_waitcnt lgkmcnt(0)
    v_mfma_f32_16x16x32_bf16 v[16:19], v[144:147], a[160:163], v[16:19]
    ds_read_b64_tr_b16 v[152:153], v231 offset:50696
    ds_read_b64_tr_b16 v[154:155], v231 offset:50952
    v_mfma_f32_16x16x32_bf16 v[16:19], v[148:151], a[164:167], v[16:19]
    ds_read_b64_tr_b16 v[156:157], v231 offset:51208
    ds_read_b64_tr_b16 v[158:159], v231 offset:51464
    v_mfma_f32_16x16x32_bf16 v[48:51], v[148:151], a[172:175], v[48:51]
    v_mfma_f32_16x16x32_bf16 v[48:51], v[144:147], a[168:171], v[48:51]
    buffer_load_dwordx4 v[192:195], v6, s[12:15], s66 offen offset:0 sc1
    v_mfma_f32_16x16x32_bf16 v[80:83], v[144:147], a[176:179], v[80:83]
    v_mfma_f32_16x16x32_bf16 v[80:83], v[148:151], a[180:183], v[80:83]
    v_mfma_f32_16x16x32_bf16 v[112:115], v[148:151], a[188:191], v[112:115]
    v_mfma_f32_16x16x32_bf16 v[112:115], v[144:147], a[184:187], v[112:115]
    s_waitcnt lgkmcnt(0)
    v_mfma_f32_16x16x32_bf16 v[116:119], v[156:159], a[188:191], v[116:119]
    ds_read_b64_tr_b16 v[144:145], v231 offset:50752
    ds_read_b64_tr_b16 v[146:147], v231 offset:51008
    v_mfma_f32_16x16x32_bf16 v[116:119], v[152:155], a[184:187], v[116:119]
    ds_read_b64_tr_b16 v[148:149], v231 offset:51264
    ds_read_b64_tr_b16 v[150:151], v231 offset:51520
    v_mfma_f32_16x16x32_bf16 v[84:87], v[152:155], a[176:179], v[84:87]
    v_mfma_f32_16x16x32_bf16 v[84:87], v[156:159], a[180:183], v[84:87]
    buffer_load_dwordx4 v[196:199], v6, s[12:15], s66 offen offset:1024 sc1
    v_mfma_f32_16x16x32_bf16 v[52:55], v[156:159], a[172:175], v[52:55]
    s_add_u32 m0, s61, 102408
    v_mfma_f32_16x16x32_bf16 v[52:55], v[152:155], a[168:171], v[52:55]
    buffer_load_dwordx4 v2, s[8:11], s65 offen  lds
    v_mfma_f32_16x16x32_bf16 v[20:23], v[152:155], a[160:163], v[20:23]
    s_add_u32 s65, s65, 8192
    v_mfma_f32_16x16x32_bf16 v[20:23], v[156:159], a[164:167], v[20:23]
    s_waitcnt lgkmcnt(0)
    v_mfma_f32_16x16x32_bf16 v[24:27], v[144:147], a[160:163], v[24:27]
    ds_read_b64_tr_b16 v[152:153], v231 offset:50760
    ds_read_b64_tr_b16 v[154:155], v231 offset:51016
    v_mfma_f32_16x16x32_bf16 v[24:27], v[148:151], a[164:167], v[24:27]
    ds_read_b64_tr_b16 v[156:157], v231 offset:51272
    ds_read_b64_tr_b16 v[158:159], v231 offset:51528
    v_mfma_f32_16x16x32_bf16 v[56:59], v[148:151], a[172:175], v[56:59]
    v_mfma_f32_16x16x32_bf16 v[56:59], v[144:147], a[168:171], v[56:59]
    buffer_load_dwordx4 v[200:203], v7, s[12:15], s66 offen offset:0 sc1
    v_mfma_f32_16x16x32_bf16 v[88:91], v[144:147], a[176:179], v[88:91]
    v_mfma_f32_16x16x32_bf16 v[88:91], v[148:151], a[180:183], v[88:91]
    v_mfma_f32_16x16x32_bf16 v[120:123], v[148:151], a[188:191], v[120:123]
    v_mfma_f32_16x16x32_bf16 v[120:123], v[144:147], a[184:187], v[120:123]
    s_waitcnt lgkmcnt(0)
    v_mfma_f32_16x16x32_bf16 v[124:127], v[156:159], a[188:191], v[124:127]
    ds_read_b64_tr_b16 v[144:145], v231 offset:50816
    ds_read_b64_tr_b16 v[146:147], v231 offset:51072
    v_mfma_f32_16x16x32_bf16 v[124:127], v[152:155], a[184:187], v[124:127]
    ds_read_b64_tr_b16 v[148:149], v231 offset:51328
    ds_read_b64_tr_b16 v[150:151], v231 offset:51584
    v_mfma_f32_16x16x32_bf16 v[92:95], v[152:155], a[176:179], v[92:95]
    v_mfma_f32_16x16x32_bf16 v[92:95], v[156:159], a[180:183], v[92:95]
    buffer_load_dwordx4 v[204:207], v7, s[12:15], s66 offen offset:1024 sc1
    v_mfma_f32_16x16x32_bf16 v[60:63], v[156:159], a[172:175], v[60:63]
    s_add_u32 m0, s61, 103488
    v_mfma_f32_16x16x32_bf16 v[60:63], v[152:155], a[168:171], v[60:63]
    buffer_load_dwordx4 v2, s[8:11], s65 offen  lds
    v_mfma_f32_16x16x32_bf16 v[28:31], v[152:155], a[160:163], v[28:31]
    s_add_u32 s65, s65, 8192
    v_mfma_f32_16x16x32_bf16 v[28:31], v[156:159], a[164:167], v[28:31]
    s_waitcnt lgkmcnt(0)
    v_mfma_f32_16x16x32_bf16 v[32:35], v[144:147], a[160:163], v[32:35]
    ds_read_b64_tr_b16 v[152:153], v231 offset:50824
    ds_read_b64_tr_b16 v[154:155], v231 offset:51080
    v_mfma_f32_16x16x32_bf16 v[32:35], v[148:151], a[164:167], v[32:35]
    ds_read_b64_tr_b16 v[156:157], v231 offset:51336
    ds_read_b64_tr_b16 v[158:159], v231 offset:51592
    v_mfma_f32_16x16x32_bf16 v[64:67], v[148:151], a[172:175], v[64:67]
    v_mfma_f32_16x16x32_bf16 v[64:67], v[144:147], a[168:171], v[64:67]
    buffer_load_dwordx4 v[208:211], v8, s[12:15], s66 offen offset:0 sc1
    v_mfma_f32_16x16x32_bf16 v[96:99], v[144:147], a[176:179], v[96:99]
    v_mfma_f32_16x16x32_bf16 v[96:99], v[148:151], a[180:183], v[96:99]
    v_mfma_f32_16x16x32_bf16 v[128:131], v[148:151], a[188:191], v[128:131]
    v_mfma_f32_16x16x32_bf16 v[128:131], v[144:147], a[184:187], v[128:131]
    s_waitcnt lgkmcnt(0)
    v_mfma_f32_16x16x32_bf16 v[132:135], v[156:159], a[188:191], v[132:135]
    ds_read_b64_tr_b16 v[144:145], v231 offset:50880
    ds_read_b64_tr_b16 v[146:147], v231 offset:51136
    v_mfma_f32_16x16x32_bf16 v[132:135], v[152:155], a[184:187], v[132:135]
    ds_read_b64_tr_b16 v[148:149], v231 offset:51392
    ds_read_b64_tr_b16 v[150:151], v231 offset:51648
    v_mfma_f32_16x16x32_bf16 v[100:103], v[152:155], a[176:179], v[100:103]
    v_mfma_f32_16x16x32_bf16 v[100:103], v[156:159], a[180:183], v[100:103]
    buffer_load_dwordx4 v[212:215], v8, s[12:15], s66 offen offset:1024 sc1
    v_mfma_f32_16x16x32_bf16 v[68:71], v[156:159], a[172:175], v[68:71]
    s_add_u32 m0, s61, 104520
    v_mfma_f32_16x16x32_bf16 v[68:71], v[152:155], a[168:171], v[68:71]
    buffer_load_dwordx4 v2, s[8:11], s65 offen  lds
    v_mfma_f32_16x16x32_bf16 v[36:39], v[152:155], a[160:163], v[36:39]
    s_add_u32 s65, s65, 499712
    v_mfma_f32_16x16x32_bf16 v[36:39], v[156:159], a[164:167], v[36:39]
    s_waitcnt lgkmcnt(0)
    v_mfma_f32_16x16x32_bf16 v[40:43], v[144:147], a[160:163], v[40:43]
    ds_read_b64_tr_b16 v[152:153], v231 offset:50888
    ds_read_b64_tr_b16 v[154:155], v231 offset:51144
    v_mfma_f32_16x16x32_bf16 v[40:43], v[148:151], a[164:167], v[40:43]
    ds_read_b64_tr_b16 v[156:157], v231 offset:51400
    ds_read_b64_tr_b16 v[158:159], v231 offset:51656
    v_mfma_f32_16x16x32_bf16 v[72:75], v[148:151], a[172:175], v[72:75]
    v_mfma_f32_16x16x32_bf16 v[72:75], v[144:147], a[168:171], v[72:75]
    buffer_load_dwordx4 v[216:219], v9, s[12:15], s66 offen offset:0 sc1
    v_mfma_f32_16x16x32_bf16 v[104:107], v[144:147], a[176:179], v[104:107]
    v_mfma_f32_16x16x32_bf16 v[104:107], v[148:151], a[180:183], v[104:107]
    v_mfma_f32_16x16x32_bf16 v[136:139], v[148:151], a[188:191], v[136:139]
    v_mfma_f32_16x16x32_bf16 v[136:139], v[144:147], a[184:187], v[136:139]
    s_waitcnt vmcnt(11) lgkmcnt(0)
    s_barrier
    v_mfma_f32_16x16x32_bf16 v[140:143], v[156:159], a[188:191], v[140:143]
    ds_read_b64_tr_b16 v[144:145], v231 offset:0
    ds_read_b64_tr_b16 v[146:147], v231 offset:256
    v_mfma_f32_16x16x32_bf16 v[140:143], v[152:155], a[184:187], v[140:143]
    ds_read_b64_tr_b16 v[148:149], v231 offset:512
    ds_read_b64_tr_b16 v[150:151], v231 offset:768
    v_mfma_f32_16x16x32_bf16 v[108:111], v[152:155], a[176:179], v[108:111]
    v_mfma_f32_16x16x32_bf16 v[108:111], v[156:159], a[180:183], v[108:111]
    buffer_load_dwordx4 v[220:223], v9, s[12:15], s66 offen offset:1024 sc1
    v_mfma_f32_16x16x32_bf16 v[76:79], v[156:159], a[172:175], v[76:79]
    s_add_u32 m0, s61, 118272
    s_add_u32 s66, s66, 2048
    v_mfma_f32_16x16x32_bf16 v[76:79], v[152:155], a[168:171], v[76:79]
    buffer_load_dwordx4 v2, s[8:11], s65 offen  lds
    v_mfma_f32_16x16x32_bf16 v[44:47], v[152:155], a[160:163], v[44:47]
    s_add_u32 s65, s65, 8192
    v_mfma_f32_16x16x32_bf16 v[44:47], v[156:159], a[164:167], v[44:47]
    s_waitcnt lgkmcnt(0)
    s_add_u32 s49, s49, 1
    s_cmp_lt_u32 s49, 3
    s_cbranch_scc1 L_qproj_13
    v_mfma_f32_16x16x32_bf16 v[16:19], v[144:147], v[160:163], v[16:19]
    ds_read_b64_tr_b16 v[152:153], v231 offset:8
    ds_read_b64_tr_b16 v[154:155], v231 offset:264
    v_mfma_f32_16x16x32_bf16 v[16:19], v[148:151], v[164:167], v[16:19]
    ds_read_b64_tr_b16 v[156:157], v231 offset:520
    ds_read_b64_tr_b16 v[158:159], v231 offset:776
    v_mfma_f32_16x16x32_bf16 v[48:51], v[148:151], v[172:175], v[48:51]
    v_mfma_f32_16x16x32_bf16 v[48:51], v[144:147], v[168:171], v[48:51]
    buffer_load_dwordx4 v[232:235], v6, s[12:15], s66 offen offset:0 sc1
    v_mfma_f32_16x16x32_bf16 v[80:83], v[144:147], v[176:179], v[80:83]
    v_mfma_f32_16x16x32_bf16 v[80:83], v[148:151], v[180:183], v[80:83]
    buffer_load_dword v253, v229, s[4:7], 0 offen sc1
    v_mfma_f32_16x16x32_bf16 v[112:115], v[148:151], v[188:191], v[112:115]
    v_mfma_f32_16x16x32_bf16 v[112:115], v[144:147], v[184:187], v[112:115]
    s_waitcnt lgkmcnt(0)
    v_mfma_f32_16x16x32_bf16 v[116:119], v[156:159], v[188:191], v[116:119]
    ds_read_b64_tr_b16 v[144:145], v231 offset:64
    ds_read_b64_tr_b16 v[146:147], v231 offset:320
    v_mfma_f32_16x16x32_bf16 v[116:119], v[152:155], v[184:187], v[116:119]
    ds_read_b64_tr_b16 v[148:149], v231 offset:576
    ds_read_b64_tr_b16 v[150:151], v231 offset:832
    v_mfma_f32_16x16x32_bf16 v[84:87], v[152:155], v[176:179], v[84:87]
    v_mfma_f32_16x16x32_bf16 v[84:87], v[156:159], v[180:183], v[84:87]
    buffer_load_dwordx4 v[236:239], v6, s[12:15], s66 offen offset:1024 sc1
    v_mfma_f32_16x16x32_bf16 v[52:55], v[156:159], v[172:175], v[52:55]
    s_add_u32 m0, s61, 119304
    v_mfma_f32_16x16x32_bf16 v[52:55], v[152:155], v[168:171], v[52:55]
    buffer_load_dwordx4 v2, s[8:11], s65 offen  lds
    v_mfma_f32_16x16x32_bf16 v[20:23], v[152:155], v[160:163], v[20:23]
    s_add_u32 s65, s65, 8192
    v_mfma_f32_16x16x32_bf16 v[20:23], v[156:159], v[164:167], v[20:23]
    s_waitcnt lgkmcnt(0)
    v_mfma_f32_16x16x32_bf16 v[24:27], v[144:147], v[160:163], v[24:27]
    ds_read_b64_tr_b16 v[152:153], v231 offset:72
    ds_read_b64_tr_b16 v[154:155], v231 offset:328
    v_mfma_f32_16x16x32_bf16 v[24:27], v[148:151], v[164:167], v[24:27]
    ds_read_b64_tr_b16 v[156:157], v231 offset:584
    ds_read_b64_tr_b16 v[158:159], v231 offset:840
    v_mfma_f32_16x16x32_bf16 v[56:59], v[148:151], v[172:175], v[56:59]
    v_mfma_f32_16x16x32_bf16 v[56:59], v[144:147], v[168:171], v[56:59]
    buffer_load_dwordx4 v[240:243], v7, s[12:15], s66 offen offset:0 sc1
    v_mfma_f32_16x16x32_bf16 v[88:91], v[144:147], v[176:179], v[88:91]
    v_mfma_f32_16x16x32_bf16 v[88:91], v[148:151], v[180:183], v[88:91]
    v_mfma_f32_16x16x32_bf16 v[120:123], v[148:151], v[188:191], v[120:123]
    v_mfma_f32_16x16x32_bf16 v[120:123], v[144:147], v[184:187], v[120:123]
    s_waitcnt lgkmcnt(0)
    v_mfma_f32_16x16x32_bf16 v[124:127], v[156:159], v[188:191], v[124:127]
    ds_read_b64_tr_b16 v[144:145], v231 offset:128
    ds_read_b64_tr_b16 v[146:147], v231 offset:384
    v_mfma_f32_16x16x32_bf16 v[124:127], v[152:155], v[184:187], v[124:127]
    ds_read_b64_tr_b16 v[148:149], v231 offset:640
    ds_read_b64_tr_b16 v[150:151], v231 offset:896
    v_mfma_f32_16x16x32_bf16 v[92:95], v[152:155], v[176:179], v[92:95]
    v_mfma_f32_16x16x32_bf16 v[92:95], v[156:159], v[180:183], v[92:95]
    buffer_load_dwordx4 v[244:247], v7, s[12:15], s66 offen offset:1024 sc1
    v_mfma_f32_16x16x32_bf16 v[60:63], v[156:159], v[172:175], v[60:63]
    s_add_u32 m0, s61, 120384
    v_mfma_f32_16x16x32_bf16 v[60:63], v[152:155], v[168:171], v[60:63]
    buffer_load_dwordx4 v2, s[8:11], s65 offen  lds
    v_mfma_f32_16x16x32_bf16 v[28:31], v[152:155], v[160:163], v[28:31]
    s_add_u32 s65, s65, 8192
    v_mfma_f32_16x16x32_bf16 v[28:31], v[156:159], v[164:167], v[28:31]
    s_waitcnt lgkmcnt(0)
    v_mfma_f32_16x16x32_bf16 v[32:35], v[144:147], v[160:163], v[32:35]
    ds_read_b64_tr_b16 v[152:153], v231 offset:136
    ds_read_b64_tr_b16 v[154:155], v231 offset:392
    v_mfma_f32_16x16x32_bf16 v[32:35], v[148:151], v[164:167], v[32:35]
    ds_read_b64_tr_b16 v[156:157], v231 offset:648
    ds_read_b64_tr_b16 v[158:159], v231 offset:904
    v_mfma_f32_16x16x32_bf16 v[64:67], v[148:151], v[172:175], v[64:67]
    v_mfma_f32_16x16x32_bf16 v[64:67], v[144:147], v[168:171], v[64:67]
    buffer_load_dwordx4 a[144:147], v8, s[12:15], s66 offen offset:0 sc1
    v_mfma_f32_16x16x32_bf16 v[96:99], v[144:147], v[176:179], v[96:99]
    v_mfma_f32_16x16x32_bf16 v[96:99], v[148:151], v[180:183], v[96:99]
    v_mfma_f32_16x16x32_bf16 v[128:131], v[148:151], v[188:191], v[128:131]
    v_mfma_f32_16x16x32_bf16 v[128:131], v[144:147], v[184:187], v[128:131]
    s_waitcnt lgkmcnt(0)
    v_mfma_f32_16x16x32_bf16 v[132:135], v[156:159], v[188:191], v[132:135]
    ds_read_b64_tr_b16 v[144:145], v231 offset:192
    ds_read_b64_tr_b16 v[146:147], v231 offset:448
    v_mfma_f32_16x16x32_bf16 v[132:135], v[152:155], v[184:187], v[132:135]
    ds_read_b64_tr_b16 v[148:149], v231 offset:704
    ds_read_b64_tr_b16 v[150:151], v231 offset:960
    v_mfma_f32_16x16x32_bf16 v[100:103], v[152:155], v[176:179], v[100:103]
    v_mfma_f32_16x16x32_bf16 v[100:103], v[156:159], v[180:183], v[100:103]
    buffer_load_dwordx4 a[148:151], v8, s[12:15], s66 offen offset:1024 sc1
    v_mfma_f32_16x16x32_bf16 v[68:71], v[156:159], v[172:175], v[68:71]
    s_add_u32 m0, s61, 121416
    v_mfma_f32_16x16x32_bf16 v[68:71], v[152:155], v[168:171], v[68:71]
    buffer_load_dwordx4 v2, s[8:11], s65 offen  lds
    v_mfma_f32_16x16x32_bf16 v[36:39], v[152:155], v[160:163], v[36:39]
    s_add_u32 s65, s65, 499712
    v_mfma_f32_16x16x32_bf16 v[36:39], v[156:159], v[164:167], v[36:39]
    s_waitcnt lgkmcnt(0)
    v_mfma_f32_16x16x32_bf16 v[40:43], v[144:147], v[160:163], v[40:43]
    ds_read_b64_tr_b16 v[152:153], v231 offset:200
    ds_read_b64_tr_b16 v[154:155], v231 offset:456
    v_mfma_f32_16x16x32_bf16 v[40:43], v[148:151], v[164:167], v[40:43]
    ds_read_b64_tr_b16 v[156:157], v231 offset:712
    ds_read_b64_tr_b16 v[158:159], v231 offset:968
    v_mfma_f32_16x16x32_bf16 v[72:75], v[148:151], v[172:175], v[72:75]
    v_mfma_f32_16x16x32_bf16 v[72:75], v[144:147], v[168:171], v[72:75]
    buffer_load_dwordx4 a[152:155], v9, s[12:15], s66 offen offset:0 sc1
    v_mfma_f32_16x16x32_bf16 v[104:107], v[144:147], v[176:179], v[104:107]
    v_mfma_f32_16x16x32_bf16 v[104:107], v[148:151], v[180:183], v[104:107]
    v_mfma_f32_16x16x32_bf16 v[136:139], v[148:151], v[188:191], v[136:139]
    v_mfma_f32_16x16x32_bf16 v[136:139], v[144:147], v[184:187], v[136:139]
    s_waitcnt vmcnt(9) lgkmcnt(0)
    s_barrier
    v_mfma_f32_16x16x32_bf16 v[140:143], v[156:159], v[188:191], v[140:143]
    ds_read_b64_tr_b16 v[144:145], v231 offset:16896
    ds_read_b64_tr_b16 v[146:147], v231 offset:17152
    v_mfma_f32_16x16x32_bf16 v[140:143], v[152:155], v[184:187], v[140:143]
    ds_read_b64_tr_b16 v[148:149], v231 offset:17408
    ds_read_b64_tr_b16 v[150:151], v231 offset:17664
    v_mfma_f32_16x16x32_bf16 v[108:111], v[152:155], v[176:179], v[108:111]
    v_mfma_f32_16x16x32_bf16 v[108:111], v[156:159], v[180:183], v[108:111]
    buffer_load_dwordx4 a[156:159], v9, s[12:15], s66 offen offset:1024 sc1
    v_mfma_f32_16x16x32_bf16 v[76:79], v[156:159], v[172:175], v[76:79]
    s_add_u32 s66, s66, 2048
    v_mfma_f32_16x16x32_bf16 v[76:79], v[152:155], v[168:171], v[76:79]
    v_mfma_f32_16x16x32_bf16 v[44:47], v[152:155], v[160:163], v[44:47]
    v_mfma_f32_16x16x32_bf16 v[44:47], v[156:159], v[164:167], v[44:47]
    s_waitcnt lgkmcnt(0)
    v_cmp_ne_u32 vcc, s60, v253
    s_cbranch_vccnz L_slowf1_14
L_backf1_15:
    v_lshlrev_b32 v253, 2, v11
    v_mfma_f32_16x16x32_bf16 v[16:19], v[144:147], v[192:195], v[16:19]
    ds_read_b64_tr_b16 v[152:153], v231 offset:16904
    ds_read_b64_tr_b16 v[154:155], v231 offset:17160
    v_mfma_f32_16x16x32_bf16 v[16:19], v[148:151], v[196:199], v[16:19]
    ds_read_b64_tr_b16 v[156:157], v231 offset:17416
    ds_read_b64_tr_b16 v[158:159], v231 offset:17672
    v_mfma_f32_16x16x32_bf16 v[48:51], v[148:151], v[204:207], v[48:51]
    v_mfma_f32_16x16x32_bf16 v[48:51], v[144:147], v[200:203], v[48:51]
    buffer_load_dwordx4 a[160:163], v6, s[12:15], s66 offen offset:0 sc1
    v_mfma_f32_16x16x32_bf16 v[80:83], v[144:147], v[208:211], v[80:83]
    s_add_u32 m0, s61, 0
    v_mfma_f32_16x16x32_bf16 v[80:83], v[148:151], v[212:215], v[80:83]
    buffer_load_dwordx4 v3, s[16:19], s63 offen offset:0  lds
    v_mfma_f32_16x16x32_bf16 v[112:115], v[148:151], v[220:223], v[112:115]
    v_mfma_f32_16x16x32_bf16 v[112:115], v[144:147], v[216:219], v[112:115]
    s_waitcnt lgkmcnt(0)
    v_mfma_f32_16x16x32_bf16 v[116:119], v[156:159], v[220:223], v[116:119]
    ds_read_b64_tr_b16 v[144:145], v231 offset:16960
    ds_read_b64_tr_b16 v[146:147], v231 offset:17216
    v_mfma_f32_16x16x32_bf16 v[116:119], v[152:155], v[216:219], v[116:119]
    ds_read_b64_tr_b16 v[148:149], v231 offset:17472
    ds_read_b64_tr_b16 v[150:151], v231 offset:17728
    v_mfma_f32_16x16x32_bf16 v[84:87], v[152:155], v[208:211], v[84:87]
    v_mfma_f32_16x16x32_bf16 v[84:87], v[156:159], v[212:215], v[84:87]
    buffer_load_dwordx4 a[164:167], v6, s[12:15], s66 offen offset:1024 sc1
    v_mfma_f32_16x16x32_bf16 v[52:55], v[156:159], v[204:207], v[52:55]
    s_add_u32 m0, s44, 0
    v_mfma_f32_16x16x32_bf16 v[52:55], v[152:155], v[200:203], v[52:55]
    buffer_load_dwordx4 v14, s[28:31], s46 offen lds
    v_mfma_f32_16x16x32_bf16 v[20:23], v[152:155], v[192:195], v[20:23]
    s_add_u32 s46, s46, 16384
    v_mfma_f32_16x16x32_bf16 v[20:23], v[156:159], v[196:199], v[20:23]
    s_waitcnt lgkmcnt(0)
    v_mfma_f32_16x16x32_bf16 v[24:27], v[144:147], v[192:195], v[24:27]
    ds_read_b64_tr_b16 v[152:153], v231 offset:16968
    ds_read_b64_tr_b16 v[154:155], v231 offset:17224
    v_mfma_f32_16x16x32_bf16 v[24:27], v[148:151], v[196:199], v[24:27]
    ds_read_b64_tr_b16 v[156:157], v231 offset:17480
    ds_read_b64_tr_b16 v[158:159], v231 offset:17736
    v_mfma_f32_16x16x32_bf16 v[56:59], v[148:151], v[204:207], v[56:59]
    v_mfma_f32_16x16x32_bf16 v[56:59], v[144:147], v[200:203], v[56:59]
    buffer_load_dwordx4 a[168:171], v7, s[12:15], s66 offen offset:0 sc1
    v_mfma_f32_16x16x32_bf16 v[88:91], v[144:147], v[208:211], v[88:91]
    s_add_u32 m0, s61, 32
    v_mfma_f32_16x16x32_bf16 v[88:91], v[148:151], v[212:215], v[88:91]
    buffer_load_dwordx4 v3, s[16:19], s63 offen offset:1024  lds
    v_mfma_f32_16x16x32_bf16 v[120:123], v[148:151], v[220:223], v[120:123]
    v_mfma_f32_16x16x32_bf16 v[120:123], v[144:147], v[216:219], v[120:123]
    s_waitcnt lgkmcnt(0)
    v_mfma_f32_16x16x32_bf16 v[124:127], v[156:159], v[220:223], v[124:127]
    ds_read_b64_tr_b16 v[144:145], v231 offset:17024
    ds_read_b64_tr_b16 v[146:147], v231 offset:17280
    v_mfma_f32_16x16x32_bf16 v[124:127], v[152:155], v[216:219], v[124:127]
    ds_read_b64_tr_b16 v[148:149], v231 offset:17536
    ds_read_b64_tr_b16 v[150:151], v231 offset:17792
    v_mfma_f32_16x16x32_bf16 v[92:95], v[152:155], v[208:211], v[92:95]
    v_mfma_f32_16x16x32_bf16 v[92:95], v[156:159], v[212:215], v[92:95]
    buffer_load_dwordx4 a[172:175], v7, s[12:15], s66 offen offset:1024 sc1
    v_mfma_f32_16x16x32_bf16 v[60:63], v[156:159], v[204:207], v[60:63]
    s_add_u32 m0, s44, 1056
    v_mfma_f32_16x16x32_bf16 v[60:63], v[152:155], v[200:203], v[60:63]
    buffer_load_dwordx4 v14, s[28:31], s46 offen lds
    v_mfma_f32_16x16x32_bf16 v[28:31], v[152:155], v[192:195], v[28:31]
    s_add_u32 s46, s46, 16384
    v_mfma_f32_16x16x32_bf16 v[28:31], v[156:159], v[196:199], v[28:31]
    s_waitcnt lgkmcnt(0)
    v_mfma_f32_16x16x32_bf16 v[32:35], v[144:147], v[192:195], v[32:35]
    ds_read_b64_tr_b16 v[152:153], v231 offset:17032
    ds_read_b64_tr_b16 v[154:155], v231 offset:17288
    v_mfma_f32_16x16x32_bf16 v[32:35], v[148:151], v[196:199], v[32:35]
    ds_read_b64_tr_b16 v[156:157], v231 offset:17544
    ds_read_b64_tr_b16 v[158:159], v231 offset:17800
    v_mfma_f32_16x16x32_bf16 v[64:67], v[148:151], v[204:207], v[64:67]
    v_mfma_f32_16x16x32_bf16 v[64:67], v[144:147], v[200:203], v[64:67]
    buffer_load_dwordx4 a[176:179], v8, s[12:15], s66 offen offset:0 sc1
    v_mfma_f32_16x16x32_bf16 v[96:99], v[144:147], v[208:211], v[96:99]
    s_add_u32 m0, s61, 64
    v_mfma_f32_16x16x32_bf16 v[96:99], v[148:151], v[212:215], v[96:99]
    buffer_load_dwordx4 v3, s[16:19], s63 offen offset:2048  lds
    v_mfma_f32_16x16x32_bf16 v[128:131], v[148:151], v[220:223], v[128:131]
    v_mfma_f32_16x16x32_bf16 v[128:131], v[144:147], v[216:219], v[128:131]
    s_waitcnt lgkmcnt(0)
    v_mfma_f32_16x16x32_bf16 v[132:135], v[156:159], v[220:223], v[132:135]
    ds_read_b64_tr_b16 v[144:145], v231 offset:17088
    ds_read_b64_tr_b16 v[146:147], v231 offset:17344
    v_mfma_f32_16x16x32_bf16 v[132:135], v[152:155], v[216:219], v[132:135]
    ds_read_b64_tr_b16 v[148:149], v231 offset:17600
    ds_read_b64_tr_b16 v[150:151], v231 offset:17856
    v_mfma_f32_16x16x32_bf16 v[100:103], v[152:155], v[208:211], v[100:103]
    v_mfma_f32_16x16x32_bf16 v[100:103], v[156:159], v[212:215], v[100:103]
    buffer_load_dwordx4 a[180:183], v8, s[12:15], s66 offen offset:1024 sc1
    v_mfma_f32_16x16x32_bf16 v[68:71], v[156:159], v[204:207], v[68:71]
    s_add_u32 m0, s44, 2112
    v_mfma_f32_16x16x32_bf16 v[68:71], v[152:155], v[200:203], v[68:71]
    buffer_load_dwordx4 v14, s[28:31], s46 offen lds
    v_mfma_f32_16x16x32_bf16 v[36:39], v[152:155], v[192:195], v[36:39]
    s_add_u32 s46, s46, 16384
    v_mfma_f32_16x16x32_bf16 v[36:39], v[156:159], v[196:199], v[36:39]
    s_waitcnt lgkmcnt(0)
    v_mfma_f32_16x16x32_bf16 v[40:43], v[144:147], v[192:195], v[40:43]
    ds_read_b64_tr_b16 v[152:153], v231 offset:17096
    ds_read_b64_tr_b16 v[154:155], v231 offset:17352
    v_mfma_f32_16x16x32_bf16 v[40:43], v[148:151], v[196:199], v[40:43]
    ds_read_b64_tr_b16 v[156:157], v231 offset:17608
    ds_read_b64_tr_b16 v[158:159], v231 offset:17864
    v_mfma_f32_16x16x32_bf16 v[72:75], v[148:151], v[204:207], v[72:75]
    v_mfma_f32_16x16x32_bf16 v[72:75], v[144:147], v[200:203], v[72:75]
    buffer_load_dwordx4 a[184:187], v9, s[12:15], s66 offen offset:0 sc1
    v_mfma_f32_16x16x32_bf16 v[104:107], v[144:147], v[208:211], v[104:107]
    s_add_u32 m0, s61, 96
    v_mfma_f32_16x16x32_bf16 v[104:107], v[148:151], v[212:215], v[104:107]
    buffer_load_dwordx4 v3, s[16:19], s63 offen offset:3072  lds
    v_mfma_f32_16x16x32_bf16 v[136:139], v[148:151], v[220:223], v[136:139]
    s_add_u32 s63, s63, 16384
    v_mfma_f32_16x16x32_bf16 v[136:139], v[144:147], v[216:219], v[136:139]
    s_waitcnt vmcnt(14) lgkmcnt(0)
    s_barrier
    v_mfma_f32_16x16x32_bf16 v[140:143], v[156:159], v[220:223], v[140:143]
    ds_read_b64_tr_b16 v[144:145], v231 offset:33792
    ds_read_b64_tr_b16 v[146:147], v231 offset:34048
    v_mfma_f32_16x16x32_bf16 v[140:143], v[152:155], v[216:219], v[140:143]
    ds_read_b64_tr_b16 v[148:149], v231 offset:34304
    ds_read_b64_tr_b16 v[150:151], v231 offset:34560
    v_mfma_f32_16x16x32_bf16 v[108:111], v[152:155], v[208:211], v[108:111]
    v_mfma_f32_16x16x32_bf16 v[108:111], v[156:159], v[212:215], v[108:111]
    buffer_load_dwordx4 a[188:191], v9, s[12:15], s66 offen offset:1024 sc1
    v_mfma_f32_16x16x32_bf16 v[76:79], v[156:159], v[204:207], v[76:79]
    s_add_u32 m0, s44, 3168
    s_add_u32 s66, s66, 2048
    v_mfma_f32_16x16x32_bf16 v[76:79], v[152:155], v[200:203], v[76:79]
    buffer_load_dwordx4 v14, s[28:31], s46 offen lds
    v_mfma_f32_16x16x32_bf16 v[44:47], v[152:155], v[192:195], v[44:47]
    s_add_u32 s46, s46, 16384
    v_mfma_f32_16x16x32_bf16 v[44:47], v[156:159], v[196:199], v[44:47]
    s_waitcnt lgkmcnt(0)
    v_mfma_f32_16x16x32_bf16 v[16:19], v[144:147], v[232:235], v[16:19]
    ds_read_b64_tr_b16 v[152:153], v231 offset:33800
    ds_read_b64_tr_b16 v[154:155], v231 offset:34056
    v_mfma_f32_16x16x32_bf16 v[16:19], v[148:151], v[236:239], v[16:19]
    ds_read_b64_tr_b16 v[156:157], v231 offset:34312
    ds_read_b64_tr_b16 v[158:159], v231 offset:34568
    v_mfma_f32_16x16x32_bf16 v[48:51], v[148:151], v[244:247], v[48:51]
    s_add_u32 m0, s61, 16896
    v_mfma_f32_16x16x32_bf16 v[48:51], v[144:147], v[240:243], v[48:51]
    buffer_load_dwordx4 v3, s[16:19], s63 offen offset:0  lds
    v_mfma_f32_16x16x32_bf16 v[80:83], v[144:147], a[144:147], v[80:83]
    s_add_u32 m0, s44, 4224
    v_mfma_f32_16x16x32_bf16 v[80:83], v[148:151], a[148:151], v[80:83]
    buffer_load_dwordx4 v15, s[4:7], s45 offen sc1 lds
    v_mfma_f32_16x16x32_bf16 v[112:115], v[148:151], a[156:159], v[112:115]
    s_add_u32 s45, s45, 16384
    v_mfma_f32_16x16x32_bf16 v[112:115], v[144:147], a[152:155], v[112:115]
    s_waitcnt lgkmcnt(0)
    v_mfma_f32_16x16x32_bf16 v[116:119], v[156:159], a[156:159], v[116:119]
    ds_read_b64_tr_b16 v[144:145], v231 offset:33856
    ds_read_b64_tr_b16 v[146:147], v231 offset:34112
    v_mfma_f32_16x16x32_bf16 v[116:119], v[152:155], a[152:155], v[116:119]
    ds_read_b64_tr_b16 v[148:149], v231 offset:34368
    ds_read_b64_tr_b16 v[150:151], v231 offset:34624
    v_mfma_f32_16x16x32_bf16 v[84:87], v[152:155], a[144:147], v[84:87]
    s_add_u32 m0, s61, 16928
    v_mfma_f32_16x16x32_bf16 v[84:87], v[156:159], a[148:151], v[84:87]
    buffer_load_dwordx4 v3, s[16:19], s63 offen offset:1024  lds
    v_mfma_f32_16x16x32_bf16 v[52:55], v[156:159], v[244:247], v[52:55]
    s_add_u32 m0, s44, 5248
    v_mfma_f32_16x16x32_bf16 v[52:55], v[152:155], v[240:243], v[52:55]
    buffer_load_dwordx4 v15, s[4:7], s45 offen sc1 lds
    v_mfma_f32_16x16x32_bf16 v[20:23], v[152:155], v[232:235], v[20:23]
    s_add_u32 s45, s45, 16384
    v_mfma_f32_16x16x32_bf16 v[20:23], v[156:159], v[236:239], v[20:23]
    s_waitcnt lgkmcnt(0)
    v_mfma_f32_16x16x32_bf16 v[24:27], v[144:147], v[232:235], v[24:27]
    ds_read_b64_tr_b16 v[152:153], v231 offset:33864
    ds_read_b64_tr_b16 v[154:155], v231 offset:34120
    v_mfma_f32_16x16x32_bf16 v[24:27], v[148:151], v[236:239], v[24:27]
    ds_read_b64_tr_b16 v[156:157], v231 offset:34376
    ds_read_b64_tr_b16 v[158:159], v231 offset:34632
    v_mfma_f32_16x16x32_bf16 v[56:59], v[148:151], v[244:247], v[56:59]
    s_add_u32 m0, s61, 16960
    v_mfma_f32_16x16x32_bf16 v[56:59], v[144:147], v[240:243], v[56:59]
    buffer_load_dwordx4 v3, s[16:19], s63 offen offset:2048  lds
    v_mfma_f32_16x16x32_bf16 v[88:91], v[144:147], a[144:147], v[88:91]
    s_add_u32 m0, s44, 6272
    v_mfma_f32_16x16x32_bf16 v[88:91], v[148:151], a[148:151], v[88:91]
    buffer_load_dword v253, s[32:35], 0 offen lds
    v_mfma_f32_16x16x32_bf16 v[120:123], v[148:151], a[156:159], v[120:123]
    v_mfma_f32_16x16x32_bf16 v[120:123], v[144:147], a[152:155], v[120:123]
    s_waitcnt lgkmcnt(0)
    v_mfma_f32_16x16x32_bf16 v[124:127], v[156:159], a[156:159], v[124:127]
    ds_read_b64_tr_b16 v[144:145], v231 offset:33920
    ds_read_b64_tr_b16 v[146:147], v231 offset:34176
    v_mfma_f32_16x16x32_bf16 v[124:127], v[152:155], a[152:155], v[124:127]
    ds_read_b64_tr_b16 v[148:149], v231 offset:34432
    ds_read_b64_tr_b16 v[150:151], v231 offset:34688
    v_mfma_f32_16x16x32_bf16 v[92:95], v[152:155], a[144:147], v[92:95]
    s_add_u32 m0, s61, 16992
    v_mfma_f32_16x16x32_bf16 v[92:95], v[156:159], a[148:151], v[92:95]
    buffer_load_dwordx4 v3, s[16:19], s63 offen offset:3072  lds
    v_mfma_f32_16x16x32_bf16 v[60:63], v[156:159], v[244:247], v[60:63]
    s_add_u32 m0, s61, 67584
    s_add_u32 s63, s63, 16384
    v_mfma_f32_16x16x32_bf16 v[60:63], v[152:155], v[240:243], v[60:63]
    buffer_load_dwordx4 v3, s[20:23], s64 offen offset:0  lds
    v_mfma_f32_16x16x32_bf16 v[28:31], v[152:155], v[232:235], v[28:31]
    v_mfma_f32_16x16x32_bf16 v[28:31], v[156:159], v[236:239], v[28:31]
    s_waitcnt lgkmcnt(0)
    v_mfma_f32_16x16x32_bf16 v[32:35], v[144:147], v[232:235], v[32:35]
    ds_read_b64_tr_b16 v[152:153], v231 offset:33928
    ds_read_b64_tr_b16 v[154:155], v231 offset:34184
    v_mfma_f32_16x16x32_bf16 v[32:35], v[148:151], v[236:239], v[32:35]
    ds_read_b64_tr_b16 v[156:157], v231 offset:34440
    ds_read_b64_tr_b16 v[158:159], v231 offset:34696
    v_mfma_f32_16x16x32_bf16 v[64:67], v[148:151], v[244:247], v[64:67]
    s_add_u32 m0, s61, 67616
    v_mfma_f32_16x16x32_bf16 v[64:67], v[144:147], v[240:243], v[64:67]
    buffer_load_dwordx4 v3, s[20:23], s64 offen offset:1024  lds
    v_mfma_f32_16x16x32_bf16 v[96:99], v[144:147], a[144:147], v[96:99]
    s_add_u32 m0, s61, 67648
    v_mfma_f32_16x16x32_bf16 v[96:99], v[148:151], a[148:151], v[96:99]
    buffer_load_dwordx4 v3, s[20:23], s64 offen offset:2048  lds
    v_mfma_f32_16x16x32_bf16 v[128:131], v[148:151], a[156:159], v[128:131]
    v_mfma_f32_16x16x32_bf16 v[128:131], v[144:147], a[152:155], v[128:131]
    s_waitcnt lgkmcnt(0)
    v_mfma_f32_16x16x32_bf16 v[132:135], v[156:159], a[156:159], v[132:135]
    ds_read_b64_tr_b16 v[144:145], v231 offset:33984
    ds_read_b64_tr_b16 v[146:147], v231 offset:34240
    v_mfma_f32_16x16x32_bf16 v[132:135], v[152:155], a[152:155], v[132:135]
    ds_read_b64_tr_b16 v[148:149], v231 offset:34496
    ds_read_b64_tr_b16 v[150:151], v231 offset:34752
    v_mfma_f32_16x16x32_bf16 v[100:103], v[152:155], a[144:147], v[100:103]
    s_add_u32 m0, s61, 67680
    v_mfma_f32_16x16x32_bf16 v[100:103], v[156:159], a[148:151], v[100:103]
    buffer_load_dwordx4 v3, s[20:23], s64 offen offset:3072  lds
    v_mfma_f32_16x16x32_bf16 v[68:71], v[156:159], v[244:247], v[68:71]
    s_add_u32 m0, s61, 33792
    s_add_u32 s64, s64, 16384
    v_mfma_f32_16x16x32_bf16 v[68:71], v[152:155], v[240:243], v[68:71]
    buffer_load_dwordx4 v3, s[16:19], s63 offen offset:0  lds
    v_mfma_f32_16x16x32_bf16 v[36:39], v[152:155], v[232:235], v[36:39]
    v_mfma_f32_16x16x32_bf16 v[36:39], v[156:159], v[236:239], v[36:39]
    s_waitcnt lgkmcnt(0)
    v_mfma_f32_16x16x32_bf16 v[40:43], v[144:147], v[232:235], v[40:43]
    ds_read_b64_tr_b16 v[152:153], v231 offset:33992
    ds_read_b64_tr_b16 v[154:155], v231 offset:34248
    v_mfma_f32_16x16x32_bf16 v[40:43], v[148:151], v[236:239], v[40:43]
    ds_read_b64_tr_b16 v[156:157], v231 offset:34504
    ds_read_b64_tr_b16 v[158:159], v231 offset:34760
    v_mfma_f32_16x16x32_bf16 v[72:75], v[148:151], v[244:247], v[72:75]
    s_add_u32 m0, s61, 33824
    v_mfma_f32_16x16x32_bf16 v[72:75], v[144:147], v[240:243], v[72:75]
    buffer_load_dwordx4 v3, s[16:19], s63 offen offset:1024  lds
    v_mfma_f32_16x16x32_bf16 v[104:107], v[144:147], a[144:147], v[104:107]
    s_add_u32 m0, s61, 33856
    v_mfma_f32_16x16x32_bf16 v[104:107], v[148:151], a[148:151], v[104:107]
    buffer_load_dwordx4 v3, s[16:19], s63 offen offset:2048  lds
    v_mfma_f32_16x16x32_bf16 v[136:139], v[148:151], a[156:159], v[136:139]
    v_mfma_f32_16x16x32_bf16 v[136:139], v[144:147], a[152:155], v[136:139]
    s_waitcnt vmcnt(15) lgkmcnt(0)
    s_barrier
    v_mfma_f32_16x16x32_bf16 v[140:143], v[156:159], a[156:159], v[140:143]
    ds_read_b64_tr_b16 v[144:145], v231 offset:50688
    ds_read_b64_tr_b16 v[146:147], v231 offset:50944
    v_mfma_f32_16x16x32_bf16 v[140:143], v[152:155], a[152:155], v[140:143]
    ds_read_b64_tr_b16 v[148:149], v231 offset:51200
    ds_read_b64_tr_b16 v[150:151], v231 offset:51456
    v_mfma_f32_16x16x32_bf16 v[108:111], v[152:155], a[144:147], v[108:111]
    s_add_u32 m0, s61, 33888
    v_mfma_f32_16x16x32_bf16 v[108:111], v[156:159], a[148:151], v[108:111]
    buffer_load_dwordx4 v3, s[16:19], s63 offen offset:3072  lds
    v_mfma_f32_16x16x32_bf16 v[76:79], v[156:159], v[244:247], v[76:79]
    s_add_u32 m0, s61, 84480
    s_add_u32 s63, s63, 16384
    v_mfma_f32_16x16x32_bf16 v[76:79], v[152:155], v[240:243], v[76:79]
    buffer_load_dwordx4 v3, s[20:23], s64 offen offset:0  lds
    v_mfma_f32_16x16x32_bf16 v[44:47], v[152:155], v[232:235], v[44:47]
    v_mfma_f32_16x16x32_bf16 v[44:47], v[156:159], v[236:239], v[44:47]
    s_waitcnt lgkmcnt(0)
    v_mfma_f32_16x16x32_bf16 v[16:19], v[144:147], a[160:163], v[16:19]
    ds_read_b64_tr_b16 v[152:153], v231 offset:50696
    ds_read_b64_tr_b16 v[154:155], v231 offset:50952
    v_mfma_f32_16x16x32_bf16 v[16:19], v[148:151], a[164:167], v[16:19]
    ds_read_b64_tr_b16 v[156:157], v231 offset:51208
    ds_read_b64_tr_b16 v[158:159], v231 offset:51464
    v_mfma_f32_16x16x32_bf16 v[48:51], v[148:151], a[172:175], v[48:51]
    s_add_u32 m0, s61, 84512
    v_mfma_f32_16x16x32_bf16 v[48:51], v[144:147], a[168:171], v[48:51]
    buffer_load_dwordx4 v3, s[20:23], s64 offen offset:1024  lds
    v_mfma_f32_16x16x32_bf16 v[80:83], v[144:147], a[176:179], v[80:83]
    s_add_u32 m0, s61, 84544
    v_mfma_f32_16x16x32_bf16 v[80:83], v[148:151], a[180:183], v[80:83]
    buffer_load_dwordx4 v3, s[20:23], s64 offen offset:2048  lds
    v_mfma_f32_16x16x32_bf16 v[112:115], v[148:151], a[188:191], v[112:115]
    v_mfma_f32_16x16x32_bf16 v[112:115], v[144:147], a[184:187], v[112:115]
    s_waitcnt lgkmcnt(0)
    v_mfma_f32_16x16x32_bf16 v[116:119], v[156:159], a[188:191], v[116:119]
    ds_read_b64_tr_b16 v[144:145], v231 offset:50752
    ds_read_b64_tr_b16 v[146:147], v231 offset:51008
    v_mfma_f32_16x16x32_bf16 v[116:119], v[152:155], a[184:187], v[116:119]
    ds_read_b64_tr_b16 v[148:149], v231 offset:51264
    ds_read_b64_tr_b16 v[150:151], v231 offset:51520
    v_mfma_f32_16x16x32_bf16 v[84:87], v[152:155], a[176:179], v[84:87]
    s_add_u32 m0, s61, 84576
    v_mfma_f32_16x16x32_bf16 v[84:87], v[156:159], a[180:183], v[84:87]
    buffer_load_dwordx4 v3, s[20:23], s64 offen offset:3072  lds
    v_mfma_f32_16x16x32_bf16 v[52:55], v[156:159], a[172:175], v[52:55]
    s_add_u32 s64, s64, 16384
    v_mfma_f32_16x16x32_bf16 v[52:55], v[152:155], a[168:171], v[52:55]
    v_mfma_f32_16x16x32_bf16 v[20:23], v[152:155], a[160:163], v[20:23]
    v_mfma_f32_16x16x32_bf16 v[20:23], v[156:159], a[164:167], v[20:23]
    s_waitcnt lgkmcnt(0)
    v_mfma_f32_16x16x32_bf16 v[24:27], v[144:147], a[160:163], v[24:27]
    ds_read_b64_tr_b16 v[152:153], v231 offset:50760
    ds_read_b64_tr_b16 v[154:155], v231 offset:51016
    v_mfma_f32_16x16x32_bf16 v[24:27], v[148:151], a[164:167], v[24:27]
    ds_read_b64_tr_b16 v[156:157], v231 offset:51272
    ds_read_b64_tr_b16 v[158:159], v231 offset:51528
    v_mfma_f32_16x16x32_bf16 v[56:59], v[148:151], a[172:175], v[56:59]
    v_lshlrev_b32 v14, 4, v12
    v_lshl_add_u32 v14, v10, 2, v14
    v_mfma_f32_16x16x32_bf16 v[56:59], v[144:147], a[168:171], v[56:59]
    v_lshlrev_b32 v14, 11, v14
    v_lshl_add_u32 v2, v13, 4, v14
    s_lshl_b32 s67, s58, 17
    v_mfma_f32_16x16x32_bf16 v[88:91], v[144:147], a[176:179], v[88:91]
    s_add_u32 s65, s67, 1048576
    s_mov_b32 s40, 256000
    s_lshr_b32 s44, s57, 1
    v_mfma_f32_16x16x32_bf16 v[88:91], v[148:151], a[180:183], v[88:91]
    s_lshl_b32 s44, s44, 8
    s_add_u32 s8, s76, s44
    s_addc_u32 s9, s77, 0
    v_mfma_f32_16x16x32_bf16 v[120:123], v[148:151], a[188:191], v[120:123]
    s_and_b32 s9, s9, 0xffff
    s_mov_b32 s10, 8386816
    s_mov_b32 s11, 0x20000
    v_mfma_f32_16x16x32_bf16 v[120:123], v[144:147], a[184:187], v[120:123]
    s_waitcnt lgkmcnt(0)
    v_mfma_f32_16x16x32_bf16 v[124:127], v[156:159], a[188:191], v[124:127]
    ds_read_b64_tr_b16 v[144:145], v231 offset:50816
    ds_read_b64_tr_b16 v[146:147], v231 offset:51072
    v_mfma_f32_16x16x32_bf16 v[124:127], v[152:155], a[184:187], v[124:127]
    ds_read_b64_tr_b16 v[148:149], v231 offset:51328
    ds_read_b64_tr_b16 v[150:151], v231 offset:51584
    v_mfma_f32_16x16x32_bf16 v[92:95], v[152:155], a[176:179], v[92:95]
    s_lshr_b32 s44, s56, 1
    s_lshl_b32 s44, s44, 13
    s_mul_i32 s45, s58, 7168
    v_mfma_f32_16x16x32_bf16 v[92:95], v[156:159], a[180:183], v[92:95]
    s_add_u32 s44, s44, s45
    s_add_u32 s44, s44, 524288
    v_mfma_f32_16x16x32_bf16 v[60:63], v[156:159], a[172:175], v[60:63]
    v_and_b32 v229, 7, v11
    v_lshl_add_u32 v229, v229, 7, s44
    s_xor_b32 s44, s58, 1
    v_mfma_f32_16x16x32_bf16 v[60:63], v[152:155], a[168:171], v[60:63]
    s_mul_i32 s41, s44, 4293920768
    s_add_u32 s41, s41, 524288
    s_mul_i32 s42, s44, 4294574080
    v_mfma_f32_16x16x32_bf16 v[28:31], v[152:155], a[160:163], v[28:31]
    s_add_u32 s42, s42, 256000
    s_mul_i32 s43, s58, 1
    s_sub_u32 s43, 6, s43
    v_mfma_f32_16x16x32_bf16 v[28:31], v[156:159], a[164:167], v[28:31]
    s_waitcnt lgkmcnt(0)
    v_mfma_f32_16x16x32_bf16 v[32:35], v[144:147], a[160:163], v[32:35]
    ds_read_b64_tr_b16 v[152:153], v231 offset:50824
    ds_read_b64_tr_b16 v[154:155], v231 offset:51080
    v_mfma_f32_16x16x32_bf16 v[32:35], v[148:151], a[164:167], v[32:35]
    ds_read_b64_tr_b16 v[156:157], v231 offset:51336
    ds_read_b64_tr_b16 v[158:159], v231 offset:51592
    v_mfma_f32_16x16x32_bf16 v[64:67], v[148:151], a[172:175], v[64:67]
    s_lshl_b32 s45, s56, 13
    s_add_u32 s45, s45, 16777216
    s_add_u32 s12, s96, s45
    v_mfma_f32_16x16x32_bf16 v[64:67], v[144:147], a[168:171], v[64:67]
    s_addc_u32 s13, s97, 0
    s_and_b32 s13, s13, 0xffff
    s_mov_b32 s14, 16261120
    v_mfma_f32_16x16x32_bf16 v[96:99], v[144:147], a[176:179], v[96:99]
    s_mov_b32 s15, 0x20000
    s_cmp_lt_u32 s2, 224
    s_cselect_b32 s46, 7340032, 0
    v_mfma_f32_16x16x32_bf16 v[96:99], v[148:151], a[180:183], v[96:99]
    s_mov_b32 s28, s82
    s_and_b32 s29, s83, 0xffff
    s_mov_b32 s30, s46
    v_mfma_f32_16x16x32_bf16 v[128:131], v[148:151], a[188:191], v[128:131]
    s_mov_b32 s31, 0x20000
    s_mov_b32 s32, s84
    s_and_b32 s33, s85, 0xffff
    v_mfma_f32_16x16x32_bf16 v[128:131], v[144:147], a[184:187], v[128:131]
    s_waitcnt lgkmcnt(0)
    v_mfma_f32_16x16x32_bf16 v[132:135], v[156:159], a[188:191], v[132:135]
    ds_read_b64_tr_b16 v[144:145], v231 offset:50880
    ds_read_b64_tr_b16 v[146:147], v231 offset:51136
    v_mfma_f32_16x16x32_bf16 v[132:135], v[152:155], a[184:187], v[132:135]
    ds_read_b64_tr_b16 v[148:149], v231 offset:51392
    ds_read_b64_tr_b16 v[150:151], v231 offset:51648
    v_mfma_f32_16x16x32_bf16 v[100:103], v[152:155], a[176:179], v[100:103]
    s_mov_b32 s34, s46
    s_mov_b32 s35, 0x20000
    v_mfma_f32_16x16x32_bf16 v[100:103], v[156:159], a[180:183], v[100:103]
    v_add_u32 v6, 0, v1
    v_add_u32 v7, 4096, v1
    v_mfma_f32_16x16x32_bf16 v[68:71], v[156:159], a[172:175], v[68:71]
    v_add_u32 v8, 8192, v1
    v_add_u32 v9, 12288, v1
    v_mfma_f32_16x16x32_bf16 v[68:71], v[152:155], a[168:171], v[68:71]
    v_lshrrev_b32 v14, 5, v11
    v_and_b32 v15, 0x1ff, v1
    v_mfma_f32_16x16x32_bf16 v[36:39], v[152:155], a[160:163], v[36:39]
    v_lshl_add_u32 v14, v14, 11, v15
    v_lshl_add_u32 v238, v10, 9, v14
    s_getpc_b64 s[50:51]
L_pc_1001:
    v_mfma_f32_16x16x32_bf16 v[36:39], v[156:159], a[164:167], v[36:39]
    s_waitcnt lgkmcnt(0)
    v_mfma_f32_16x16x32_bf16 v[40:43], v[144:147], a[160:163], v[40:43]
    ds_read_b64_tr_b16 v[152:153], v231 offset:50888
    ds_read_b64_tr_b16 v[154:155], v231 offset:51144
    v_mfma_f32_16x16x32_bf16 v[40:43], v[148:151], a[164:167], v[40:43]
    ds_read_b64_tr_b16 v[156:157], v231 offset:51400
    ds_read_b64_tr_b16 v[158:159], v231 offset:51656
    v_mfma_f32_16x16x32_bf16 v[72:75], v[148:151], a[172:175], v[72:75]
    s_lshr_b32 s44, s2, 3
    s_lshl_b32 s44, s44, 4
    v_mfma_f32_16x16x32_bf16 v[72:75], v[144:147], a[168:171], v[72:75]
    v_and_b32 v236, 3, v0
    v_lshl_add_u32 v236, v10, 2, v236
    v_mfma_f32_16x16x32_bf16 v[104:107], v[144:147], a[176:179], v[104:107]
    v_add_u32 v236, s44, v236
    v_lshlrev_b32 v236, 6, v236
    v_mfma_f32_16x16x32_bf16 v[104:107], v[148:151], a[180:183], v[104:107]
    v_min_u32 v236, L_code_tail-L_code_mid-4, v236
    v_add_u32 v236, L_code_mid-L_pc_1001, v236
    v_mfma_f32_16x16x32_bf16 v[136:139], v[148:151], a[188:191], v[136:139]
    v_mov_b32 v237, s51
    v_add_co_u32 v236, vcc, s50, v236
    s_nop 1
    v_mfma_f32_16x16x32_bf16 v[136:139], v[144:147], a[184:187], v[136:139]
    s_waitcnt vmcnt(21) lgkmcnt(0)
    s_barrier
    v_mfma_f32_16x16x32_bf16 v[140:143], v[156:159], a[188:191], v[140:143]
    v_mfma_f32_16x16x32_bf16 v[140:143], v[152:155], a[184:187], v[140:143]
    v_mfma_f32_16x16x32_bf16 v[108:111], v[152:155], a[176:179], v[108:111]
    v_addc_co_u32 v237, vcc, 0, v237, vcc
    s_mul_i32 s44, s3, 1835008
    s_xor_b32 s45, s59, 4
    v_mfma_f32_16x16x32_bf16 v[108:111], v[156:159], a[180:183], v[108:111]
    s_lshl_b32 s45, s45, 5
    s_add_u32 s44, s44, s45
    s_mov_b32 s45, -12
    v_mfma_f32_16x16x32_bf16 v[76:79], v[156:159], a[172:175], v[76:79]
    s_mov_b32 s66, 0
    s_lshl_b32 s46, s58, 5
    s_add_u32 s46, s46, s54
    v_mfma_f32_16x16x32_bf16 v[76:79], v[152:155], a[168:171], v[76:79]
    s_lshl_b32 s46, s46, 17
    s_mov_b32 s47, 0
    s_mov_b32 s50, 0x400293ee
    v_mfma_f32_16x16x32_bf16 v[44:47], v[152:155], a[160:163], v[44:47]
    s_mov_b32 s51, s50
    v_mov_b32 v232, -1
    v_mfma_f32_16x16x32_bf16 v[44:47], v[156:159], a[164:167], v[44:47]
    v_mov_b32 v233, -1
    v_mov_b32 v234, -1
    v_mov_b32 v235, -1
    v_mov_b32 v240, 0x41500000
    v_mov_b32 v241, 0x41500000
    v_mov_b32 v242, 0x41500000
    v_mov_b32 v243, 0x41500000
    v_mov_b32 v224, 0x3f803f80
    v_mov_b32 v225, 0x3f803f80
    v_mov_b32 v226, 0x3f803f80
    v_mov_b32 v227, 0x3f803f80
L_code_att:
    ds_read_b128 v[176:179], v5 offset:0
    ds_read_b128 v[180:183], v5 offset:64
    ds_read_b128 v[184:187], v5 offset:128
    ds_read_b128 v[188:191], v5 offset:192
    ds_read_b128 v[192:195], v5 offset:256
    v_pk_mul_f32 v[16:17], v[16:17], s[50:51]
    v_pk_mul_f32 v[18:19], v[18:19], s[50:51]
    v_pk_mul_f32 v[20:21], v[20:21], s[50:51]
    v_pk_mul_f32 v[22:23], v[22:23], s[50:51]
    v_cvt_pk_bf16_f32 v16, v16, v17
    v_cvt_pk_bf16_f32 v17, v18, v19
    v_cvt_pk_bf16_f32 v18, v20, v21
    v_cvt_pk_bf16_f32 v19, v22, v23
    v_pk_mul_f32 v[24:25], v[24:25], s[50:51]
    v_pk_mul_f32 v[26:27], v[26:27], s[50:51]
    v_pk_mul_f32 v[28:29], v[28:29], s[50:51]
    v_pk_mul_f32 v[30:31], v[30:31], s[50:51]
    v_cvt_pk_bf16_f32 v20, v24, v25
    v_cvt_pk_bf16_f32 v21, v26, v27
    v_cvt_pk_bf16_f32 v22, v28, v29
    v_cvt_pk_bf16_f32 v23, v30, v31
    v_pk_mul_f32 v[32:33], v[32:33], s[50:51]
    v_pk_mul_f32 v[34:35], v[34:35], s[50:51]
    v_pk_mul_f32 v[36:37], v[36:37], s[50:51]
    v_pk_mul_f32 v[38:39], v[38:39], s[50:51]
    v_cvt_pk_bf16_f32 v24, v32, v33
    v_cvt_pk_bf16_f32 v25, v34, v35
    v_cvt_pk_bf16_f32 v26, v36, v37
    v_cvt_pk_bf16_f32 v27, v38, v39
    v_pk_mul_f32 v[40:41], v[40:41], s[50:51]
    v_pk_mul_f32 v[42:43], v[42:43], s[50:51]
    v_pk_mul_f32 v[44:45], v[44:45], s[50:51]
    v_pk_mul_f32 v[46:47], v[46:47], s[50:51]
    v_cvt_pk_bf16_f32 v28, v40, v41
    v_cvt_pk_bf16_f32 v29, v42, v43
    v_cvt_pk_bf16_f32 v30, v44, v45
    v_cvt_pk_bf16_f32 v31, v46, v47
    v_pk_mul_f32 v[48:49], v[48:49], s[50:51]
    v_pk_mul_f32 v[50:51], v[50:51], s[50:51]
    v_pk_mul_f32 v[52:53], v[52:53], s[50:51]
    v_pk_mul_f32 v[54:55], v[54:55], s[50:51]
    v_cvt_pk_bf16_f32 v32, v48, v49
    v_cvt_pk_bf16_f32 v33, v50, v51
    v_cvt_pk_bf16_f32 v34, v52, v53
    v_cvt_pk_bf16_f32 v35, v54, v55
    v_pk_mul_f32 v[56:57], v[56:57], s[50:51]
    v_pk_mul_f32 v[58:59], v[58:59], s[50:51]
    v_pk_mul_f32 v[60:61], v[60:61], s[50:51]
    v_pk_mul_f32 v[62:63], v[62:63], s[50:51]
    v_cvt_pk_bf16_f32 v36, v56, v57
    v_cvt_pk_bf16_f32 v37, v58, v59
    v_cvt_pk_bf16_f32 v38, v60, v61
    v_cvt_pk_bf16_f32 v39, v62, v63
    v_pk_mul_f32 v[64:65], v[64:65], s[50:51]
    v_pk_mul_f32 v[66:67], v[66:67], s[50:51]
    v_pk_mul_f32 v[68:69], v[68:69], s[50:51]
    v_pk_mul_f32 v[70:71], v[70:71], s[50:51]
    v_cvt_pk_bf16_f32 v40, v64, v65
    v_cvt_pk_bf16_f32 v41, v66, v67
    v_cvt_pk_bf16_f32 v42, v68, v69
    v_cvt_pk_bf16_f32 v43, v70, v71
    v_pk_mul_f32 v[72:73], v[72:73], s[50:51]
    v_pk_mul_f32 v[74:75], v[74:75], s[50:51]
    v_pk_mul_f32 v[76:77], v[76:77], s[50:51]
    v_pk_mul_f32 v[78:79], v[78:79], s[50:51]
    v_cvt_pk_bf16_f32 v44, v72, v73
    v_cvt_pk_bf16_f32 v45, v74, v75
    v_cvt_pk_bf16_f32 v46, v76, v77
    v_cvt_pk_bf16_f32 v47, v78, v79
    v_pk_mul_f32 v[80:81], v[80:81], s[50:51]
    v_pk_mul_f32 v[82:83], v[82:83], s[50:51]
    v_pk_mul_f32 v[84:85], v[84:85], s[50:51]
    v_pk_mul_f32 v[86:87], v[86:87], s[50:51]
    v_cvt_pk_bf16_f32 v48, v80, v81
    v_cvt_pk_bf16_f32 v49, v82, v83
    v_cvt_pk_bf16_f32 v50, v84, v85
    v_cvt_pk_bf16_f32 v51, v86, v87
    v_pk_mul_f32 v[88:89], v[88:89], s[50:51]
    v_pk_mul_f32 v[90:91], v[90:91], s[50:51]
    v_pk_mul_f32 v[92:93], v[92:93], s[50:51]
    v_pk_mul_f32 v[94:95], v[94:95], s[50:51]
    v_cvt_pk_bf16_f32 v52, v88, v89
    v_cvt_pk_bf16_f32 v53, v90, v91
    v_cvt_pk_bf16_f32 v54, v92, v93
    v_cvt_pk_bf16_f32 v55, v94, v95
    v_pk_mul_f32 v[96:97], v[96:97], s[50:51]
    v_pk_mul_f32 v[98:99], v[98:99], s[50:51]
    v_pk_mul_f32 v[100:101], v[100:101], s[50:51]
    v_pk_mul_f32 v[102:103], v[102:103], s[50:51]
    v_cvt_pk_bf16_f32 v56, v96, v97
    v_cvt_pk_bf16_f32 v57, v98, v99
    v_cvt_pk_bf16_f32 v58, v100, v101
    v_cvt_pk_bf16_f32 v59, v102, v103
    v_pk_mul_f32 v[104:105], v[104:105], s[50:51]
    v_pk_mul_f32 v[106:107], v[106:107], s[50:51]
    v_pk_mul_f32 v[108:109], v[108:109], s[50:51]
    v_pk_mul_f32 v[110:111], v[110:111], s[50:51]
    v_cvt_pk_bf16_f32 v60, v104, v105
    v_cvt_pk_bf16_f32 v61, v106, v107
    v_cvt_pk_bf16_f32 v62, v108, v109
    v_cvt_pk_bf16_f32 v63, v110, v111
    v_pk_mul_f32 v[112:113], v[112:113], s[50:51]
    v_pk_mul_f32 v[114:115], v[114:115], s[50:51]
    v_pk_mul_f32 v[116:117], v[116:117], s[50:51]
    v_pk_mul_f32 v[118:119], v[118:119], s[50:51]
    v_cvt_pk_bf16_f32 v64, v112, v113
    v_cvt_pk_bf16_f32 v65, v114, v115
    v_cvt_pk_bf16_f32 v66, v116, v117
    v_cvt_pk_bf16_f32 v67, v118, v119
    v_pk_mul_f32 v[120:121], v[120:121], s[50:51]
    v_pk_mul_f32 v[122:123], v[122:123], s[50:51]
    v_pk_mul_f32 v[124:125], v[124:125], s[50:51]
    v_pk_mul_f32 v[126:127], v[126:127], s[50:51]
    v_cvt_pk_bf16_f32 v68, v120, v121
    v_cvt_pk_bf16_f32 v69, v122, v123
    v_cvt_pk_bf16_f32 v70, v124, v125
    v_cvt_pk_bf16_f32 v71, v126, v127
    v_pk_mul_f32 v[128:129], v[128:129], s[50:51]
    v_pk_mul_f32 v[130:131], v[130:131], s[50:51]
    v_pk_mul_f32 v[132:133], v[132:133], s[50:51]
    v_pk_mul_f32 v[134:135], v[134:135], s[50:51]
    v_cvt_pk_bf16_f32 v72, v128, v129
    v_cvt_pk_bf16_f32 v73, v130, v131
    v_cvt_pk_bf16_f32 v74, v132, v133
    v_cvt_pk_bf16_f32 v75, v134, v135
    v_pk_mul_f32 v[136:137], v[136:137], s[50:51]
    v_pk_mul_f32 v[138:139], v[138:139], s[50:51]
    v_pk_mul_f32 v[140:141], v[140:141], s[50:51]
    v_pk_mul_f32 v[142:143], v[142:143], s[50:51]
    v_cvt_pk_bf16_f32 v76, v136, v137
    v_cvt_pk_bf16_f32 v77, v138, v139
    v_cvt_pk_bf16_f32 v78, v140, v141
    v_cvt_pk_bf16_f32 v79, v142, v143
    s_waitcnt lgkmcnt(1)
    v_mfma_f32_16x16x32_bf16 v[80:83], v[176:179], v[16:19], v[240:243]
    v_mfma_f32_16x16x32_bf16 v[80:83], v[180:183], v[20:23], v[80:83]
    v_mfma_f32_16x16x32_bf16 v[80:83], v[184:187], v[24:27], v[80:83]
    v_mfma_f32_16x16x32_bf16 v[80:83], v[188:191], v[28:31], v[80:83]
    ds_read_b128 v[196:199], v5 offset:320
    v_mfma_f32_16x16x32_bf16 v[84:87], v[188:191], v[44:47], v[240:243]
    v_mfma_f32_16x16x32_bf16 v[84:87], v[184:187], v[40:43], v[84:87]
    v_mfma_f32_16x16x32_bf16 v[84:87], v[180:183], v[36:39], v[84:87]
    v_mfma_f32_16x16x32_bf16 v[84:87], v[176:179], v[32:35], v[84:87]
    ds_read_b128 v[200:203], v5 offset:384
    s_nop 1
    v_mfma_f32_16x16x32_bf16 v[88:91], v[176:179], v[48:51], v[240:243]
    v_exp_f32 v80, v80
    v_mfma_f32_16x16x32_bf16 v[88:91], v[180:183], v[52:55], v[88:91]
    v_exp_f32 v81, v81
    v_mfma_f32_16x16x32_bf16 v[88:91], v[184:187], v[56:59], v[88:91]
    v_exp_f32 v82, v82
    v_mfma_f32_16x16x32_bf16 v[88:91], v[188:191], v[60:63], v[88:91]
    ds_read_b128 v[204:207], v5 offset:448
    v_exp_f32 v83, v83
    v_mfma_f32_16x16x32_bf16 v[92:95], v[188:191], v[76:79], v[240:243]
    v_cvt_pk_bf16_f32 v112, v80, v81
    v_cvt_pk_bf16_f32 v113, v82, v83
    v_exp_f32 v84, v84
    v_mfma_f32_16x16x32_bf16 v[92:95], v[184:187], v[72:75], v[92:95]
    v_exp_f32 v85, v85
    v_mfma_f32_16x16x32_bf16 v[92:95], v[180:183], v[68:71], v[92:95]
    v_exp_f32 v86, v86
    v_mfma_f32_16x16x32_bf16 v[92:95], v[176:179], v[64:67], v[92:95]
    ds_read_b128 v[176:179], v5 offset:512
    v_exp_f32 v87, v87
    s_waitcnt lgkmcnt(1)
    v_mfma_f32_16x16x32_bf16 v[80:83], v[192:195], v[16:19], v[240:243]
    v_cvt_pk_bf16_f32 v120, v84, v85
    v_cvt_pk_bf16_f32 v121, v86, v87
    v_exp_f32 v88, v88
    v_mfma_f32_16x16x32_bf16 v[80:83], v[196:199], v[20:23], v[80:83]
    v_exp_f32 v89, v89
    v_mfma_f32_16x16x32_bf16 v[80:83], v[200:203], v[24:27], v[80:83]
    v_exp_f32 v90, v90
    v_mfma_f32_16x16x32_bf16 v[80:83], v[204:207], v[28:31], v[80:83]
    ds_read_b128 v[180:183], v5 offset:576
    v_exp_f32 v91, v91
    v_mfma_f32_16x16x32_bf16 v[84:87], v[204:207], v[44:47], v[240:243]
    v_cvt_pk_bf16_f32 v128, v88, v89
    v_cvt_pk_bf16_f32 v129, v90, v91
    v_exp_f32 v92, v92
    v_mfma_f32_16x16x32_bf16 v[84:87], v[200:203], v[40:43], v[84:87]
    v_exp_f32 v93, v93
    v_mfma_f32_16x16x32_bf16 v[84:87], v[196:199], v[36:39], v[84:87]
    v_exp_f32 v94, v94
    v_mfma_f32_16x16x32_bf16 v[84:87], v[192:195], v[32:35], v[84:87]
    ds_read_b128 v[184:187], v5 offset:640
    v_exp_f32 v95, v95
    v_mfma_f32_16x16x32_bf16 v[88:91], v[192:195], v[48:51], v[240:243]
    v_cvt_pk_bf16_f32 v136, v92, v93
    v_cvt_pk_bf16_f32 v137, v94, v95
    v_exp_f32 v80, v80
    v_mfma_f32_16x16x32_bf16 v[88:91], v[196:199], v[52:55], v[88:91]
    v_exp_f32 v81, v81
    v_mfma_f32_16x16x32_bf16 v[88:91], v[200:203], v[56:59], v[88:91]
    v_exp_f32 v82, v82
    v_mfma_f32_16x16x32_bf16 v[88:91], v[204:207], v[60:63], v[88:91]
    ds_read_b128 v[188:191], v5 offset:704
    v_exp_f32 v83, v83
    v_mfma_f32_16x16x32_bf16 v[92:95], v[204:207], v[76:79], v[240:243]
    v_cvt_pk_bf16_f32 v114, v80, v81
    v_cvt_pk_bf16_f32 v115, v82, v83
    v_exp_f32 v84, v84
    v_mfma_f32_16x16x32_bf16 v[92:95], v[200:203], v[72:75], v[92:95]
    v_exp_f32 v85, v85
    v_mfma_f32_16x16x32_bf16 v[92:95], v[196:199], v[68:71], v[92:95]
    v_exp_f32 v86, v86
    v_mfma_f32_16x16x32_bf16 v[92:95], v[192:195], v[64:67], v[92:95]
    ds_read_b128 v[192:195], v5 offset:768
    v_exp_f32 v87, v87
    s_waitcnt lgkmcnt(1)
    v_mfma_f32_16x16x32_bf16 v[80:83], v[176:179], v[16:19], v[240:243]
    v_cvt_pk_bf16_f32 v122, v84, v85
    v_cvt_pk_bf16_f32 v123, v86, v87
    v_exp_f32 v88, v88
    v_mfma_f32_16x16x32_bf16 v[80:83], v[180:183], v[20:23], v[80:83]
    v_exp_f32 v89, v89
    v_mfma_f32_16x16x32_bf16 v[80:83], v[184:187], v[24:27], v[80:83]
    v_exp_f32 v90, v90
    v_mfma_f32_16x16x32_bf16 v[80:83], v[188:191], v[28:31], v[80:83]
    ds_read_b128 v[196:199], v5 offset:832
    v_exp_f32 v91, v91
    v_mfma_f32_16x16x32_bf16 v[84:87], v[188:191], v[44:47], v[240:243]
    v_cvt_pk_bf16_f32 v130, v88, v89
    v_cvt_pk_bf16_f32 v131, v90, v91
    v_exp_f32 v92, v92
    v_mfma_f32_16x16x32_bf16 v[84:87], v[184:187], v[40:43], v[84:87]
    v_exp_f32 v93, v93
    v_mfma_f32_16x16x32_bf16 v[84:87], v[180:183], v[36:39], v[84:87]
    v_exp_f32 v94, v94
    v_mfma_f32_16x16x32_bf16 v[84:87], v[176:179], v[32:35], v[84:87]
    ds_read_b128 v[200:203], v5 offset:896
    v_exp_f32 v95, v95
    v_mfma_f32_16x16x32_bf16 v[88:91], v[176:179], v[48:51], v[240:243]
    v_cvt_pk_bf16_f32 v138, v92, v93
    v_cvt_pk_bf16_f32 v139, v94, v95
    v_exp_f32 v80, v80
    v_mfma_f32_16x16x32_bf16 v[88:91], v[180:183], v[52:55], v[88:91]
    v_exp_f32 v81, v81
    v_mfma_f32_16x16x32_bf16 v[88:91], v[184:187], v[56:59], v[88:91]
    v_exp_f32 v82, v82
    v_mfma_f32_16x16x32_bf16 v[88:91], v[188:191], v[60:63], v[88:91]
    ds_read_b128 v[204:207], v5 offset:960
    v_exp_f32 v83, v83
    s_waitcnt vmcnt(8)
    s_barrier
    v_mfma_f32_16x16x32_bf16 v[92:95], v[188:191], v[76:79], v[240:243]
    s_add_u32 m0, s61, 50688
    v_cvt_pk_bf16_f32 v116, v80, v81
    v_cvt_pk_bf16_f32 v117, v82, v83
    v_exp_f32 v84, v84
    v_mfma_f32_16x16x32_bf16 v[92:95], v[184:187], v[72:75], v[92:95]
    buffer_load_dwordx4 v3, s[16:19], s63 offen offset:0  lds
    v_exp_f32 v85, v85
    v_mfma_f32_16x16x32_bf16 v[92:95], v[180:183], v[68:71], v[92:95]
    v_exp_f32 v86, v86
    v_mfma_f32_16x16x32_bf16 v[92:95], v[176:179], v[64:67], v[92:95]
    ds_read_b128 v[176:179], v5 offset:16896
    v_exp_f32 v87, v87
    s_waitcnt lgkmcnt(1)
    v_mfma_f32_16x16x32_bf16 v[80:83], v[192:195], v[16:19], v[240:243]
    v_cvt_pk_bf16_f32 v124, v84, v85
    v_cvt_pk_bf16_f32 v125, v86, v87
    v_exp_f32 v88, v88
    v_mfma_f32_16x16x32_bf16 v[80:83], v[196:199], v[20:23], v[80:83]
    v_exp_f32 v89, v89
    v_mfma_f32_16x16x32_bf16 v[80:83], v[200:203], v[24:27], v[80:83]
    v_exp_f32 v90, v90
    v_mfma_f32_16x16x32_bf16 v[80:83], v[204:207], v[28:31], v[80:83]
    ds_read_b128 v[180:183], v5 offset:16960
    v_exp_f32 v91, v91
    v_mfma_f32_16x16x32_bf16 v[84:87], v[204:207], v[44:47], v[240:243]
    s_add_u32 m0, s61, 50720
    v_cvt_pk_bf16_f32 v132, v88, v89
    v_cvt_pk_bf16_f32 v133, v90, v91
    v_exp_f32 v92, v92
    v_mfma_f32_16x16x32_bf16 v[84:87], v[200:203], v[40:43], v[84:87]
    buffer_load_dwordx4 v3, s[16:19], s63 offen offset:1024  lds
    v_exp_f32 v93, v93
    v_mfma_f32_16x16x32_bf16 v[84:87], v[196:199], v[36:39], v[84:87]
    v_exp_f32 v94, v94
    v_mfma_f32_16x16x32_bf16 v[84:87], v[192:195], v[32:35], v[84:87]
    ds_read_b128 v[184:187], v5 offset:17024
    v_exp_f32 v95, v95
    v_mfma_f32_16x16x32_bf16 v[88:91], v[192:195], v[48:51], v[240:243]
    v_cvt_pk_bf16_f32 v140, v92, v93
    v_cvt_pk_bf16_f32 v141, v94, v95
    v_exp_f32 v80, v80
    v_mfma_f32_16x16x32_bf16 v[88:91], v[196:199], v[52:55], v[88:91]
    v_exp_f32 v81, v81
    v_mfma_f32_16x16x32_bf16 v[88:91], v[200:203], v[56:59], v[88:91]
    v_exp_f32 v82, v82
    v_mfma_f32_16x16x32_bf16 v[88:91], v[204:207], v[60:63], v[88:91]
    ds_read_b128 v[188:191], v5 offset:17088
    v_exp_f32 v83, v83
    v_mfma_f32_16x16x32_bf16 v[92:95], v[204:207], v[76:79], v[240:243]
    s_add_u32 m0, s61, 50752
    ds_read_b64_tr_b16 v[208:209], v4 offset:0
    ds_read_b64_tr_b16 v[210:211], v4 offset:256
    v_cvt_pk_bf16_f32 v118, v80, v81
    v_cvt_pk_bf16_f32 v119, v82, v83
    v_exp_f32 v84, v84
    v_mfma_f32_16x16x32_bf16 v[92:95], v[200:203], v[72:75], v[92:95]
    buffer_load_dwordx4 v3, s[16:19], s63 offen offset:2048  lds
    v_exp_f32 v85, v85
    v_mfma_f32_16x16x32_bf16 v[92:95], v[196:199], v[68:71], v[92:95]
    v_exp_f32 v86, v86
    v_mfma_f32_16x16x32_bf16 v[92:95], v[192:195], v[64:67], v[92:95]
    ds_read_b128 v[192:195], v5 offset:17152
    v_exp_f32 v87, v87
    s_waitcnt lgkmcnt(3)
    s_nop 0
    v_cvt_pk_bf16_f32 v126, v84, v85
    v_cvt_pk_bf16_f32 v127, v86, v87
    v_exp_f32 v88, v88
    v_exp_f32 v89, v89
    v_exp_f32 v90, v90
    v_exp_f32 v91, v91
    s_mov_b32 s49, 0
    .p2align 3
L_attn_16:
    v_mfma_f32_16x16x32_bf16 v[80:83], v[176:179], v[16:19], v[240:243]
    v_exp_f32 v92, v92
    v_mfma_f32_16x16x32_bf16 v[80:83], v[180:183], v[20:23], v[80:83]
    ds_read_b64_tr_b16 v[212:213], v4 offset:512
    ds_read_b64_tr_b16 v[214:215], v4 offset:768
    v_mfma_f32_16x16x32_bf16 v[80:83], v[184:187], v[24:27], v[80:83]
    v_exp_f32 v93, v93
    v_mfma_f32_16x16x32_bf16 v[80:83], v[188:191], v[28:31], v[80:83]
    v_cvt_pk_bf16_f32 v134, v88, v89
    v_cvt_pk_bf16_f32 v135, v90, v91
    v_mfma_f32_16x16x32_bf16 v[84:87], v[188:191], v[44:47], v[240:243]
    v_exp_f32 v94, v94
    v_mfma_f32_16x16x32_bf16 v[84:87], v[184:187], v[40:43], v[84:87]
    ds_read_b128 v[196:199], v5 offset:17216
    v_mfma_f32_16x16x32_bf16 v[84:87], v[180:183], v[36:39], v[84:87]
    v_exp_f32 v95, v95
    v_mfma_f32_16x16x32_bf16 v[84:87], v[176:179], v[32:35], v[84:87]
    v_mfma_f32_16x16x32_bf16 v[88:91], v[176:179], v[48:51], v[240:243]
    v_exp_f32 v80, v80
    v_mfma_f32_16x16x32_bf16 v[88:91], v[180:183], v[52:55], v[88:91]
    ds_read_b64_tr_b16 v[216:217], v4 offset:32
    ds_read_b64_tr_b16 v[218:219], v4 offset:288
    v_mfma_f32_16x16x32_bf16 v[88:91], v[184:187], v[56:59], v[88:91]
    v_exp_f32 v81, v81
    v_mfma_f32_16x16x32_bf16 v[88:91], v[188:191], v[60:63], v[88:91]
    v_cvt_pk_bf16_f32 v142, v92, v93
    v_cvt_pk_bf16_f32 v143, v94, v95
    v_mfma_f32_16x16x32_bf16 v[92:95], v[188:191], v[76:79], v[240:243]
    v_exp_f32 v82, v82
    v_mfma_f32_16x16x32_bf16 v[92:95], v[184:187], v[72:75], v[92:95]
    ds_read_b128 v[200:203], v5 offset:17280
    v_mfma_f32_16x16x32_bf16 v[92:95], v[180:183], v[68:71], v[92:95]
    s_add_u32 m0, s61, 50784
    v_exp_f32 v83, v83
    v_mfma_f32_16x16x32_bf16 v[92:95], v[176:179], v[64:67], v[92:95]
    s_waitcnt lgkmcnt(4)
    buffer_load_dwordx4 v3, s[16:19], s63 offen offset:3072  lds
    s_add_u32 s63, s63, 16384
    v_mfma_f32_16x16x32_bf16 a[0:3], v[208:211], v[112:115], a[0:3]
    v_exp_f32 v84, v84
    v_mfma_f32_16x16x32_bf16 a[0:3], v[212:215], v[116:119], a[0:3]
    ds_read_b64_tr_b16 v[220:221], v4 offset:544
    ds_read_b64_tr_b16 v[222:223], v4 offset:800
    v_mfma_f32_16x16x32_bf16 a[32:35], v[208:211], v[120:123], a[32:35]
    v_exp_f32 v85, v85
    v_mfma_f32_16x16x32_bf16 a[32:35], v[212:215], v[124:127], a[32:35]
    v_cvt_pk_bf16_f32 v144, v80, v81
    v_cvt_pk_bf16_f32 v145, v82, v83
    v_mfma_f32_16x16x32_bf16 a[64:67], v[208:211], v[128:131], a[64:67]
    v_exp_f32 v86, v86
    v_mfma_f32_16x16x32_bf16 a[64:67], v[212:215], v[132:135], a[64:67]
    ds_read_b128 v[204:207], v5 offset:17344
    v_mfma_f32_16x16x32_bf16 a[96:99], v[208:211], v[136:139], a[96:99]
    v_exp_f32 v87, v87
    v_mfma_f32_16x16x32_bf16 a[96:99], v[212:215], v[140:143], a[96:99]
    s_waitcnt lgkmcnt(4)
    v_mfma_f32_16x16x32_bf16 a[100:103], v[216:219], v[136:139], a[100:103]
    s_waitcnt lgkmcnt(1)
    v_exp_f32 v88, v88
    v_mfma_f32_16x16x32_bf16 a[100:103], v[220:223], v[140:143], a[100:103]
    ds_read_b64_tr_b16 v[208:209], v4 offset:64
    ds_read_b64_tr_b16 v[210:211], v4 offset:320
    v_mfma_f32_16x16x32_bf16 a[68:71], v[216:219], v[128:131], a[68:71]
    v_exp_f32 v89, v89
    v_mfma_f32_16x16x32_bf16 a[68:71], v[220:223], v[132:135], a[68:71]
    v_cvt_pk_bf16_f32 v152, v84, v85
    v_cvt_pk_bf16_f32 v153, v86, v87
    v_mfma_f32_16x16x32_bf16 a[36:39], v[216:219], v[120:123], a[36:39]
    v_exp_f32 v90, v90
    v_mfma_f32_16x16x32_bf16 a[36:39], v[220:223], v[124:127], a[36:39]
    ds_read_b128 v[176:179], v5 offset:17408
    v_mfma_f32_16x16x32_bf16 a[4:7], v[216:219], v[112:115], a[4:7]
    s_add_u32 m0, s61, 101376
    v_exp_f32 v91, v91
    v_mfma_f32_16x16x32_bf16 a[4:7], v[220:223], v[116:119], a[4:7]
    buffer_load_dwordx4 v3, s[20:23], s64 offen offset:0  lds
    v_smfmac_f32_16x16x64_bf16 a[128:131], v[224:227], v[112:119], v228
    s_waitcnt lgkmcnt(3)
    v_mfma_f32_16x16x32_bf16 v[80:83], v[192:195], v[16:19], v[240:243]
    s_add_u32 s45, s45, 12
    v_exp_f32 v92, v92
    v_mfma_f32_16x16x32_bf16 v[80:83], v[196:199], v[20:23], v[80:83]
    ds_read_b64_tr_b16 v[212:213], v4 offset:576
    ds_read_b64_tr_b16 v[214:215], v4 offset:832
    v_mfma_f32_16x16x32_bf16 v[80:83], v[200:203], v[24:27], v[80:83]
    v_exp_f32 v93, v93
    v_mfma_f32_16x16x32_bf16 v[80:83], v[204:207], v[28:31], v[80:83]
    v_cvt_pk_bf16_f32 v160, v88, v89
    v_cvt_pk_bf16_f32 v161, v90, v91
    v_mfma_f32_16x16x32_bf16 v[84:87], v[204:207], v[44:47], v[240:243]
    v_exp_f32 v94, v94
    v_mfma_f32_16x16x32_bf16 v[84:87], v[200:203], v[40:43], v[84:87]
    ds_read_b128 v[180:183], v5 offset:17472
    v_mfma_f32_16x16x32_bf16 v[84:87], v[196:199], v[36:39], v[84:87]
    v_exp_f32 v95, v95
    v_mfma_f32_16x16x32_bf16 v[84:87], v[192:195], v[32:35], v[84:87]
    v_mfma_f32_16x16x32_bf16 v[88:91], v[192:195], v[48:51], v[240:243]
    v_exp_f32 v80, v80
    v_mfma_f32_16x16x32_bf16 v[88:91], v[196:199], v[52:55], v[88:91]
    ds_read_b64_tr_b16 v[216:217], v4 offset:96
    ds_read_b64_tr_b16 v[218:219], v4 offset:352
    v_mfma_f32_16x16x32_bf16 v[88:91], v[200:203], v[56:59], v[88:91]
    v_exp_f32 v81, v81
    v_mfma_f32_16x16x32_bf16 v[88:91], v[204:207], v[60:63], v[88:91]
    v_cvt_pk_bf16_f32 v168, v92, v93
    v_cvt_pk_bf16_f32 v169, v94, v95
    v_mfma_f32_16x16x32_bf16 v[92:95], v[204:207], v[76:79], v[240:243]
    v_exp_f32 v82, v82
    v_mfma_f32_16x16x32_bf16 v[92:95], v[200:203], v[72:75], v[92:95]
    ds_read_b128 v[184:187], v5 offset:17536
    v_mfma_f32_16x16x32_bf16 v[92:95], v[196:199], v[68:71], v[92:95]
    s_add_u32 m0, s61, 101408
    v_exp_f32 v83, v83
    v_mfma_f32_16x16x32_bf16 v[92:95], v[192:195], v[64:67], v[92:95]
    s_waitcnt lgkmcnt(4)
    buffer_load_dwordx4 v3, s[20:23], s64 offen offset:1024  lds
    v_mfma_f32_16x16x32_bf16 a[8:11], v[208:211], v[112:115], a[8:11]
    v_exp_f32 v84, v84
    v_mfma_f32_16x16x32_bf16 a[8:11], v[212:215], v[116:119], a[8:11]
    ds_read_b64_tr_b16 v[220:221], v4 offset:608
    ds_read_b64_tr_b16 v[222:223], v4 offset:864
    v_mfma_f32_16x16x32_bf16 a[40:43], v[208:211], v[120:123], a[40:43]
    v_exp_f32 v85, v85
    v_mfma_f32_16x16x32_bf16 a[40:43], v[212:215], v[124:127], a[40:43]
    v_cvt_pk_bf16_f32 v146, v80, v81
    v_cvt_pk_bf16_f32 v147, v82, v83
    v_mfma_f32_16x16x32_bf16 a[72:75], v[208:211], v[128:131], a[72:75]
    v_exp_f32 v86, v86
    v_mfma_f32_16x16x32_bf16 a[72:75], v[212:215], v[132:135], a[72:75]
    ds_read_b128 v[188:191], v5 offset:17600
    v_mfma_f32_16x16x32_bf16 a[104:107], v[208:211], v[136:139], a[104:107]
    v_exp_f32 v87, v87
    v_mfma_f32_16x16x32_bf16 a[104:107], v[212:215], v[140:143], a[104:107]
    s_waitcnt lgkmcnt(4)
    v_mfma_f32_16x16x32_bf16 a[108:111], v[216:219], v[136:139], a[108:111]
    s_waitcnt lgkmcnt(1)
    v_exp_f32 v88, v88
    v_mfma_f32_16x16x32_bf16 a[108:111], v[220:223], v[140:143], a[108:111]
    ds_read_b64_tr_b16 v[208:209], v4 offset:128
    ds_read_b64_tr_b16 v[210:211], v4 offset:384
    v_mfma_f32_16x16x32_bf16 a[76:79], v[216:219], v[128:131], a[76:79]
    v_exp_f32 v89, v89
    v_mfma_f32_16x16x32_bf16 a[76:79], v[220:223], v[132:135], a[76:79]
    v_cvt_pk_bf16_f32 v154, v84, v85
    v_cvt_pk_bf16_f32 v155, v86, v87
    v_mfma_f32_16x16x32_bf16 a[44:47], v[216:219], v[120:123], a[44:47]
    v_exp_f32 v90, v90
    v_mfma_f32_16x16x32_bf16 a[44:47], v[220:223], v[124:127], a[44:47]
    ds_read_b128 v[192:195], v5 offset:17664
    v_mfma_f32_16x16x32_bf16 a[12:15], v[216:219], v[112:115], a[12:15]
    s_add_u32 m0, s61, 101440
    v_exp_f32 v91, v91
    v_mfma_f32_16x16x32_bf16 a[12:15], v[220:223], v[116:119], a[12:15]
    buffer_load_dwordx4 v3, s[20:23], s64 offen offset:2048  lds
    v_smfmac_f32_16x16x64_bf16 a[132:135], v[224:227], v[120:127], v228
    s_waitcnt lgkmcnt(3)
    v_mfma_f32_16x16x32_bf16 v[80:83], v[176:179], v[16:19], v[240:243]
    v_exp_f32 v92, v92
    v_mfma_f32_16x16x32_bf16 v[80:83], v[180:183], v[20:23], v[80:83]
    ds_read_b64_tr_b16 v[212:213], v4 offset:640
    ds_read_b64_tr_b16 v[214:215], v4 offset:896
    v_mfma_f32_16x16x32_bf16 v[80:83], v[184:187], v[24:27], v[80:83]
    v_exp_f32 v93, v93
    v_mfma_f32_16x16x32_bf16 v[80:83], v[188:191], v[28:31], v[80:83]
    v_cvt_pk_bf16_f32 v162, v88, v89
    v_cvt_pk_bf16_f32 v163, v90, v91
    v_mfma_f32_16x16x32_bf16 v[84:87], v[188:191], v[44:47], v[240:243]
    v_exp_f32 v94, v94
    v_mfma_f32_16x16x32_bf16 v[84:87], v[184:187], v[40:43], v[84:87]
    ds_read_b128 v[196:199], v5 offset:17728
    v_mfma_f32_16x16x32_bf16 v[84:87], v[180:183], v[36:39], v[84:87]
    v_exp_f32 v95, v95
    v_mfma_f32_16x16x32_bf16 v[84:87], v[176:179], v[32:35], v[84:87]
    v_mfma_f32_16x16x32_bf16 v[88:91], v[176:179], v[48:51], v[240:243]
    v_exp_f32 v80, v80
    v_mfma_f32_16x16x32_bf16 v[88:91], v[180:183], v[52:55], v[88:91]
    ds_read_b64_tr_b16 v[216:217], v4 offset:160
    ds_read_b64_tr_b16 v[218:219], v4 offset:416
    v_mfma_f32_16x16x32_bf16 v[88:91], v[184:187], v[56:59], v[88:91]
    v_exp_f32 v81, v81
    v_mfma_f32_16x16x32_bf16 v[88:91], v[188:191], v[60:63], v[88:91]
    v_cvt_pk_bf16_f32 v170, v92, v93
    v_cvt_pk_bf16_f32 v171, v94, v95
    v_mfma_f32_16x16x32_bf16 v[92:95], v[188:191], v[76:79], v[240:243]
    v_exp_f32 v82, v82
    v_mfma_f32_16x16x32_bf16 v[92:95], v[184:187], v[72:75], v[92:95]
    ds_read_b128 v[200:203], v5 offset:17792
    v_mfma_f32_16x16x32_bf16 v[92:95], v[180:183], v[68:71], v[92:95]
    s_add_u32 m0, s61, 101472
    v_exp_f32 v83, v83
    v_mfma_f32_16x16x32_bf16 v[92:95], v[176:179], v[64:67], v[92:95]
    s_waitcnt lgkmcnt(4)
    buffer_load_dwordx4 v3, s[20:23], s64 offen offset:3072  lds
    s_add_u32 s64, s64, 16384
    v_mfma_f32_16x16x32_bf16 a[16:19], v[208:211], v[112:115], a[16:19]
    v_exp_f32 v84, v84
    v_mfma_f32_16x16x32_bf16 a[16:19], v[212:215], v[116:119], a[16:19]
    ds_read_b64_tr_b16 v[220:221], v4 offset:672
    ds_read_b64_tr_b16 v[222:223], v4 offset:928
    v_mfma_f32_16x16x32_bf16 a[48:51], v[208:211], v[120:123], a[48:51]
    v_exp_f32 v85, v85
    v_mfma_f32_16x16x32_bf16 a[48:51], v[212:215], v[124:127], a[48:51]
    v_cvt_pk_bf16_f32 v148, v80, v81
    v_cvt_pk_bf16_f32 v149, v82, v83
    v_mfma_f32_16x16x32_bf16 a[80:83], v[208:211], v[128:131], a[80:83]
    v_exp_f32 v86, v86
    v_mfma_f32_16x16x32_bf16 a[80:83], v[212:215], v[132:135], a[80:83]
    ds_read_b128 v[204:207], v5 offset:17856
    v_mfma_f32_16x16x32_bf16 a[112:115], v[208:211], v[136:139], a[112:115]
    v_exp_f32 v87, v87
    v_mfma_f32_16x16x32_bf16 a[112:115], v[212:215], v[140:143], a[112:115]
    s_waitcnt lgkmcnt(4)
    s_waitcnt vmcnt(8)
    s_barrier
    v_mfma_f32_16x16x32_bf16 a[116:119], v[216:219], v[136:139], a[116:119]
    s_waitcnt lgkmcnt(1)
    v_exp_f32 v88, v88
    v_mfma_f32_16x16x32_bf16 a[116:119], v[220:223], v[140:143], a[116:119]
    ds_read_b64_tr_b16 v[208:209], v4 offset:192
    ds_read_b64_tr_b16 v[210:211], v4 offset:448
    v_mfma_f32_16x16x32_bf16 a[84:87], v[216:219], v[128:131], a[84:87]
    v_exp_f32 v89, v89
    v_mfma_f32_16x16x32_bf16 a[84:87], v[220:223], v[132:135], a[84:87]
    v_cvt_pk_bf16_f32 v156, v84, v85
    v_cvt_pk_bf16_f32 v157, v86, v87
    v_mfma_f32_16x16x32_bf16 a[52:55], v[216:219], v[120:123], a[52:55]
    v_exp_f32 v90, v90
    v_mfma_f32_16x16x32_bf16 a[52:55], v[220:223], v[124:127], a[52:55]
    ds_read_b128 v[176:179], v5 offset:33792
    v_mfma_f32_16x16x32_bf16 a[20:23], v[216:219], v[112:115], a[20:23]
    s_add_u32 m0, s61, 0
    v_exp_f32 v91, v91
    v_mfma_f32_16x16x32_bf16 a[20:23], v[220:223], v[116:119], a[20:23]
    buffer_load_dwordx4 v3, s[16:19], s63 offen offset:0  lds
    v_smfmac_f32_16x16x64_bf16 a[136:139], v[224:227], v[128:135], v228
    s_waitcnt lgkmcnt(3)
    v_mfma_f32_16x16x32_bf16 v[80:83], v[192:195], v[16:19], v[240:243]
    v_exp_f32 v92, v92
    v_mfma_f32_16x16x32_bf16 v[80:83], v[196:199], v[20:23], v[80:83]
    ds_read_b64_tr_b16 v[212:213], v4 offset:704
    ds_read_b64_tr_b16 v[214:215], v4 offset:960
    v_mfma_f32_16x16x32_bf16 v[80:83], v[200:203], v[24:27], v[80:83]
    v_exp_f32 v93, v93
    v_mfma_f32_16x16x32_bf16 v[80:83], v[204:207], v[28:31], v[80:83]
    v_cvt_pk_bf16_f32 v164, v88, v89
    v_cvt_pk_bf16_f32 v165, v90, v91
    v_mfma_f32_16x16x32_bf16 v[84:87], v[204:207], v[44:47], v[240:243]
    v_exp_f32 v94, v94
    v_mfma_f32_16x16x32_bf16 v[84:87], v[200:203], v[40:43], v[84:87]
    ds_read_b128 v[180:183], v5 offset:33856
    v_mfma_f32_16x16x32_bf16 v[84:87], v[196:199], v[36:39], v[84:87]
    v_exp_f32 v95, v95
    v_mfma_f32_16x16x32_bf16 v[84:87], v[192:195], v[32:35], v[84:87]
    buffer_load_dwordx4 v[96:99], v248, s[28:31], s44 offen
    v_mfma_f32_16x16x32_bf16 v[88:91], v[192:195], v[48:51], v[240:243]
    v_exp_f32 v80, v80
    v_mfma_f32_16x16x32_bf16 v[88:91], v[196:199], v[52:55], v[88:91]
    ds_read_b64_tr_b16 v[216:217], v4 offset:224
    ds_read_b64_tr_b16 v[218:219], v4 offset:480
    v_mfma_f32_16x16x32_bf16 v[88:91], v[200:203], v[56:59], v[88:91]
    v_exp_f32 v81, v81
    v_mfma_f32_16x16x32_bf16 v[88:91], v[204:207], v[60:63], v[88:91]
    v_cvt_pk_bf16_f32 v172, v92, v93
    v_cvt_pk_bf16_f32 v173, v94, v95
    v_mfma_f32_16x16x32_bf16 v[92:95], v[204:207], v[76:79], v[240:243]
    v_exp_f32 v82, v82
    v_mfma_f32_16x16x32_bf16 v[92:95], v[200:203], v[72:75], v[92:95]
    ds_read_b128 v[184:187], v5 offset:33920
    v_mfma_f32_16x16x32_bf16 v[92:95], v[196:199], v[68:71], v[92:95]
    s_add_u32 m0, s61, 32
    v_exp_f32 v83, v83
    v_mfma_f32_16x16x32_bf16 v[92:95], v[192:195], v[64:67], v[92:95]
    s_waitcnt lgkmcnt(4)
    buffer_load_dwordx4 v3, s[16:19], s63 offen offset:1024  lds
    v_mfma_f32_16x16x32_bf16 a[24:27], v[208:211], v[112:115], a[24:27]
    v_exp_f32 v84, v84
    v_mfma_f32_16x16x32_bf16 a[24:27], v[212:215], v[116:119], a[24:27]
    ds_read_b64_tr_b16 v[220:221], v4 offset:736
    ds_read_b64_tr_b16 v[222:223], v4 offset:992
    v_mfma_f32_16x16x32_bf16 a[56:59], v[208:211], v[120:123], a[56:59]
    v_exp_f32 v85, v85
    v_mfma_f32_16x16x32_bf16 a[56:59], v[212:215], v[124:127], a[56:59]
    v_cvt_pk_bf16_f32 v150, v80, v81
    v_cvt_pk_bf16_f32 v151, v82, v83
    v_mfma_f32_16x16x32_bf16 a[88:91], v[208:211], v[128:131], a[88:91]
    v_exp_f32 v86, v86
    v_mfma_f32_16x16x32_bf16 a[88:91], v[212:215], v[132:135], a[88:91]
    ds_read_b128 v[188:191], v5 offset:33984
    v_mfma_f32_16x16x32_bf16 a[120:123], v[208:211], v[136:139], a[120:123]
    v_exp_f32 v87, v87
    v_mfma_f32_16x16x32_bf16 a[120:123], v[212:215], v[140:143], a[120:123]
    s_waitcnt lgkmcnt(4)
    buffer_load_dword v108, v249, s[8:11], s46 offen
    v_mfma_f32_16x16x32_bf16 a[124:127], v[216:219], v[136:139], a[124:127]
    s_add_u32 s46, s46, 16384
    s_waitcnt lgkmcnt(1)
    v_exp_f32 v88, v88
    v_mfma_f32_16x16x32_bf16 a[124:127], v[220:223], v[140:143], a[124:127]
    ds_read_b64_tr_b16 v[208:209], v4 offset:16896
    ds_read_b64_tr_b16 v[210:211], v4 offset:17152
    v_mfma_f32_16x16x32_bf16 a[92:95], v[216:219], v[128:131], a[92:95]
    v_exp_f32 v89, v89
    v_mfma_f32_16x16x32_bf16 a[92:95], v[220:223], v[132:135], a[92:95]
    v_cvt_pk_bf16_f32 v158, v84, v85
    v_cvt_pk_bf16_f32 v159, v86, v87
    v_mfma_f32_16x16x32_bf16 a[60:63], v[216:219], v[120:123], a[60:63]
    v_exp_f32 v90, v90
    v_mfma_f32_16x16x32_bf16 a[60:63], v[220:223], v[124:127], a[60:63]
    ds_read_b128 v[192:195], v5 offset:34048
    v_mfma_f32_16x16x32_bf16 a[28:31], v[216:219], v[112:115], a[28:31]
    s_add_u32 m0, s61, 64
    v_exp_f32 v91, v91
    v_mfma_f32_16x16x32_bf16 a[28:31], v[220:223], v[116:119], a[28:31]
    buffer_load_dwordx4 v3, s[16:19], s63 offen offset:2048  lds
    v_smfmac_f32_16x16x64_bf16 a[140:143], v[224:227], v[136:143], v228
    s_waitcnt lgkmcnt(3)
    v_mfma_f32_16x16x32_bf16 v[80:83], v[176:179], v[16:19], v[240:243]
    v_exp_f32 v92, v92
    v_mfma_f32_16x16x32_bf16 v[80:83], v[180:183], v[20:23], v[80:83]
    ds_read_b64_tr_b16 v[212:213], v4 offset:17408
    ds_read_b64_tr_b16 v[214:215], v4 offset:17664
    v_mfma_f32_16x16x32_bf16 v[80:83], v[184:187], v[24:27], v[80:83]
    v_exp_f32 v93, v93
    v_mfma_f32_16x16x32_bf16 v[80:83], v[188:191], v[28:31], v[80:83]
    v_cvt_pk_bf16_f32 v166, v88, v89
    v_cvt_pk_bf16_f32 v167, v90, v91
    v_mfma_f32_16x16x32_bf16 v[84:87], v[188:191], v[44:47], v[240:243]
    v_exp_f32 v94, v94
    v_mfma_f32_16x16x32_bf16 v[84:87], v[184:187], v[40:43], v[84:87]
    ds_read_b128 v[196:199], v5 offset:34112
    v_mfma_f32_16x16x32_bf16 v[84:87], v[180:183], v[36:39], v[84:87]
    v_exp_f32 v95, v95
    v_mfma_f32_16x16x32_bf16 v[84:87], v[176:179], v[32:35], v[84:87]
    v_mfma_f32_16x16x32_bf16 v[88:91], v[176:179], v[48:51], v[240:243]
    v_exp_f32 v80, v80
    v_mfma_f32_16x16x32_bf16 v[88:91], v[180:183], v[52:55], v[88:91]
    ds_read_b64_tr_b16 v[216:217], v4 offset:16928
    ds_read_b64_tr_b16 v[218:219], v4 offset:17184
    v_mfma_f32_16x16x32_bf16 v[88:91], v[184:187], v[56:59], v[88:91]
    v_exp_f32 v81, v81
    v_mfma_f32_16x16x32_bf16 v[88:91], v[188:191], v[60:63], v[88:91]
    v_cvt_pk_bf16_f32 v174, v92, v93
    v_cvt_pk_bf16_f32 v175, v94, v95
    v_mfma_f32_16x16x32_bf16 v[92:95], v[188:191], v[76:79], v[240:243]
    v_exp_f32 v82, v82
    v_mfma_f32_16x16x32_bf16 v[92:95], v[184:187], v[72:75], v[92:95]
    ds_read_b128 v[200:203], v5 offset:34176
    v_mfma_f32_16x16x32_bf16 v[92:95], v[180:183], v[68:71], v[92:95]
    s_add_u32 m0, s61, 96
    v_exp_f32 v83, v83
    v_mfma_f32_16x16x32_bf16 v[92:95], v[176:179], v[64:67], v[92:95]
    s_waitcnt lgkmcnt(4)
    buffer_load_dwordx4 v3, s[16:19], s63 offen offset:3072  lds
    s_add_u32 s63, s63, 16384
    v_mfma_f32_16x16x32_bf16 a[0:3], v[208:211], v[144:147], a[0:3]
    v_exp_f32 v84, v84
    v_mfma_f32_16x16x32_bf16 a[0:3], v[212:215], v[148:151], a[0:3]
    ds_read_b64_tr_b16 v[220:221], v4 offset:17440
    ds_read_b64_tr_b16 v[222:223], v4 offset:17696
    v_mfma_f32_16x16x32_bf16 a[32:35], v[208:211], v[152:155], a[32:35]
    v_exp_f32 v85, v85
    v_mfma_f32_16x16x32_bf16 a[32:35], v[212:215], v[156:159], a[32:35]
    v_cvt_pk_bf16_f32 v112, v80, v81
    v_cvt_pk_bf16_f32 v113, v82, v83
    v_mfma_f32_16x16x32_bf16 a[64:67], v[208:211], v[160:163], a[64:67]
    v_exp_f32 v86, v86
    v_mfma_f32_16x16x32_bf16 a[64:67], v[212:215], v[164:167], a[64:67]
    ds_read_b128 v[204:207], v5 offset:34240
    v_mfma_f32_16x16x32_bf16 a[96:99], v[208:211], v[168:171], a[96:99]
    v_exp_f32 v87, v87
    v_mfma_f32_16x16x32_bf16 a[96:99], v[212:215], v[172:175], a[96:99]
    s_waitcnt lgkmcnt(4)
    v_mfma_f32_16x16x32_bf16 a[100:103], v[216:219], v[168:171], a[100:103]
    s_waitcnt lgkmcnt(1)
    v_exp_f32 v88, v88
    v_mfma_f32_16x16x32_bf16 a[100:103], v[220:223], v[172:175], a[100:103]
    ds_read_b64_tr_b16 v[208:209], v4 offset:16960
    ds_read_b64_tr_b16 v[210:211], v4 offset:17216
    v_mfma_f32_16x16x32_bf16 a[68:71], v[216:219], v[160:163], a[68:71]
    v_exp_f32 v89, v89
    v_mfma_f32_16x16x32_bf16 a[68:71], v[220:223], v[164:167], a[68:71]
    v_cvt_pk_bf16_f32 v120, v84, v85
    v_cvt_pk_bf16_f32 v121, v86, v87
    v_mfma_f32_16x16x32_bf16 a[36:39], v[216:219], v[152:155], a[36:39]
    v_exp_f32 v90, v90
    v_mfma_f32_16x16x32_bf16 a[36:39], v[220:223], v[156:159], a[36:39]
    ds_read_b128 v[176:179], v5 offset:34304
    v_mfma_f32_16x16x32_bf16 a[4:7], v[216:219], v[144:147], a[4:7]
    s_add_u32 m0, s61, 118272
    v_exp_f32 v91, v91
    v_mfma_f32_16x16x32_bf16 a[4:7], v[220:223], v[148:151], a[4:7]
    buffer_load_dwordx4 v3, s[20:23], s64 offen offset:0  lds
    v_smfmac_f32_16x16x64_bf16 a[128:131], v[224:227], v[144:151], v228
    s_waitcnt lgkmcnt(3)
    v_mfma_f32_16x16x32_bf16 v[80:83], v[192:195], v[16:19], v[240:243]
    v_exp_f32 v92, v92
    v_mfma_f32_16x16x32_bf16 v[80:83], v[196:199], v[20:23], v[80:83]
    ds_read_b64_tr_b16 v[212:213], v4 offset:17472
    ds_read_b64_tr_b16 v[214:215], v4 offset:17728
    v_mfma_f32_16x16x32_bf16 v[80:83], v[200:203], v[24:27], v[80:83]
    v_exp_f32 v93, v93
    v_mfma_f32_16x16x32_bf16 v[80:83], v[204:207], v[28:31], v[80:83]
    v_cvt_pk_bf16_f32 v128, v88, v89
    v_cvt_pk_bf16_f32 v129, v90, v91
    v_mfma_f32_16x16x32_bf16 v[84:87], v[204:207], v[44:47], v[240:243]
    v_exp_f32 v94, v94
    v_mfma_f32_16x16x32_bf16 v[84:87], v[200:203], v[40:43], v[84:87]
    ds_read_b128 v[180:183], v5 offset:34368
    v_mfma_f32_16x16x32_bf16 v[84:87], v[196:199], v[36:39], v[84:87]
    v_exp_f32 v95, v95
    v_mfma_f32_16x16x32_bf16 v[84:87], v[192:195], v[32:35], v[84:87]
    v_mfma_f32_16x16x32_bf16 v[88:91], v[192:195], v[48:51], v[240:243]
    v_exp_f32 v80, v80
    v_mfma_f32_16x16x32_bf16 v[88:91], v[196:199], v[52:55], v[88:91]
    ds_read_b64_tr_b16 v[216:217], v4 offset:16992
    ds_read_b64_tr_b16 v[218:219], v4 offset:17248
    v_mfma_f32_16x16x32_bf16 v[88:91], v[200:203], v[56:59], v[88:91]
    v_exp_f32 v81, v81
    v_mfma_f32_16x16x32_bf16 v[88:91], v[204:207], v[60:63], v[88:91]
    v_cvt_pk_bf16_f32 v136, v92, v93
    v_cvt_pk_bf16_f32 v137, v94, v95
    v_mfma_f32_16x16x32_bf16 v[92:95], v[204:207], v[76:79], v[240:243]
    v_exp_f32 v82, v82
    v_mfma_f32_16x16x32_bf16 v[92:95], v[200:203], v[72:75], v[92:95]
    ds_read_b128 v[184:187], v5 offset:34432
    v_mfma_f32_16x16x32_bf16 v[92:95], v[196:199], v[68:71], v[92:95]
    s_add_u32 m0, s61, 118304
    v_exp_f32 v83, v83
    v_mfma_f32_16x16x32_bf16 v[92:95], v[192:195], v[64:67], v[92:95]
    s_waitcnt lgkmcnt(4)
    buffer_load_dwordx4 v3, s[20:23], s64 offen offset:1024  lds
    v_mfma_f32_16x16x32_bf16 a[8:11], v[208:211], v[144:147], a[8:11]
    v_exp_f32 v84, v84
    v_mfma_f32_16x16x32_bf16 a[8:11], v[212:215], v[148:151], a[8:11]
    ds_read_b64_tr_b16 v[220:221], v4 offset:17504
    ds_read_b64_tr_b16 v[222:223], v4 offset:17760
    v_mfma_f32_16x16x32_bf16 a[40:43], v[208:211], v[152:155], a[40:43]
    v_exp_f32 v85, v85
    v_mfma_f32_16x16x32_bf16 a[40:43], v[212:215], v[156:159], a[40:43]
    v_cvt_pk_bf16_f32 v114, v80, v81
    v_cvt_pk_bf16_f32 v115, v82, v83
    v_mfma_f32_16x16x32_bf16 a[72:75], v[208:211], v[160:163], a[72:75]
    v_exp_f32 v86, v86
    v_mfma_f32_16x16x32_bf16 a[72:75], v[212:215], v[164:167], a[72:75]
    ds_read_b128 v[188:191], v5 offset:34496
    v_mfma_f32_16x16x32_bf16 a[104:107], v[208:211], v[168:171], a[104:107]
    v_exp_f32 v87, v87
    v_mfma_f32_16x16x32_bf16 a[104:107], v[212:215], v[172:175], a[104:107]
    s_waitcnt lgkmcnt(4)
    v_mfma_f32_16x16x32_bf16 a[108:111], v[216:219], v[168:171], a[108:111]
    s_waitcnt lgkmcnt(1)
    v_exp_f32 v88, v88
    v_mfma_f32_16x16x32_bf16 a[108:111], v[220:223], v[172:175], a[108:111]
    ds_read_b64_tr_b16 v[208:209], v4 offset:17024
    ds_read_b64_tr_b16 v[210:211], v4 offset:17280
    v_mfma_f32_16x16x32_bf16 a[76:79], v[216:219], v[160:163], a[76:79]
    v_exp_f32 v89, v89
    v_mfma_f32_16x16x32_bf16 a[76:79], v[220:223], v[164:167], a[76:79]
    v_cvt_pk_bf16_f32 v122, v84, v85
    v_cvt_pk_bf16_f32 v123, v86, v87
    v_mfma_f32_16x16x32_bf16 a[44:47], v[216:219], v[152:155], a[44:47]
    v_exp_f32 v90, v90
    v_mfma_f32_16x16x32_bf16 a[44:47], v[220:223], v[156:159], a[44:47]
    ds_read_b128 v[192:195], v5 offset:34560
    v_mfma_f32_16x16x32_bf16 a[12:15], v[216:219], v[144:147], a[12:15]
    s_add_u32 m0, s61, 118336
    v_exp_f32 v91, v91
    v_mfma_f32_16x16x32_bf16 a[12:15], v[220:223], v[148:151], a[12:15]
    buffer_load_dwordx4 v3, s[20:23], s64 offen offset:2048  lds
    v_smfmac_f32_16x16x64_bf16 a[132:135], v[224:227], v[152:159], v228
    s_waitcnt lgkmcnt(3)
    v_mfma_f32_16x16x32_bf16 v[80:83], v[176:179], v[16:19], v[240:243]
    v_exp_f32 v92, v92
    v_mfma_f32_16x16x32_bf16 v[80:83], v[180:183], v[20:23], v[80:83]
    ds_read_b64_tr_b16 v[212:213], v4 offset:17536
    ds_read_b64_tr_b16 v[214:215], v4 offset:17792
    v_mfma_f32_16x16x32_bf16 v[80:83], v[184:187], v[24:27], v[80:83]
    v_exp_f32 v93, v93
    v_mfma_f32_16x16x32_bf16 v[80:83], v[188:191], v[28:31], v[80:83]
    v_cvt_pk_bf16_f32 v130, v88, v89
    v_cvt_pk_bf16_f32 v131, v90, v91
    v_mfma_f32_16x16x32_bf16 v[84:87], v[188:191], v[44:47], v[240:243]
    v_exp_f32 v94, v94
    v_mfma_f32_16x16x32_bf16 v[84:87], v[184:187], v[40:43], v[84:87]
    ds_read_b128 v[196:199], v5 offset:34624
    v_mfma_f32_16x16x32_bf16 v[84:87], v[180:183], v[36:39], v[84:87]
    v_exp_f32 v95, v95
    v_mfma_f32_16x16x32_bf16 v[84:87], v[176:179], v[32:35], v[84:87]
    v_mfma_f32_16x16x32_bf16 v[88:91], v[176:179], v[48:51], v[240:243]
    v_exp_f32 v80, v80
    v_mfma_f32_16x16x32_bf16 v[88:91], v[180:183], v[52:55], v[88:91]
    ds_read_b64_tr_b16 v[216:217], v4 offset:17056
    ds_read_b64_tr_b16 v[218:219], v4 offset:17312
    v_mfma_f32_16x16x32_bf16 v[88:91], v[184:187], v[56:59], v[88:91]
    v_exp_f32 v81, v81
    v_mfma_f32_16x16x32_bf16 v[88:91], v[188:191], v[60:63], v[88:91]
    v_cvt_pk_bf16_f32 v138, v92, v93
    v_cvt_pk_bf16_f32 v139, v94, v95
    v_mfma_f32_16x16x32_bf16 v[92:95], v[188:191], v[76:79], v[240:243]
    v_exp_f32 v82, v82
    v_mfma_f32_16x16x32_bf16 v[92:95], v[184:187], v[72:75], v[92:95]
    ds_read_b128 v[200:203], v5 offset:34688
    v_mfma_f32_16x16x32_bf16 v[92:95], v[180:183], v[68:71], v[92:95]
    s_add_u32 m0, s61, 118368
    v_exp_f32 v83, v83
    v_mfma_f32_16x16x32_bf16 v[92:95], v[176:179], v[64:67], v[92:95]
    s_waitcnt lgkmcnt(4)
    buffer_load_dwordx4 v3, s[20:23], s64 offen offset:3072  lds
    s_add_u32 s64, s64, 16384
    v_mfma_f32_16x16x32_bf16 a[16:19], v[208:211], v[144:147], a[16:19]
    v_exp_f32 v84, v84
    v_mfma_f32_16x16x32_bf16 a[16:19], v[212:215], v[148:151], a[16:19]
    ds_read_b64_tr_b16 v[220:221], v4 offset:17568
    ds_read_b64_tr_b16 v[222:223], v4 offset:17824
    v_mfma_f32_16x16x32_bf16 a[48:51], v[208:211], v[152:155], a[48:51]
    v_exp_f32 v85, v85
    v_mfma_f32_16x16x32_bf16 a[48:51], v[212:215], v[156:159], a[48:51]
    v_cvt_pk_bf16_f32 v116, v80, v81
    v_cvt_pk_bf16_f32 v117, v82, v83
    v_mfma_f32_16x16x32_bf16 a[80:83], v[208:211], v[160:163], a[80:83]
    v_exp_f32 v86, v86
    v_mfma_f32_16x16x32_bf16 a[80:83], v[212:215], v[164:167], a[80:83]
    ds_read_b128 v[204:207], v5 offset:34752
    v_mfma_f32_16x16x32_bf16 a[112:115], v[208:211], v[168:171], a[112:115]
    v_exp_f32 v87, v87
    v_mfma_f32_16x16x32_bf16 a[112:115], v[212:215], v[172:175], a[112:115]
    s_waitcnt lgkmcnt(4)
    s_waitcnt vmcnt(10)
    s_barrier
    v_mfma_f32_16x16x32_bf16 a[116:119], v[216:219], v[168:171], a[116:119]
    s_waitcnt lgkmcnt(1)
    v_exp_f32 v88, v88
    v_mfma_f32_16x16x32_bf16 a[116:119], v[220:223], v[172:175], a[116:119]
    ds_read_b64_tr_b16 v[208:209], v4 offset:17088
    ds_read_b64_tr_b16 v[210:211], v4 offset:17344
    v_mfma_f32_16x16x32_bf16 a[84:87], v[216:219], v[160:163], a[84:87]
    v_exp_f32 v89, v89
    v_mfma_f32_16x16x32_bf16 a[84:87], v[220:223], v[164:167], a[84:87]
    v_cvt_pk_bf16_f32 v124, v84, v85
    v_cvt_pk_bf16_f32 v125, v86, v87
    v_mfma_f32_16x16x32_bf16 a[52:55], v[216:219], v[152:155], a[52:55]
    v_exp_f32 v90, v90
    v_mfma_f32_16x16x32_bf16 a[52:55], v[220:223], v[156:159], a[52:55]
    ds_read_b128 v[176:179], v5 offset:50688
    v_mfma_f32_16x16x32_bf16 a[20:23], v[216:219], v[144:147], a[20:23]
    s_add_u32 m0, s61, 16896
    v_exp_f32 v91, v91
    v_mfma_f32_16x16x32_bf16 a[20:23], v[220:223], v[148:151], a[20:23]
    buffer_load_dwordx4 v3, s[16:19], s63 offen offset:0  lds
    v_smfmac_f32_16x16x64_bf16 a[136:139], v[224:227], v[160:167], v228
    s_waitcnt lgkmcnt(3)
    v_mfma_f32_16x16x32_bf16 v[80:83], v[192:195], v[16:19], v[240:243]
    v_exp_f32 v92, v92
    v_mfma_f32_16x16x32_bf16 v[80:83], v[196:199], v[20:23], v[80:83]
    ds_read_b64_tr_b16 v[212:213], v4 offset:17600
    ds_read_b64_tr_b16 v[214:215], v4 offset:17856
    v_mfma_f32_16x16x32_bf16 v[80:83], v[200:203], v[24:27], v[80:83]
    v_exp_f32 v93, v93
    v_mfma_f32_16x16x32_bf16 v[80:83], v[204:207], v[28:31], v[80:83]
    v_cvt_pk_bf16_f32 v132, v88, v89
    v_cvt_pk_bf16_f32 v133, v90, v91
    v_mfma_f32_16x16x32_bf16 v[84:87], v[204:207], v[44:47], v[240:243]
    v_exp_f32 v94, v94
    v_mfma_f32_16x16x32_bf16 v[84:87], v[200:203], v[40:43], v[84:87]
    ds_read_b128 v[180:183], v5 offset:50752
    v_mfma_f32_16x16x32_bf16 v[84:87], v[196:199], v[36:39], v[84:87]
    v_exp_f32 v95, v95
    v_mfma_f32_16x16x32_bf16 v[84:87], v[192:195], v[32:35], v[84:87]
    buffer_load_dwordx4 v[100:103], v248, s[32:35], s44 offen
    v_mfma_f32_16x16x32_bf16 v[88:91], v[192:195], v[48:51], v[240:243]
    s_add_u32 s44, s44, 229376
    v_exp_f32 v80, v80
    v_mfma_f32_16x16x32_bf16 v[88:91], v[196:199], v[52:55], v[88:91]
    ds_read_b64_tr_b16 v[216:217], v4 offset:17120
    ds_read_b64_tr_b16 v[218:219], v4 offset:17376
    v_mfma_f32_16x16x32_bf16 v[88:91], v[200:203], v[56:59], v[88:91]
    v_exp_f32 v81, v81
    v_mfma_f32_16x16x32_bf16 v[88:91], v[204:207], v[60:63], v[88:91]
    v_cvt_pk_bf16_f32 v140, v92, v93
    v_cvt_pk_bf16_f32 v141, v94, v95
    v_mfma_f32_16x16x32_bf16 v[92:95], v[204:207], v[76:79], v[240:243]
    v_exp_f32 v82, v82
    v_mfma_f32_16x16x32_bf16 v[92:95], v[200:203], v[72:75], v[92:95]
    ds_read_b128 v[184:187], v5 offset:50816
    v_mfma_f32_16x16x32_bf16 v[92:95], v[196:199], v[68:71], v[92:95]
    s_add_u32 m0, s61, 16928
    v_exp_f32 v83, v83
    v_mfma_f32_16x16x32_bf16 v[92:95], v[192:195], v[64:67], v[92:95]
    s_waitcnt lgkmcnt(4)
    buffer_load_dwordx4 v3, s[16:19], s63 offen offset:1024  lds
    v_mfma_f32_16x16x32_bf16 a[24:27], v[208:211], v[144:147], a[24:27]
    v_exp_f32 v84, v84
    v_mfma_f32_16x16x32_bf16 a[24:27], v[212:215], v[148:151], a[24:27]
    ds_read_b64_tr_b16 v[220:221], v4 offset:17632
    ds_read_b64_tr_b16 v[222:223], v4 offset:17888
    v_mfma_f32_16x16x32_bf16 a[56:59], v[208:211], v[152:155], a[56:59]
    v_exp_f32 v85, v85
    v_mfma_f32_16x16x32_bf16 a[56:59], v[212:215], v[156:159], a[56:59]
    v_cvt_pk_bf16_f32 v118, v80, v81
    v_cvt_pk_bf16_f32 v119, v82, v83
    v_mfma_f32_16x16x32_bf16 a[88:91], v[208:211], v[160:163], a[88:91]
    v_exp_f32 v86, v86
    v_mfma_f32_16x16x32_bf16 a[88:91], v[212:215], v[164:167], a[88:91]
    ds_read_b128 v[188:191], v5 offset:50880
    v_mfma_f32_16x16x32_bf16 a[120:123], v[208:211], v[168:171], a[120:123]
    v_exp_f32 v87, v87
    v_mfma_f32_16x16x32_bf16 a[120:123], v[212:215], v[172:175], a[120:123]
    s_waitcnt lgkmcnt(4)
    buffer_load_dwordx4 v[104:107], v238, s[36:39], s66 offen
    v_mfma_f32_16x16x32_bf16 a[124:127], v[216:219], v[168:171], a[124:127]
    s_add_u32 s66, s66, 4096
    s_waitcnt lgkmcnt(1)
    v_exp_f32 v88, v88
    v_mfma_f32_16x16x32_bf16 a[124:127], v[220:223], v[172:175], a[124:127]
    ds_read_b64_tr_b16 v[208:209], v4 offset:33792
    ds_read_b64_tr_b16 v[210:211], v4 offset:34048
    v_mfma_f32_16x16x32_bf16 a[92:95], v[216:219], v[160:163], a[92:95]
    v_exp_f32 v89, v89
    v_mfma_f32_16x16x32_bf16 a[92:95], v[220:223], v[164:167], a[92:95]
    v_cvt_pk_bf16_f32 v126, v84, v85
    v_cvt_pk_bf16_f32 v127, v86, v87
    v_mfma_f32_16x16x32_bf16 a[60:63], v[216:219], v[152:155], a[60:63]
    v_exp_f32 v90, v90
    v_mfma_f32_16x16x32_bf16 a[60:63], v[220:223], v[156:159], a[60:63]
    ds_read_b128 v[192:195], v5 offset:50944
    v_mfma_f32_16x16x32_bf16 a[28:31], v[216:219], v[144:147], a[28:31]
    s_add_u32 m0, s61, 16960
    v_exp_f32 v91, v91
    v_mfma_f32_16x16x32_bf16 a[28:31], v[220:223], v[148:151], a[28:31]
    buffer_load_dwordx4 v3, s[16:19], s63 offen offset:2048  lds
    v_smfmac_f32_16x16x64_bf16 a[140:143], v[224:227], v[168:175], v228
    s_waitcnt lgkmcnt(3)
    v_mfma_f32_16x16x32_bf16 v[80:83], v[176:179], v[16:19], v[240:243]
    v_exp_f32 v92, v92
    v_mfma_f32_16x16x32_bf16 v[80:83], v[180:183], v[20:23], v[80:83]
    ds_read_b64_tr_b16 v[212:213], v4 offset:34304
    ds_read_b64_tr_b16 v[214:215], v4 offset:34560
    v_mfma_f32_16x16x32_bf16 v[80:83], v[184:187], v[24:27], v[80:83]
    v_exp_f32 v93, v93
    v_mfma_f32_16x16x32_bf16 v[80:83], v[188:191], v[28:31], v[80:83]
    v_cvt_pk_bf16_f32 v134, v88, v89
    v_cvt_pk_bf16_f32 v135, v90, v91
    v_mfma_f32_16x16x32_bf16 v[84:87], v[188:191], v[44:47], v[240:243]
    v_exp_f32 v94, v94
    v_mfma_f32_16x16x32_bf16 v[84:87], v[184:187], v[40:43], v[84:87]
    ds_read_b128 v[196:199], v5 offset:51008
    v_mfma_f32_16x16x32_bf16 v[84:87], v[180:183], v[36:39], v[84:87]
    v_exp_f32 v95, v95
    v_mfma_f32_16x16x32_bf16 v[84:87], v[176:179], v[32:35], v[84:87]
    v_mfma_f32_16x16x32_bf16 v[88:91], v[176:179], v[48:51], v[240:243]
    v_exp_f32 v80, v80
    v_mfma_f32_16x16x32_bf16 v[88:91], v[180:183], v[52:55], v[88:91]
    ds_read_b64_tr_b16 v[216:217], v4 offset:33824
    ds_read_b64_tr_b16 v[218:219], v4 offset:34080
    v_mfma_f32_16x16x32_bf16 v[88:91], v[184:187], v[56:59], v[88:91]
    v_exp_f32 v81, v81
    v_mfma_f32_16x16x32_bf16 v[88:91], v[188:191], v[60:63], v[88:91]
    v_cvt_pk_bf16_f32 v142, v92, v93
    v_cvt_pk_bf16_f32 v143, v94, v95
    v_mfma_f32_16x16x32_bf16 v[92:95], v[188:191], v[76:79], v[240:243]
    v_exp_f32 v82, v82
    v_mfma_f32_16x16x32_bf16 v[92:95], v[184:187], v[72:75], v[92:95]
    ds_read_b128 v[200:203], v5 offset:51072
    v_mfma_f32_16x16x32_bf16 v[92:95], v[180:183], v[68:71], v[92:95]
    s_add_u32 m0, s61, 16992
    v_exp_f32 v83, v83
    v_mfma_f32_16x16x32_bf16 v[92:95], v[176:179], v[64:67], v[92:95]
    s_waitcnt lgkmcnt(4)
    buffer_load_dwordx4 v3, s[16:19], s63 offen offset:3072  lds
    s_add_u32 s63, s63, 16384
    v_mfma_f32_16x16x32_bf16 a[0:3], v[208:211], v[112:115], a[0:3]
    v_exp_f32 v84, v84
    v_mfma_f32_16x16x32_bf16 a[0:3], v[212:215], v[116:119], a[0:3]
    ds_read_b64_tr_b16 v[220:221], v4 offset:34336
    ds_read_b64_tr_b16 v[222:223], v4 offset:34592
    v_mfma_f32_16x16x32_bf16 a[32:35], v[208:211], v[120:123], a[32:35]
    v_exp_f32 v85, v85
    v_mfma_f32_16x16x32_bf16 a[32:35], v[212:215], v[124:127], a[32:35]
    v_cvt_pk_bf16_f32 v144, v80, v81
    v_cvt_pk_bf16_f32 v145, v82, v83
    v_mfma_f32_16x16x32_bf16 a[64:67], v[208:211], v[128:131], a[64:67]
    v_exp_f32 v86, v86
    v_mfma_f32_16x16x32_bf16 a[64:67], v[212:215], v[132:135], a[64:67]
    ds_read_b128 v[204:207], v5 offset:51136
    v_mfma_f32_16x16x32_bf16 a[96:99], v[208:211], v[136:139], a[96:99]
    v_exp_f32 v87, v87
    v_mfma_f32_16x16x32_bf16 a[96:99], v[212:215], v[140:143], a[96:99]
    s_waitcnt lgkmcnt(4)
    v_mfma_f32_16x16x32_bf16 a[100:103], v[216:219], v[136:139], a[100:103]
    s_waitcnt lgkmcnt(1)
    v_exp_f32 v88, v88
    v_mfma_f32_16x16x32_bf16 a[100:103], v[220:223], v[140:143], a[100:103]
    ds_read_b64_tr_b16 v[208:209], v4 offset:33856
    ds_read_b64_tr_b16 v[210:211], v4 offset:34112
    v_mfma_f32_16x16x32_bf16 a[68:71], v[216:219], v[128:131], a[68:71]
    v_exp_f32 v89, v89
    v_mfma_f32_16x16x32_bf16 a[68:71], v[220:223], v[132:135], a[68:71]
    v_cvt_pk_bf16_f32 v152, v84, v85
    v_cvt_pk_bf16_f32 v153, v86, v87
    v_mfma_f32_16x16x32_bf16 a[36:39], v[216:219], v[120:123], a[36:39]
    v_exp_f32 v90, v90
    v_mfma_f32_16x16x32_bf16 a[36:39], v[220:223], v[124:127], a[36:39]
    ds_read_b128 v[176:179], v5 offset:51200
    v_mfma_f32_16x16x32_bf16 a[4:7], v[216:219], v[112:115], a[4:7]
    s_add_u32 m0, s61, 67584
    v_exp_f32 v91, v91
    v_mfma_f32_16x16x32_bf16 a[4:7], v[220:223], v[116:119], a[4:7]
    buffer_load_dwordx4 v3, s[20:23], s64 offen offset:0  lds
    v_smfmac_f32_16x16x64_bf16 a[128:131], v[224:227], v[112:119], v228
    s_waitcnt lgkmcnt(3)
    v_mfma_f32_16x16x32_bf16 v[80:83], v[192:195], v[16:19], v[240:243]
    v_exp_f32 v92, v92
    v_mfma_f32_16x16x32_bf16 v[80:83], v[196:199], v[20:23], v[80:83]
    ds_read_b64_tr_b16 v[212:213], v4 offset:34368
    ds_read_b64_tr_b16 v[214:215], v4 offset:34624
    v_mfma_f32_16x16x32_bf16 v[80:83], v[200:203], v[24:27], v[80:83]
    v_exp_f32 v93, v93
    v_mfma_f32_16x16x32_bf16 v[80:83], v[204:207], v[28:31], v[80:83]
    v_cvt_pk_bf16_f32 v160, v88, v89
    v_cvt_pk_bf16_f32 v161, v90, v91
    v_mfma_f32_16x16x32_bf16 v[84:87], v[204:207], v[44:47], v[240:243]
    v_exp_f32 v94, v94
    v_mfma_f32_16x16x32_bf16 v[84:87], v[200:203], v[40:43], v[84:87]
    ds_read_b128 v[180:183], v5 offset:51264
    v_mfma_f32_16x16x32_bf16 v[84:87], v[196:199], v[36:39], v[84:87]
    v_exp_f32 v95, v95
    v_mfma_f32_16x16x32_bf16 v[84:87], v[192:195], v[32:35], v[84:87]
    v_mfma_f32_16x16x32_bf16 v[88:91], v[192:195], v[48:51], v[240:243]
    v_exp_f32 v80, v80
    v_mfma_f32_16x16x32_bf16 v[88:91], v[196:199], v[52:55], v[88:91]
    ds_read_b64_tr_b16 v[216:217], v4 offset:33888
    ds_read_b64_tr_b16 v[218:219], v4 offset:34144
    v_mfma_f32_16x16x32_bf16 v[88:91], v[200:203], v[56:59], v[88:91]
    v_exp_f32 v81, v81
    v_mfma_f32_16x16x32_bf16 v[88:91], v[204:207], v[60:63], v[88:91]
    v_cvt_pk_bf16_f32 v168, v92, v93
    v_cvt_pk_bf16_f32 v169, v94, v95
    v_mfma_f32_16x16x32_bf16 v[92:95], v[204:207], v[76:79], v[240:243]
    v_exp_f32 v82, v82
    v_mfma_f32_16x16x32_bf16 v[92:95], v[200:203], v[72:75], v[92:95]
    ds_read_b128 v[184:187], v5 offset:51328
    v_mfma_f32_16x16x32_bf16 v[92:95], v[196:199], v[68:71], v[92:95]
    s_add_u32 m0, s61, 67616
    v_exp_f32 v83, v83
    v_mfma_f32_16x16x32_bf16 v[92:95], v[192:195], v[64:67], v[92:95]
    s_waitcnt lgkmcnt(4)
    buffer_load_dwordx4 v3, s[20:23], s64 offen offset:1024  lds
    v_mfma_f32_16x16x32_bf16 a[8:11], v[208:211], v[112:115], a[8:11]
    v_exp_f32 v84, v84
    v_mfma_f32_16x16x32_bf16 a[8:11], v[212:215], v[116:119], a[8:11]
    ds_read_b64_tr_b16 v[220:221], v4 offset:34400
    ds_read_b64_tr_b16 v[222:223], v4 offset:34656
    v_mfma_f32_16x16x32_bf16 a[40:43], v[208:211], v[120:123], a[40:43]
    v_exp_f32 v85, v85
    v_mfma_f32_16x16x32_bf16 a[40:43], v[212:215], v[124:127], a[40:43]
    v_cvt_pk_bf16_f32 v146, v80, v81
    v_cvt_pk_bf16_f32 v147, v82, v83
    v_mfma_f32_16x16x32_bf16 a[72:75], v[208:211], v[128:131], a[72:75]
    v_exp_f32 v86, v86
    v_mfma_f32_16x16x32_bf16 a[72:75], v[212:215], v[132:135], a[72:75]
    ds_read_b128 v[188:191], v5 offset:51392
    v_mfma_f32_16x16x32_bf16 a[104:107], v[208:211], v[136:139], a[104:107]
    v_exp_f32 v87, v87
    v_mfma_f32_16x16x32_bf16 a[104:107], v[212:215], v[140:143], a[104:107]
    s_waitcnt lgkmcnt(4)
    v_mfma_f32_16x16x32_bf16 a[108:111], v[216:219], v[136:139], a[108:111]
    s_waitcnt lgkmcnt(1)
    v_exp_f32 v88, v88
    v_mfma_f32_16x16x32_bf16 a[108:111], v[220:223], v[140:143], a[108:111]
    ds_read_b64_tr_b16 v[208:209], v4 offset:33920
    ds_read_b64_tr_b16 v[210:211], v4 offset:34176
    v_mfma_f32_16x16x32_bf16 a[76:79], v[216:219], v[128:131], a[76:79]
    v_exp_f32 v89, v89
    v_mfma_f32_16x16x32_bf16 a[76:79], v[220:223], v[132:135], a[76:79]
    v_cvt_pk_bf16_f32 v154, v84, v85
    v_cvt_pk_bf16_f32 v155, v86, v87
    v_mfma_f32_16x16x32_bf16 a[44:47], v[216:219], v[120:123], a[44:47]
    v_exp_f32 v90, v90
    v_mfma_f32_16x16x32_bf16 a[44:47], v[220:223], v[124:127], a[44:47]
    ds_read_b128 v[192:195], v5 offset:51456
    v_mfma_f32_16x16x32_bf16 a[12:15], v[216:219], v[112:115], a[12:15]
    s_add_u32 m0, s61, 67648
    v_exp_f32 v91, v91
    v_mfma_f32_16x16x32_bf16 a[12:15], v[220:223], v[116:119], a[12:15]
    buffer_load_dwordx4 v3, s[20:23], s64 offen offset:2048  lds
    v_smfmac_f32_16x16x64_bf16 a[132:135], v[224:227], v[120:127], v228
    s_waitcnt lgkmcnt(3)
    v_mfma_f32_16x16x32_bf16 v[80:83], v[176:179], v[16:19], v[240:243]
    v_exp_f32 v92, v92
    v_mfma_f32_16x16x32_bf16 v[80:83], v[180:183], v[20:23], v[80:83]
    ds_read_b64_tr_b16 v[212:213], v4 offset:34432
    ds_read_b64_tr_b16 v[214:215], v4 offset:34688
    v_mfma_f32_16x16x32_bf16 v[80:83], v[184:187], v[24:27], v[80:83]
    v_exp_f32 v93, v93
    v_mfma_f32_16x16x32_bf16 v[80:83], v[188:191], v[28:31], v[80:83]
    v_cvt_pk_bf16_f32 v162, v88, v89
    v_cvt_pk_bf16_f32 v163, v90, v91
    v_mfma_f32_16x16x32_bf16 v[84:87], v[188:191], v[44:47], v[240:243]
    v_exp_f32 v94, v94
    v_mfma_f32_16x16x32_bf16 v[84:87], v[184:187], v[40:43], v[84:87]
    ds_read_b128 v[196:199], v5 offset:51520
    v_mfma_f32_16x16x32_bf16 v[84:87], v[180:183], v[36:39], v[84:87]
    v_exp_f32 v95, v95
    v_mfma_f32_16x16x32_bf16 v[84:87], v[176:179], v[32:35], v[84:87]
    v_mfma_f32_16x16x32_bf16 v[88:91], v[176:179], v[48:51], v[240:243]
    v_exp_f32 v80, v80
    v_mfma_f32_16x16x32_bf16 v[88:91], v[180:183], v[52:55], v[88:91]
    ds_read_b64_tr_b16 v[216:217], v4 offset:33952
    ds_read_b64_tr_b16 v[218:219], v4 offset:34208
    v_mfma_f32_16x16x32_bf16 v[88:91], v[184:187], v[56:59], v[88:91]
    v_exp_f32 v81, v81
    v_mfma_f32_16x16x32_bf16 v[88:91], v[188:191], v[60:63], v[88:91]
    v_cvt_pk_bf16_f32 v170, v92, v93
    v_cvt_pk_bf16_f32 v171, v94, v95
    v_mfma_f32_16x16x32_bf16 v[92:95], v[188:191], v[76:79], v[240:243]
    v_exp_f32 v82, v82
    v_mfma_f32_16x16x32_bf16 v[92:95], v[184:187], v[72:75], v[92:95]
    ds_read_b128 v[200:203], v5 offset:51584
    v_mfma_f32_16x16x32_bf16 v[92:95], v[180:183], v[68:71], v[92:95]
    s_add_u32 m0, s61, 67680
    v_exp_f32 v83, v83
    v_mfma_f32_16x16x32_bf16 v[92:95], v[176:179], v[64:67], v[92:95]
    s_waitcnt lgkmcnt(4)
    buffer_load_dwordx4 v3, s[20:23], s64 offen offset:3072  lds
    s_add_u32 s64, s64, 16384
    v_mfma_f32_16x16x32_bf16 a[16:19], v[208:211], v[112:115], a[16:19]
    v_exp_f32 v84, v84
    v_mfma_f32_16x16x32_bf16 a[16:19], v[212:215], v[116:119], a[16:19]
    ds_read_b64_tr_b16 v[220:221], v4 offset:34464
    ds_read_b64_tr_b16 v[222:223], v4 offset:34720
    v_mfma_f32_16x16x32_bf16 a[48:51], v[208:211], v[120:123], a[48:51]
    v_exp_f32 v85, v85
    v_mfma_f32_16x16x32_bf16 a[48:51], v[212:215], v[124:127], a[48:51]
    v_cvt_pk_bf16_f32 v148, v80, v81
    v_cvt_pk_bf16_f32 v149, v82, v83
    v_mfma_f32_16x16x32_bf16 a[80:83], v[208:211], v[128:131], a[80:83]
    v_exp_f32 v86, v86
    v_mfma_f32_16x16x32_bf16 a[80:83], v[212:215], v[132:135], a[80:83]
    ds_read_b128 v[204:207], v5 offset:51648
    v_mfma_f32_16x16x32_bf16 a[112:115], v[208:211], v[136:139], a[112:115]
    v_exp_f32 v87, v87
    v_mfma_f32_16x16x32_bf16 a[112:115], v[212:215], v[140:143], a[112:115]
    s_waitcnt lgkmcnt(4)
    s_waitcnt vmcnt(10)
    s_barrier
    v_mfma_f32_16x16x32_bf16 a[116:119], v[216:219], v[136:139], a[116:119]
    s_waitcnt lgkmcnt(1)
    v_exp_f32 v88, v88
    v_mfma_f32_16x16x32_bf16 a[116:119], v[220:223], v[140:143], a[116:119]
    ds_read_b64_tr_b16 v[208:209], v4 offset:33984
    ds_read_b64_tr_b16 v[210:211], v4 offset:34240
    v_mfma_f32_16x16x32_bf16 a[84:87], v[216:219], v[128:131], a[84:87]
    v_exp_f32 v89, v89
    v_mfma_f32_16x16x32_bf16 a[84:87], v[220:223], v[132:135], a[84:87]
    v_cvt_pk_bf16_f32 v156, v84, v85
    v_cvt_pk_bf16_f32 v157, v86, v87
    v_mfma_f32_16x16x32_bf16 a[52:55], v[216:219], v[120:123], a[52:55]
    v_exp_f32 v90, v90
    v_mfma_f32_16x16x32_bf16 a[52:55], v[220:223], v[124:127], a[52:55]
    ds_read_b128 v[176:179], v5 offset:0
    v_mfma_f32_16x16x32_bf16 a[20:23], v[216:219], v[112:115], a[20:23]
    s_add_u32 m0, s61, 33792
    v_exp_f32 v91, v91
    v_mfma_f32_16x16x32_bf16 a[20:23], v[220:223], v[116:119], a[20:23]
    buffer_load_dwordx4 v3, s[16:19], s63 offen offset:0  lds
    v_smfmac_f32_16x16x64_bf16 a[136:139], v[224:227], v[128:135], v228
    s_waitcnt lgkmcnt(3)
    v_mfma_f32_16x16x32_bf16 v[80:83], v[192:195], v[16:19], v[240:243]
    v_exp_f32 v92, v92
    v_mfma_f32_16x16x32_bf16 v[80:83], v[196:199], v[20:23], v[80:83]
    ds_read_b64_tr_b16 v[212:213], v4 offset:34496
    ds_read_b64_tr_b16 v[214:215], v4 offset:34752
    v_mfma_f32_16x16x32_bf16 v[80:83], v[200:203], v[24:27], v[80:83]
    v_exp_f32 v93, v93
    v_mfma_f32_16x16x32_bf16 v[80:83], v[204:207], v[28:31], v[80:83]
    v_cvt_pk_bf16_f32 v164, v88, v89
    v_cvt_pk_bf16_f32 v165, v90, v91
    v_mfma_f32_16x16x32_bf16 v[84:87], v[204:207], v[44:47], v[240:243]
    v_exp_f32 v94, v94
    v_mfma_f32_16x16x32_bf16 v[84:87], v[200:203], v[40:43], v[84:87]
    ds_read_b128 v[180:183], v5 offset:64
    v_mfma_f32_16x16x32_bf16 v[84:87], v[196:199], v[36:39], v[84:87]
    v_exp_f32 v95, v95
    v_mfma_f32_16x16x32_bf16 v[84:87], v[192:195], v[32:35], v[84:87]
    buffer_store_dwordx4 v[232:235], v251, s[4:7], s47 offen sc1
    v_mfma_f32_16x16x32_bf16 v[88:91], v[192:195], v[48:51], v[240:243]
    s_add_u32 s47, s47, 1024
    v_exp_f32 v80, v80
    v_mfma_f32_16x16x32_bf16 v[88:91], v[196:199], v[52:55], v[88:91]
    ds_read_b64_tr_b16 v[216:217], v4 offset:34016
    ds_read_b64_tr_b16 v[218:219], v4 offset:34272
    v_mfma_f32_16x16x32_bf16 v[88:91], v[200:203], v[56:59], v[88:91]
    v_exp_f32 v81, v81
    v_mfma_f32_16x16x32_bf16 v[88:91], v[204:207], v[60:63], v[88:91]
    v_cvt_pk_bf16_f32 v172, v92, v93
    v_cvt_pk_bf16_f32 v173, v94, v95
    v_mfma_f32_16x16x32_bf16 v[92:95], v[204:207], v[76:79], v[240:243]
    v_exp_f32 v82, v82
    v_mfma_f32_16x16x32_bf16 v[92:95], v[200:203], v[72:75], v[92:95]
    ds_read_b128 v[184:187], v5 offset:128
    v_mfma_f32_16x16x32_bf16 v[92:95], v[196:199], v[68:71], v[92:95]
    s_add_u32 m0, s61, 33824
    v_exp_f32 v83, v83
    v_mfma_f32_16x16x32_bf16 v[92:95], v[192:195], v[64:67], v[92:95]
    s_waitcnt lgkmcnt(4)
    buffer_load_dwordx4 v3, s[16:19], s63 offen offset:1024  lds
    v_mfma_f32_16x16x32_bf16 a[24:27], v[208:211], v[112:115], a[24:27]
    v_exp_f32 v84, v84
    v_mfma_f32_16x16x32_bf16 a[24:27], v[212:215], v[116:119], a[24:27]
    ds_read_b64_tr_b16 v[220:221], v4 offset:34528
    ds_read_b64_tr_b16 v[222:223], v4 offset:34784
    v_mfma_f32_16x16x32_bf16 a[56:59], v[208:211], v[120:123], a[56:59]
    v_exp_f32 v85, v85
    v_mfma_f32_16x16x32_bf16 a[56:59], v[212:215], v[124:127], a[56:59]
    v_cvt_pk_bf16_f32 v150, v80, v81
    v_cvt_pk_bf16_f32 v151, v82, v83
    v_mfma_f32_16x16x32_bf16 a[88:91], v[208:211], v[128:131], a[88:91]
    v_exp_f32 v86, v86
    v_mfma_f32_16x16x32_bf16 a[88:91], v[212:215], v[132:135], a[88:91]
    ds_read_b128 v[188:191], v5 offset:192
    v_mfma_f32_16x16x32_bf16 a[120:123], v[208:211], v[136:139], a[120:123]
    v_exp_f32 v87, v87
    v_mfma_f32_16x16x32_bf16 a[120:123], v[212:215], v[140:143], a[120:123]
    s_waitcnt lgkmcnt(4)
    global_load_dword v110, v[236:237], off
    v_mfma_f32_16x16x32_bf16 a[124:127], v[216:219], v[136:139], a[124:127]
    s_waitcnt lgkmcnt(1)
    v_exp_f32 v88, v88
    v_mfma_f32_16x16x32_bf16 a[124:127], v[220:223], v[140:143], a[124:127]
    ds_read_b64_tr_b16 v[208:209], v4 offset:50688
    ds_read_b64_tr_b16 v[210:211], v4 offset:50944
    v_mfma_f32_16x16x32_bf16 a[92:95], v[216:219], v[128:131], a[92:95]
    v_exp_f32 v89, v89
    v_mfma_f32_16x16x32_bf16 a[92:95], v[220:223], v[132:135], a[92:95]
    v_cvt_pk_bf16_f32 v158, v84, v85
    v_cvt_pk_bf16_f32 v159, v86, v87
    v_mfma_f32_16x16x32_bf16 a[60:63], v[216:219], v[120:123], a[60:63]
    v_exp_f32 v90, v90
    v_mfma_f32_16x16x32_bf16 a[60:63], v[220:223], v[124:127], a[60:63]
    ds_read_b128 v[192:195], v5 offset:256
    v_mfma_f32_16x16x32_bf16 a[28:31], v[216:219], v[112:115], a[28:31]
    s_add_u32 m0, s61, 33856
    v_exp_f32 v91, v91
    v_mfma_f32_16x16x32_bf16 a[28:31], v[220:223], v[116:119], a[28:31]
    buffer_load_dwordx4 v3, s[16:19], s63 offen offset:2048  lds
    v_smfmac_f32_16x16x64_bf16 a[140:143], v[224:227], v[136:143], v228
    s_waitcnt lgkmcnt(3)
    v_mfma_f32_16x16x32_bf16 v[80:83], v[176:179], v[16:19], v[240:243]
    v_exp_f32 v92, v92
    v_mfma_f32_16x16x32_bf16 v[80:83], v[180:183], v[20:23], v[80:83]
    ds_read_b64_tr_b16 v[212:213], v4 offset:51200
    ds_read_b64_tr_b16 v[214:215], v4 offset:51456
    v_mfma_f32_16x16x32_bf16 v[80:83], v[184:187], v[24:27], v[80:83]
    v_exp_f32 v93, v93
    v_mfma_f32_16x16x32_bf16 v[80:83], v[188:191], v[28:31], v[80:83]
    v_cvt_pk_bf16_f32 v166, v88, v89
    v_cvt_pk_bf16_f32 v167, v90, v91
    v_mfma_f32_16x16x32_bf16 v[84:87], v[188:191], v[44:47], v[240:243]
    v_exp_f32 v94, v94
    v_mfma_f32_16x16x32_bf16 v[84:87], v[184:187], v[40:43], v[84:87]
    ds_read_b128 v[196:199], v5 offset:320
    v_mfma_f32_16x16x32_bf16 v[84:87], v[180:183], v[36:39], v[84:87]
    v_exp_f32 v95, v95
    v_mfma_f32_16x16x32_bf16 v[84:87], v[176:179], v[32:35], v[84:87]
    v_mfma_f32_16x16x32_bf16 v[88:91], v[176:179], v[48:51], v[240:243]
    v_exp_f32 v80, v80
    v_mfma_f32_16x16x32_bf16 v[88:91], v[180:183], v[52:55], v[88:91]
    ds_read_b64_tr_b16 v[216:217], v4 offset:50720
    ds_read_b64_tr_b16 v[218:219], v4 offset:50976
    v_mfma_f32_16x16x32_bf16 v[88:91], v[184:187], v[56:59], v[88:91]
    v_exp_f32 v81, v81
    v_mfma_f32_16x16x32_bf16 v[88:91], v[188:191], v[60:63], v[88:91]
    v_cvt_pk_bf16_f32 v174, v92, v93
    v_cvt_pk_bf16_f32 v175, v94, v95
    v_mfma_f32_16x16x32_bf16 v[92:95], v[188:191], v[76:79], v[240:243]
    v_exp_f32 v82, v82
    v_mfma_f32_16x16x32_bf16 v[92:95], v[184:187], v[72:75], v[92:95]
    ds_read_b128 v[200:203], v5 offset:384
    v_mfma_f32_16x16x32_bf16 v[92:95], v[180:183], v[68:71], v[92:95]
    s_add_u32 m0, s61, 33888
    v_exp_f32 v83, v83
    v_mfma_f32_16x16x32_bf16 v[92:95], v[176:179], v[64:67], v[92:95]
    s_waitcnt lgkmcnt(4)
    buffer_load_dwordx4 v3, s[16:19], s63 offen offset:3072  lds
    s_add_u32 s63, s63, 16384
    v_mfma_f32_16x16x32_bf16 a[0:3], v[208:211], v[144:147], a[0:3]
    v_exp_f32 v84, v84
    v_mfma_f32_16x16x32_bf16 a[0:3], v[212:215], v[148:151], a[0:3]
    ds_read_b64_tr_b16 v[220:221], v4 offset:51232
    ds_read_b64_tr_b16 v[222:223], v4 offset:51488
    v_mfma_f32_16x16x32_bf16 a[32:35], v[208:211], v[152:155], a[32:35]
    v_exp_f32 v85, v85
    v_mfma_f32_16x16x32_bf16 a[32:35], v[212:215], v[156:159], a[32:35]
    v_cvt_pk_bf16_f32 v112, v80, v81
    v_cvt_pk_bf16_f32 v113, v82, v83
    v_mfma_f32_16x16x32_bf16 a[64:67], v[208:211], v[160:163], a[64:67]
    v_exp_f32 v86, v86
    v_mfma_f32_16x16x32_bf16 a[64:67], v[212:215], v[164:167], a[64:67]
    ds_read_b128 v[204:207], v5 offset:448
    v_mfma_f32_16x16x32_bf16 a[96:99], v[208:211], v[168:171], a[96:99]
    v_exp_f32 v87, v87
    v_mfma_f32_16x16x32_bf16 a[96:99], v[212:215], v[172:175], a[96:99]
    s_waitcnt lgkmcnt(4)
    v_mfma_f32_16x16x32_bf16 a[100:103], v[216:219], v[168:171], a[100:103]
    s_waitcnt lgkmcnt(1)
    v_exp_f32 v88, v88
    v_mfma_f32_16x16x32_bf16 a[100:103], v[220:223], v[172:175], a[100:103]
    ds_read_b64_tr_b16 v[208:209], v4 offset:50752
    ds_read_b64_tr_b16 v[210:211], v4 offset:51008
    v_mfma_f32_16x16x32_bf16 a[68:71], v[216:219], v[160:163], a[68:71]
    v_exp_f32 v89, v89
    v_mfma_f32_16x16x32_bf16 a[68:71], v[220:223], v[164:167], a[68:71]
    v_cvt_pk_bf16_f32 v120, v84, v85
    v_cvt_pk_bf16_f32 v121, v86, v87
    v_mfma_f32_16x16x32_bf16 a[36:39], v[216:219], v[152:155], a[36:39]
    v_exp_f32 v90, v90
    v_mfma_f32_16x16x32_bf16 a[36:39], v[220:223], v[156:159], a[36:39]
    ds_read_b128 v[176:179], v5 offset:512
    v_mfma_f32_16x16x32_bf16 a[4:7], v[216:219], v[144:147], a[4:7]
    s_add_u32 m0, s61, 84480
    v_exp_f32 v91, v91
    v_mfma_f32_16x16x32_bf16 a[4:7], v[220:223], v[148:151], a[4:7]
    buffer_load_dwordx4 v3, s[20:23], s64 offen offset:0  lds
    v_smfmac_f32_16x16x64_bf16 a[128:131], v[224:227], v[144:151], v228
    s_waitcnt lgkmcnt(3)
    v_mfma_f32_16x16x32_bf16 v[80:83], v[192:195], v[16:19], v[240:243]
    v_exp_f32 v92, v92
    v_mfma_f32_16x16x32_bf16 v[80:83], v[196:199], v[20:23], v[80:83]
    ds_read_b64_tr_b16 v[212:213], v4 offset:51264
    ds_read_b64_tr_b16 v[214:215], v4 offset:51520
    v_mfma_f32_16x16x32_bf16 v[80:83], v[200:203], v[24:27], v[80:83]
    v_exp_f32 v93, v93
    v_mfma_f32_16x16x32_bf16 v[80:83], v[204:207], v[28:31], v[80:83]
    v_cvt_pk_bf16_f32 v128, v88, v89
    v_cvt_pk_bf16_f32 v129, v90, v91
    v_mfma_f32_16x16x32_bf16 v[84:87], v[204:207], v[44:47], v[240:243]
    v_exp_f32 v94, v94
    v_mfma_f32_16x16x32_bf16 v[84:87], v[200:203], v[40:43], v[84:87]
    ds_read_b128 v[180:183], v5 offset:576
    v_mfma_f32_16x16x32_bf16 v[84:87], v[196:199], v[36:39], v[84:87]
    v_exp_f32 v95, v95
    v_mfma_f32_16x16x32_bf16 v[84:87], v[192:195], v[32:35], v[84:87]
    v_mfma_f32_16x16x32_bf16 v[88:91], v[192:195], v[48:51], v[240:243]
    v_exp_f32 v80, v80
    v_mfma_f32_16x16x32_bf16 v[88:91], v[196:199], v[52:55], v[88:91]
    ds_read_b64_tr_b16 v[216:217], v4 offset:50784
    ds_read_b64_tr_b16 v[218:219], v4 offset:51040
    v_mfma_f32_16x16x32_bf16 v[88:91], v[200:203], v[56:59], v[88:91]
    v_exp_f32 v81, v81
    v_mfma_f32_16x16x32_bf16 v[88:91], v[204:207], v[60:63], v[88:91]
    v_cvt_pk_bf16_f32 v136, v92, v93
    v_cvt_pk_bf16_f32 v137, v94, v95
    v_mfma_f32_16x16x32_bf16 v[92:95], v[204:207], v[76:79], v[240:243]
    v_exp_f32 v82, v82
    v_mfma_f32_16x16x32_bf16 v[92:95], v[200:203], v[72:75], v[92:95]
    ds_read_b128 v[184:187], v5 offset:640
    v_mfma_f32_16x16x32_bf16 v[92:95], v[196:199], v[68:71], v[92:95]
    s_add_u32 m0, s61, 84512
    v_exp_f32 v83, v83
    v_mfma_f32_16x16x32_bf16 v[92:95], v[192:195], v[64:67], v[92:95]
    s_waitcnt lgkmcnt(4)
    buffer_load_dwordx4 v3, s[20:23], s64 offen offset:1024  lds
    v_mfma_f32_16x16x32_bf16 a[8:11], v[208:211], v[144:147], a[8:11]
    v_exp_f32 v84, v84
    v_mfma_f32_16x16x32_bf16 a[8:11], v[212:215], v[148:151], a[8:11]
    ds_read_b64_tr_b16 v[220:221], v4 offset:51296
    ds_read_b64_tr_b16 v[222:223], v4 offset:51552
    v_mfma_f32_16x16x32_bf16 a[40:43], v[208:211], v[152:155], a[40:43]
    v_exp_f32 v85, v85
    v_mfma_f32_16x16x32_bf16 a[40:43], v[212:215], v[156:159], a[40:43]
    v_cvt_pk_bf16_f32 v114, v80, v81
    v_cvt_pk_bf16_f32 v115, v82, v83
    v_mfma_f32_16x16x32_bf16 a[72:75], v[208:211], v[160:163], a[72:75]
    v_exp_f32 v86, v86
    v_mfma_f32_16x16x32_bf16 a[72:75], v[212:215], v[164:167], a[72:75]
    ds_read_b128 v[188:191], v5 offset:704
    v_mfma_f32_16x16x32_bf16 a[104:107], v[208:211], v[168:171], a[104:107]
    v_exp_f32 v87, v87
    v_mfma_f32_16x16x32_bf16 a[104:107], v[212:215], v[172:175], a[104:107]
    s_waitcnt lgkmcnt(4)
    v_mfma_f32_16x16x32_bf16 a[108:111], v[216:219], v[168:171], a[108:111]
    s_waitcnt lgkmcnt(1)
    v_exp_f32 v88, v88
    v_mfma_f32_16x16x32_bf16 a[108:111], v[220:223], v[172:175], a[108:111]
    ds_read_b64_tr_b16 v[208:209], v4 offset:50816
    ds_read_b64_tr_b16 v[210:211], v4 offset:51072
    v_mfma_f32_16x16x32_bf16 a[76:79], v[216:219], v[160:163], a[76:79]
    v_exp_f32 v89, v89
    v_mfma_f32_16x16x32_bf16 a[76:79], v[220:223], v[164:167], a[76:79]
    v_cvt_pk_bf16_f32 v122, v84, v85
    v_cvt_pk_bf16_f32 v123, v86, v87
    v_mfma_f32_16x16x32_bf16 a[44:47], v[216:219], v[152:155], a[44:47]
    v_exp_f32 v90, v90
    v_mfma_f32_16x16x32_bf16 a[44:47], v[220:223], v[156:159], a[44:47]
    ds_read_b128 v[192:195], v5 offset:768
    v_mfma_f32_16x16x32_bf16 a[12:15], v[216:219], v[144:147], a[12:15]
    s_add_u32 m0, s61, 84544
    v_exp_f32 v91, v91
    v_mfma_f32_16x16x32_bf16 a[12:15], v[220:223], v[148:151], a[12:15]
    buffer_load_dwordx4 v3, s[20:23], s64 offen offset:2048  lds
    v_smfmac_f32_16x16x64_bf16 a[132:135], v[224:227], v[152:159], v228
    s_waitcnt lgkmcnt(3)
    v_mfma_f32_16x16x32_bf16 v[80:83], v[176:179], v[16:19], v[240:243]
    v_exp_f32 v92, v92
    v_mfma_f32_16x16x32_bf16 v[80:83], v[180:183], v[20:23], v[80:83]
    ds_read_b64_tr_b16 v[212:213], v4 offset:51328
    ds_read_b64_tr_b16 v[214:215], v4 offset:51584
    v_mfma_f32_16x16x32_bf16 v[80:83], v[184:187], v[24:27], v[80:83]
    v_exp_f32 v93, v93
    v_mfma_f32_16x16x32_bf16 v[80:83], v[188:191], v[28:31], v[80:83]
    v_cvt_pk_bf16_f32 v130, v88, v89
    v_cvt_pk_bf16_f32 v131, v90, v91
    v_mfma_f32_16x16x32_bf16 v[84:87], v[188:191], v[44:47], v[240:243]
    v_exp_f32 v94, v94
    v_mfma_f32_16x16x32_bf16 v[84:87], v[184:187], v[40:43], v[84:87]
    ds_read_b128 v[196:199], v5 offset:832
    v_mfma_f32_16x16x32_bf16 v[84:87], v[180:183], v[36:39], v[84:87]
    v_exp_f32 v95, v95
    v_mfma_f32_16x16x32_bf16 v[84:87], v[176:179], v[32:35], v[84:87]
    v_mfma_f32_16x16x32_bf16 v[88:91], v[176:179], v[48:51], v[240:243]
    v_exp_f32 v80, v80
    v_mfma_f32_16x16x32_bf16 v[88:91], v[180:183], v[52:55], v[88:91]
    ds_read_b64_tr_b16 v[216:217], v4 offset:50848
    ds_read_b64_tr_b16 v[218:219], v4 offset:51104
    v_mfma_f32_16x16x32_bf16 v[88:91], v[184:187], v[56:59], v[88:91]
    v_exp_f32 v81, v81
    v_mfma_f32_16x16x32_bf16 v[88:91], v[188:191], v[60:63], v[88:91]
    v_cvt_pk_bf16_f32 v138, v92, v93
    v_cvt_pk_bf16_f32 v139, v94, v95
    v_mfma_f32_16x16x32_bf16 v[92:95], v[188:191], v[76:79], v[240:243]
    v_exp_f32 v82, v82
    v_mfma_f32_16x16x32_bf16 v[92:95], v[184:187], v[72:75], v[92:95]
    ds_read_b128 v[200:203], v5 offset:896
    v_mfma_f32_16x16x32_bf16 v[92:95], v[180:183], v[68:71], v[92:95]
    s_add_u32 m0, s61, 84576
    v_exp_f32 v83, v83
    v_mfma_f32_16x16x32_bf16 v[92:95], v[176:179], v[64:67], v[92:95]
    s_waitcnt lgkmcnt(4)
    buffer_load_dwordx4 v3, s[20:23], s64 offen offset:3072  lds
    s_add_u32 s64, s64, 16384
    v_mfma_f32_16x16x32_bf16 a[16:19], v[208:211], v[144:147], a[16:19]
    v_exp_f32 v84, v84
    v_mfma_f32_16x16x32_bf16 a[16:19], v[212:215], v[148:151], a[16:19]
    ds_read_b64_tr_b16 v[220:221], v4 offset:51360
    ds_read_b64_tr_b16 v[222:223], v4 offset:51616
    v_mfma_f32_16x16x32_bf16 a[48:51], v[208:211], v[152:155], a[48:51]
    v_exp_f32 v85, v85
    v_mfma_f32_16x16x32_bf16 a[48:51], v[212:215], v[156:159], a[48:51]
    v_cvt_pk_bf16_f32 v116, v80, v81
    v_cvt_pk_bf16_f32 v117, v82, v83
    v_mfma_f32_16x16x32_bf16 a[80:83], v[208:211], v[160:163], a[80:83]
    v_exp_f32 v86, v86
    v_mfma_f32_16x16x32_bf16 a[80:83], v[212:215], v[164:167], a[80:83]
    ds_read_b128 v[204:207], v5 offset:960
    v_mfma_f32_16x16x32_bf16 a[112:115], v[208:211], v[168:171], a[112:115]
    v_exp_f32 v87, v87
    v_mfma_f32_16x16x32_bf16 a[112:115], v[212:215], v[172:175], a[112:115]
    s_waitcnt lgkmcnt(4)
    s_waitcnt vmcnt(10)
    s_barrier
    v_mfma_f32_16x16x32_bf16 a[116:119], v[216:219], v[168:171], a[116:119]
    s_waitcnt lgkmcnt(1)
    v_exp_f32 v88, v88
    v_mfma_f32_16x16x32_bf16 a[116:119], v[220:223], v[172:175], a[116:119]
    ds_read_b64_tr_b16 v[208:209], v4 offset:50880
    ds_read_b64_tr_b16 v[210:211], v4 offset:51136
    v_mfma_f32_16x16x32_bf16 a[84:87], v[216:219], v[160:163], a[84:87]
    v_exp_f32 v89, v89
    v_mfma_f32_16x16x32_bf16 a[84:87], v[220:223], v[164:167], a[84:87]
    v_cvt_pk_bf16_f32 v124, v84, v85
    v_cvt_pk_bf16_f32 v125, v86, v87
    v_mfma_f32_16x16x32_bf16 a[52:55], v[216:219], v[152:155], a[52:55]
    v_exp_f32 v90, v90
    v_mfma_f32_16x16x32_bf16 a[52:55], v[220:223], v[156:159], a[52:55]
    ds_read_b128 v[176:179], v5 offset:16896
    v_mfma_f32_16x16x32_bf16 a[20:23], v[216:219], v[144:147], a[20:23]
    s_add_u32 m0, s61, 50688
    v_exp_f32 v91, v91
    v_mfma_f32_16x16x32_bf16 a[20:23], v[220:223], v[148:151], a[20:23]
    buffer_load_dwordx4 v3, s[16:19], s63 offen offset:0  lds
    v_smfmac_f32_16x16x64_bf16 a[136:139], v[224:227], v[160:167], v228
    s_waitcnt lgkmcnt(3)
    v_mfma_f32_16x16x32_bf16 v[80:83], v[192:195], v[16:19], v[240:243]
    v_exp_f32 v92, v92
    v_mfma_f32_16x16x32_bf16 v[80:83], v[196:199], v[20:23], v[80:83]
    ds_read_b64_tr_b16 v[212:213], v4 offset:51392
    ds_read_b64_tr_b16 v[214:215], v4 offset:51648
    v_mfma_f32_16x16x32_bf16 v[80:83], v[200:203], v[24:27], v[80:83]
    v_exp_f32 v93, v93
    v_mfma_f32_16x16x32_bf16 v[80:83], v[204:207], v[28:31], v[80:83]
    v_cvt_pk_bf16_f32 v132, v88, v89
    v_cvt_pk_bf16_f32 v133, v90, v91
    v_mfma_f32_16x16x32_bf16 v[84:87], v[204:207], v[44:47], v[240:243]
    v_exp_f32 v94, v94
    v_mfma_f32_16x16x32_bf16 v[84:87], v[200:203], v[40:43], v[84:87]
    ds_read_b128 v[180:183], v5 offset:16960
    v_mfma_f32_16x16x32_bf16 v[84:87], v[196:199], v[36:39], v[84:87]
    v_exp_f32 v95, v95
    v_mfma_f32_16x16x32_bf16 v[84:87], v[192:195], v[32:35], v[84:87]
    s_set_gpr_idx_on s45, gpr_idx(DST)
    v_accvgpr_write_b32 a144, v96
    v_accvgpr_write_b32 a145, v97
    v_accvgpr_write_b32 a146, v98
    v_accvgpr_write_b32 a147, v99
    v_accvgpr_write_b32 a148, v100
    v_accvgpr_write_b32 a149, v101
    v_accvgpr_write_b32 a150, v102
    v_accvgpr_write_b32 a151, v103
    v_accvgpr_write_b32 a152, v104
    v_accvgpr_write_b32 a153, v105
    v_accvgpr_write_b32 a154, v106
    v_accvgpr_write_b32 a155, v107
    s_set_gpr_idx_off
    v_mfma_f32_16x16x32_bf16 v[88:91], v[192:195], v[48:51], v[240:243]
    v_exp_f32 v80, v80
    v_mfma_f32_16x16x32_bf16 v[88:91], v[196:199], v[52:55], v[88:91]
    ds_read_b64_tr_b16 v[216:217], v4 offset:50912
    ds_read_b64_tr_b16 v[218:219], v4 offset:51168
    v_mfma_f32_16x16x32_bf16 v[88:91], v[200:203], v[56:59], v[88:91]
    v_exp_f32 v81, v81
    v_mfma_f32_16x16x32_bf16 v[88:91], v[204:207], v[60:63], v[88:91]
    v_cvt_pk_bf16_f32 v140, v92, v93
    v_cvt_pk_bf16_f32 v141, v94, v95
    v_mfma_f32_16x16x32_bf16 v[92:95], v[204:207], v[76:79], v[240:243]
    v_exp_f32 v82, v82
    v_mfma_f32_16x16x32_bf16 v[92:95], v[200:203], v[72:75], v[92:95]
    ds_read_b128 v[184:187], v5 offset:17024
    v_mfma_f32_16x16x32_bf16 v[92:95], v[196:199], v[68:71], v[92:95]
    s_add_u32 m0, s61, 50720
    v_exp_f32 v83, v83
    v_mfma_f32_16x16x32_bf16 v[92:95], v[192:195], v[64:67], v[92:95]
    s_waitcnt lgkmcnt(4)
    buffer_load_dwordx4 v3, s[16:19], s63 offen offset:1024  lds
    v_mfma_f32_16x16x32_bf16 a[24:27], v[208:211], v[144:147], a[24:27]
    v_exp_f32 v84, v84
    v_mfma_f32_16x16x32_bf16 a[24:27], v[212:215], v[148:151], a[24:27]
    ds_read_b64_tr_b16 v[220:221], v4 offset:51424
    ds_read_b64_tr_b16 v[222:223], v4 offset:51680
    v_mfma_f32_16x16x32_bf16 a[56:59], v[208:211], v[152:155], a[56:59]
    v_exp_f32 v85, v85
    v_mfma_f32_16x16x32_bf16 a[56:59], v[212:215], v[156:159], a[56:59]
    v_cvt_pk_bf16_f32 v118, v80, v81
    v_cvt_pk_bf16_f32 v119, v82, v83
    v_mfma_f32_16x16x32_bf16 a[88:91], v[208:211], v[160:163], a[88:91]
    v_exp_f32 v86, v86
    v_mfma_f32_16x16x32_bf16 a[88:91], v[212:215], v[164:167], a[88:91]
    ds_read_b128 v[188:191], v5 offset:17088
    v_mfma_f32_16x16x32_bf16 a[120:123], v[208:211], v[168:171], a[120:123]
    v_exp_f32 v87, v87
    v_mfma_f32_16x16x32_bf16 a[120:123], v[212:215], v[172:175], a[120:123]
    s_waitcnt lgkmcnt(4)
    v_mfma_f32_16x16x32_bf16 a[124:127], v[216:219], v[168:171], a[124:127]
    s_waitcnt lgkmcnt(1)
    v_exp_f32 v88, v88
    v_mfma_f32_16x16x32_bf16 a[124:127], v[220:223], v[172:175], a[124:127]
    ds_read_b64_tr_b16 v[208:209], v4 offset:0
    ds_read_b64_tr_b16 v[210:211], v4 offset:256
    v_mfma_f32_16x16x32_bf16 a[92:95], v[216:219], v[160:163], a[92:95]
    v_exp_f32 v89, v89
    v_mfma_f32_16x16x32_bf16 a[92:95], v[220:223], v[164:167], a[92:95]
    v_cvt_pk_bf16_f32 v126, v84, v85
    v_cvt_pk_bf16_f32 v127, v86, v87
    v_mfma_f32_16x16x32_bf16 a[60:63], v[216:219], v[152:155], a[60:63]
    v_exp_f32 v90, v90
    v_mfma_f32_16x16x32_bf16 a[60:63], v[220:223], v[156:159], a[60:63]
    ds_read_b128 v[192:195], v5 offset:17152
    v_mfma_f32_16x16x32_bf16 a[28:31], v[216:219], v[144:147], a[28:31]
    s_add_u32 m0, s61, 50752
    v_exp_f32 v91, v91
    v_mfma_f32_16x16x32_bf16 a[28:31], v[220:223], v[148:151], a[28:31]
    buffer_load_dwordx4 v3, s[16:19], s63 offen offset:2048  lds
    v_smfmac_f32_16x16x64_bf16 a[140:143], v[224:227], v[168:175], v228
    s_waitcnt lgkmcnt(3)
    s_add_u32 s49, s49, 1
    s_cmp_lt_u32 s49, 7
    s_cbranch_scc1 L_attn_16
L_attn_done_17:
L_code_mid:
    v_mfma_f32_16x16x32_bf16 v[80:83], v[176:179], v[16:19], v[240:243]
    v_exp_f32 v92, v92
    v_mfma_f32_16x16x32_bf16 v[80:83], v[180:183], v[20:23], v[80:83]
    ds_read_b64_tr_b16 v[212:213], v4 offset:512
    ds_read_b64_tr_b16 v[214:215], v4 offset:768
    v_mfma_f32_16x16x32_bf16 v[80:83], v[184:187], v[24:27], v[80:83]
    v_exp_f32 v93, v93
    v_mfma_f32_16x16x32_bf16 v[80:83], v[188:191], v[28:31], v[80:83]
    v_cvt_pk_bf16_f32 v134, v88, v89
    v_cvt_pk_bf16_f32 v135, v90, v91
    v_mfma_f32_16x16x32_bf16 v[84:87], v[188:191], v[44:47], v[240:243]
    v_exp_f32 v94, v94
    v_mfma_f32_16x16x32_bf16 v[84:87], v[184:187], v[40:43], v[84:87]
    ds_read_b128 v[196:199], v5 offset:17216
    v_mfma_f32_16x16x32_bf16 v[84:87], v[180:183], v[36:39], v[84:87]
    v_exp_f32 v95, v95
    v_mfma_f32_16x16x32_bf16 v[84:87], v[176:179], v[32:35], v[84:87]
    v_mfma_f32_16x16x32_bf16 v[88:91], v[176:179], v[48:51], v[240:243]
    v_exp_f32 v80, v80
    v_mfma_f32_16x16x32_bf16 v[88:91], v[180:183], v[52:55], v[88:91]
    ds_read_b64_tr_b16 v[216:217], v4 offset:32
    ds_read_b64_tr_b16 v[218:219], v4 offset:288
    v_mfma_f32_16x16x32_bf16 v[88:91], v[184:187], v[56:59], v[88:91]
    v_exp_f32 v81, v81
    v_mfma_f32_16x16x32_bf16 v[88:91], v[188:191], v[60:63], v[88:91]
    v_cvt_pk_bf16_f32 v142, v92, v93
    v_cvt_pk_bf16_f32 v143, v94, v95
    v_mfma_f32_16x16x32_bf16 v[92:95], v[188:191], v[76:79], v[240:243]
    v_exp_f32 v82, v82
    v_mfma_f32_16x16x32_bf16 v[92:95], v[184:187], v[72:75], v[92:95]
    ds_read_b128 v[200:203], v5 offset:17280
    v_mfma_f32_16x16x32_bf16 v[92:95], v[180:183], v[68:71], v[92:95]
    s_add_u32 m0, s61, 50784
    v_exp_f32 v83, v83
    v_mfma_f32_16x16x32_bf16 v[92:95], v[176:179], v[64:67], v[92:95]
    s_waitcnt lgkmcnt(4)
    buffer_load_dwordx4 v3, s[16:19], s63 offen offset:3072  lds
    s_add_u32 s63, s63, 16384
    v_mfma_f32_16x16x32_bf16 a[0:3], v[208:211], v[112:115], a[0:3]
    v_exp_f32 v84, v84
    v_mfma_f32_16x16x32_bf16 a[0:3], v[212:215], v[116:119], a[0:3]
    ds_read_b64_tr_b16 v[220:221], v4 offset:544
    ds_read_b64_tr_b16 v[222:223], v4 offset:800
    v_mfma_f32_16x16x32_bf16 a[32:35], v[208:211], v[120:123], a[32:35]
    v_exp_f32 v85, v85
    v_mfma_f32_16x16x32_bf16 a[32:35], v[212:215], v[124:127], a[32:35]
    v_cvt_pk_bf16_f32 v144, v80, v81
    v_cvt_pk_bf16_f32 v145, v82, v83
    v_mfma_f32_16x16x32_bf16 a[64:67], v[208:211], v[128:131], a[64:67]
    v_exp_f32 v86, v86
    v_mfma_f32_16x16x32_bf16 a[64:67], v[212:215], v[132:135], a[64:67]
    ds_read_b128 v[204:207], v5 offset:17344
    v_mfma_f32_16x16x32_bf16 a[96:99], v[208:211], v[136:139], a[96:99]
    v_exp_f32 v87, v87
    v_mfma_f32_16x16x32_bf16 a[96:99], v[212:215], v[140:143], a[96:99]
    s_waitcnt lgkmcnt(4)
    buffer_load_dwordx4 a[228:231], v248, s[28:31], s44 offen
    v_mfma_f32_16x16x32_bf16 a[100:103], v[216:219], v[136:139], a[100:103]
    s_waitcnt lgkmcnt(1)
    v_exp_f32 v88, v88
    v_mfma_f32_16x16x32_bf16 a[100:103], v[220:223], v[140:143], a[100:103]
    ds_read_b64_tr_b16 v[208:209], v4 offset:64
    ds_read_b64_tr_b16 v[210:211], v4 offset:320
    v_mfma_f32_16x16x32_bf16 a[68:71], v[216:219], v[128:131], a[68:71]
    v_exp_f32 v89, v89
    v_mfma_f32_16x16x32_bf16 a[68:71], v[220:223], v[132:135], a[68:71]
    v_cvt_pk_bf16_f32 v152, v84, v85
    v_cvt_pk_bf16_f32 v153, v86, v87
    v_mfma_f32_16x16x32_bf16 a[36:39], v[216:219], v[120:123], a[36:39]
    v_exp_f32 v90, v90
    v_mfma_f32_16x16x32_bf16 a[36:39], v[220:223], v[124:127], a[36:39]
    ds_read_b128 v[176:179], v5 offset:17408
    v_mfma_f32_16x16x32_bf16 a[4:7], v[216:219], v[112:115], a[4:7]
    s_add_u32 m0, s61, 101376
    v_exp_f32 v91, v91
    v_mfma_f32_16x16x32_bf16 a[4:7], v[220:223], v[116:119], a[4:7]
    buffer_load_dwordx4 v3, s[20:23], s64 offen offset:0  lds
    v_smfmac_f32_16x16x64_bf16 a[128:131], v[224:227], v[112:119], v228
    s_waitcnt lgkmcnt(3)
    v_mfma_f32_16x16x32_bf16 v[80:83], v[192:195], v[16:19], v[240:243]
    v_exp_f32 v92, v92
    v_mfma_f32_16x16x32_bf16 v[80:83], v[196:199], v[20:23], v[80:83]
    ds_read_b64_tr_b16 v[212:213], v4 offset:576
    ds_read_b64_tr_b16 v[214:215], v4 offset:832
    v_mfma_f32_16x16x32_bf16 v[80:83], v[200:203], v[24:27], v[80:83]
    v_exp_f32 v93, v93
    v_mfma_f32_16x16x32_bf16 v[80:83], v[204:207], v[28:31], v[80:83]
    v_cvt_pk_bf16_f32 v160, v88, v89
    v_cvt_pk_bf16_f32 v161, v90, v91
    v_mfma_f32_16x16x32_bf16 v[84:87], v[204:207], v[44:47], v[240:243]
    v_exp_f32 v94, v94
    v_mfma_f32_16x16x32_bf16 v[84:87], v[200:203], v[40:43], v[84:87]
    ds_read_b128 v[180:183], v5 offset:17472
    v_mfma_f32_16x16x32_bf16 v[84:87], v[196:199], v[36:39], v[84:87]
    v_exp_f32 v95, v95
    v_mfma_f32_16x16x32_bf16 v[84:87], v[192:195], v[32:35], v[84:87]
    v_mfma_f32_16x16x32_bf16 v[88:91], v[192:195], v[48:51], v[240:243]
    v_exp_f32 v80, v80
    v_mfma_f32_16x16x32_bf16 v[88:91], v[196:199], v[52:55], v[88:91]
    ds_read_b64_tr_b16 v[216:217], v4 offset:96
    ds_read_b64_tr_b16 v[218:219], v4 offset:352
    v_mfma_f32_16x16x32_bf16 v[88:91], v[200:203], v[56:59], v[88:91]
    v_exp_f32 v81, v81
    v_mfma_f32_16x16x32_bf16 v[88:91], v[204:207], v[60:63], v[88:91]
    v_cvt_pk_bf16_f32 v168, v92, v93
    v_cvt_pk_bf16_f32 v169, v94, v95
    v_mfma_f32_16x16x32_bf16 v[92:95], v[204:207], v[76:79], v[240:243]
    v_exp_f32 v82, v82
    v_mfma_f32_16x16x32_bf16 v[92:95], v[200:203], v[72:75], v[92:95]
    ds_read_b128 v[184:187], v5 offset:17536
    v_mfma_f32_16x16x32_bf16 v[92:95], v[196:199], v[68:71], v[92:95]
    s_add_u32 m0, s61, 101408
    v_exp_f32 v83, v83
    v_mfma_f32_16x16x32_bf16 v[92:95], v[192:195], v[64:67], v[92:95]
    s_waitcnt lgkmcnt(4)
    buffer_load_dwordx4 v3, s[20:23], s64 offen offset:1024  lds
    v_mfma_f32_16x16x32_bf16 a[8:11], v[208:211], v[112:115], a[8:11]
    v_exp_f32 v84, v84
    v_mfma_f32_16x16x32_bf16 a[8:11], v[212:215], v[116:119], a[8:11]
    ds_read_b64_tr_b16 v[220:221], v4 offset:608
    ds_read_b64_tr_b16 v[222:223], v4 offset:864
    v_mfma_f32_16x16x32_bf16 a[40:43], v[208:211], v[120:123], a[40:43]
    v_exp_f32 v85, v85
    v_mfma_f32_16x16x32_bf16 a[40:43], v[212:215], v[124:127], a[40:43]
    v_cvt_pk_bf16_f32 v146, v80, v81
    v_cvt_pk_bf16_f32 v147, v82, v83
    v_mfma_f32_16x16x32_bf16 a[72:75], v[208:211], v[128:131], a[72:75]
    v_exp_f32 v86, v86
    v_mfma_f32_16x16x32_bf16 a[72:75], v[212:215], v[132:135], a[72:75]
    ds_read_b128 v[188:191], v5 offset:17600
    v_mfma_f32_16x16x32_bf16 a[104:107], v[208:211], v[136:139], a[104:107]
    v_exp_f32 v87, v87
    v_mfma_f32_16x16x32_bf16 a[104:107], v[212:215], v[140:143], a[104:107]
    s_waitcnt lgkmcnt(4)
    buffer_load_dword v108, v249, s[8:11], s46 offen
    v_mfma_f32_16x16x32_bf16 a[108:111], v[216:219], v[136:139], a[108:111]
    s_waitcnt lgkmcnt(1)
    v_exp_f32 v88, v88
    v_mfma_f32_16x16x32_bf16 a[108:111], v[220:223], v[140:143], a[108:111]
    ds_read_b64_tr_b16 v[208:209], v4 offset:128
    ds_read_b64_tr_b16 v[210:211], v4 offset:384
    v_mfma_f32_16x16x32_bf16 a[76:79], v[216:219], v[128:131], a[76:79]
    v_exp_f32 v89, v89
    v_mfma_f32_16x16x32_bf16 a[76:79], v[220:223], v[132:135], a[76:79]
    v_cvt_pk_bf16_f32 v154, v84, v85
    v_cvt_pk_bf16_f32 v155, v86, v87
    v_mfma_f32_16x16x32_bf16 a[44:47], v[216:219], v[120:123], a[44:47]
    v_exp_f32 v90, v90
    v_mfma_f32_16x16x32_bf16 a[44:47], v[220:223], v[124:127], a[44:47]
    ds_read_b128 v[192:195], v5 offset:17664
    v_mfma_f32_16x16x32_bf16 a[12:15], v[216:219], v[112:115], a[12:15]
    s_add_u32 m0, s61, 101440
    v_exp_f32 v91, v91
    v_mfma_f32_16x16x32_bf16 a[12:15], v[220:223], v[116:119], a[12:15]
    buffer_load_dwordx4 v3, s[20:23], s64 offen offset:2048  lds
    v_smfmac_f32_16x16x64_bf16 a[132:135], v[224:227], v[120:127], v228
    s_waitcnt lgkmcnt(3)
    v_mfma_f32_16x16x32_bf16 v[80:83], v[176:179], v[16:19], v[240:243]
    v_exp_f32 v92, v92
    v_mfma_f32_16x16x32_bf16 v[80:83], v[180:183], v[20:23], v[80:83]
    ds_read_b64_tr_b16 v[212:213], v4 offset:640
    ds_read_b64_tr_b16 v[214:215], v4 offset:896
    v_mfma_f32_16x16x32_bf16 v[80:83], v[184:187], v[24:27], v[80:83]
    v_exp_f32 v93, v93
    v_mfma_f32_16x16x32_bf16 v[80:83], v[188:191], v[28:31], v[80:83]
    v_cvt_pk_bf16_f32 v162, v88, v89
    v_cvt_pk_bf16_f32 v163, v90, v91
    v_mfma_f32_16x16x32_bf16 v[84:87], v[188:191], v[44:47], v[240:243]
    v_exp_f32 v94, v94
    v_mfma_f32_16x16x32_bf16 v[84:87], v[184:187], v[40:43], v[84:87]
    ds_read_b128 v[196:199], v5 offset:17728
    v_mfma_f32_16x16x32_bf16 v[84:87], v[180:183], v[36:39], v[84:87]
    v_exp_f32 v95, v95
    v_mfma_f32_16x16x32_bf16 v[84:87], v[176:179], v[32:35], v[84:87]
    v_mfma_f32_16x16x32_bf16 v[88:91], v[176:179], v[48:51], v[240:243]
    v_exp_f32 v80, v80
    v_mfma_f32_16x16x32_bf16 v[88:91], v[180:183], v[52:55], v[88:91]
    ds_read_b64_tr_b16 v[216:217], v4 offset:160
    ds_read_b64_tr_b16 v[218:219], v4 offset:416
    v_mfma_f32_16x16x32_bf16 v[88:91], v[184:187], v[56:59], v[88:91]
    v_exp_f32 v81, v81
    v_mfma_f32_16x16x32_bf16 v[88:91], v[188:191], v[60:63], v[88:91]
    v_cvt_pk_bf16_f32 v170, v92, v93
    v_cvt_pk_bf16_f32 v171, v94, v95
    v_mfma_f32_16x16x32_bf16 v[92:95], v[188:191], v[76:79], v[240:243]
    v_exp_f32 v82, v82
    v_mfma_f32_16x16x32_bf16 v[92:95], v[184:187], v[72:75], v[92:95]
    ds_read_b128 v[200:203], v5 offset:17792
    v_mfma_f32_16x16x32_bf16 v[92:95], v[180:183], v[68:71], v[92:95]
    s_add_u32 m0, s61, 101472
    v_exp_f32 v83, v83
    v_mfma_f32_16x16x32_bf16 v[92:95], v[176:179], v[64:67], v[92:95]
    s_waitcnt lgkmcnt(4)
    buffer_load_dwordx4 v3, s[20:23], s64 offen offset:3072  lds
    s_add_u32 s64, s64, 16384
    v_mfma_f32_16x16x32_bf16 a[16:19], v[208:211], v[112:115], a[16:19]
    v_exp_f32 v84, v84
    v_mfma_f32_16x16x32_bf16 a[16:19], v[212:215], v[116:119], a[16:19]
    ds_read_b64_tr_b16 v[220:221], v4 offset:672
    ds_read_b64_tr_b16 v[222:223], v4 offset:928
    v_mfma_f32_16x16x32_bf16 a[48:51], v[208:211], v[120:123], a[48:51]
    v_exp_f32 v85, v85
    v_mfma_f32_16x16x32_bf16 a[48:51], v[212:215], v[124:127], a[48:51]
    v_cvt_pk_bf16_f32 v148, v80, v81
    v_cvt_pk_bf16_f32 v149, v82, v83
    v_mfma_f32_16x16x32_bf16 a[80:83], v[208:211], v[128:131], a[80:83]
    v_exp_f32 v86, v86
    v_mfma_f32_16x16x32_bf16 a[80:83], v[212:215], v[132:135], a[80:83]
    ds_read_b128 v[204:207], v5 offset:17856
    v_mfma_f32_16x16x32_bf16 a[112:115], v[208:211], v[136:139], a[112:115]
    v_exp_f32 v87, v87
    v_mfma_f32_16x16x32_bf16 a[112:115], v[212:215], v[140:143], a[112:115]
    s_waitcnt lgkmcnt(4)
    s_waitcnt vmcnt(10)
    s_barrier
    v_mfma_f32_16x16x32_bf16 a[116:119], v[216:219], v[136:139], a[116:119]
    s_waitcnt lgkmcnt(1)
    v_exp_f32 v88, v88
    v_mfma_f32_16x16x32_bf16 a[116:119], v[220:223], v[140:143], a[116:119]
    ds_read_b64_tr_b16 v[208:209], v4 offset:192
    ds_read_b64_tr_b16 v[210:211], v4 offset:448
    v_mfma_f32_16x16x32_bf16 a[84:87], v[216:219], v[128:131], a[84:87]
    v_exp_f32 v89, v89
    v_mfma_f32_16x16x32_bf16 a[84:87], v[220:223], v[132:135], a[84:87]
    v_cvt_pk_bf16_f32 v156, v84, v85
    v_cvt_pk_bf16_f32 v157, v86, v87
    v_mfma_f32_16x16x32_bf16 a[52:55], v[216:219], v[120:123], a[52:55]
    v_exp_f32 v90, v90
    v_mfma_f32_16x16x32_bf16 a[52:55], v[220:223], v[124:127], a[52:55]
    ds_read_b128 v[176:179], v5 offset:33792
    v_mfma_f32_16x16x32_bf16 a[20:23], v[216:219], v[112:115], a[20:23]
    s_add_u32 m0, s61, 0
    v_exp_f32 v91, v91
    v_mfma_f32_16x16x32_bf16 a[20:23], v[220:223], v[116:119], a[20:23]
    buffer_load_dwordx4 v2, s[8:11], s67 offen  lds
    v_smfmac_f32_16x16x64_bf16 a[136:139], v[224:227], v[128:135], v228
    s_add_u32 s67, s67, 2048
    s_waitcnt lgkmcnt(3)
    v_mfma_f32_16x16x32_bf16 v[80:83], v[192:195], v[16:19], v[240:243]
    v_exp_f32 v92, v92
    v_mfma_f32_16x16x32_bf16 v[80:83], v[196:199], v[20:23], v[80:83]
    ds_read_b64_tr_b16 v[212:213], v4 offset:704
    ds_read_b64_tr_b16 v[214:215], v4 offset:960
    v_mfma_f32_16x16x32_bf16 v[80:83], v[200:203], v[24:27], v[80:83]
    v_exp_f32 v93, v93
    v_mfma_f32_16x16x32_bf16 v[80:83], v[204:207], v[28:31], v[80:83]
    v_cvt_pk_bf16_f32 v164, v88, v89
    v_cvt_pk_bf16_f32 v165, v90, v91
    v_mfma_f32_16x16x32_bf16 v[84:87], v[204:207], v[44:47], v[240:243]
    v_exp_f32 v94, v94
    v_mfma_f32_16x16x32_bf16 v[84:87], v[200:203], v[40:43], v[84:87]
    ds_read_b128 v[180:183], v5 offset:33856
    v_mfma_f32_16x16x32_bf16 v[84:87], v[196:199], v[36:39], v[84:87]
    v_exp_f32 v95, v95
    v_mfma_f32_16x16x32_bf16 v[84:87], v[192:195], v[32:35], v[84:87]
    buffer_load_dwordx4 a[232:235], v248, s[32:35], s44 offen
    v_mfma_f32_16x16x32_bf16 v[88:91], v[192:195], v[48:51], v[240:243]
    v_exp_f32 v80, v80
    v_mfma_f32_16x16x32_bf16 v[88:91], v[196:199], v[52:55], v[88:91]
    ds_read_b64_tr_b16 v[216:217], v4 offset:224
    ds_read_b64_tr_b16 v[218:219], v4 offset:480
    v_mfma_f32_16x16x32_bf16 v[88:91], v[200:203], v[56:59], v[88:91]
    v_exp_f32 v81, v81
    v_mfma_f32_16x16x32_bf16 v[88:91], v[204:207], v[60:63], v[88:91]
    v_cvt_pk_bf16_f32 v172, v92, v93
    v_cvt_pk_bf16_f32 v173, v94, v95
    v_mfma_f32_16x16x32_bf16 v[92:95], v[204:207], v[76:79], v[240:243]
    v_exp_f32 v82, v82
    v_mfma_f32_16x16x32_bf16 v[92:95], v[200:203], v[72:75], v[92:95]
    ds_read_b128 v[184:187], v5 offset:33920
    v_mfma_f32_16x16x32_bf16 v[92:95], v[196:199], v[68:71], v[92:95]
    s_add_u32 m0, s61, 1032
    v_exp_f32 v83, v83
    v_mfma_f32_16x16x32_bf16 v[92:95], v[192:195], v[64:67], v[92:95]
    s_waitcnt lgkmcnt(4)
    buffer_load_dwordx4 v2, s[8:11], s67 offen  lds
    s_add_u32 s67, s67, 2048
    v_mfma_f32_16x16x32_bf16 a[24:27], v[208:211], v[112:115], a[24:27]
    v_exp_f32 v84, v84
    v_mfma_f32_16x16x32_bf16 a[24:27], v[212:215], v[116:119], a[24:27]
    ds_read_b64_tr_b16 v[220:221], v4 offset:736
    ds_read_b64_tr_b16 v[222:223], v4 offset:992
    v_mfma_f32_16x16x32_bf16 a[56:59], v[208:211], v[120:123], a[56:59]
    v_exp_f32 v85, v85
    v_mfma_f32_16x16x32_bf16 a[56:59], v[212:215], v[124:127], a[56:59]
    v_cvt_pk_bf16_f32 v150, v80, v81
    v_cvt_pk_bf16_f32 v151, v82, v83
    v_mfma_f32_16x16x32_bf16 a[88:91], v[208:211], v[128:131], a[88:91]
    v_exp_f32 v86, v86
    v_mfma_f32_16x16x32_bf16 a[88:91], v[212:215], v[132:135], a[88:91]
    ds_read_b128 v[188:191], v5 offset:33984
    v_mfma_f32_16x16x32_bf16 a[120:123], v[208:211], v[136:139], a[120:123]
    v_exp_f32 v87, v87
    v_mfma_f32_16x16x32_bf16 a[120:123], v[212:215], v[140:143], a[120:123]
    s_waitcnt lgkmcnt(4)
    v_mfma_f32_16x16x32_bf16 a[124:127], v[216:219], v[136:139], a[124:127]
    s_waitcnt lgkmcnt(1)
    v_exp_f32 v88, v88
    v_mfma_f32_16x16x32_bf16 a[124:127], v[220:223], v[140:143], a[124:127]
    ds_read_b64_tr_b16 v[208:209], v4 offset:16896
    ds_read_b64_tr_b16 v[210:211], v4 offset:17152
    v_mfma_f32_16x16x32_bf16 a[92:95], v[216:219], v[128:131], a[92:95]
    v_exp_f32 v89, v89
    v_mfma_f32_16x16x32_bf16 a[92:95], v[220:223], v[132:135], a[92:95]
    v_cvt_pk_bf16_f32 v158, v84, v85
    v_cvt_pk_bf16_f32 v159, v86, v87
    v_mfma_f32_16x16x32_bf16 a[60:63], v[216:219], v[120:123], a[60:63]
    v_exp_f32 v90, v90
    v_mfma_f32_16x16x32_bf16 a[60:63], v[220:223], v[124:127], a[60:63]
    ds_read_b128 v[192:195], v5 offset:34048
    v_mfma_f32_16x16x32_bf16 a[28:31], v[216:219], v[112:115], a[28:31]
    s_add_u32 m0, s61, 2112
    v_exp_f32 v91, v91
    v_mfma_f32_16x16x32_bf16 a[28:31], v[220:223], v[116:119], a[28:31]
    buffer_load_dwordx4 v2, s[8:11], s67 offen  lds
    v_smfmac_f32_16x16x64_bf16 a[140:143], v[224:227], v[136:143], v228
    s_add_u32 s67, s67, 2048
    s_waitcnt lgkmcnt(3)
    v_mfma_f32_16x16x32_bf16 v[80:83], v[176:179], v[16:19], v[240:243]
    v_exp_f32 v92, v92
    v_mfma_f32_16x16x32_bf16 v[80:83], v[180:183], v[20:23], v[80:83]
    ds_read_b64_tr_b16 v[212:213], v4 offset:17408
    ds_read_b64_tr_b16 v[214:215], v4 offset:17664
    v_mfma_f32_16x16x32_bf16 v[80:83], v[184:187], v[24:27], v[80:83]
    v_exp_f32 v93, v93
    v_mfma_f32_16x16x32_bf16 v[80:83], v[188:191], v[28:31], v[80:83]
    v_cvt_pk_bf16_f32 v166, v88, v89
    v_cvt_pk_bf16_f32 v167, v90, v91
    v_mfma_f32_16x16x32_bf16 v[84:87], v[188:191], v[44:47], v[240:243]
    v_exp_f32 v94, v94
    v_mfma_f32_16x16x32_bf16 v[84:87], v[184:187], v[40:43], v[84:87]
    ds_read_b128 v[196:199], v5 offset:34112
    v_mfma_f32_16x16x32_bf16 v[84:87], v[180:183], v[36:39], v[84:87]
    v_exp_f32 v95, v95
    v_mfma_f32_16x16x32_bf16 v[84:87], v[176:179], v[32:35], v[84:87]
    v_mfma_f32_16x16x32_bf16 v[88:91], v[176:179], v[48:51], v[240:243]
    v_exp_f32 v80, v80
    v_mfma_f32_16x16x32_bf16 v[88:91], v[180:183], v[52:55], v[88:91]
    ds_read_b64_tr_b16 v[216:217], v4 offset:16928
    ds_read_b64_tr_b16 v[218:219], v4 offset:17184
    v_mfma_f32_16x16x32_bf16 v[88:91], v[184:187], v[56:59], v[88:91]
    v_exp_f32 v81, v81
    v_mfma_f32_16x16x32_bf16 v[88:91], v[188:191], v[60:63], v[88:91]
    v_cvt_pk_bf16_f32 v174, v92, v93
    v_cvt_pk_bf16_f32 v175, v94, v95
    v_mfma_f32_16x16x32_bf16 v[92:95], v[188:191], v[76:79], v[240:243]
    v_exp_f32 v82, v82
    v_mfma_f32_16x16x32_bf16 v[92:95], v[184:187], v[72:75], v[92:95]
    ds_read_b128 v[200:203], v5 offset:34176
    v_mfma_f32_16x16x32_bf16 v[92:95], v[180:183], v[68:71], v[92:95]
    s_add_u32 m0, s61, 3144
    v_exp_f32 v83, v83
    v_mfma_f32_16x16x32_bf16 v[92:95], v[176:179], v[64:67], v[92:95]
    s_waitcnt lgkmcnt(4)
    buffer_load_dwordx4 v2, s[8:11], s67 offen  lds
    s_add_u32 s67, s67, 256000
    v_mfma_f32_16x16x32_bf16 a[0:3], v[208:211], v[144:147], a[0:3]
    v_exp_f32 v84, v84
    v_mfma_f32_16x16x32_bf16 a[0:3], v[212:215], v[148:151], a[0:3]
    ds_read_b64_tr_b16 v[220:221], v4 offset:17440
    ds_read_b64_tr_b16 v[222:223], v4 offset:17696
    v_mfma_f32_16x16x32_bf16 a[32:35], v[208:211], v[152:155], a[32:35]
    v_exp_f32 v85, v85
    v_mfma_f32_16x16x32_bf16 a[32:35], v[212:215], v[156:159], a[32:35]
    v_cvt_pk_bf16_f32 v112, v80, v81
    v_cvt_pk_bf16_f32 v113, v82, v83
    v_mfma_f32_16x16x32_bf16 a[64:67], v[208:211], v[160:163], a[64:67]
    v_exp_f32 v86, v86
    v_mfma_f32_16x16x32_bf16 a[64:67], v[212:215], v[164:167], a[64:67]
    ds_read_b128 v[204:207], v5 offset:34240
    v_mfma_f32_16x16x32_bf16 a[96:99], v[208:211], v[168:171], a[96:99]
    v_exp_f32 v87, v87
    v_mfma_f32_16x16x32_bf16 a[96:99], v[212:215], v[172:175], a[96:99]
    s_waitcnt lgkmcnt(4)
    buffer_load_dwordx4 a[236:239], v238, s[36:39], s66 offen
    v_mfma_f32_16x16x32_bf16 a[100:103], v[216:219], v[168:171], a[100:103]
    s_waitcnt lgkmcnt(1)
    v_exp_f32 v88, v88
    v_mfma_f32_16x16x32_bf16 a[100:103], v[220:223], v[172:175], a[100:103]
    ds_read_b64_tr_b16 v[208:209], v4 offset:16960
    ds_read_b64_tr_b16 v[210:211], v4 offset:17216
    v_mfma_f32_16x16x32_bf16 a[68:71], v[216:219], v[160:163], a[68:71]
    v_exp_f32 v89, v89
    v_mfma_f32_16x16x32_bf16 a[68:71], v[220:223], v[164:167], a[68:71]
    v_cvt_pk_bf16_f32 v120, v84, v85
    v_cvt_pk_bf16_f32 v121, v86, v87
    v_mfma_f32_16x16x32_bf16 a[36:39], v[216:219], v[152:155], a[36:39]
    v_exp_f32 v90, v90
    v_mfma_f32_16x16x32_bf16 a[36:39], v[220:223], v[156:159], a[36:39]
    ds_read_b128 v[176:179], v5 offset:34304
    v_mfma_f32_16x16x32_bf16 a[4:7], v[216:219], v[144:147], a[4:7]
    s_add_u32 m0, s61, 118272
    v_exp_f32 v91, v91
    v_mfma_f32_16x16x32_bf16 a[4:7], v[220:223], v[148:151], a[4:7]
    buffer_load_dwordx4 v3, s[20:23], s64 offen offset:0  lds
    v_smfmac_f32_16x16x64_bf16 a[128:131], v[224:227], v[144:151], v228
    s_waitcnt lgkmcnt(3)
    v_mfma_f32_16x16x32_bf16 v[80:83], v[192:195], v[16:19], v[240:243]
    v_exp_f32 v92, v92
    v_mfma_f32_16x16x32_bf16 v[80:83], v[196:199], v[20:23], v[80:83]
    ds_read_b64_tr_b16 v[212:213], v4 offset:17472
    ds_read_b64_tr_b16 v[214:215], v4 offset:17728
    v_mfma_f32_16x16x32_bf16 v[80:83], v[200:203], v[24:27], v[80:83]
    v_exp_f32 v93, v93
    v_mfma_f32_16x16x32_bf16 v[80:83], v[204:207], v[28:31], v[80:83]
    v_cvt_pk_bf16_f32 v128, v88, v89
    v_cvt_pk_bf16_f32 v129, v90, v91
    v_mfma_f32_16x16x32_bf16 v[84:87], v[204:207], v[44:47], v[240:243]
    v_exp_f32 v94, v94
    v_mfma_f32_16x16x32_bf16 v[84:87], v[200:203], v[40:43], v[84:87]
    ds_read_b128 v[180:183], v5 offset:34368
    v_mfma_f32_16x16x32_bf16 v[84:87], v[196:199], v[36:39], v[84:87]
    v_exp_f32 v95, v95
    v_mfma_f32_16x16x32_bf16 v[84:87], v[192:195], v[32:35], v[84:87]
    v_mfma_f32_16x16x32_bf16 v[88:91], v[192:195], v[48:51], v[240:243]
    v_exp_f32 v80, v80
    v_mfma_f32_16x16x32_bf16 v[88:91], v[196:199], v[52:55], v[88:91]
    ds_read_b64_tr_b16 v[216:217], v4 offset:16992
    ds_read_b64_tr_b16 v[218:219], v4 offset:17248
    v_mfma_f32_16x16x32_bf16 v[88:91], v[200:203], v[56:59], v[88:91]
    v_exp_f32 v81, v81
    v_mfma_f32_16x16x32_bf16 v[88:91], v[204:207], v[60:63], v[88:91]
    v_cvt_pk_bf16_f32 v136, v92, v93
    v_cvt_pk_bf16_f32 v137, v94, v95
    v_mfma_f32_16x16x32_bf16 v[92:95], v[204:207], v[76:79], v[240:243]
    v_exp_f32 v82, v82
    v_mfma_f32_16x16x32_bf16 v[92:95], v[200:203], v[72:75], v[92:95]
    ds_read_b128 v[184:187], v5 offset:34432
    v_mfma_f32_16x16x32_bf16 v[92:95], v[196:199], v[68:71], v[92:95]
    s_add_u32 m0, s61, 118304
    v_exp_f32 v83, v83
    v_mfma_f32_16x16x32_bf16 v[92:95], v[192:195], v[64:67], v[92:95]
    s_waitcnt lgkmcnt(4)
    buffer_load_dwordx4 v3, s[20:23], s64 offen offset:1024  lds
    v_mfma_f32_16x16x32_bf16 a[8:11], v[208:211], v[144:147], a[8:11]
    v_exp_f32 v84, v84
    v_mfma_f32_16x16x32_bf16 a[8:11], v[212:215], v[148:151], a[8:11]
    ds_read_b64_tr_b16 v[220:221], v4 offset:17504
    ds_read_b64_tr_b16 v[222:223], v4 offset:17760
    v_mfma_f32_16x16x32_bf16 a[40:43], v[208:211], v[152:155], a[40:43]
    v_exp_f32 v85, v85
    v_mfma_f32_16x16x32_bf16 a[40:43], v[212:215], v[156:159], a[40:43]
    v_cvt_pk_bf16_f32 v114, v80, v81
    v_cvt_pk_bf16_f32 v115, v82, v83
    v_mfma_f32_16x16x32_bf16 a[72:75], v[208:211], v[160:163], a[72:75]
    v_exp_f32 v86, v86
    v_mfma_f32_16x16x32_bf16 a[72:75], v[212:215], v[164:167], a[72:75]
    ds_read_b128 v[188:191], v5 offset:34496
    v_mfma_f32_16x16x32_bf16 a[104:107], v[208:211], v[168:171], a[104:107]
    v_exp_f32 v87, v87
    v_mfma_f32_16x16x32_bf16 a[104:107], v[212:215], v[172:175], a[104:107]
    s_waitcnt lgkmcnt(4)
    v_mfma_f32_16x16x32_bf16 a[108:111], v[216:219], v[168:171], a[108:111]
    s_waitcnt lgkmcnt(1)
    v_exp_f32 v88, v88
    v_mfma_f32_16x16x32_bf16 a[108:111], v[220:223], v[172:175], a[108:111]
    ds_read_b64_tr_b16 v[208:209], v4 offset:17024
    ds_read_b64_tr_b16 v[210:211], v4 offset:17280
    v_mfma_f32_16x16x32_bf16 a[76:79], v[216:219], v[160:163], a[76:79]
    v_exp_f32 v89, v89
    v_mfma_f32_16x16x32_bf16 a[76:79], v[220:223], v[164:167], a[76:79]
    v_cvt_pk_bf16_f32 v122, v84, v85
    v_cvt_pk_bf16_f32 v123, v86, v87
    v_mfma_f32_16x16x32_bf16 a[44:47], v[216:219], v[152:155], a[44:47]
    v_exp_f32 v90, v90
    v_mfma_f32_16x16x32_bf16 a[44:47], v[220:223], v[156:159], a[44:47]
    ds_read_b128 v[192:195], v5 offset:34560
    v_mfma_f32_16x16x32_bf16 a[12:15], v[216:219], v[144:147], a[12:15]
    s_add_u32 m0, s61, 118336
    v_exp_f32 v91, v91
    v_mfma_f32_16x16x32_bf16 a[12:15], v[220:223], v[148:151], a[12:15]
    buffer_load_dwordx4 v3, s[20:23], s64 offen offset:2048  lds
    v_smfmac_f32_16x16x64_bf16 a[132:135], v[224:227], v[152:159], v228
    s_waitcnt lgkmcnt(3)
    v_mfma_f32_16x16x32_bf16 v[80:83], v[176:179], v[16:19], v[240:243]
    v_exp_f32 v92, v92
    v_mfma_f32_16x16x32_bf16 v[80:83], v[180:183], v[20:23], v[80:83]
    ds_read_b64_tr_b16 v[212:213], v4 offset:17536
    ds_read_b64_tr_b16 v[214:215], v4 offset:17792
    v_mfma_f32_16x16x32_bf16 v[80:83], v[184:187], v[24:27], v[80:83]
    v_exp_f32 v93, v93
    v_mfma_f32_16x16x32_bf16 v[80:83], v[188:191], v[28:31], v[80:83]
    v_cvt_pk_bf16_f32 v130, v88, v89
    v_cvt_pk_bf16_f32 v131, v90, v91
    v_mfma_f32_16x16x32_bf16 v[84:87], v[188:191], v[44:47], v[240:243]
    v_exp_f32 v94, v94
    v_mfma_f32_16x16x32_bf16 v[84:87], v[184:187], v[40:43], v[84:87]
    ds_read_b128 v[196:199], v5 offset:34624
    v_mfma_f32_16x16x32_bf16 v[84:87], v[180:183], v[36:39], v[84:87]
    v_exp_f32 v95, v95
    v_mfma_f32_16x16x32_bf16 v[84:87], v[176:179], v[32:35], v[84:87]
    v_mfma_f32_16x16x32_bf16 v[88:91], v[176:179], v[48:51], v[240:243]
    v_exp_f32 v80, v80
    v_mfma_f32_16x16x32_bf16 v[88:91], v[180:183], v[52:55], v[88:91]
    ds_read_b64_tr_b16 v[216:217], v4 offset:17056
    ds_read_b64_tr_b16 v[218:219], v4 offset:17312
    v_mfma_f32_16x16x32_bf16 v[88:91], v[184:187], v[56:59], v[88:91]
    v_exp_f32 v81, v81
    v_mfma_f32_16x16x32_bf16 v[88:91], v[188:191], v[60:63], v[88:91]
    v_cvt_pk_bf16_f32 v138, v92, v93
    v_cvt_pk_bf16_f32 v139, v94, v95
    v_mfma_f32_16x16x32_bf16 v[92:95], v[188:191], v[76:79], v[240:243]
    v_exp_f32 v82, v82
    v_mfma_f32_16x16x32_bf16 v[92:95], v[184:187], v[72:75], v[92:95]
    ds_read_b128 v[200:203], v5 offset:34688
    v_mfma_f32_16x16x32_bf16 v[92:95], v[180:183], v[68:71], v[92:95]
    s_add_u32 m0, s61, 118368
    v_exp_f32 v83, v83
    v_mfma_f32_16x16x32_bf16 v[92:95], v[176:179], v[64:67], v[92:95]
    s_waitcnt lgkmcnt(4)
    buffer_load_dwordx4 v3, s[20:23], s64 offen offset:3072  lds
    s_add_u32 s64, s64, 16384
    v_mfma_f32_16x16x32_bf16 a[16:19], v[208:211], v[144:147], a[16:19]
    v_exp_f32 v84, v84
    v_mfma_f32_16x16x32_bf16 a[16:19], v[212:215], v[148:151], a[16:19]
    ds_read_b64_tr_b16 v[220:221], v4 offset:17568
    ds_read_b64_tr_b16 v[222:223], v4 offset:17824
    v_mfma_f32_16x16x32_bf16 a[48:51], v[208:211], v[152:155], a[48:51]
    v_exp_f32 v85, v85
    v_mfma_f32_16x16x32_bf16 a[48:51], v[212:215], v[156:159], a[48:51]
    v_cvt_pk_bf16_f32 v116, v80, v81
    v_cvt_pk_bf16_f32 v117, v82, v83
    v_mfma_f32_16x16x32_bf16 a[80:83], v[208:211], v[160:163], a[80:83]
    v_exp_f32 v86, v86
    v_mfma_f32_16x16x32_bf16 a[80:83], v[212:215], v[164:167], a[80:83]
    ds_read_b128 v[204:207], v5 offset:34752
    v_mfma_f32_16x16x32_bf16 a[112:115], v[208:211], v[168:171], a[112:115]
    v_exp_f32 v87, v87
    v_mfma_f32_16x16x32_bf16 a[112:115], v[212:215], v[172:175], a[112:115]
    s_waitcnt lgkmcnt(4)
    s_waitcnt vmcnt(10)
    s_barrier
    v_mfma_f32_16x16x32_bf16 a[116:119], v[216:219], v[168:171], a[116:119]
    s_waitcnt lgkmcnt(1)
    v_exp_f32 v88, v88
    v_mfma_f32_16x16x32_bf16 a[116:119], v[220:223], v[172:175], a[116:119]
    ds_read_b64_tr_b16 v[208:209], v4 offset:17088
    ds_read_b64_tr_b16 v[210:211], v4 offset:17344
    v_mfma_f32_16x16x32_bf16 a[84:87], v[216:219], v[160:163], a[84:87]
    v_exp_f32 v89, v89
    v_mfma_f32_16x16x32_bf16 a[84:87], v[220:223], v[164:167], a[84:87]
    v_cvt_pk_bf16_f32 v124, v84, v85
    v_cvt_pk_bf16_f32 v125, v86, v87
    v_mfma_f32_16x16x32_bf16 a[52:55], v[216:219], v[152:155], a[52:55]
    v_exp_f32 v90, v90
    v_mfma_f32_16x16x32_bf16 a[52:55], v[220:223], v[156:159], a[52:55]
    ds_read_b128 v[176:179], v5 offset:50688
    v_mfma_f32_16x16x32_bf16 a[20:23], v[216:219], v[144:147], a[20:23]
    s_add_u32 m0, s61, 16896
    v_exp_f32 v91, v91
    v_mfma_f32_16x16x32_bf16 a[20:23], v[220:223], v[148:151], a[20:23]
    buffer_load_dwordx4 v2, s[8:11], s67 offen  lds
    v_smfmac_f32_16x16x64_bf16 a[136:139], v[224:227], v[160:167], v228
    s_add_u32 s67, s67, 2048
    s_waitcnt lgkmcnt(3)
    v_mfma_f32_16x16x32_bf16 v[80:83], v[192:195], v[16:19], v[240:243]
    v_exp_f32 v92, v92
    v_mfma_f32_16x16x32_bf16 v[80:83], v[196:199], v[20:23], v[80:83]
    ds_read_b64_tr_b16 v[212:213], v4 offset:17600
    ds_read_b64_tr_b16 v[214:215], v4 offset:17856
    v_mfma_f32_16x16x32_bf16 v[80:83], v[200:203], v[24:27], v[80:83]
    v_exp_f32 v93, v93
    v_mfma_f32_16x16x32_bf16 v[80:83], v[204:207], v[28:31], v[80:83]
    v_cvt_pk_bf16_f32 v132, v88, v89
    v_cvt_pk_bf16_f32 v133, v90, v91
    v_mfma_f32_16x16x32_bf16 v[84:87], v[204:207], v[44:47], v[240:243]
    v_exp_f32 v94, v94
    v_mfma_f32_16x16x32_bf16 v[84:87], v[200:203], v[40:43], v[84:87]
    ds_read_b128 v[180:183], v5 offset:50752
    v_mfma_f32_16x16x32_bf16 v[84:87], v[196:199], v[36:39], v[84:87]
    v_exp_f32 v95, v95
    v_mfma_f32_16x16x32_bf16 v[84:87], v[192:195], v[32:35], v[84:87]
    v_mfma_f32_16x16x32_bf16 v[88:91], v[192:195], v[48:51], v[240:243]
    v_exp_f32 v80, v80
    v_mfma_f32_16x16x32_bf16 v[88:91], v[196:199], v[52:55], v[88:91]
    ds_read_b64_tr_b16 v[216:217], v4 offset:17120
    ds_read_b64_tr_b16 v[218:219], v4 offset:17376
    v_mfma_f32_16x16x32_bf16 v[88:91], v[200:203], v[56:59], v[88:91]
    v_exp_f32 v81, v81
    v_mfma_f32_16x16x32_bf16 v[88:91], v[204:207], v[60:63], v[88:91]
    v_cvt_pk_bf16_f32 v140, v92, v93
    v_cvt_pk_bf16_f32 v141, v94, v95
    v_mfma_f32_16x16x32_bf16 v[92:95], v[204:207], v[76:79], v[240:243]
    v_exp_f32 v82, v82
    v_mfma_f32_16x16x32_bf16 v[92:95], v[200:203], v[72:75], v[92:95]
    ds_read_b128 v[184:187], v5 offset:50816
    v_mfma_f32_16x16x32_bf16 v[92:95], v[196:199], v[68:71], v[92:95]
    s_add_u32 m0, s61, 17928
    v_exp_f32 v83, v83
    v_mfma_f32_16x16x32_bf16 v[92:95], v[192:195], v[64:67], v[92:95]
    s_waitcnt lgkmcnt(4)
    buffer_load_dwordx4 v2, s[8:11], s67 offen  lds
    s_add_u32 s67, s67, 2048
    v_mfma_f32_16x16x32_bf16 a[24:27], v[208:211], v[144:147], a[24:27]
    v_exp_f32 v84, v84
    v_mfma_f32_16x16x32_bf16 a[24:27], v[212:215], v[148:151], a[24:27]
    ds_read_b64_tr_b16 v[220:221], v4 offset:17632
    ds_read_b64_tr_b16 v[222:223], v4 offset:17888
    v_mfma_f32_16x16x32_bf16 a[56:59], v[208:211], v[152:155], a[56:59]
    v_exp_f32 v85, v85
    v_mfma_f32_16x16x32_bf16 a[56:59], v[212:215], v[156:159], a[56:59]
    v_cvt_pk_bf16_f32 v118, v80, v81
    v_cvt_pk_bf16_f32 v119, v82, v83
    v_mfma_f32_16x16x32_bf16 a[88:91], v[208:211], v[160:163], a[88:91]
    v_exp_f32 v86, v86
    v_mfma_f32_16x16x32_bf16 a[88:91], v[212:215], v[164:167], a[88:91]
    ds_read_b128 v[188:191], v5 offset:50880
    v_mfma_f32_16x16x32_bf16 a[120:123], v[208:211], v[168:171], a[120:123]
    v_exp_f32 v87, v87
    v_mfma_f32_16x16x32_bf16 a[120:123], v[212:215], v[172:175], a[120:123]
    s_waitcnt lgkmcnt(4)
    v_mfma_f32_16x16x32_bf16 a[124:127], v[216:219], v[168:171], a[124:127]
    s_waitcnt lgkmcnt(1)
    v_exp_f32 v88, v88
    v_mfma_f32_16x16x32_bf16 a[124:127], v[220:223], v[172:175], a[124:127]
    ds_read_b64_tr_b16 v[208:209], v4 offset:33792
    ds_read_b64_tr_b16 v[210:211], v4 offset:34048
    v_mfma_f32_16x16x32_bf16 a[92:95], v[216:219], v[160:163], a[92:95]
    v_exp_f32 v89, v89
    v_mfma_f32_16x16x32_bf16 a[92:95], v[220:223], v[164:167], a[92:95]
    v_cvt_pk_bf16_f32 v126, v84, v85
    v_cvt_pk_bf16_f32 v127, v86, v87
    v_mfma_f32_16x16x32_bf16 a[60:63], v[216:219], v[152:155], a[60:63]
    v_exp_f32 v90, v90
    v_mfma_f32_16x16x32_bf16 a[60:63], v[220:223], v[156:159], a[60:63]
    ds_read_b128 v[192:195], v5 offset:50944
    v_mfma_f32_16x16x32_bf16 a[28:31], v[216:219], v[144:147], a[28:31]
    s_add_u32 m0, s61, 19008
    v_exp_f32 v91, v91
    v_mfma_f32_16x16x32_bf16 a[28:31], v[220:223], v[148:151], a[28:31]
    buffer_load_dwordx4 v2, s[8:11], s67 offen  lds
    v_smfmac_f32_16x16x64_bf16 a[140:143], v[224:227], v[168:175], v228
    s_add_u32 s67, s67, 2048
    s_waitcnt lgkmcnt(3)
    v_mfma_f32_16x16x32_bf16 v[80:83], v[176:179], v[16:19], v[240:243]
    v_exp_f32 v92, v92
    v_mfma_f32_16x16x32_bf16 v[80:83], v[180:183], v[20:23], v[80:83]
    ds_read_b64_tr_b16 v[212:213], v4 offset:34304
    ds_read_b64_tr_b16 v[214:215], v4 offset:34560
    v_mfma_f32_16x16x32_bf16 v[80:83], v[184:187], v[24:27], v[80:83]
    v_exp_f32 v93, v93
    v_mfma_f32_16x16x32_bf16 v[80:83], v[188:191], v[28:31], v[80:83]
    v_cvt_pk_bf16_f32 v134, v88, v89
    v_cvt_pk_bf16_f32 v135, v90, v91
    v_mfma_f32_16x16x32_bf16 v[84:87], v[188:191], v[44:47], v[240:243]
    v_exp_f32 v94, v94
    v_mfma_f32_16x16x32_bf16 v[84:87], v[184:187], v[40:43], v[84:87]
    ds_read_b128 v[196:199], v5 offset:51008
    v_mfma_f32_16x16x32_bf16 v[84:87], v[180:183], v[36:39], v[84:87]
    v_exp_f32 v95, v95
    v_mfma_f32_16x16x32_bf16 v[84:87], v[176:179], v[32:35], v[84:87]
    v_mfma_f32_16x16x32_bf16 v[88:91], v[176:179], v[48:51], v[240:243]
    v_exp_f32 v80, v80
    v_mfma_f32_16x16x32_bf16 v[88:91], v[180:183], v[52:55], v[88:91]
    ds_read_b64_tr_b16 v[216:217], v4 offset:33824
    ds_read_b64_tr_b16 v[218:219], v4 offset:34080
    v_mfma_f32_16x16x32_bf16 v[88:91], v[184:187], v[56:59], v[88:91]
    v_exp_f32 v81, v81
    v_mfma_f32_16x16x32_bf16 v[88:91], v[188:191], v[60:63], v[88:91]
    v_cvt_pk_bf16_f32 v142, v92, v93
    v_cvt_pk_bf16_f32 v143, v94, v95
    v_mfma_f32_16x16x32_bf16 v[92:95], v[188:191], v[76:79], v[240:243]
    v_exp_f32 v82, v82
    v_mfma_f32_16x16x32_bf16 v[92:95], v[184:187], v[72:75], v[92:95]
    ds_read_b128 v[200:203], v5 offset:51072
    v_mfma_f32_16x16x32_bf16 v[92:95], v[180:183], v[68:71], v[92:95]
    s_add_u32 m0, s61, 20040
    v_exp_f32 v83, v83
    v_mfma_f32_16x16x32_bf16 v[92:95], v[176:179], v[64:67], v[92:95]
    s_waitcnt lgkmcnt(4)
    buffer_load_dwordx4 v2, s[8:11], s67 offen  lds
    s_add_u32 s67, s67, 256000
    v_mfma_f32_16x16x32_bf16 a[0:3], v[208:211], v[112:115], a[0:3]
    v_exp_f32 v84, v84
    v_mfma_f32_16x16x32_bf16 a[0:3], v[212:215], v[116:119], a[0:3]
    ds_read_b64_tr_b16 v[220:221], v4 offset:34336
    ds_read_b64_tr_b16 v[222:223], v4 offset:34592
    v_mfma_f32_16x16x32_bf16 a[32:35], v[208:211], v[120:123], a[32:35]
    v_exp_f32 v85, v85
    v_mfma_f32_16x16x32_bf16 a[32:35], v[212:215], v[124:127], a[32:35]
    v_cvt_pk_bf16_f32 v144, v80, v81
    v_cvt_pk_bf16_f32 v145, v82, v83
    v_mfma_f32_16x16x32_bf16 a[64:67], v[208:211], v[128:131], a[64:67]
    v_exp_f32 v86, v86
    v_mfma_f32_16x16x32_bf16 a[64:67], v[212:215], v[132:135], a[64:67]
    ds_read_b128 v[204:207], v5 offset:51136
    v_mfma_f32_16x16x32_bf16 a[96:99], v[208:211], v[136:139], a[96:99]
    v_exp_f32 v87, v87
    v_mfma_f32_16x16x32_bf16 a[96:99], v[212:215], v[140:143], a[96:99]
    s_waitcnt lgkmcnt(4)
    v_mfma_f32_16x16x32_bf16 a[100:103], v[216:219], v[136:139], a[100:103]
    s_waitcnt lgkmcnt(1)
    v_exp_f32 v88, v88
    v_mfma_f32_16x16x32_bf16 a[100:103], v[220:223], v[140:143], a[100:103]
    ds_read_b64_tr_b16 v[208:209], v4 offset:33856
    ds_read_b64_tr_b16 v[210:211], v4 offset:34112
    v_mfma_f32_16x16x32_bf16 a[68:71], v[216:219], v[128:131], a[68:71]
    v_exp_f32 v89, v89
    v_mfma_f32_16x16x32_bf16 a[68:71], v[220:223], v[132:135], a[68:71]
    v_cvt_pk_bf16_f32 v152, v84, v85
    v_cvt_pk_bf16_f32 v153, v86, v87
    v_mfma_f32_16x16x32_bf16 a[36:39], v[216:219], v[120:123], a[36:39]
    v_exp_f32 v90, v90
    v_mfma_f32_16x16x32_bf16 a[36:39], v[220:223], v[124:127], a[36:39]
    ds_read_b128 v[176:179], v5 offset:51200
    v_mfma_f32_16x16x32_bf16 a[4:7], v[216:219], v[112:115], a[4:7]
    s_add_u32 m0, s62, 0
    v_exp_f32 v91, v91
    v_mfma_f32_16x16x32_bf16 a[4:7], v[220:223], v[116:119], a[4:7]
    buffer_load_dwordx4 v2, s[8:11], s65 offen  lds
    v_smfmac_f32_16x16x64_bf16 a[128:131], v[224:227], v[112:119], v228
    s_add_u32 s65, s65, 2048
    s_waitcnt lgkmcnt(3)
    v_mfma_f32_16x16x32_bf16 v[80:83], v[192:195], v[16:19], v[240:243]
    v_exp_f32 v92, v92
    v_mfma_f32_16x16x32_bf16 v[80:83], v[196:199], v[20:23], v[80:83]
    ds_read_b64_tr_b16 v[212:213], v4 offset:34368
    ds_read_b64_tr_b16 v[214:215], v4 offset:34624
    v_mfma_f32_16x16x32_bf16 v[80:83], v[200:203], v[24:27], v[80:83]
    v_exp_f32 v93, v93
    v_mfma_f32_16x16x32_bf16 v[80:83], v[204:207], v[28:31], v[80:83]
    v_cvt_pk_bf16_f32 v160, v88, v89
    v_cvt_pk_bf16_f32 v161, v90, v91
    v_mfma_f32_16x16x32_bf16 v[84:87], v[204:207], v[44:47], v[240:243]
    v_exp_f32 v94, v94
    v_mfma_f32_16x16x32_bf16 v[84:87], v[200:203], v[40:43], v[84:87]
    ds_read_b128 v[180:183], v5 offset:51264
    v_mfma_f32_16x16x32_bf16 v[84:87], v[196:199], v[36:39], v[84:87]
    v_exp_f32 v95, v95
    v_mfma_f32_16x16x32_bf16 v[84:87], v[192:195], v[32:35], v[84:87]
    v_mfma_f32_16x16x32_bf16 v[88:91], v[192:195], v[48:51], v[240:243]
    v_exp_f32 v80, v80
    v_mfma_f32_16x16x32_bf16 v[88:91], v[196:199], v[52:55], v[88:91]
    ds_read_b64_tr_b16 v[216:217], v4 offset:33888
    ds_read_b64_tr_b16 v[218:219], v4 offset:34144
    v_mfma_f32_16x16x32_bf16 v[88:91], v[200:203], v[56:59], v[88:91]
    v_exp_f32 v81, v81
    v_mfma_f32_16x16x32_bf16 v[88:91], v[204:207], v[60:63], v[88:91]
    v_cvt_pk_bf16_f32 v168, v92, v93
    v_cvt_pk_bf16_f32 v169, v94, v95
    v_mfma_f32_16x16x32_bf16 v[92:95], v[204:207], v[76:79], v[240:243]
    v_exp_f32 v82, v82
    v_mfma_f32_16x16x32_bf16 v[92:95], v[200:203], v[72:75], v[92:95]
    ds_read_b128 v[184:187], v5 offset:51328
    v_mfma_f32_16x16x32_bf16 v[92:95], v[196:199], v[68:71], v[92:95]
    s_add_u32 m0, s62, 1032
    v_exp_f32 v83, v83
    v_mfma_f32_16x16x32_bf16 v[92:95], v[192:195], v[64:67], v[92:95]
    s_waitcnt lgkmcnt(4)
    buffer_load_dwordx4 v2, s[8:11], s65 offen  lds
    s_add_u32 s65, s65, 2048
    v_mfma_f32_16x16x32_bf16 a[8:11], v[208:211], v[112:115], a[8:11]
    v_exp_f32 v84, v84
    v_mfma_f32_16x16x32_bf16 a[8:11], v[212:215], v[116:119], a[8:11]
    ds_read_b64_tr_b16 v[220:221], v4 offset:34400
    ds_read_b64_tr_b16 v[222:223], v4 offset:34656
    v_mfma_f32_16x16x32_bf16 a[40:43], v[208:211], v[120:123], a[40:43]
    v_exp_f32 v85, v85
    v_mfma_f32_16x16x32_bf16 a[40:43], v[212:215], v[124:127], a[40:43]
    v_cvt_pk_bf16_f32 v146, v80, v81
    v_cvt_pk_bf16_f32 v147, v82, v83
    v_mfma_f32_16x16x32_bf16 a[72:75], v[208:211], v[128:131], a[72:75]
    v_exp_f32 v86, v86
    v_mfma_f32_16x16x32_bf16 a[72:75], v[212:215], v[132:135], a[72:75]
    ds_read_b128 v[188:191], v5 offset:51392
    v_mfma_f32_16x16x32_bf16 a[104:107], v[208:211], v[136:139], a[104:107]
    v_exp_f32 v87, v87
    v_mfma_f32_16x16x32_bf16 a[104:107], v[212:215], v[140:143], a[104:107]
    s_waitcnt lgkmcnt(4)
    v_mfma_f32_16x16x32_bf16 a[108:111], v[216:219], v[136:139], a[108:111]
    s_waitcnt lgkmcnt(1)
    v_exp_f32 v88, v88
    v_mfma_f32_16x16x32_bf16 a[108:111], v[220:223], v[140:143], a[108:111]
    ds_read_b64_tr_b16 v[208:209], v4 offset:33920
    ds_read_b64_tr_b16 v[210:211], v4 offset:34176
    v_mfma_f32_16x16x32_bf16 a[76:79], v[216:219], v[128:131], a[76:79]
    v_exp_f32 v89, v89
    v_mfma_f32_16x16x32_bf16 a[76:79], v[220:223], v[132:135], a[76:79]
    v_cvt_pk_bf16_f32 v154, v84, v85
    v_cvt_pk_bf16_f32 v155, v86, v87
    v_mfma_f32_16x16x32_bf16 a[44:47], v[216:219], v[120:123], a[44:47]
    v_exp_f32 v90, v90
    v_mfma_f32_16x16x32_bf16 a[44:47], v[220:223], v[124:127], a[44:47]
    ds_read_b128 v[192:195], v5 offset:51456
    v_mfma_f32_16x16x32_bf16 a[12:15], v[216:219], v[112:115], a[12:15]
    s_add_u32 m0, s62, 2112
    v_exp_f32 v91, v91
    v_mfma_f32_16x16x32_bf16 a[12:15], v[220:223], v[116:119], a[12:15]
    buffer_load_dwordx4 v2, s[8:11], s65 offen  lds
    v_smfmac_f32_16x16x64_bf16 a[132:135], v[224:227], v[120:127], v228
    s_add_u32 s65, s65, 2048
    s_waitcnt lgkmcnt(3)
    v_mfma_f32_16x16x32_bf16 v[80:83], v[176:179], v[16:19], v[240:243]
    v_exp_f32 v92, v92
    v_mfma_f32_16x16x32_bf16 v[80:83], v[180:183], v[20:23], v[80:83]
    ds_read_b64_tr_b16 v[212:213], v4 offset:34432
    ds_read_b64_tr_b16 v[214:215], v4 offset:34688
    v_mfma_f32_16x16x32_bf16 v[80:83], v[184:187], v[24:27], v[80:83]
    v_exp_f32 v93, v93
    v_mfma_f32_16x16x32_bf16 v[80:83], v[188:191], v[28:31], v[80:83]
    v_cvt_pk_bf16_f32 v162, v88, v89
    v_cvt_pk_bf16_f32 v163, v90, v91
    v_mfma_f32_16x16x32_bf16 v[84:87], v[188:191], v[44:47], v[240:243]
    v_exp_f32 v94, v94
    v_mfma_f32_16x16x32_bf16 v[84:87], v[184:187], v[40:43], v[84:87]
    ds_read_b128 v[196:199], v5 offset:51520
    v_mfma_f32_16x16x32_bf16 v[84:87], v[180:183], v[36:39], v[84:87]
    v_exp_f32 v95, v95
    v_mfma_f32_16x16x32_bf16 v[84:87], v[176:179], v[32:35], v[84:87]
    v_mfma_f32_16x16x32_bf16 v[88:91], v[176:179], v[48:51], v[240:243]
    v_exp_f32 v80, v80
    v_mfma_f32_16x16x32_bf16 v[88:91], v[180:183], v[52:55], v[88:91]
    ds_read_b64_tr_b16 v[216:217], v4 offset:33952
    ds_read_b64_tr_b16 v[218:219], v4 offset:34208
    v_mfma_f32_16x16x32_bf16 v[88:91], v[184:187], v[56:59], v[88:91]
    v_exp_f32 v81, v81
    v_mfma_f32_16x16x32_bf16 v[88:91], v[188:191], v[60:63], v[88:91]
    v_cvt_pk_bf16_f32 v170, v92, v93
    v_cvt_pk_bf16_f32 v171, v94, v95
    v_mfma_f32_16x16x32_bf16 v[92:95], v[188:191], v[76:79], v[240:243]
    v_exp_f32 v82, v82
    v_mfma_f32_16x16x32_bf16 v[92:95], v[184:187], v[72:75], v[92:95]
    ds_read_b128 v[200:203], v5 offset:51584
    v_mfma_f32_16x16x32_bf16 v[92:95], v[180:183], v[68:71], v[92:95]
    s_add_u32 m0, s62, 3144
    v_exp_f32 v83, v83
    v_mfma_f32_16x16x32_bf16 v[92:95], v[176:179], v[64:67], v[92:95]
    s_waitcnt lgkmcnt(4)
    buffer_load_dwordx4 v2, s[8:11], s65 offen  lds
    s_add_u32 s65, s65, 256000
    v_mfma_f32_16x16x32_bf16 a[16:19], v[208:211], v[112:115], a[16:19]
    v_exp_f32 v84, v84
    v_mfma_f32_16x16x32_bf16 a[16:19], v[212:215], v[116:119], a[16:19]
    ds_read_b64_tr_b16 v[220:221], v4 offset:34464
    ds_read_b64_tr_b16 v[222:223], v4 offset:34720
    v_mfma_f32_16x16x32_bf16 a[48:51], v[208:211], v[120:123], a[48:51]
    v_exp_f32 v85, v85
    v_mfma_f32_16x16x32_bf16 a[48:51], v[212:215], v[124:127], a[48:51]
    v_cvt_pk_bf16_f32 v148, v80, v81
    v_cvt_pk_bf16_f32 v149, v82, v83
    v_mfma_f32_16x16x32_bf16 a[80:83], v[208:211], v[128:131], a[80:83]
    v_exp_f32 v86, v86
    v_mfma_f32_16x16x32_bf16 a[80:83], v[212:215], v[132:135], a[80:83]
    ds_read_b128 v[204:207], v5 offset:51648
    v_mfma_f32_16x16x32_bf16 a[112:115], v[208:211], v[136:139], a[112:115]
    v_exp_f32 v87, v87
    v_mfma_f32_16x16x32_bf16 a[112:115], v[212:215], v[140:143], a[112:115]
    s_waitcnt lgkmcnt(4)
    s_waitcnt vmcnt(8)
    s_barrier
    v_mfma_f32_16x16x32_bf16 a[116:119], v[216:219], v[136:139], a[116:119]
    s_waitcnt lgkmcnt(1)
    v_exp_f32 v88, v88
    v_mfma_f32_16x16x32_bf16 a[116:119], v[220:223], v[140:143], a[116:119]
    ds_read_b64_tr_b16 v[208:209], v4 offset:33984
    ds_read_b64_tr_b16 v[210:211], v4 offset:34240
    v_mfma_f32_16x16x32_bf16 a[84:87], v[216:219], v[128:131], a[84:87]
    v_exp_f32 v89, v89
    v_mfma_f32_16x16x32_bf16 a[84:87], v[220:223], v[132:135], a[84:87]
    v_cvt_pk_bf16_f32 v156, v84, v85
    v_cvt_pk_bf16_f32 v157, v86, v87
    v_mfma_f32_16x16x32_bf16 a[52:55], v[216:219], v[120:123], a[52:55]
    v_exp_f32 v90, v90
    v_mfma_f32_16x16x32_bf16 a[52:55], v[220:223], v[124:127], a[52:55]
    v_mfma_f32_16x16x32_bf16 a[20:23], v[216:219], v[112:115], a[20:23]
    s_add_u32 m0, s61, 33792
    v_exp_f32 v91, v91
    v_mfma_f32_16x16x32_bf16 a[20:23], v[220:223], v[116:119], a[20:23]
    buffer_load_dwordx4 v2, s[8:11], s67 offen  lds
    v_smfmac_f32_16x16x64_bf16 a[136:139], v[224:227], v[128:135], v228
    s_add_u32 s67, s67, 2048
    s_waitcnt lgkmcnt(2)
    v_mfma_f32_16x16x32_bf16 v[80:83], v[192:195], v[16:19], v[240:243]
    v_exp_f32 v92, v92
    v_mfma_f32_16x16x32_bf16 v[80:83], v[196:199], v[20:23], v[80:83]
    ds_read_b64_tr_b16 v[212:213], v4 offset:34496
    ds_read_b64_tr_b16 v[214:215], v4 offset:34752
    v_mfma_f32_16x16x32_bf16 v[80:83], v[200:203], v[24:27], v[80:83]
    v_exp_f32 v93, v93
    v_mfma_f32_16x16x32_bf16 v[80:83], v[204:207], v[28:31], v[80:83]
    v_cvt_pk_bf16_f32 v164, v88, v89
    v_cvt_pk_bf16_f32 v165, v90, v91
    v_mfma_f32_16x16x32_bf16 v[84:87], v[204:207], v[44:47], v[240:243]
    v_exp_f32 v94, v94
    v_mfma_f32_16x16x32_bf16 v[84:87], v[200:203], v[40:43], v[84:87]
    v_mfma_f32_16x16x32_bf16 v[84:87], v[196:199], v[36:39], v[84:87]
    s_add_u32 m0, s61, 34824
    v_exp_f32 v95, v95
    v_mfma_f32_16x16x32_bf16 v[84:87], v[192:195], v[32:35], v[84:87]
    buffer_load_dwordx4 v2, s[8:11], s67 offen  lds
    s_add_u32 s67, s67, 2048
    v_mfma_f32_16x16x32_bf16 v[88:91], v[192:195], v[48:51], v[240:243]
    v_exp_f32 v80, v80
    v_mfma_f32_16x16x32_bf16 v[88:91], v[196:199], v[52:55], v[88:91]
    ds_read_b64_tr_b16 v[216:217], v4 offset:34016
    ds_read_b64_tr_b16 v[218:219], v4 offset:34272
    v_mfma_f32_16x16x32_bf16 v[88:91], v[200:203], v[56:59], v[88:91]
    v_exp_f32 v81, v81
    v_mfma_f32_16x16x32_bf16 v[88:91], v[204:207], v[60:63], v[88:91]
    v_cvt_pk_bf16_f32 v172, v92, v93
    v_cvt_pk_bf16_f32 v173, v94, v95
    v_mfma_f32_16x16x32_bf16 v[92:95], v[204:207], v[76:79], v[240:243]
    v_exp_f32 v82, v82
    v_mfma_f32_16x16x32_bf16 v[92:95], v[200:203], v[72:75], v[92:95]
    v_mfma_f32_16x16x32_bf16 v[92:95], v[196:199], v[68:71], v[92:95]
    s_add_u32 m0, s61, 35904
    v_exp_f32 v83, v83
    v_mfma_f32_16x16x32_bf16 v[92:95], v[192:195], v[64:67], v[92:95]
    s_waitcnt lgkmcnt(2)
    buffer_load_dwordx4 v2, s[8:11], s67 offen  lds
    s_add_u32 s67, s67, 2048
    v_mfma_f32_16x16x32_bf16 a[24:27], v[208:211], v[112:115], a[24:27]
    v_exp_f32 v84, v84
    v_mfma_f32_16x16x32_bf16 a[24:27], v[212:215], v[116:119], a[24:27]
    ds_read_b64_tr_b16 v[220:221], v4 offset:34528
    ds_read_b64_tr_b16 v[222:223], v4 offset:34784
    v_mfma_f32_16x16x32_bf16 a[56:59], v[208:211], v[120:123], a[56:59]
    v_exp_f32 v85, v85
    v_mfma_f32_16x16x32_bf16 a[56:59], v[212:215], v[124:127], a[56:59]
    v_cvt_pk_bf16_f32 v150, v80, v81
    v_cvt_pk_bf16_f32 v151, v82, v83
    v_mfma_f32_16x16x32_bf16 a[88:91], v[208:211], v[128:131], a[88:91]
    v_exp_f32 v86, v86
    v_mfma_f32_16x16x32_bf16 a[88:91], v[212:215], v[132:135], a[88:91]
    v_mfma_f32_16x16x32_bf16 a[120:123], v[208:211], v[136:139], a[120:123]
    s_add_u32 m0, s61, 36936
    v_exp_f32 v87, v87
    v_mfma_f32_16x16x32_bf16 a[120:123], v[212:215], v[140:143], a[120:123]
    s_waitcnt lgkmcnt(2)
    buffer_load_dwordx4 v2, s[8:11], s67 offen  lds
    s_add_u32 s67, s67, 256000
    v_mfma_f32_16x16x32_bf16 a[124:127], v[216:219], v[136:139], a[124:127]
    s_waitcnt lgkmcnt(0)
    v_exp_f32 v88, v88
    v_mfma_f32_16x16x32_bf16 a[124:127], v[220:223], v[140:143], a[124:127]
    ds_read_b64_tr_b16 v[208:209], v4 offset:50688
    ds_read_b64_tr_b16 v[210:211], v4 offset:50944
    v_mfma_f32_16x16x32_bf16 a[92:95], v[216:219], v[128:131], a[92:95]
    v_exp_f32 v89, v89
    v_mfma_f32_16x16x32_bf16 a[92:95], v[220:223], v[132:135], a[92:95]
    v_cvt_pk_bf16_f32 v158, v84, v85
    v_cvt_pk_bf16_f32 v159, v86, v87
    v_mfma_f32_16x16x32_bf16 a[60:63], v[216:219], v[120:123], a[60:63]
    v_exp_f32 v90, v90
    v_mfma_f32_16x16x32_bf16 a[60:63], v[220:223], v[124:127], a[60:63]
    v_mfma_f32_16x16x32_bf16 a[28:31], v[216:219], v[112:115], a[28:31]
    s_add_u32 m0, s62, 16896
    v_exp_f32 v91, v91
    v_mfma_f32_16x16x32_bf16 a[28:31], v[220:223], v[116:119], a[28:31]
    buffer_load_dwordx4 v2, s[8:11], s65 offen  lds
    v_smfmac_f32_16x16x64_bf16 a[140:143], v[224:227], v[136:143], v228
    s_add_u32 s65, s65, 2048
    s_waitcnt lgkmcnt(2)
    v_smfmac_f32_16x16x64_bf16 a[128:131], v[224:227], v[144:151], v228
    ds_read_b64_tr_b16 v[212:213], v4 offset:51200
    ds_read_b64_tr_b16 v[214:215], v4 offset:51456
    ds_read_b64_tr_b16 v[216:217], v4 offset:50720
    ds_read_b64_tr_b16 v[218:219], v4 offset:50976
    ds_read_b64_tr_b16 v[220:221], v4 offset:51232
    ds_read_b64_tr_b16 v[222:223], v4 offset:51488
    v_cvt_pk_bf16_f32 v166, v88, v89
    v_cvt_pk_bf16_f32 v167, v90, v91
    v_smfmac_f32_16x16x64_bf16 a[132:135], v[224:227], v[152:159], v228
    v_exp_f32 v92, v92
    v_exp_f32 v93, v93
    v_exp_f32 v94, v94
    v_exp_f32 v95, v95
    v_smfmac_f32_16x16x64_bf16 a[136:139], v[224:227], v[160:167], v228
    v_cvt_pk_bf16_f32 v174, v92, v93
    v_cvt_pk_bf16_f32 v175, v94, v95
    s_mov_b32 s44, 0x33800000
    s_mov_b32 s45, 0x64000000
    s_waitcnt lgkmcnt(0)
    s_barrier
    v_smfmac_f32_16x16x64_bf16 a[140:143], v[224:227], v[168:175], v228
    v_mfma_f32_16x16x32_bf16 a[0:3], v[208:211], v[144:147], a[0:3]
    v_accvgpr_read_b32 v96, a128
    v_accvgpr_read_b32 v97, a129
    v_add_f32 v97, v96, v97
    v_accvgpr_read_b32 v98, a132
    v_accvgpr_read_b32 v99, a133
    v_mfma_f32_16x16x32_bf16 a[0:3], v[212:215], v[148:151], a[0:3]
    ds_read_b64_tr_b16 v[80:81], v4 offset:50752
    ds_read_b64_tr_b16 v[82:83], v4 offset:51008
    s_add_u32 m0, s62, 17928
    v_add_f32 v99, v98, v99
    v_accvgpr_read_b32 v100, a136
    v_accvgpr_read_b32 v101, a137
    v_add_f32 v101, v100, v101
    v_rcp_f32 v96, v97
    v_mfma_f32_16x16x32_bf16 a[4:7], v[216:219], v[144:147], a[4:7]
    ds_read_b64_tr_b16 v[84:85], v4 offset:51264
    ds_read_b64_tr_b16 v[86:87], v4 offset:51520
    v_accvgpr_read_b32 v102, a140
    v_accvgpr_read_b32 v103, a141
    v_add_f32 v103, v102, v103
    v_rcp_f32 v98, v99
    v_rcp_f32 v100, v101
    v_mfma_f32_16x16x32_bf16 a[4:7], v[220:223], v[148:151], a[4:7]
    buffer_load_dwordx4 v2, s[8:11], s65 offen  lds
    s_add_u32 s65, s65, 2048
    v_rcp_f32 v102, v103
    v_mul_f32 v96, 0x41000000, v96
    v_mul_f32 v98, 0x41000000, v98
    v_mul_f32 v100, 0x41000000, v100
    v_mul_f32 v102, 0x41000000, v102
    v_mfma_f32_16x16x32_bf16 a[32:35], v[208:211], v[152:155], a[32:35]
    v_mov_b32 v104, 0
    v_mov_b32 v105, 0
    v_mov_b32 v106, 0
    v_mov_b32 v107, 0
    v_mfma_f32_16x16x32_bf16 a[32:35], v[212:215], v[156:159], a[32:35]
    ds_read_b64_tr_b16 v[88:89], v4 offset:50784
    ds_read_b64_tr_b16 v[90:91], v4 offset:51040
    s_add_u32 m0, s62, 19008
    v_mov_b32 v108, 0
    v_mov_b32 v109, 0
    v_mov_b32 v110, 0
    v_mov_b32 v111, 0
    v_mfma_f32_16x16x32_bf16 a[36:39], v[216:219], v[152:155], a[36:39]
    ds_read_b64_tr_b16 v[92:93], v4 offset:51296
    ds_read_b64_tr_b16 v[94:95], v4 offset:51552
    v_min3_f32 v14, v97, v99, v101
    v_max3_f32 v15, v97, v99, v101
    v_min_f32 v14, v14, v103
    v_mfma_f32_16x16x32_bf16 a[36:39], v[220:223], v[156:159], a[36:39]
    buffer_load_dwordx4 v2, s[8:11], s65 offen  lds
    s_add_u32 s65, s65, 2048
    v_max_f32 v15, v15, v103
    v_cmp_nle_f32 s[50:51], s44, v14
    v_cmp_nge_f32 s[46:47], s45, v15
    v_mfma_f32_16x16x32_bf16 a[64:67], v[208:211], v[160:163], a[64:67]
    v_accvgpr_read_b32 v176, a0
    v_accvgpr_read_b32 v177, a1
    v_accvgpr_read_b32 v178, a2
    v_accvgpr_read_b32 v179, a3
    v_accvgpr_read_b32 v180, a4
    v_mfma_f32_16x16x32_bf16 a[64:67], v[212:215], v[164:167], a[64:67]
    s_add_u32 m0, s62, 20040
    v_accvgpr_read_b32 v181, a5
    v_accvgpr_read_b32 v182, a6
    v_accvgpr_read_b32 v183, a7
    v_mul_f32 v176, v176, v96
    v_mul_f32 v177, v177, v96
    v_mfma_f32_16x16x32_bf16 a[68:71], v[216:219], v[160:163], a[68:71]
    v_mul_f32 v178, v178, v96
    v_mul_f32 v179, v179, v96
    v_mul_f32 v180, v180, v96
    v_mul_f32 v181, v181, v96
    v_mul_f32 v182, v182, v96
    v_mfma_f32_16x16x32_bf16 a[68:71], v[220:223], v[164:167], a[68:71]
    buffer_load_dwordx4 v2, s[8:11], s65 offen  lds
    s_add_u32 s65, s65, 256000
    v_mul_f32 v183, v183, v96
    v_cvt_pk_bf16_f32 v112, v176, v177
    v_cvt_pk_bf16_f32 v113, v178, v179
    v_cvt_pk_bf16_f32 v114, v180, v181
    v_cvt_pk_bf16_f32 v115, v182, v183
    v_mfma_f32_16x16x32_bf16 a[96:99], v[208:211], v[168:171], a[96:99]
    buffer_store_dwordx4 v[112:115], v6, s[24:27], 0 offen offset:0 sc1
    v_accvgpr_read_b32 v184, a32
    v_accvgpr_read_b32 v185, a33
    v_accvgpr_read_b32 v186, a34
    v_accvgpr_read_b32 v187, a35
    v_accvgpr_read_b32 v188, a36
    v_mfma_f32_16x16x32_bf16 a[96:99], v[212:215], v[172:175], a[96:99]
    s_add_u32 m0, s61, 50688
    v_accvgpr_read_b32 v189, a37
    v_accvgpr_read_b32 v190, a38
    v_accvgpr_read_b32 v191, a39
    v_mul_f32 v184, v184, v98
    v_mul_f32 v185, v185, v98
    v_mfma_f32_16x16x32_bf16 a[100:103], v[216:219], v[168:171], a[100:103]
    v_mul_f32 v186, v186, v98
    v_mul_f32 v187, v187, v98
    v_mul_f32 v188, v188, v98
    v_mul_f32 v189, v189, v98
    v_mul_f32 v190, v190, v98
    v_mfma_f32_16x16x32_bf16 a[100:103], v[220:223], v[172:175], a[100:103]
    buffer_load_dwordx4 v2, s[8:11], s67 offen  lds
    s_add_u32 s67, s67, 2048
    v_mul_f32 v191, v191, v98
    v_cvt_pk_bf16_f32 v116, v184, v185
    v_cvt_pk_bf16_f32 v117, v186, v187
    v_cvt_pk_bf16_f32 v118, v188, v189
    v_cvt_pk_bf16_f32 v119, v190, v191
    s_waitcnt lgkmcnt(0)
    v_mfma_f32_16x16x32_bf16 a[8:11], v[80:83], v[144:147], a[8:11]
    buffer_store_dwordx4 v[116:119], v7, s[24:27], 0 offen offset:0 sc1
    v_accvgpr_read_b32 v176, a64
    v_accvgpr_read_b32 v177, a65
    v_accvgpr_read_b32 v178, a66
    v_accvgpr_read_b32 v179, a67
    v_accvgpr_read_b32 v180, a68
    v_mfma_f32_16x16x32_bf16 a[8:11], v[84:87], v[148:151], a[8:11]
    ds_read_b64_tr_b16 v[208:209], v4 offset:50816
    ds_read_b64_tr_b16 v[210:211], v4 offset:51072
    s_add_u32 m0, s61, 51720
    v_accvgpr_read_b32 v181, a69
    v_accvgpr_read_b32 v182, a70
    v_accvgpr_read_b32 v183, a71
    v_mul_f32 v176, v176, v100
    v_mul_f32 v177, v177, v100
    v_mfma_f32_16x16x32_bf16 a[12:15], v[88:91], v[144:147], a[12:15]
    ds_read_b64_tr_b16 v[212:213], v4 offset:51328
    ds_read_b64_tr_b16 v[214:215], v4 offset:51584
    v_mul_f32 v178, v178, v100
    v_mul_f32 v179, v179, v100
    v_mul_f32 v180, v180, v100
    v_mul_f32 v181, v181, v100
    v_mul_f32 v182, v182, v100
    v_mfma_f32_16x16x32_bf16 a[12:15], v[92:95], v[148:151], a[12:15]
    buffer_load_dwordx4 v2, s[8:11], s67 offen  lds
    s_add_u32 s67, s67, 2048
    v_mul_f32 v183, v183, v100
    v_cvt_pk_bf16_f32 v120, v176, v177
    v_cvt_pk_bf16_f32 v121, v178, v179
    v_cvt_pk_bf16_f32 v122, v180, v181
    v_cvt_pk_bf16_f32 v123, v182, v183
    v_mfma_f32_16x16x32_bf16 a[40:43], v[80:83], v[152:155], a[40:43]
    buffer_store_dwordx4 v[120:123], v8, s[24:27], 0 offen offset:0 sc1
    v_accvgpr_read_b32 v184, a96
    v_accvgpr_read_b32 v185, a97
    v_accvgpr_read_b32 v186, a98
    v_accvgpr_read_b32 v187, a99
    v_mfma_f32_16x16x32_bf16 a[40:43], v[84:87], v[156:159], a[40:43]
    ds_read_b64_tr_b16 v[216:217], v4 offset:50848
    ds_read_b64_tr_b16 v[218:219], v4 offset:51104
    s_add_u32 m0, s61, 52800
    v_accvgpr_read_b32 v188, a100
    v_accvgpr_read_b32 v189, a101
    v_accvgpr_read_b32 v190, a102
    v_accvgpr_read_b32 v191, a103
    v_mfma_f32_16x16x32_bf16 a[44:47], v[88:91], v[152:155], a[44:47]
    ds_read_b64_tr_b16 v[220:221], v4 offset:51360
    ds_read_b64_tr_b16 v[222:223], v4 offset:51616
    v_mul_f32 v184, v184, v102
    v_mul_f32 v185, v185, v102
    v_mul_f32 v186, v186, v102
    v_mul_f32 v187, v187, v102
    v_mfma_f32_16x16x32_bf16 a[44:47], v[92:95], v[156:159], a[44:47]
    buffer_load_dwordx4 v2, s[8:11], s67 offen  lds
    s_add_u32 s67, s67, 2048
    v_mul_f32 v188, v188, v102
    v_mul_f32 v189, v189, v102
    v_mul_f32 v190, v190, v102
    v_mul_f32 v191, v191, v102
    v_smfmac_f32_16x16x64_bf16 v[108:111], v[104:107], v[112:119], v228
    v_cvt_pk_bf16_f32 v124, v184, v185
    v_cvt_pk_bf16_f32 v125, v186, v187
    v_cvt_pk_bf16_f32 v126, v188, v189
    v_cvt_pk_bf16_f32 v127, v190, v191
    v_mfma_f32_16x16x32_bf16 a[72:75], v[80:83], v[160:163], a[72:75]
    buffer_store_dwordx4 v[124:127], v9, s[24:27], 0 offen offset:0 sc1
    v_accvgpr_read_b32 v176, a8
    v_accvgpr_read_b32 v177, a9
    v_accvgpr_read_b32 v178, a10
    v_accvgpr_read_b32 v179, a11
    v_accvgpr_read_b32 v180, a12
    v_mfma_f32_16x16x32_bf16 a[72:75], v[84:87], v[164:167], a[72:75]
    s_add_u32 m0, s61, 53832
    v_accvgpr_read_b32 v181, a13
    v_accvgpr_read_b32 v182, a14
    v_accvgpr_read_b32 v183, a15
    v_mul_f32 v176, v176, v96
    v_mul_f32 v177, v177, v96
    v_mfma_f32_16x16x32_bf16 a[76:79], v[88:91], v[160:163], a[76:79]
    v_mul_f32 v178, v178, v96
    v_mul_f32 v179, v179, v96
    v_mul_f32 v180, v180, v96
    v_mul_f32 v181, v181, v96
    v_mul_f32 v182, v182, v96
    v_mfma_f32_16x16x32_bf16 a[76:79], v[92:95], v[164:167], a[76:79]
    buffer_load_dwordx4 v2, s[8:11], s67 offen  lds
    s_add_u32 s67, s67, s40
    v_mul_f32 v183, v183, v96
    v_cvt_pk_bf16_f32 v128, v176, v177
    v_cvt_pk_bf16_f32 v129, v178, v179
    v_cvt_pk_bf16_f32 v130, v180, v181
    v_cvt_pk_bf16_f32 v131, v182, v183
    v_mfma_f32_16x16x32_bf16 a[104:107], v[80:83], v[168:171], a[104:107]
    buffer_store_dwordx4 v[128:131], v6, s[24:27], 0 offen offset:1024 sc1
    v_accvgpr_read_b32 v184, a40
    v_accvgpr_read_b32 v185, a41
    v_accvgpr_read_b32 v186, a42
    v_accvgpr_read_b32 v187, a43
    v_mfma_f32_16x16x32_bf16 a[104:107], v[84:87], v[172:175], a[104:107]
    v_accvgpr_read_b32 v188, a44
    v_accvgpr_read_b32 v189, a45
    v_accvgpr_read_b32 v190, a46
    v_accvgpr_read_b32 v191, a47
    v_mfma_f32_16x16x32_bf16 a[108:111], v[88:91], v[168:171], a[108:111]
    v_mul_f32 v184, v184, v98
    v_mul_f32 v185, v185, v98
    v_mul_f32 v186, v186, v98
    v_mul_f32 v187, v187, v98
    v_mfma_f32_16x16x32_bf16 a[108:111], v[92:95], v[172:175], a[108:111]
    v_mul_f32 v188, v188, v98
    v_mul_f32 v189, v189, v98
    v_mul_f32 v190, v190, v98
    v_mul_f32 v191, v191, v98
    v_smfmac_f32_16x16x64_bf16 v[108:111], v[104:107], v[120:127], v228
    v_cvt_pk_bf16_f32 v132, v184, v185
    v_cvt_pk_bf16_f32 v133, v186, v187
    v_cvt_pk_bf16_f32 v134, v188, v189
    v_cvt_pk_bf16_f32 v135, v190, v191
    s_waitcnt lgkmcnt(0)
    v_mfma_f32_16x16x32_bf16 a[16:19], v[208:211], v[144:147], a[16:19]
    buffer_store_dwordx4 v[132:135], v7, s[24:27], 0 offen offset:1024 sc1
    v_accvgpr_read_b32 v176, a72
    v_accvgpr_read_b32 v177, a73
    v_accvgpr_read_b32 v178, a74
    v_accvgpr_read_b32 v179, a75
    v_accvgpr_read_b32 v180, a76
    v_mfma_f32_16x16x32_bf16 a[16:19], v[212:215], v[148:151], a[16:19]
    ds_read_b64_tr_b16 v[80:81], v4 offset:50880
    ds_read_b64_tr_b16 v[82:83], v4 offset:51136
    v_accvgpr_read_b32 v181, a77
    v_accvgpr_read_b32 v182, a78
    v_accvgpr_read_b32 v183, a79
    v_mul_f32 v176, v176, v100
    v_mul_f32 v177, v177, v100
    v_mfma_f32_16x16x32_bf16 a[20:23], v[216:219], v[144:147], a[20:23]
    ds_read_b64_tr_b16 v[84:85], v4 offset:51392
    ds_read_b64_tr_b16 v[86:87], v4 offset:51648
    v_mul_f32 v178, v178, v100
    v_mul_f32 v179, v179, v100
    v_mul_f32 v180, v180, v100
    v_mul_f32 v181, v181, v100
    v_mul_f32 v182, v182, v100
    v_mfma_f32_16x16x32_bf16 a[20:23], v[220:223], v[148:151], a[20:23]
    v_mul_f32 v183, v183, v100
    v_cvt_pk_bf16_f32 v136, v176, v177
    v_cvt_pk_bf16_f32 v137, v178, v179
    v_cvt_pk_bf16_f32 v138, v180, v181
    v_cvt_pk_bf16_f32 v139, v182, v183
    v_mfma_f32_16x16x32_bf16 a[48:51], v[208:211], v[152:155], a[48:51]
    buffer_store_dwordx4 v[136:139], v8, s[24:27], 0 offen offset:1024 sc1
    v_accvgpr_read_b32 v184, a104
    v_accvgpr_read_b32 v185, a105
    v_accvgpr_read_b32 v186, a106
    v_accvgpr_read_b32 v187, a107
    v_mfma_f32_16x16x32_bf16 a[48:51], v[212:215], v[156:159], a[48:51]
    ds_read_b64_tr_b16 v[88:89], v4 offset:50912
    ds_read_b64_tr_b16 v[90:91], v4 offset:51168
    v_accvgpr_read_b32 v188, a108
    v_accvgpr_read_b32 v189, a109
    v_accvgpr_read_b32 v190, a110
    v_accvgpr_read_b32 v191, a111
    v_mfma_f32_16x16x32_bf16 a[52:55], v[216:219], v[152:155], a[52:55]
    ds_read_b64_tr_b16 v[92:93], v4 offset:51424
    ds_read_b64_tr_b16 v[94:95], v4 offset:51680
    v_mul_f32 v184, v184, v102
    v_mul_f32 v185, v185, v102
    v_mul_f32 v186, v186, v102
    v_mul_f32 v187, v187, v102
    v_mfma_f32_16x16x32_bf16 a[52:55], v[220:223], v[156:159], a[52:55]
    v_mul_f32 v188, v188, v102
    v_mul_f32 v189, v189, v102
    v_mul_f32 v190, v190, v102
    v_mul_f32 v191, v191, v102
    v_smfmac_f32_16x16x64_bf16 v[108:111], v[104:107], v[128:135], v228
    v_cvt_pk_bf16_f32 v140, v184, v185
    v_cvt_pk_bf16_f32 v141, v186, v187
    v_cvt_pk_bf16_f32 v142, v188, v189
    v_cvt_pk_bf16_f32 v143, v190, v191
    v_mfma_f32_16x16x32_bf16 a[80:83], v[208:211], v[160:163], a[80:83]
    buffer_store_dwordx4 v[140:143], v9, s[24:27], 0 offen offset:1024 sc1
    v_accvgpr_read_b32 v176, a16
    v_accvgpr_read_b32 v177, a17
    v_accvgpr_read_b32 v178, a18
    v_accvgpr_read_b32 v179, a19
    v_accvgpr_read_b32 v180, a20
    v_mfma_f32_16x16x32_bf16 a[80:83], v[212:215], v[164:167], a[80:83]
    v_accvgpr_read_b32 v181, a21
    v_accvgpr_read_b32 v182, a22
    v_accvgpr_read_b32 v183, a23
    v_mul_f32 v176, v176, v96
    v_mul_f32 v177, v177, v96
    v_mfma_f32_16x16x32_bf16 a[84:87], v[216:219], v[160:163], a[84:87]
    v_mul_f32 v178, v178, v96
    v_mul_f32 v179, v179, v96
    v_mul_f32 v180, v180, v96
    v_mul_f32 v181, v181, v96
    v_mul_f32 v182, v182, v96
    v_mfma_f32_16x16x32_bf16 a[84:87], v[220:223], v[164:167], a[84:87]
    v_mul_f32 v183, v183, v96
    v_cvt_pk_bf16_f32 v192, v176, v177
    v_cvt_pk_bf16_f32 v193, v178, v179
    v_cvt_pk_bf16_f32 v194, v180, v181
    v_cvt_pk_bf16_f32 v195, v182, v183
    v_mfma_f32_16x16x32_bf16 a[112:115], v[208:211], v[168:171], a[112:115]
    v_accvgpr_read_b32 v184, a48
    v_accvgpr_read_b32 v185, a49
    v_accvgpr_read_b32 v186, a50
    v_accvgpr_read_b32 v187, a51
    v_mfma_f32_16x16x32_bf16 a[112:115], v[212:215], v[172:175], a[112:115]
    v_accvgpr_read_b32 v188, a52
    v_accvgpr_read_b32 v189, a53
    v_accvgpr_read_b32 v190, a54
    v_accvgpr_read_b32 v191, a55
    v_mfma_f32_16x16x32_bf16 a[116:119], v[216:219], v[168:171], a[116:119]
    v_mul_f32 v184, v184, v98
    v_mul_f32 v185, v185, v98
    v_mul_f32 v186, v186, v98
    v_mul_f32 v187, v187, v98
    v_mfma_f32_16x16x32_bf16 a[116:119], v[220:223], v[172:175], a[116:119]
    v_mul_f32 v188, v188, v98
    v_mul_f32 v189, v189, v98
    v_mul_f32 v190, v190, v98
    v_mul_f32 v191, v191, v98
    v_smfmac_f32_16x16x64_bf16 v[108:111], v[104:107], v[136:143], v228
    v_cvt_pk_bf16_f32 v196, v184, v185
    v_cvt_pk_bf16_f32 v197, v186, v187
    v_cvt_pk_bf16_f32 v198, v188, v189
    v_cvt_pk_bf16_f32 v199, v190, v191
    s_waitcnt lgkmcnt(0)
    v_mfma_f32_16x16x32_bf16 a[24:27], v[80:83], v[144:147], a[24:27]
    v_accvgpr_read_b32 v176, a80
    v_accvgpr_read_b32 v177, a81
    v_accvgpr_read_b32 v178, a82
    v_accvgpr_read_b32 v179, a83
    v_accvgpr_read_b32 v180, a84
    v_mfma_f32_16x16x32_bf16 a[24:27], v[84:87], v[148:151], a[24:27]
    v_accvgpr_read_b32 v181, a85
    v_accvgpr_read_b32 v182, a86
    v_accvgpr_read_b32 v183, a87
    v_mul_f32 v176, v176, v100
    v_mul_f32 v177, v177, v100
    v_mfma_f32_16x16x32_bf16 a[28:31], v[88:91], v[144:147], a[28:31]
    v_mul_f32 v178, v178, v100
    v_mul_f32 v179, v179, v100
    v_mul_f32 v180, v180, v100
    v_mul_f32 v181, v181, v100
    v_mul_f32 v182, v182, v100
    v_mfma_f32_16x16x32_bf16 a[28:31], v[92:95], v[148:151], a[28:31]
    v_mul_f32 v183, v183, v100
    v_cvt_pk_bf16_f32 v200, v176, v177
    v_cvt_pk_bf16_f32 v201, v178, v179
    v_cvt_pk_bf16_f32 v202, v180, v181
    v_cvt_pk_bf16_f32 v203, v182, v183
    v_mfma_f32_16x16x32_bf16 a[56:59], v[80:83], v[152:155], a[56:59]
    v_accvgpr_read_b32 v184, a112
    v_accvgpr_read_b32 v185, a113
    v_accvgpr_read_b32 v186, a114
    v_accvgpr_read_b32 v187, a115
    v_mfma_f32_16x16x32_bf16 a[56:59], v[84:87], v[156:159], a[56:59]
    v_accvgpr_read_b32 v188, a116
    v_accvgpr_read_b32 v189, a117
    v_accvgpr_read_b32 v190, a118
    v_accvgpr_read_b32 v191, a119
    v_mfma_f32_16x16x32_bf16 a[60:63], v[88:91], v[152:155], a[60:63]
    v_mul_f32 v184, v184, v102
    v_mul_f32 v185, v185, v102
    v_mul_f32 v186, v186, v102
    v_mul_f32 v187, v187, v102
    v_mfma_f32_16x16x32_bf16 a[60:63], v[92:95], v[156:159], a[60:63]
    v_mul_f32 v188, v188, v102
    v_mul_f32 v189, v189, v102
    v_mul_f32 v190, v190, v102
    v_mul_f32 v191, v191, v102
    v_smfmac_f32_16x16x64_bf16 v[108:111], v[104:107], v[192:199], v228
    v_cvt_pk_bf16_f32 v204, v184, v185
    v_cvt_pk_bf16_f32 v205, v186, v187
    v_cvt_pk_bf16_f32 v206, v188, v189
    v_cvt_pk_bf16_f32 v207, v190, v191
    v_mfma_f32_16x16x32_bf16 a[88:91], v[80:83], v[160:163], a[88:91]
    v_accvgpr_read_b32 v176, a24
    v_accvgpr_read_b32 v177, a25
    v_accvgpr_read_b32 v178, a26
    v_accvgpr_read_b32 v179, a27
    v_accvgpr_read_b32 v180, a28
    v_mfma_f32_16x16x32_bf16 a[88:91], v[84:87], v[164:167], a[88:91]
    v_accvgpr_read_b32 v181, a29
    v_accvgpr_read_b32 v182, a30
    v_accvgpr_read_b32 v183, a31
    v_mul_f32 v176, v176, v96
    v_mul_f32 v177, v177, v96
    v_mfma_f32_16x16x32_bf16 a[92:95], v[88:91], v[160:163], a[92:95]
    v_mul_f32 v178, v178, v96
    v_mul_f32 v179, v179, v96
    v_mul_f32 v180, v180, v96
    v_mul_f32 v181, v181, v96
    v_mul_f32 v182, v182, v96
    v_mfma_f32_16x16x32_bf16 a[92:95], v[92:95], v[164:167], a[92:95]
    v_mul_f32 v183, v183, v96
    v_cvt_pk_bf16_f32 v208, v176, v177
    v_cvt_pk_bf16_f32 v209, v178, v179
    v_cvt_pk_bf16_f32 v210, v180, v181
    v_cvt_pk_bf16_f32 v211, v182, v183
    v_mfma_f32_16x16x32_bf16 a[120:123], v[80:83], v[168:171], a[120:123]
    v_accvgpr_read_b32 v184, a56
    v_accvgpr_read_b32 v185, a57
    v_accvgpr_read_b32 v186, a58
    v_accvgpr_read_b32 v187, a59
    v_mfma_f32_16x16x32_bf16 a[120:123], v[84:87], v[172:175], a[120:123]
    v_accvgpr_read_b32 v188, a60
    v_accvgpr_read_b32 v189, a61
    v_accvgpr_read_b32 v190, a62
    v_accvgpr_read_b32 v191, a63
    v_mfma_f32_16x16x32_bf16 a[124:127], v[88:91], v[168:171], a[124:127]
    v_mul_f32 v184, v184, v98
    v_mul_f32 v185, v185, v98
    v_mul_f32 v186, v186, v98
    v_mul_f32 v187, v187, v98
    v_mfma_f32_16x16x32_bf16 a[124:127], v[92:95], v[172:175], a[124:127]
    v_mul_f32 v188, v188, v98
    v_mul_f32 v189, v189, v98
    v_mul_f32 v190, v190, v98
    v_mul_f32 v191, v191, v98
    v_smfmac_f32_16x16x64_bf16 v[108:111], v[104:107], v[200:207], v228
    v_cvt_pk_bf16_f32 v212, v184, v185
    v_cvt_pk_bf16_f32 v213, v186, v187
    v_cvt_pk_bf16_f32 v214, v188, v189
    v_cvt_pk_bf16_f32 v215, v190, v191
    v_accvgpr_read_b32 v176, a88
    v_accvgpr_read_b32 v177, a89
    v_accvgpr_read_b32 v178, a90
    v_accvgpr_read_b32 v179, a91
    v_accvgpr_read_b32 v180, a92
    v_accvgpr_read_b32 v181, a93
    v_accvgpr_read_b32 v182, a94
    v_accvgpr_read_b32 v183, a95
    v_smfmac_f32_16x16x64_bf16 v[108:111], v[104:107], v[208:215], v228
    v_accvgpr_read_b32 v184, a120
    v_accvgpr_read_b32 v185, a121
    v_accvgpr_read_b32 v186, a122
    v_accvgpr_read_b32 v187, a123
    v_accvgpr_read_b32 v188, a124
    v_accvgpr_read_b32 v189, a125
    v_accvgpr_read_b32 v190, a126
    v_accvgpr_read_b32 v191, a127
    v_pk_mul_f32 v[176:177], v[176:177], v[100:101] op_sel_hi:[1,0]
    v_pk_mul_f32 v[178:179], v[178:179], v[100:101] op_sel_hi:[1,0]
    v_pk_mul_f32 v[180:181], v[180:181], v[100:101] op_sel_hi:[1,0]
    v_pk_mul_f32 v[182:183], v[182:183], v[100:101] op_sel_hi:[1,0]
    v_cvt_pk_bf16_f32 v232, v176, v177
    v_cvt_pk_bf16_f32 v233, v178, v179
    v_cvt_pk_bf16_f32 v234, v180, v181
    v_cvt_pk_bf16_f32 v235, v182, v183
    v_pk_mul_f32 v[184:185], v[184:185], v[102:103] op_sel_hi:[1,0]
    v_pk_mul_f32 v[186:187], v[186:187], v[102:103] op_sel_hi:[1,0]
    v_pk_mul_f32 v[188:189], v[188:189], v[102:103] op_sel_hi:[1,0]
    v_pk_mul_f32 v[190:191], v[190:191], v[102:103] op_sel_hi:[1,0]
    v_cvt_pk_bf16_f32 v236, v184, v185
    v_cvt_pk_bf16_f32 v237, v186, v187
    v_cvt_pk_bf16_f32 v238, v188, v189
    v_cvt_pk_bf16_f32 v239, v190, v191
    buffer_store_dwordx4 v[232:235], v8, s[24:27], 0 offen offset:3072 sc1
    buffer_store_dwordx4 v[236:239], v9, s[24:27], 0 offen offset:3072 sc1
    s_nop 1
    v_smfmac_f32_16x16x64_bf16 v[108:111], v[104:107], v[232:239], v228
    s_or_b64 s[50:51], s[50:51], s[46:47]
    s_nop 6
    v_cmp_u_f32 vcc, v108, v109
    s_or_b64 s[50:51], s[50:51], vcc
    s_or_b32 s50, s50, s51
    v_mov_b32 v14, s50
    s_lshl_b32 s51, s3, 2
    s_add_u32 s51, s51, 135168
    v_mov_b32 v15, s51
    ds_write_b32 v15, v14
    v_mov_b32 v15, 135168
    s_waitcnt lgkmcnt(0)
    s_barrier
    ds_read_b128 v[80:83], v15
    s_waitcnt lgkmcnt(0)
    v_or_b32 v80, v80, v81
    v_or3_b32 v80, v80, v82, v83
    s_nop 0
    v_readfirstlane_b32 s50, v80
    s_nop 3
    s_cmp_lg_u32 s50, 0
    s_cbranch_scc1 L_safe_18
L_cont_19:
    s_lshl_b32 s44, s54, 13
    s_add_u32 s44, s44, 524288
    s_lshl_b32 s45, s52, 7
    s_add_u32 s46, s44, s45
    s_sub_u32 s47, s44, s45
    s_add_u32 s47, s47, 8064
    v_mov_b32 v252, s60
    v_lshrrev_b32 v253, 5, v11
    v_lshlrev_b32 v253, 24, v253
    v_lshl_add_u32 v253, v11, 2, v253
    s_cmp_eq_u32 s58, 1
    s_cbranch_scc1 L_odd_20
    s_waitcnt vmcnt(2)
    buffer_store_dword v252, v253, s[4:7], s46 offen sc1
    buffer_store_dwordx4 v[192:195], v6, s[24:27], 0 offen offset:2048 sc1
    buffer_store_dwordx4 v[196:199], v7, s[24:27], 0 offen offset:2048 sc1
    buffer_store_dwordx4 v[200:203], v8, s[24:27], 0 offen offset:2048 sc1
    buffer_store_dwordx4 v[204:207], v9, s[24:27], 0 offen offset:2048 sc1
    buffer_store_dwordx4 v[208:211], v6, s[24:27], 0 offen offset:3072 sc1
    buffer_store_dwordx4 v[212:215], v7, s[24:27], 0 offen offset:3072 sc1
    s_mov_b32 s46, s47
    s_mov_b32 s47, 16777216
    s_mov_b32 s26, 0
L_odd_20:
    buffer_load_dword v230, v229, s[4:7], 0 offen sc1
    s_lshr_b32 s44, s56, 1
    s_lshl_b32 s44, s44, 13
    s_add_u32 s44, s44, 524288
    v_and_b32 v248, 3, v11
    v_lshl_add_u32 v248, v248, 7, s44
    s_mul_i32 s63, s58, 5632
    s_add_u32 s63, s63, 1024
    s_mul_i32 s64, s58, 4294966272
    s_add_u32 s64, s64, 512
    s_lshl_b32 s66, s58, 11
    s_lshl_b32 s44, s58, 7
    s_xor_b32 s45, s44, 128
    v_and_b32 v20, 3, v11
    v_lshl_add_u32 v4, v20, 3, v4
    v_bfe_u32 v20, v11, 2, 1
    v_mul_u32_u24 v20, 24, v20
    v_sub_u32 v4, v4, v20
    v_add_u32 v15, s44, v4
    v_add_u32 v4, s45, v4
    v_subrev_u32 v3, 67584, v4
    v_subrev_u32 v5, 67584, v15
    s_lshl_b32 s67, s55, 15
    s_add_u32 s67, s67, 8388608
    s_nop 0
    s_mul_i32 s44, s3, 6528
    s_add_u32 s44, s44, 135232
    v_lshl_add_u32 v21, v12, 4, s44
    v_lshrrev_b32 v20, 3, v13
    v_mul_u32_u24 v20, 32, v20
    v_lshl_add_u32 v20, v13, 7, v20
    v_add_u32 v20, v20, v21
    v_add_u32 v22, s44, v1
    ds_read_b128 v[24:27], v22 offset:4224
    ds_read_b128 v[28:31], v22 offset:5248
    ds_read_b128 v[84:87], v20 offset:0
    ds_read_b128 v[92:95], v20 offset:64
    ds_read_b128 v[100:103], v20 offset:2112
    ds_read_b128 v[108:111], v20 offset:2176
    ds_read_b128 v[180:183], v21 offset:6272
    ds_read_b128 v[188:191], v21 offset:6336
    v_cmp_eq_u32 vcc, 2, v12
    v_lshl_add_u32 v21, v12, 5, s44
    v_mov_b32 v33, 0
    v_cndmask_b32 v32, 0, 1.0, vcc
    s_waitcnt lgkmcnt(6)
    v_pk_add_f32 v[24:25], v[24:25], v[28:29]
    v_cvt_pk_bf16_f32 v25, v24, v25
    v_lshlrev_b32 v24, 16, v25
    v_and_b32 v25, 0xffff0000, v25
    v_pk_add_f32 v[24:25], v[24:25], v[32:33] op_sel_hi:[1,0]
    v_cvt_pk_bf16_f32 v25, v24, v25
    v_lshlrev_b32 v24, 16, v25
    v_and_b32 v25, 0xffff0000, v25
    v_pk_add_f32 v[26:27], v[26:27], v[30:31]
    v_cvt_pk_bf16_f32 v27, v26, v27
    v_lshlrev_b32 v26, 16, v27
    v_and_b32 v27, 0xffff0000, v27
    v_pk_add_f32 v[26:27], v[26:27], v[32:33] op_sel_hi:[1,0]
    v_cvt_pk_bf16_f32 v27, v26, v27
    v_lshlrev_b32 v26, 16, v27
    v_and_b32 v27, 0xffff0000, v27
    ds_write_b128 v22, v[24:27] offset:4224
    s_waitcnt lgkmcnt(0)
    ds_read_b128 v[112:115], v21 offset:4224
    ds_read_b128 v[116:119], v21 offset:4240
    ds_read_b128 v[120:123], v21 offset:4352
    ds_read_b128 v[124:127], v21 offset:4368
    ds_read_b128 v[144:147], v21 offset:4480
    ds_read_b128 v[148:151], v21 offset:4496
    ds_read_b128 v[152:155], v21 offset:4608
    ds_read_b128 v[156:159], v21 offset:4624
    ds_read_b128 v[128:131], v21 offset:4736
    ds_read_b128 v[132:135], v21 offset:4752
    ds_read_b128 v[136:139], v21 offset:4864
    ds_read_b128 v[140:143], v21 offset:4880
    s_waitcnt lgkmcnt(8)
    ds_read_b128 v[160:163], v21 offset:4992
    ds_read_b128 v[164:167], v21 offset:5008
    ds_read_b128 v[168:171], v21 offset:5120
    ds_read_b128 v[172:175], v21 offset:5136
    v_lshlrev_b32 v80, 16, v84
    v_and_b32 v81, 0xffff0000, v84
    v_lshlrev_b32 v82, 16, v85
    v_and_b32 v83, 0xffff0000, v85
    v_lshlrev_b32 v84, 16, v86
    v_and_b32 v85, 0xffff0000, v86
    v_lshlrev_b32 v86, 16, v87
    v_and_b32 v87, 0xffff0000, v87
    v_lshlrev_b32 v88, 16, v92
    v_and_b32 v89, 0xffff0000, v92
    v_lshlrev_b32 v90, 16, v93
    v_and_b32 v91, 0xffff0000, v93
    v_lshlrev_b32 v92, 16, v94
    v_and_b32 v93, 0xffff0000, v94
    v_lshlrev_b32 v94, 16, v95
    v_and_b32 v95, 0xffff0000, v95
    v_lshlrev_b32 v96, 16, v100
    v_and_b32 v97, 0xffff0000, v100
    v_lshlrev_b32 v98, 16, v101
    v_and_b32 v99, 0xffff0000, v101
    v_lshlrev_b32 v100, 16, v102
    v_and_b32 v101, 0xffff0000, v102
    v_lshlrev_b32 v102, 16, v103
    v_and_b32 v103, 0xffff0000, v103
    v_lshlrev_b32 v104, 16, v108
    v_and_b32 v105, 0xffff0000, v108
    v_lshlrev_b32 v106, 16, v109
    v_and_b32 v107, 0xffff0000, v109
    v_lshlrev_b32 v108, 16, v110
    v_and_b32 v109, 0xffff0000, v110
    v_lshlrev_b32 v110, 16, v111
    v_and_b32 v111, 0xffff0000, v111
    v_lshlrev_b32 v176, 16, v180
    v_and_b32 v177, 0xffff0000, v180
    v_lshlrev_b32 v178, 16, v181
    v_and_b32 v179, 0xffff0000, v181
    v_lshlrev_b32 v180, 16, v182
    v_and_b32 v181, 0xffff0000, v182
    v_lshlrev_b32 v182, 16, v183
    v_and_b32 v183, 0xffff0000, v183
    v_lshlrev_b32 v184, 16, v188
    v_and_b32 v185, 0xffff0000, v188
    v_lshlrev_b32 v186, 16, v189
    v_and_b32 v187, 0xffff0000, v189
    v_lshlrev_b32 v188, 16, v190
    v_and_b32 v189, 0xffff0000, v190
    v_lshlrev_b32 v190, 16, v191
    v_and_b32 v191, 0xffff0000, v191
    s_waitcnt lgkmcnt(0)
    s_mov_b32 s50, 0x3e000000
    s_mov_b32 s51, s50
    v_pk_mul_f32 v[112:113], v[112:113], s[50:51]
    v_pk_mul_f32 v[114:115], v[114:115], s[50:51]
    v_pk_mul_f32 v[116:117], v[116:117], s[50:51]
    v_pk_mul_f32 v[118:119], v[118:119], s[50:51]
    v_pk_mul_f32 v[120:121], v[120:121], s[50:51]
    v_pk_mul_f32 v[122:123], v[122:123], s[50:51]
    v_pk_mul_f32 v[124:125], v[124:125], s[50:51]
    v_pk_mul_f32 v[126:127], v[126:127], s[50:51]
    v_pk_mul_f32 v[26:27], v[144:145], v[176:177]
    v_pk_mul_f32 v[176:177], v[176:177], v[128:129]
    v_pk_fma_f32 v[26:27], v[146:147], v[178:179], v[26:27]
    v_pk_mul_f32 v[178:179], v[178:179], v[130:131]
    v_pk_add_f32 v[28:29], v[176:177], v[178:179]
    v_pk_fma_f32 v[26:27], v[148:149], v[180:181], v[26:27]
    v_pk_mul_f32 v[180:181], v[180:181], v[132:133]
    v_pk_add_f32 v[28:29], v[28:29], v[180:181]
    v_pk_fma_f32 v[26:27], v[150:151], v[182:183], v[26:27]
    v_pk_mul_f32 v[182:183], v[182:183], v[134:135]
    v_pk_add_f32 v[28:29], v[28:29], v[182:183]
    v_pk_fma_f32 v[26:27], v[152:153], v[184:185], v[26:27]
    v_pk_mul_f32 v[184:185], v[184:185], v[136:137]
    v_pk_add_f32 v[28:29], v[28:29], v[184:185]
    v_pk_fma_f32 v[26:27], v[154:155], v[186:187], v[26:27]
    v_pk_mul_f32 v[186:187], v[186:187], v[138:139]
    v_pk_add_f32 v[28:29], v[28:29], v[186:187]
    v_pk_fma_f32 v[26:27], v[156:157], v[188:189], v[26:27]
    v_pk_mul_f32 v[188:189], v[188:189], v[140:141]
    v_pk_add_f32 v[28:29], v[28:29], v[188:189]
    v_pk_fma_f32 v[26:27], v[158:159], v[190:191], v[26:27]
    v_pk_mul_f32 v[190:191], v[190:191], v[142:143]
    v_pk_add_f32 v[28:29], v[28:29], v[190:191]
    v_and_b32 v24, 1, v0
    v_cmp_eq_u32 vcc, 1, v24
    v_add_f32 v26, v26, v27
    v_add_f32 v28, v28, v29
    v_cndmask_b32 v14, v28, v26, vcc
    v_mov_b32 v24, v14
    s_nop 1
    v_permlane16_swap_b32 v14, v24
    v_add_f32 v14, v14, v24
    v_mov_b32 v24, v14
    s_nop 1
    v_permlane32_swap_b32 v14, v24
    v_add_f32 v14, v14, v24
    s_getpc_b64 s[50:51]
L_pc_21:
    s_lshr_b32 s44, s2, 3
    s_lshl_b32 s44, s44, 4
    v_and_b32 v250, 3, v0
    v_lshl_add_u32 v250, v10, 2, v250
    v_add_u32 v250, s44, v250
    v_lshlrev_b32 v250, 6, v250
    v_min_u32 v250, L_code_hi-L_code_tail-4, v250
    v_add_u32 v250, L_code_tail-L_pc_21, v250
    v_mov_b32 v251, s51
    v_add_co_u32 v250, vcc, s50, v250
    s_nop 1
    v_addc_co_u32 v251, vcc, 0, v251, vcc
    s_waitcnt vmcnt(1)
    buffer_store_dword v252, v253, s[4:7], s46 offen sc1
    s_mov_b32 s48, 0
    s_waitcnt vmcnt(1)
    s_branch L_chk_24
L_poll_22:
    buffer_load_dword v230, v229, s[4:7], 0 offen sc1
    s_waitcnt vmcnt(0)
L_chk_24:
    v_cmp_ne_u32 vcc, s60, v230
    s_add_u32 s48, s48, 1
    s_cbranch_vccz L_gotf3_23
    s_cmp_lt_u32 s48, 65536
    s_cbranch_scc1 L_poll_22
L_gotf3_23:
    buffer_load_dwordx4 a[0:3], v6, s[12:15], s66 offen offset:0 sc1
    buffer_load_dwordx4 a[4:7], v6, s[12:15], s66 offen offset:1024 sc1
    buffer_load_dwordx4 a[8:11], v7, s[12:15], s66 offen offset:0 sc1
    buffer_load_dwordx4 a[12:15], v7, s[12:15], s66 offen offset:1024 sc1
    s_add_u32 s66, s66, 524288
    buffer_load_dwordx4 a[16:19], v6, s[12:15], s66 offen offset:0 sc1
    buffer_load_dwordx4 a[20:23], v6, s[12:15], s66 offen offset:1024 sc1
    buffer_load_dwordx4 a[24:27], v7, s[12:15], s66 offen offset:0 sc1
    buffer_load_dwordx4 a[28:31], v7, s[12:15], s66 offen offset:1024 sc1
    s_add_u32 s66, s66, 524288
    buffer_load_dwordx4 a[32:35], v6, s[12:15], s66 offen offset:0 sc1
    buffer_load_dwordx4 a[36:39], v6, s[12:15], s66 offen offset:1024 sc1
    buffer_load_dwordx4 a[40:43], v7, s[12:15], s66 offen offset:0 sc1
    buffer_load_dwordx4 a[44:47], v7, s[12:15], s66 offen offset:1024 sc1
    s_add_u32 s66, s66, 524288
    s_barrier
    ds_read_b64_tr_b16 v[48:49], v3 offset:0
    ds_read_b64_tr_b16 v[50:51], v3 offset:256
    ds_read_b64_tr_b16 v[52:53], v3 offset:512
    ds_read_b64_tr_b16 v[54:55], v3 offset:768
    ds_read_b64_tr_b16 v[56:57], v3 offset:8
    ds_read_b64_tr_b16 v[58:59], v3 offset:264
    ds_read_b64_tr_b16 v[60:61], v3 offset:520
    ds_read_b64_tr_b16 v[62:63], v3 offset:776
    s_waitcnt vmcnt(8) lgkmcnt(0)
    s_mov_b32 s49, 0
    v_mfma_f32_16x16x32_bf16 v[216:219], v[48:51], a[0:3], 0
    v_mfma_f32_16x16x32_bf16 v[216:219], v[52:55], a[4:7], v[216:219]
    ds_read_b64_tr_b16 v[64:65], v3 offset:64
    ds_read_b64_tr_b16 v[66:67], v3 offset:320
    v_mfma_f32_16x16x32_bf16 v[232:235], v[52:55], a[12:15], 0
    ds_read_b64_tr_b16 v[68:69], v3 offset:576
    ds_read_b64_tr_b16 v[70:71], v3 offset:832
    v_mfma_f32_16x16x32_bf16 v[232:235], v[48:51], a[8:11], v[232:235]
    buffer_load_dwordx4 a[48:51], v6, s[12:15], s66 offen offset:0 sc1
    v_mfma_f32_16x16x32_bf16 v[236:239], v[60:63], a[12:15], 0
    ds_read_b64_tr_b16 v[72:73], v3 offset:72
    ds_read_b64_tr_b16 v[74:75], v3 offset:328
    v_mfma_f32_16x16x32_bf16 v[236:239], v[56:59], a[8:11], v[236:239]
    ds_read_b64_tr_b16 v[76:77], v3 offset:584
    ds_read_b64_tr_b16 v[78:79], v3 offset:840
    v_mfma_f32_16x16x32_bf16 v[220:223], v[56:59], a[0:3], 0
    v_mfma_f32_16x16x32_bf16 v[220:223], v[60:63], a[4:7], v[220:223]
    s_waitcnt lgkmcnt(4)
    v_mfma_f32_16x16x32_bf16 v[224:227], v[64:67], a[0:3], 0
    buffer_store_dwordx4 v[192:195], v6, s[24:27], 0 offen offset:2048 sc1
    v_mfma_f32_16x16x32_bf16 v[224:227], v[68:71], a[4:7], v[224:227]
    ds_read_b64_tr_b16 v[48:49], v5 offset:0
    ds_read_b64_tr_b16 v[50:51], v5 offset:256
    v_mfma_f32_16x16x32_bf16 v[240:243], v[68:71], a[12:15], 0
    ds_read_b64_tr_b16 v[52:53], v5 offset:512
    ds_read_b64_tr_b16 v[54:55], v5 offset:768
    v_mfma_f32_16x16x32_bf16 v[240:243], v[64:67], a[8:11], v[240:243]
    s_waitcnt lgkmcnt(4)
    buffer_load_dwordx4 a[52:55], v6, s[12:15], s66 offen offset:1024 sc1
    v_mfma_f32_16x16x32_bf16 v[244:247], v[76:79], a[12:15], 0
    ds_read_b64_tr_b16 v[56:57], v5 offset:8
    ds_read_b64_tr_b16 v[58:59], v5 offset:264
    v_mfma_f32_16x16x32_bf16 v[244:247], v[72:75], a[8:11], v[244:247]
    ds_read_b64_tr_b16 v[60:61], v5 offset:520
    ds_read_b64_tr_b16 v[62:63], v5 offset:776
    v_mfma_f32_16x16x32_bf16 v[228:231], v[72:75], a[0:3], 0
    v_mfma_f32_16x16x32_bf16 v[228:231], v[76:79], a[4:7], v[228:231]
    s_waitcnt lgkmcnt(4)
    v_mfma_f32_16x16x32_bf16 v[16:19], v[48:51], a[0:3], 0
    buffer_store_dwordx4 v[196:199], v7, s[24:27], 0 offen offset:2048 sc1
    v_mfma_f32_16x16x32_bf16 v[16:19], v[52:55], a[4:7], v[16:19]
    ds_read_b64_tr_b16 v[64:65], v5 offset:64
    ds_read_b64_tr_b16 v[66:67], v5 offset:320
    v_mfma_f32_16x16x32_bf16 v[32:35], v[52:55], a[12:15], 0
    ds_read_b64_tr_b16 v[68:69], v5 offset:576
    ds_read_b64_tr_b16 v[70:71], v5 offset:832
    v_mfma_f32_16x16x32_bf16 v[32:35], v[48:51], a[8:11], v[32:35]
    s_waitcnt lgkmcnt(4)
    buffer_load_dwordx4 a[56:59], v7, s[12:15], s66 offen offset:0 sc1
    v_mfma_f32_16x16x32_bf16 v[36:39], v[60:63], a[12:15], 0
    ds_read_b64_tr_b16 v[72:73], v5 offset:72
    ds_read_b64_tr_b16 v[74:75], v5 offset:328
    v_mfma_f32_16x16x32_bf16 v[36:39], v[56:59], a[8:11], v[36:39]
    ds_read_b64_tr_b16 v[76:77], v5 offset:584
    ds_read_b64_tr_b16 v[78:79], v5 offset:840
    v_mfma_f32_16x16x32_bf16 v[20:23], v[56:59], a[0:3], 0
    v_mfma_f32_16x16x32_bf16 v[20:23], v[60:63], a[4:7], v[20:23]
    s_waitcnt lgkmcnt(4)
    v_mfma_f32_16x16x32_bf16 v[24:27], v[64:67], a[0:3], 0
    buffer_store_dwordx4 v[200:203], v8, s[24:27], 0 offen offset:2048 sc1
    v_mfma_f32_16x16x32_bf16 v[24:27], v[68:71], a[4:7], v[24:27]
    ds_read_b64_tr_b16 v[48:49], v3 offset:16896
    ds_read_b64_tr_b16 v[50:51], v3 offset:17152
    v_mfma_f32_16x16x32_bf16 v[40:43], v[68:71], a[12:15], 0
    ds_read_b64_tr_b16 v[52:53], v3 offset:17408
    ds_read_b64_tr_b16 v[54:55], v3 offset:17664
    v_mfma_f32_16x16x32_bf16 v[40:43], v[64:67], a[8:11], v[40:43]
    s_waitcnt lgkmcnt(4)
    buffer_load_dwordx4 a[60:63], v7, s[12:15], s66 offen offset:1024 sc1
    v_mfma_f32_16x16x32_bf16 v[44:47], v[76:79], a[12:15], 0
    s_add_u32 s66, s66, 524288
    ds_read_b64_tr_b16 v[56:57], v3 offset:16904
    ds_read_b64_tr_b16 v[58:59], v3 offset:17160
    v_mfma_f32_16x16x32_bf16 v[44:47], v[72:75], a[8:11], v[44:47]
    s_add_u32 m0, s62, 33792
    ds_read_b64_tr_b16 v[60:61], v3 offset:17416
    ds_read_b64_tr_b16 v[62:63], v3 offset:17672
    v_mfma_f32_16x16x32_bf16 v[28:31], v[72:75], a[0:3], 0
    buffer_load_dwordx4 v2, s[8:11], s65 offen  lds
    v_mfma_f32_16x16x32_bf16 v[28:31], v[76:79], a[4:7], v[28:31]
    s_waitcnt vmcnt(12) lgkmcnt(4)
    s_add_u32 s65, s65, 2048
    v_mfma_f32_16x16x32_bf16 v[216:219], v[48:51], a[16:19], v[216:219]
    buffer_store_dwordx4 v[204:207], v9, s[24:27], 0 offen offset:2048 sc1
    v_mfma_f32_16x16x32_bf16 v[216:219], v[52:55], a[20:23], v[216:219]
    ds_read_b64_tr_b16 v[64:65], v3 offset:16960
    ds_read_b64_tr_b16 v[66:67], v3 offset:17216
    v_mfma_f32_16x16x32_bf16 v[232:235], v[52:55], a[28:31], v[232:235]
    ds_read_b64_tr_b16 v[68:69], v3 offset:17472
    ds_read_b64_tr_b16 v[70:71], v3 offset:17728
    v_mfma_f32_16x16x32_bf16 v[232:235], v[48:51], a[24:27], v[232:235]
    s_waitcnt lgkmcnt(4)
    buffer_load_dwordx4 a[0:3], v6, s[12:15], s66 offen offset:0 sc1
    v_mfma_f32_16x16x32_bf16 v[236:239], v[60:63], a[28:31], v[236:239]
    ds_read_b64_tr_b16 v[72:73], v3 offset:16968
    ds_read_b64_tr_b16 v[74:75], v3 offset:17224
    v_mfma_f32_16x16x32_bf16 v[236:239], v[56:59], a[24:27], v[236:239]
    s_add_u32 m0, s62, 34824
    ds_read_b64_tr_b16 v[76:77], v3 offset:17480
    ds_read_b64_tr_b16 v[78:79], v3 offset:17736
    v_mfma_f32_16x16x32_bf16 v[220:223], v[56:59], a[16:19], v[220:223]
    buffer_load_dwordx4 v2, s[8:11], s65 offen  lds
    v_mfma_f32_16x16x32_bf16 v[220:223], v[60:63], a[20:23], v[220:223]
    s_waitcnt lgkmcnt(4)
    s_add_u32 s65, s65, 2048
    v_mfma_f32_16x16x32_bf16 v[224:227], v[64:67], a[16:19], v[224:227]
    buffer_store_dwordx4 v[208:211], v6, s[24:27], 0 offen offset:3072 sc1
    v_mfma_f32_16x16x32_bf16 v[224:227], v[68:71], a[20:23], v[224:227]
    ds_read_b64_tr_b16 v[48:49], v5 offset:16896
    ds_read_b64_tr_b16 v[50:51], v5 offset:17152
    v_mfma_f32_16x16x32_bf16 v[240:243], v[68:71], a[28:31], v[240:243]
    ds_read_b64_tr_b16 v[52:53], v5 offset:17408
    ds_read_b64_tr_b16 v[54:55], v5 offset:17664
    v_mfma_f32_16x16x32_bf16 v[240:243], v[64:67], a[24:27], v[240:243]
    s_waitcnt lgkmcnt(4)
    buffer_load_dwordx4 a[4:7], v6, s[12:15], s66 offen offset:1024 sc1
    v_mfma_f32_16x16x32_bf16 v[244:247], v[76:79], a[28:31], v[244:247]
    ds_read_b64_tr_b16 v[56:57], v5 offset:16904
    ds_read_b64_tr_b16 v[58:59], v5 offset:17160
    v_mfma_f32_16x16x32_bf16 v[244:247], v[72:75], a[24:27], v[244:247]
    s_add_u32 m0, s62, 35904
    ds_read_b64_tr_b16 v[60:61], v5 offset:17416
    ds_read_b64_tr_b16 v[62:63], v5 offset:17672
    v_mfma_f32_16x16x32_bf16 v[228:231], v[72:75], a[16:19], v[228:231]
    buffer_load_dwordx4 v2, s[8:11], s65 offen  lds
    v_mfma_f32_16x16x32_bf16 v[228:231], v[76:79], a[20:23], v[228:231]
    s_waitcnt lgkmcnt(4)
    s_add_u32 s65, s65, 2048
    v_mfma_f32_16x16x32_bf16 v[16:19], v[48:51], a[16:19], v[16:19]
    buffer_store_dwordx4 v[212:215], v7, s[24:27], 0 offen offset:3072 sc1
    v_mfma_f32_16x16x32_bf16 v[16:19], v[52:55], a[20:23], v[16:19]
    ds_read_b64_tr_b16 v[64:65], v5 offset:16960
    ds_read_b64_tr_b16 v[66:67], v5 offset:17216
    v_mfma_f32_16x16x32_bf16 v[32:35], v[52:55], a[28:31], v[32:35]
    ds_read_b64_tr_b16 v[68:69], v5 offset:17472
    ds_read_b64_tr_b16 v[70:71], v5 offset:17728
    v_mfma_f32_16x16x32_bf16 v[32:35], v[48:51], a[24:27], v[32:35]
    s_waitcnt lgkmcnt(4)
    buffer_load_dwordx4 a[8:11], v7, s[12:15], s66 offen offset:0 sc1
    v_mfma_f32_16x16x32_bf16 v[36:39], v[60:63], a[28:31], v[36:39]
    ds_read_b64_tr_b16 v[72:73], v5 offset:16968
    ds_read_b64_tr_b16 v[74:75], v5 offset:17224
    v_mfma_f32_16x16x32_bf16 v[36:39], v[56:59], a[24:27], v[36:39]
    s_add_u32 m0, s62, 36936
    ds_read_b64_tr_b16 v[76:77], v5 offset:17480
    ds_read_b64_tr_b16 v[78:79], v5 offset:17736
    v_mfma_f32_16x16x32_bf16 v[20:23], v[56:59], a[16:19], v[20:23]
    buffer_load_dwordx4 v2, s[8:11], s65 offen  lds
    v_mfma_f32_16x16x32_bf16 v[20:23], v[60:63], a[20:23], v[20:23]
    s_waitcnt lgkmcnt(4)
    s_add_u32 s65, s65, 256000
    v_mfma_f32_16x16x32_bf16 v[24:27], v[64:67], a[16:19], v[24:27]
    v_mfma_f32_16x16x32_bf16 v[24:27], v[68:71], a[20:23], v[24:27]
    s_barrier
    ds_read_b64_tr_b16 v[48:49], v3 offset:33792
    ds_read_b64_tr_b16 v[50:51], v3 offset:34048
    v_mfma_f32_16x16x32_bf16 v[40:43], v[68:71], a[28:31], v[40:43]
    ds_read_b64_tr_b16 v[52:53], v3 offset:34304
    ds_read_b64_tr_b16 v[54:55], v3 offset:34560
    v_mfma_f32_16x16x32_bf16 v[40:43], v[64:67], a[24:27], v[40:43]
    s_waitcnt lgkmcnt(4)
    buffer_load_dwordx4 a[12:15], v7, s[12:15], s66 offen offset:1024 sc1
    v_mfma_f32_16x16x32_bf16 v[44:47], v[76:79], a[28:31], v[44:47]
    s_add_u32 s66, s66, 524288
    ds_read_b64_tr_b16 v[56:57], v3 offset:33800
    ds_read_b64_tr_b16 v[58:59], v3 offset:34056
    v_mfma_f32_16x16x32_bf16 v[44:47], v[72:75], a[24:27], v[44:47]
    s_add_u32 m0, s62, 50688
    ds_read_b64_tr_b16 v[60:61], v3 offset:34312
    ds_read_b64_tr_b16 v[62:63], v3 offset:34568
    v_mfma_f32_16x16x32_bf16 v[28:31], v[72:75], a[16:19], v[28:31]
    buffer_load_dwordx4 v2, s[8:11], s65 offen  lds
    v_mfma_f32_16x16x32_bf16 v[28:31], v[76:79], a[20:23], v[28:31]
    s_waitcnt vmcnt(19) lgkmcnt(4)
    s_add_u32 s65, s65, 2048
    v_mfma_f32_16x16x32_bf16 v[216:219], v[48:51], a[32:35], v[216:219]
    v_mfma_f32_16x16x32_bf16 v[216:219], v[52:55], a[36:39], v[216:219]
    ds_read_b64_tr_b16 v[64:65], v3 offset:33856
    ds_read_b64_tr_b16 v[66:67], v3 offset:34112
    v_mfma_f32_16x16x32_bf16 v[232:235], v[52:55], a[44:47], v[232:235]
    ds_read_b64_tr_b16 v[68:69], v3 offset:34368
    ds_read_b64_tr_b16 v[70:71], v3 offset:34624
    v_mfma_f32_16x16x32_bf16 v[232:235], v[48:51], a[40:43], v[232:235]
    s_waitcnt lgkmcnt(4)
    buffer_load_dwordx4 a[16:19], v6, s[12:15], s66 offen offset:0 sc1
    v_mfma_f32_16x16x32_bf16 v[236:239], v[60:63], a[44:47], v[236:239]
    ds_read_b64_tr_b16 v[72:73], v3 offset:33864
    ds_read_b64_tr_b16 v[74:75], v3 offset:34120
    v_mfma_f32_16x16x32_bf16 v[236:239], v[56:59], a[40:43], v[236:239]
    s_add_u32 m0, s62, 51720
    ds_read_b64_tr_b16 v[76:77], v3 offset:34376
    ds_read_b64_tr_b16 v[78:79], v3 offset:34632
    v_mfma_f32_16x16x32_bf16 v[220:223], v[56:59], a[32:35], v[220:223]
    buffer_load_dwordx4 v2, s[8:11], s65 offen  lds
    v_mfma_f32_16x16x32_bf16 v[220:223], v[60:63], a[36:39], v[220:223]
    s_waitcnt lgkmcnt(4)
    s_add_u32 s65, s65, 2048
    v_mfma_f32_16x16x32_bf16 v[224:227], v[64:67], a[32:35], v[224:227]
    v_mfma_f32_16x16x32_bf16 v[224:227], v[68:71], a[36:39], v[224:227]
    ds_read_b64_tr_b16 v[48:49], v5 offset:33792
    ds_read_b64_tr_b16 v[50:51], v5 offset:34048
    v_mfma_f32_16x16x32_bf16 v[240:243], v[68:71], a[44:47], v[240:243]
    ds_read_b64_tr_b16 v[52:53], v5 offset:34304
    ds_read_b64_tr_b16 v[54:55], v5 offset:34560
    v_mfma_f32_16x16x32_bf16 v[240:243], v[64:67], a[40:43], v[240:243]
    s_waitcnt lgkmcnt(4)
    buffer_load_dwordx4 a[20:23], v6, s[12:15], s66 offen offset:1024 sc1
    v_mfma_f32_16x16x32_bf16 v[244:247], v[76:79], a[44:47], v[244:247]
    ds_read_b64_tr_b16 v[56:57], v5 offset:33800
    ds_read_b64_tr_b16 v[58:59], v5 offset:34056
    v_mfma_f32_16x16x32_bf16 v[244:247], v[72:75], a[40:43], v[244:247]
    s_add_u32 m0, s62, 52800
    ds_read_b64_tr_b16 v[60:61], v5 offset:34312
    ds_read_b64_tr_b16 v[62:63], v5 offset:34568
    v_mfma_f32_16x16x32_bf16 v[228:231], v[72:75], a[32:35], v[228:231]
    buffer_load_dwordx4 v2, s[8:11], s65 offen  lds
    v_mfma_f32_16x16x32_bf16 v[228:231], v[76:79], a[36:39], v[228:231]
    s_waitcnt lgkmcnt(4)
    s_add_u32 s65, s65, 2048
    v_mfma_f32_16x16x32_bf16 v[16:19], v[48:51], a[32:35], v[16:19]
    v_mfma_f32_16x16x32_bf16 v[16:19], v[52:55], a[36:39], v[16:19]
    ds_read_b64_tr_b16 v[64:65], v5 offset:33856
    ds_read_b64_tr_b16 v[66:67], v5 offset:34112
    v_mfma_f32_16x16x32_bf16 v[32:35], v[52:55], a[44:47], v[32:35]
    ds_read_b64_tr_b16 v[68:69], v5 offset:34368
    ds_read_b64_tr_b16 v[70:71], v5 offset:34624
    v_mfma_f32_16x16x32_bf16 v[32:35], v[48:51], a[40:43], v[32:35]
    s_waitcnt lgkmcnt(4)
    buffer_load_dwordx4 a[24:27], v7, s[12:15], s66 offen offset:0 sc1
    v_mfma_f32_16x16x32_bf16 v[36:39], v[60:63], a[44:47], v[36:39]
    ds_read_b64_tr_b16 v[72:73], v5 offset:33864
    ds_read_b64_tr_b16 v[74:75], v5 offset:34120
    v_mfma_f32_16x16x32_bf16 v[36:39], v[56:59], a[40:43], v[36:39]
    s_add_u32 m0, s62, 53832
    ds_read_b64_tr_b16 v[76:77], v5 offset:34376
    ds_read_b64_tr_b16 v[78:79], v5 offset:34632
    v_mfma_f32_16x16x32_bf16 v[20:23], v[56:59], a[32:35], v[20:23]
    buffer_load_dwordx4 v2, s[8:11], s65 offen  lds
    v_mfma_f32_16x16x32_bf16 v[20:23], v[60:63], a[36:39], v[20:23]
    s_waitcnt lgkmcnt(4)
    s_add_u32 s65, s65, s40
    v_mfma_f32_16x16x32_bf16 v[24:27], v[64:67], a[32:35], v[24:27]
    v_mfma_f32_16x16x32_bf16 v[24:27], v[68:71], a[36:39], v[24:27]
    ds_read_b64_tr_b16 v[48:49], v3 offset:50688
    ds_read_b64_tr_b16 v[50:51], v3 offset:50944
    v_mfma_f32_16x16x32_bf16 v[40:43], v[68:71], a[44:47], v[40:43]
    ds_read_b64_tr_b16 v[52:53], v3 offset:51200
    ds_read_b64_tr_b16 v[54:55], v3 offset:51456
    v_mfma_f32_16x16x32_bf16 v[40:43], v[64:67], a[40:43], v[40:43]
    s_waitcnt lgkmcnt(4)
    buffer_load_dwordx4 a[28:31], v7, s[12:15], s66 offen offset:1024 sc1
    v_mfma_f32_16x16x32_bf16 v[44:47], v[76:79], a[44:47], v[44:47]
    s_add_u32 s66, s66, 524288
    ds_read_b64_tr_b16 v[56:57], v3 offset:50696
    ds_read_b64_tr_b16 v[58:59], v3 offset:50952
    v_mfma_f32_16x16x32_bf16 v[44:47], v[72:75], a[40:43], v[44:47]
    s_add_u32 m0, s61, 0
    ds_read_b64_tr_b16 v[60:61], v3 offset:51208
    ds_read_b64_tr_b16 v[62:63], v3 offset:51464
    v_mfma_f32_16x16x32_bf16 v[28:31], v[72:75], a[32:35], v[28:31]
    buffer_load_dwordx4 v2, s[8:11], s65 offen  lds
    v_mfma_f32_16x16x32_bf16 v[28:31], v[76:79], a[36:39], v[28:31]
    s_waitcnt vmcnt(20) lgkmcnt(4)
    s_add_u32 s65, s65, 2048
    v_mfma_f32_16x16x32_bf16 v[216:219], v[48:51], a[48:51], v[216:219]
    buffer_load_dword v254, v248, s[4:7], s63 offen sc1
    v_mfma_f32_16x16x32_bf16 v[216:219], v[52:55], a[52:55], v[216:219]
    ds_read_b64_tr_b16 v[64:65], v3 offset:50752
    ds_read_b64_tr_b16 v[66:67], v3 offset:51008
    v_mfma_f32_16x16x32_bf16 v[232:235], v[52:55], a[60:63], v[232:235]
    ds_read_b64_tr_b16 v[68:69], v3 offset:51264
    ds_read_b64_tr_b16 v[70:71], v3 offset:51520
    v_mfma_f32_16x16x32_bf16 v[232:235], v[48:51], a[56:59], v[232:235]
    s_waitcnt lgkmcnt(4)
    buffer_load_dwordx4 a[32:35], v6, s[12:15], s66 offen offset:0 sc1
    v_mfma_f32_16x16x32_bf16 v[236:239], v[60:63], a[60:63], v[236:239]
    ds_read_b64_tr_b16 v[72:73], v3 offset:50760
    ds_read_b64_tr_b16 v[74:75], v3 offset:51016
    v_mfma_f32_16x16x32_bf16 v[236:239], v[56:59], a[56:59], v[236:239]
    s_add_u32 m0, s61, 1032
    ds_read_b64_tr_b16 v[76:77], v3 offset:51272
    ds_read_b64_tr_b16 v[78:79], v3 offset:51528
    v_mfma_f32_16x16x32_bf16 v[220:223], v[56:59], a[48:51], v[220:223]
    buffer_load_dwordx4 v2, s[8:11], s65 offen  lds
    v_mfma_f32_16x16x32_bf16 v[220:223], v[60:63], a[52:55], v[220:223]
    s_waitcnt lgkmcnt(4)
    s_add_u32 s65, s65, 2048
    v_mfma_f32_16x16x32_bf16 v[224:227], v[64:67], a[48:51], v[224:227]
    v_mfma_f32_16x16x32_bf16 v[224:227], v[68:71], a[52:55], v[224:227]
    ds_read_b64_tr_b16 v[48:49], v5 offset:50688
    ds_read_b64_tr_b16 v[50:51], v5 offset:50944
    v_mfma_f32_16x16x32_bf16 v[240:243], v[68:71], a[60:63], v[240:243]
    ds_read_b64_tr_b16 v[52:53], v5 offset:51200
    ds_read_b64_tr_b16 v[54:55], v5 offset:51456
    v_mfma_f32_16x16x32_bf16 v[240:243], v[64:67], a[56:59], v[240:243]
    s_waitcnt lgkmcnt(4)
    buffer_load_dwordx4 a[36:39], v6, s[12:15], s66 offen offset:1024 sc1
    v_mfma_f32_16x16x32_bf16 v[244:247], v[76:79], a[60:63], v[244:247]
    ds_read_b64_tr_b16 v[56:57], v5 offset:50696
    ds_read_b64_tr_b16 v[58:59], v5 offset:50952
    v_mfma_f32_16x16x32_bf16 v[244:247], v[72:75], a[56:59], v[244:247]
    s_add_u32 m0, s61, 2112
    ds_read_b64_tr_b16 v[60:61], v5 offset:51208
    ds_read_b64_tr_b16 v[62:63], v5 offset:51464
    v_mfma_f32_16x16x32_bf16 v[228:231], v[72:75], a[48:51], v[228:231]
    buffer_load_dwordx4 v2, s[8:11], s65 offen  lds
    v_mfma_f32_16x16x32_bf16 v[228:231], v[76:79], a[52:55], v[228:231]
    s_waitcnt lgkmcnt(4)
    s_add_u32 s65, s65, 2048
    v_mfma_f32_16x16x32_bf16 v[16:19], v[48:51], a[48:51], v[16:19]
    v_mfma_f32_16x16x32_bf16 v[16:19], v[52:55], a[52:55], v[16:19]
    ds_read_b64_tr_b16 v[64:65], v5 offset:50752
    ds_read_b64_tr_b16 v[66:67], v5 offset:51008
    v_mfma_f32_16x16x32_bf16 v[32:35], v[52:55], a[60:63], v[32:35]
    ds_read_b64_tr_b16 v[68:69], v5 offset:51264
    ds_read_b64_tr_b16 v[70:71], v5 offset:51520
    v_mfma_f32_16x16x32_bf16 v[32:35], v[48:51], a[56:59], v[32:35]
    s_waitcnt lgkmcnt(4)
    buffer_load_dwordx4 a[40:43], v7, s[12:15], s66 offen offset:0 sc1
    v_mfma_f32_16x16x32_bf16 v[36:39], v[60:63], a[60:63], v[36:39]
    ds_read_b64_tr_b16 v[72:73], v5 offset:50760
    ds_read_b64_tr_b16 v[74:75], v5 offset:51016
    v_mfma_f32_16x16x32_bf16 v[36:39], v[56:59], a[56:59], v[36:39]
    s_add_u32 m0, s61, 3144
    ds_read_b64_tr_b16 v[76:77], v5 offset:51272
    ds_read_b64_tr_b16 v[78:79], v5 offset:51528
    v_mfma_f32_16x16x32_bf16 v[20:23], v[56:59], a[48:51], v[20:23]
    buffer_load_dwordx4 v2, s[8:11], s65 offen  lds
    v_mfma_f32_16x16x32_bf16 v[20:23], v[60:63], a[52:55], v[20:23]
    s_waitcnt lgkmcnt(4)
    s_add_u32 s65, s65, 256000
    v_mfma_f32_16x16x32_bf16 v[24:27], v[64:67], a[48:51], v[24:27]
    s_waitcnt vmcnt(19)
    buffer_store_dword v252, v253, s[4:7], s47 offen sc1
    v_mfma_f32_16x16x32_bf16 v[24:27], v[68:71], a[52:55], v[24:27]
    s_barrier
    ds_read_b64_tr_b16 v[48:49], v4 offset:0
    ds_read_b64_tr_b16 v[50:51], v4 offset:256
    v_mfma_f32_16x16x32_bf16 v[40:43], v[68:71], a[60:63], v[40:43]
    ds_read_b64_tr_b16 v[52:53], v4 offset:512
    ds_read_b64_tr_b16 v[54:55], v4 offset:768
    v_mfma_f32_16x16x32_bf16 v[40:43], v[64:67], a[56:59], v[40:43]
    s_waitcnt lgkmcnt(4)
    buffer_load_dwordx4 a[44:47], v7, s[12:15], s66 offen offset:1024 sc1
    v_mfma_f32_16x16x32_bf16 v[44:47], v[76:79], a[60:63], v[44:47]
    s_add_u32 s66, s66, 524288
    ds_read_b64_tr_b16 v[56:57], v4 offset:8
    ds_read_b64_tr_b16 v[58:59], v4 offset:264
    v_mfma_f32_16x16x32_bf16 v[44:47], v[72:75], a[56:59], v[44:47]
    s_add_u32 m0, s61, 16896
    ds_read_b64_tr_b16 v[60:61], v4 offset:520
    ds_read_b64_tr_b16 v[62:63], v4 offset:776
    v_mfma_f32_16x16x32_bf16 v[28:31], v[72:75], a[48:51], v[28:31]
    buffer_load_dwordx4 v2, s[8:11], s65 offen  lds
    s_mov_b32 s44, s61
    v_mfma_f32_16x16x32_bf16 v[28:31], v[76:79], a[52:55], v[28:31]
    s_waitcnt vmcnt(19) lgkmcnt(4)
    s_add_u32 s65, s65, 2048
    v_swap_b32 v3, v4
    v_swap_b32 v5, v15
    s_mov_b32 s61, s62
    s_mov_b32 s62, s44
    s_waitcnt vmcnt(9)
    v_cmp_ne_u32 vcc, s60, v254
    s_add_u32 s49, s49, 1
    s_cbranch_vccnz L_slowgate_25
L_gateback_26:
    s_add_u32 s63, s63, s64
L_oploop_27:
    s_cmp_eq_u32 s49, s43
    s_cselect_b32 s40, s42, s40
    v_mfma_f32_16x16x32_bf16 v[216:219], v[48:51], a[0:3], v[216:219]
    v_mfma_f32_16x16x32_bf16 v[216:219], v[52:55], a[4:7], v[216:219]
    ds_read_b64_tr_b16 v[64:65], v3 offset:64
    ds_read_b64_tr_b16 v[66:67], v3 offset:320
    v_mfma_f32_16x16x32_bf16 v[232:235], v[52:55], a[12:15], v[232:235]
    ds_read_b64_tr_b16 v[68:69], v3 offset:576
    ds_read_b64_tr_b16 v[70:71], v3 offset:832
    v_mfma_f32_16x16x32_bf16 v[232:235], v[48:51], a[8:11], v[232:235]
    s_waitcnt lgkmcnt(4)
    buffer_load_dwordx4 a[48:51], v6, s[12:15], s66 offen offset:0 sc1
    v_mfma_f32_16x16x32_bf16 v[236:239], v[60:63], a[12:15], v[236:239]
    ds_read_b64_tr_b16 v[72:73], v3 offset:72
    ds_read_b64_tr_b16 v[74:75], v3 offset:328
    v_mfma_f32_16x16x32_bf16 v[236:239], v[56:59], a[8:11], v[236:239]
    s_add_u32 m0, s62, 17928
    ds_read_b64_tr_b16 v[76:77], v3 offset:584
    ds_read_b64_tr_b16 v[78:79], v3 offset:840
    v_mfma_f32_16x16x32_bf16 v[220:223], v[56:59], a[0:3], v[220:223]
    buffer_load_dwordx4 v2, s[8:11], s65 offen  lds
    v_mfma_f32_16x16x32_bf16 v[220:223], v[60:63], a[4:7], v[220:223]
    s_waitcnt lgkmcnt(4)
    s_add_u32 s65, s65, 2048
    v_mfma_f32_16x16x32_bf16 v[224:227], v[64:67], a[0:3], v[224:227]
    v_mfma_f32_16x16x32_bf16 v[224:227], v[68:71], a[4:7], v[224:227]
    ds_read_b64_tr_b16 v[48:49], v5 offset:0
    ds_read_b64_tr_b16 v[50:51], v5 offset:256
    v_mfma_f32_16x16x32_bf16 v[240:243], v[68:71], a[12:15], v[240:243]
    ds_read_b64_tr_b16 v[52:53], v5 offset:512
    ds_read_b64_tr_b16 v[54:55], v5 offset:768
    v_mfma_f32_16x16x32_bf16 v[240:243], v[64:67], a[8:11], v[240:243]
    s_waitcnt lgkmcnt(4)
    buffer_load_dwordx4 a[52:55], v6, s[12:15], s66 offen offset:1024 sc1
    v_mfma_f32_16x16x32_bf16 v[244:247], v[76:79], a[12:15], v[244:247]
    ds_read_b64_tr_b16 v[56:57], v5 offset:8
    ds_read_b64_tr_b16 v[58:59], v5 offset:264
    v_mfma_f32_16x16x32_bf16 v[244:247], v[72:75], a[8:11], v[244:247]
    s_add_u32 m0, s62, 19008
    ds_read_b64_tr_b16 v[60:61], v5 offset:520
    ds_read_b64_tr_b16 v[62:63], v5 offset:776
    v_mfma_f32_16x16x32_bf16 v[228:231], v[72:75], a[0:3], v[228:231]
    buffer_load_dwordx4 v2, s[8:11], s65 offen  lds
    v_mfma_f32_16x16x32_bf16 v[228:231], v[76:79], a[4:7], v[228:231]
    s_waitcnt lgkmcnt(4)
    s_add_u32 s65, s65, 2048
    v_mfma_f32_16x16x32_bf16 v[16:19], v[48:51], a[0:3], v[16:19]
    v_mfma_f32_16x16x32_bf16 v[16:19], v[52:55], a[4:7], v[16:19]
    ds_read_b64_tr_b16 v[64:65], v5 offset:64
    ds_read_b64_tr_b16 v[66:67], v5 offset:320
    v_mfma_f32_16x16x32_bf16 v[32:35], v[52:55], a[12:15], v[32:35]
    ds_read_b64_tr_b16 v[68:69], v5 offset:576
    ds_read_b64_tr_b16 v[70:71], v5 offset:832
    v_mfma_f32_16x16x32_bf16 v[32:35], v[48:51], a[8:11], v[32:35]
    s_waitcnt lgkmcnt(4)
    buffer_load_dwordx4 a[56:59], v7, s[12:15], s66 offen offset:0 sc1
    v_mfma_f32_16x16x32_bf16 v[36:39], v[60:63], a[12:15], v[36:39]
    ds_read_b64_tr_b16 v[72:73], v5 offset:72
    ds_read_b64_tr_b16 v[74:75], v5 offset:328
    v_mfma_f32_16x16x32_bf16 v[36:39], v[56:59], a[8:11], v[36:39]
    s_add_u32 m0, s62, 20040
    ds_read_b64_tr_b16 v[76:77], v5 offset:584
    ds_read_b64_tr_b16 v[78:79], v5 offset:840
    v_mfma_f32_16x16x32_bf16 v[20:23], v[56:59], a[0:3], v[20:23]
    buffer_load_dwordx4 v2, s[8:11], s65 offen  lds
    v_mfma_f32_16x16x32_bf16 v[20:23], v[60:63], a[4:7], v[20:23]
    s_waitcnt lgkmcnt(4)
    s_add_u32 s65, s65, 256000
    v_mfma_f32_16x16x32_bf16 v[24:27], v[64:67], a[0:3], v[24:27]
    v_mfma_f32_16x16x32_bf16 v[24:27], v[68:71], a[4:7], v[24:27]
    ds_read_b64_tr_b16 v[48:49], v3 offset:16896
    ds_read_b64_tr_b16 v[50:51], v3 offset:17152
    v_mfma_f32_16x16x32_bf16 v[40:43], v[68:71], a[12:15], v[40:43]
    ds_read_b64_tr_b16 v[52:53], v3 offset:17408
    ds_read_b64_tr_b16 v[54:55], v3 offset:17664
    v_mfma_f32_16x16x32_bf16 v[40:43], v[64:67], a[8:11], v[40:43]
    s_waitcnt lgkmcnt(4)
    buffer_load_dwordx4 a[60:63], v7, s[12:15], s66 offen offset:1024 sc1
    v_mfma_f32_16x16x32_bf16 v[44:47], v[76:79], a[12:15], v[44:47]
    s_add_u32 s66, s66, 524288
    ds_read_b64_tr_b16 v[56:57], v3 offset:16904
    ds_read_b64_tr_b16 v[58:59], v3 offset:17160
    v_mfma_f32_16x16x32_bf16 v[44:47], v[72:75], a[8:11], v[44:47]
    s_add_u32 m0, s62, 33792
    ds_read_b64_tr_b16 v[60:61], v3 offset:17416
    ds_read_b64_tr_b16 v[62:63], v3 offset:17672
    v_mfma_f32_16x16x32_bf16 v[28:31], v[72:75], a[0:3], v[28:31]
    buffer_load_dwordx4 v2, s[8:11], s65 offen  lds
    v_mfma_f32_16x16x32_bf16 v[28:31], v[76:79], a[4:7], v[28:31]
    s_waitcnt vmcnt(18) lgkmcnt(4)
    s_add_u32 s65, s65, 2048
    v_mfma_f32_16x16x32_bf16 v[216:219], v[48:51], a[16:19], v[216:219]
    v_mfma_f32_16x16x32_bf16 v[216:219], v[52:55], a[20:23], v[216:219]
    ds_read_b64_tr_b16 v[64:65], v3 offset:16960
    ds_read_b64_tr_b16 v[66:67], v3 offset:17216
    v_mfma_f32_16x16x32_bf16 v[232:235], v[52:55], a[28:31], v[232:235]
    ds_read_b64_tr_b16 v[68:69], v3 offset:17472
    ds_read_b64_tr_b16 v[70:71], v3 offset:17728
    v_mfma_f32_16x16x32_bf16 v[232:235], v[48:51], a[24:27], v[232:235]
    s_waitcnt lgkmcnt(4)
    buffer_load_dwordx4 a[0:3], v6, s[12:15], s66 offen offset:0 sc1
    v_mfma_f32_16x16x32_bf16 v[236:239], v[60:63], a[28:31], v[236:239]
    ds_read_b64_tr_b16 v[72:73], v3 offset:16968
    ds_read_b64_tr_b16 v[74:75], v3 offset:17224
    v_mfma_f32_16x16x32_bf16 v[236:239], v[56:59], a[24:27], v[236:239]
    s_add_u32 m0, s62, 34824
    ds_read_b64_tr_b16 v[76:77], v3 offset:17480
    ds_read_b64_tr_b16 v[78:79], v3 offset:17736
    v_mfma_f32_16x16x32_bf16 v[220:223], v[56:59], a[16:19], v[220:223]
    buffer_load_dwordx4 v2, s[8:11], s65 offen  lds
    v_mfma_f32_16x16x32_bf16 v[220:223], v[60:63], a[20:23], v[220:223]
    s_waitcnt lgkmcnt(4)
    s_add_u32 s65, s65, 2048
    v_mfma_f32_16x16x32_bf16 v[224:227], v[64:67], a[16:19], v[224:227]
    v_mfma_f32_16x16x32_bf16 v[224:227], v[68:71], a[20:23], v[224:227]
    ds_read_b64_tr_b16 v[48:49], v5 offset:16896
    ds_read_b64_tr_b16 v[50:51], v5 offset:17152
    v_mfma_f32_16x16x32_bf16 v[240:243], v[68:71], a[28:31], v[240:243]
    ds_read_b64_tr_b16 v[52:53], v5 offset:17408
    ds_read_b64_tr_b16 v[54:55], v5 offset:17664
    v_mfma_f32_16x16x32_bf16 v[240:243], v[64:67], a[24:27], v[240:243]
    s_waitcnt lgkmcnt(4)
    buffer_load_dwordx4 a[4:7], v6, s[12:15], s66 offen offset:1024 sc1
    v_mfma_f32_16x16x32_bf16 v[244:247], v[76:79], a[28:31], v[244:247]
    ds_read_b64_tr_b16 v[56:57], v5 offset:16904
    ds_read_b64_tr_b16 v[58:59], v5 offset:17160
    v_mfma_f32_16x16x32_bf16 v[244:247], v[72:75], a[24:27], v[244:247]
    s_add_u32 m0, s62, 35904
    ds_read_b64_tr_b16 v[60:61], v5 offset:17416
    ds_read_b64_tr_b16 v[62:63], v5 offset:17672
    v_mfma_f32_16x16x32_bf16 v[228:231], v[72:75], a[16:19], v[228:231]
    buffer_load_dwordx4 v2, s[8:11], s65 offen  lds
    v_mfma_f32_16x16x32_bf16 v[228:231], v[76:79], a[20:23], v[228:231]
    s_waitcnt lgkmcnt(4)
    s_add_u32 s65, s65, 2048
    v_mfma_f32_16x16x32_bf16 v[16:19], v[48:51], a[16:19], v[16:19]
    v_mfma_f32_16x16x32_bf16 v[16:19], v[52:55], a[20:23], v[16:19]
    ds_read_b64_tr_b16 v[64:65], v5 offset:16960
    ds_read_b64_tr_b16 v[66:67], v5 offset:17216
    v_mfma_f32_16x16x32_bf16 v[32:35], v[52:55], a[28:31], v[32:35]
    ds_read_b64_tr_b16 v[68:69], v5 offset:17472
    ds_read_b64_tr_b16 v[70:71], v5 offset:17728
    v_mfma_f32_16x16x32_bf16 v[32:35], v[48:51], a[24:27], v[32:35]
    s_waitcnt lgkmcnt(4)
    buffer_load_dwordx4 a[8:11], v7, s[12:15], s66 offen offset:0 sc1
    v_mfma_f32_16x16x32_bf16 v[36:39], v[60:63], a[28:31], v[36:39]
    ds_read_b64_tr_b16 v[72:73], v5 offset:16968
    ds_read_b64_tr_b16 v[74:75], v5 offset:17224
    v_mfma_f32_16x16x32_bf16 v[36:39], v[56:59], a[24:27], v[36:39]
    s_add_u32 m0, s62, 36936
    ds_read_b64_tr_b16 v[76:77], v5 offset:17480
    ds_read_b64_tr_b16 v[78:79], v5 offset:17736
    v_mfma_f32_16x16x32_bf16 v[20:23], v[56:59], a[16:19], v[20:23]
    buffer_load_dwordx4 v2, s[8:11], s65 offen  lds
    v_mfma_f32_16x16x32_bf16 v[20:23], v[60:63], a[20:23], v[20:23]
    s_waitcnt lgkmcnt(4)
    s_add_u32 s65, s65, 256000
    v_mfma_f32_16x16x32_bf16 v[24:27], v[64:67], a[16:19], v[24:27]
    v_mfma_f32_16x16x32_bf16 v[24:27], v[68:71], a[20:23], v[24:27]
    s_barrier
    ds_read_b64_tr_b16 v[48:49], v3 offset:33792
    ds_read_b64_tr_b16 v[50:51], v3 offset:34048
    v_mfma_f32_16x16x32_bf16 v[40:43], v[68:71], a[28:31], v[40:43]
    ds_read_b64_tr_b16 v[52:53], v3 offset:34304
    ds_read_b64_tr_b16 v[54:55], v3 offset:34560
    v_mfma_f32_16x16x32_bf16 v[40:43], v[64:67], a[24:27], v[40:43]
    s_waitcnt lgkmcnt(4)
    buffer_load_dwordx4 a[12:15], v7, s[12:15], s66 offen offset:1024 sc1
    v_mfma_f32_16x16x32_bf16 v[44:47], v[76:79], a[28:31], v[44:47]
    s_add_u32 s66, s66, 524288
    ds_read_b64_tr_b16 v[56:57], v3 offset:33800
    ds_read_b64_tr_b16 v[58:59], v3 offset:34056
    v_mfma_f32_16x16x32_bf16 v[44:47], v[72:75], a[24:27], v[44:47]
    s_add_u32 m0, s62, 50688
    ds_read_b64_tr_b16 v[60:61], v3 offset:34312
    ds_read_b64_tr_b16 v[62:63], v3 offset:34568
    v_mfma_f32_16x16x32_bf16 v[28:31], v[72:75], a[16:19], v[28:31]
    buffer_load_dwordx4 v2, s[8:11], s65 offen  lds
    v_mfma_f32_16x16x32_bf16 v[28:31], v[76:79], a[20:23], v[28:31]
    s_waitcnt vmcnt(17) lgkmcnt(4)
    s_add_u32 s65, s65, 2048
    v_mfma_f32_16x16x32_bf16 v[216:219], v[48:51], a[32:35], v[216:219]
    v_mfma_f32_16x16x32_bf16 v[216:219], v[52:55], a[36:39], v[216:219]
    ds_read_b64_tr_b16 v[64:65], v3 offset:33856
    ds_read_b64_tr_b16 v[66:67], v3 offset:34112
    v_mfma_f32_16x16x32_bf16 v[232:235], v[52:55], a[44:47], v[232:235]
    ds_read_b64_tr_b16 v[68:69], v3 offset:34368
    ds_read_b64_tr_b16 v[70:71], v3 offset:34624
    v_mfma_f32_16x16x32_bf16 v[232:235], v[48:51], a[40:43], v[232:235]
    s_waitcnt lgkmcnt(4)
    buffer_load_dwordx4 a[16:19], v6, s[12:15], s66 offen offset:0 sc1
    v_mfma_f32_16x16x32_bf16 v[236:239], v[60:63], a[44:47], v[236:239]
    ds_read_b64_tr_b16 v[72:73], v3 offset:33864
    ds_read_b64_tr_b16 v[74:75], v3 offset:34120
    v_mfma_f32_16x16x32_bf16 v[236:239], v[56:59], a[40:43], v[236:239]
    s_add_u32 m0, s62, 51720
    ds_read_b64_tr_b16 v[76:77], v3 offset:34376
    ds_read_b64_tr_b16 v[78:79], v3 offset:34632
    v_mfma_f32_16x16x32_bf16 v[220:223], v[56:59], a[32:35], v[220:223]
    buffer_load_dwordx4 v2, s[8:11], s65 offen  lds
    v_mfma_f32_16x16x32_bf16 v[220:223], v[60:63], a[36:39], v[220:223]
    s_waitcnt lgkmcnt(4)
    s_add_u32 s65, s65, 2048
    v_mfma_f32_16x16x32_bf16 v[224:227], v[64:67], a[32:35], v[224:227]
    v_mfma_f32_16x16x32_bf16 v[224:227], v[68:71], a[36:39], v[224:227]
    ds_read_b64_tr_b16 v[48:49], v5 offset:33792
    ds_read_b64_tr_b16 v[50:51], v5 offset:34048
    v_mfma_f32_16x16x32_bf16 v[240:243], v[68:71], a[44:47], v[240:243]
    ds_read_b64_tr_b16 v[52:53], v5 offset:34304
    ds_read_b64_tr_b16 v[54:55], v5 offset:34560
    v_mfma_f32_16x16x32_bf16 v[240:243], v[64:67], a[40:43], v[240:243]
    s_waitcnt lgkmcnt(4)
    buffer_load_dwordx4 a[20:23], v6, s[12:15], s66 offen offset:1024 sc1
    v_mfma_f32_16x16x32_bf16 v[244:247], v[76:79], a[44:47], v[244:247]
    ds_read_b64_tr_b16 v[56:57], v5 offset:33800
    ds_read_b64_tr_b16 v[58:59], v5 offset:34056
    v_mfma_f32_16x16x32_bf16 v[244:247], v[72:75], a[40:43], v[244:247]
    s_add_u32 m0, s62, 52800
    ds_read_b64_tr_b16 v[60:61], v5 offset:34312
    ds_read_b64_tr_b16 v[62:63], v5 offset:34568
    v_mfma_f32_16x16x32_bf16 v[228:231], v[72:75], a[32:35], v[228:231]
    buffer_load_dwordx4 v2, s[8:11], s65 offen  lds
    v_mfma_f32_16x16x32_bf16 v[228:231], v[76:79], a[36:39], v[228:231]
    s_waitcnt lgkmcnt(4)
    s_add_u32 s65, s65, 2048
    v_mfma_f32_16x16x32_bf16 v[16:19], v[48:51], a[32:35], v[16:19]
    v_mfma_f32_16x16x32_bf16 v[16:19], v[52:55], a[36:39], v[16:19]
    ds_read_b64_tr_b16 v[64:65], v5 offset:33856
    ds_read_b64_tr_b16 v[66:67], v5 offset:34112
    v_mfma_f32_16x16x32_bf16 v[32:35], v[52:55], a[44:47], v[32:35]
    ds_read_b64_tr_b16 v[68:69], v5 offset:34368
    ds_read_b64_tr_b16 v[70:71], v5 offset:34624
    v_mfma_f32_16x16x32_bf16 v[32:35], v[48:51], a[40:43], v[32:35]
    s_waitcnt lgkmcnt(4)
    buffer_load_dwordx4 a[24:27], v7, s[12:15], s66 offen offset:0 sc1
    v_mfma_f32_16x16x32_bf16 v[36:39], v[60:63], a[44:47], v[36:39]
    ds_read_b64_tr_b16 v[72:73], v5 offset:33864
    ds_read_b64_tr_b16 v[74:75], v5 offset:34120
    v_mfma_f32_16x16x32_bf16 v[36:39], v[56:59], a[40:43], v[36:39]
    s_add_u32 m0, s62, 53832
    ds_read_b64_tr_b16 v[76:77], v5 offset:34376
    ds_read_b64_tr_b16 v[78:79], v5 offset:34632
    v_mfma_f32_16x16x32_bf16 v[20:23], v[56:59], a[32:35], v[20:23]
    buffer_load_dwordx4 v2, s[8:11], s65 offen  lds
    v_mfma_f32_16x16x32_bf16 v[20:23], v[60:63], a[36:39], v[20:23]
    s_waitcnt lgkmcnt(4)
    s_add_u32 s65, s65, s40
    v_mfma_f32_16x16x32_bf16 v[24:27], v[64:67], a[32:35], v[24:27]
    v_mfma_f32_16x16x32_bf16 v[24:27], v[68:71], a[36:39], v[24:27]
    ds_read_b64_tr_b16 v[48:49], v3 offset:50688
    ds_read_b64_tr_b16 v[50:51], v3 offset:50944
    v_mfma_f32_16x16x32_bf16 v[40:43], v[68:71], a[44:47], v[40:43]
    ds_read_b64_tr_b16 v[52:53], v3 offset:51200
    ds_read_b64_tr_b16 v[54:55], v3 offset:51456
    v_mfma_f32_16x16x32_bf16 v[40:43], v[64:67], a[40:43], v[40:43]
    s_waitcnt lgkmcnt(4)
    buffer_load_dwordx4 a[28:31], v7, s[12:15], s66 offen offset:1024 sc1
    v_mfma_f32_16x16x32_bf16 v[44:47], v[76:79], a[44:47], v[44:47]
    s_add_u32 s66, s66, 524288
    ds_read_b64_tr_b16 v[56:57], v3 offset:50696
    ds_read_b64_tr_b16 v[58:59], v3 offset:50952
    v_mfma_f32_16x16x32_bf16 v[44:47], v[72:75], a[40:43], v[44:47]
    s_add_u32 m0, s61, 0
    ds_read_b64_tr_b16 v[60:61], v3 offset:51208
    ds_read_b64_tr_b16 v[62:63], v3 offset:51464
    v_mfma_f32_16x16x32_bf16 v[28:31], v[72:75], a[32:35], v[28:31]
    buffer_load_dwordx4 v2, s[8:11], s65 offen  lds
    v_mfma_f32_16x16x32_bf16 v[28:31], v[76:79], a[36:39], v[28:31]
    s_waitcnt vmcnt(17) lgkmcnt(4)
    s_add_u32 s65, s65, 2048
    v_mfma_f32_16x16x32_bf16 v[216:219], v[48:51], a[48:51], v[216:219]
    buffer_load_dword v254, v248, s[4:7], s63 offen sc1
    v_mfma_f32_16x16x32_bf16 v[216:219], v[52:55], a[52:55], v[216:219]
    ds_read_b64_tr_b16 v[64:65], v3 offset:50752
    ds_read_b64_tr_b16 v[66:67], v3 offset:51008
    v_mfma_f32_16x16x32_bf16 v[232:235], v[52:55], a[60:63], v[232:235]
    ds_read_b64_tr_b16 v[68:69], v3 offset:51264
    ds_read_b64_tr_b16 v[70:71], v3 offset:51520
    v_mfma_f32_16x16x32_bf16 v[232:235], v[48:51], a[56:59], v[232:235]
    s_waitcnt lgkmcnt(4)
    buffer_load_dwordx4 a[32:35], v6, s[12:15], s66 offen offset:0 sc1
    v_mfma_f32_16x16x32_bf16 v[236:239], v[60:63], a[60:63], v[236:239]
    ds_read_b64_tr_b16 v[72:73], v3 offset:50760
    ds_read_b64_tr_b16 v[74:75], v3 offset:51016
    v_mfma_f32_16x16x32_bf16 v[236:239], v[56:59], a[56:59], v[236:239]
    s_add_u32 m0, s61, 1032
    ds_read_b64_tr_b16 v[76:77], v3 offset:51272
    ds_read_b64_tr_b16 v[78:79], v3 offset:51528
    v_mfma_f32_16x16x32_bf16 v[220:223], v[56:59], a[48:51], v[220:223]
    buffer_load_dwordx4 v2, s[8:11], s65 offen  lds
    v_mfma_f32_16x16x32_bf16 v[220:223], v[60:63], a[52:55], v[220:223]
    s_waitcnt lgkmcnt(4)
    s_add_u32 s65, s65, 2048
    v_mfma_f32_16x16x32_bf16 v[224:227], v[64:67], a[48:51], v[224:227]
    v_mfma_f32_16x16x32_bf16 v[224:227], v[68:71], a[52:55], v[224:227]
    ds_read_b64_tr_b16 v[48:49], v5 offset:50688
    ds_read_b64_tr_b16 v[50:51], v5 offset:50944
    v_mfma_f32_16x16x32_bf16 v[240:243], v[68:71], a[60:63], v[240:243]
    ds_read_b64_tr_b16 v[52:53], v5 offset:51200
    ds_read_b64_tr_b16 v[54:55], v5 offset:51456
    v_mfma_f32_16x16x32_bf16 v[240:243], v[64:67], a[56:59], v[240:243]
    s_waitcnt lgkmcnt(4)
    buffer_load_dwordx4 a[36:39], v6, s[12:15], s66 offen offset:1024 sc1
    v_mfma_f32_16x16x32_bf16 v[244:247], v[76:79], a[60:63], v[244:247]
    ds_read_b64_tr_b16 v[56:57], v5 offset:50696
    ds_read_b64_tr_b16 v[58:59], v5 offset:50952
    v_mfma_f32_16x16x32_bf16 v[244:247], v[72:75], a[56:59], v[244:247]
    s_add_u32 m0, s61, 2112
    ds_read_b64_tr_b16 v[60:61], v5 offset:51208
    ds_read_b64_tr_b16 v[62:63], v5 offset:51464
    v_mfma_f32_16x16x32_bf16 v[228:231], v[72:75], a[48:51], v[228:231]
    buffer_load_dwordx4 v2, s[8:11], s65 offen  lds
    v_mfma_f32_16x16x32_bf16 v[228:231], v[76:79], a[52:55], v[228:231]
    s_waitcnt lgkmcnt(4)
    s_add_u32 s65, s65, 2048
    v_mfma_f32_16x16x32_bf16 v[16:19], v[48:51], a[48:51], v[16:19]
    v_mfma_f32_16x16x32_bf16 v[16:19], v[52:55], a[52:55], v[16:19]
    ds_read_b64_tr_b16 v[64:65], v5 offset:50752
    ds_read_b64_tr_b16 v[66:67], v5 offset:51008
    v_mfma_f32_16x16x32_bf16 v[32:35], v[52:55], a[60:63], v[32:35]
    ds_read_b64_tr_b16 v[68:69], v5 offset:51264
    ds_read_b64_tr_b16 v[70:71], v5 offset:51520
    v_mfma_f32_16x16x32_bf16 v[32:35], v[48:51], a[56:59], v[32:35]
    s_waitcnt lgkmcnt(4)
    buffer_load_dwordx4 a[40:43], v7, s[12:15], s66 offen offset:0 sc1
    v_mfma_f32_16x16x32_bf16 v[36:39], v[60:63], a[60:63], v[36:39]
    ds_read_b64_tr_b16 v[72:73], v5 offset:50760
    ds_read_b64_tr_b16 v[74:75], v5 offset:51016
    v_mfma_f32_16x16x32_bf16 v[36:39], v[56:59], a[56:59], v[36:39]
    s_add_u32 m0, s61, 3144
    ds_read_b64_tr_b16 v[76:77], v5 offset:51272
    ds_read_b64_tr_b16 v[78:79], v5 offset:51528
    v_mfma_f32_16x16x32_bf16 v[20:23], v[56:59], a[48:51], v[20:23]
    buffer_load_dwordx4 v2, s[8:11], s65 offen  lds
    v_mfma_f32_16x16x32_bf16 v[20:23], v[60:63], a[52:55], v[20:23]
    s_waitcnt lgkmcnt(4)
    s_add_u32 s65, s65, 256000
    v_mfma_f32_16x16x32_bf16 v[24:27], v[64:67], a[48:51], v[24:27]
    v_mfma_f32_16x16x32_bf16 v[24:27], v[68:71], a[52:55], v[24:27]
    s_barrier
    ds_read_b64_tr_b16 v[48:49], v4 offset:0
    ds_read_b64_tr_b16 v[50:51], v4 offset:256
    v_mfma_f32_16x16x32_bf16 v[40:43], v[68:71], a[60:63], v[40:43]
    ds_read_b64_tr_b16 v[52:53], v4 offset:512
    ds_read_b64_tr_b16 v[54:55], v4 offset:768
    v_mfma_f32_16x16x32_bf16 v[40:43], v[64:67], a[56:59], v[40:43]
    s_waitcnt lgkmcnt(4)
    buffer_load_dwordx4 a[44:47], v7, s[12:15], s66 offen offset:1024 sc1
    v_mfma_f32_16x16x32_bf16 v[44:47], v[76:79], a[60:63], v[44:47]
    s_add_u32 s66, s66, 524288
    ds_read_b64_tr_b16 v[56:57], v4 offset:8
    ds_read_b64_tr_b16 v[58:59], v4 offset:264
    v_mfma_f32_16x16x32_bf16 v[44:47], v[72:75], a[56:59], v[44:47]
    s_add_u32 m0, s61, 16896
    ds_read_b64_tr_b16 v[60:61], v4 offset:520
    ds_read_b64_tr_b16 v[62:63], v4 offset:776
    v_mfma_f32_16x16x32_bf16 v[28:31], v[72:75], a[48:51], v[28:31]
    buffer_load_dwordx4 v2, s[8:11], s65 offen  lds
    s_mov_b32 s44, s61
    v_mfma_f32_16x16x32_bf16 v[28:31], v[76:79], a[52:55], v[28:31]
    s_waitcnt vmcnt(18) lgkmcnt(4)
    s_add_u32 s65, s65, 2048
    v_swap_b32 v3, v4
    v_swap_b32 v5, v15
    s_mov_b32 s61, s62
    s_mov_b32 s62, s44
    s_waitcnt vmcnt(8)
    v_cmp_ne_u32 vcc, s60, v254
    s_add_u32 s49, s49, 1
    s_cbranch_vccnz L_slowgate_28
L_gateback_29:
    s_add_u32 s63, s63, s64
    s_cmp_le_u32 s49, s43
    s_cbranch_scc1 L_oploop_27
    v_mfma_f32_16x16x32_bf16 v[216:219], v[48:51], a[0:3], v[216:219]
    buffer_load_dwordx4 a[48:51], v6, s[12:15], s66 offen offset:0 sc1
    v_mfma_f32_16x16x32_bf16 v[216:219], v[52:55], a[4:7], v[216:219]
    ds_read_b64_tr_b16 v[64:65], v3 offset:64
    ds_read_b64_tr_b16 v[66:67], v3 offset:320
    v_mfma_f32_16x16x32_bf16 v[232:235], v[52:55], a[12:15], v[232:235]
    ds_read_b64_tr_b16 v[68:69], v3 offset:576
    ds_read_b64_tr_b16 v[70:71], v3 offset:832
    v_mfma_f32_16x16x32_bf16 v[232:235], v[48:51], a[8:11], v[232:235]
    s_waitcnt lgkmcnt(4)
    buffer_load_dwordx4 a[52:55], v6, s[12:15], s66 offen offset:1024 sc1
    v_mfma_f32_16x16x32_bf16 v[236:239], v[60:63], a[12:15], v[236:239]
    ds_read_b64_tr_b16 v[72:73], v3 offset:72
    ds_read_b64_tr_b16 v[74:75], v3 offset:328
    v_mfma_f32_16x16x32_bf16 v[236:239], v[56:59], a[8:11], v[236:239]
    s_add_u32 m0, s62, 17928
    ds_read_b64_tr_b16 v[76:77], v3 offset:584
    ds_read_b64_tr_b16 v[78:79], v3 offset:840
    v_mfma_f32_16x16x32_bf16 v[220:223], v[56:59], a[0:3], v[220:223]
    buffer_load_dwordx4 v2, s[8:11], s65 offen  lds
    v_mfma_f32_16x16x32_bf16 v[220:223], v[60:63], a[4:7], v[220:223]
    s_waitcnt lgkmcnt(4)
    s_add_u32 s65, s65, 2048
    v_mfma_f32_16x16x32_bf16 v[224:227], v[64:67], a[0:3], v[224:227]
    buffer_load_dwordx4 a[56:59], v7, s[12:15], s66 offen offset:0 sc1
    v_mfma_f32_16x16x32_bf16 v[224:227], v[68:71], a[4:7], v[224:227]
    ds_read_b64_tr_b16 v[48:49], v3 offset:16896
    ds_read_b64_tr_b16 v[50:51], v3 offset:17152
    v_mfma_f32_16x16x32_bf16 v[240:243], v[68:71], a[12:15], v[240:243]
    ds_read_b64_tr_b16 v[52:53], v3 offset:17408
    ds_read_b64_tr_b16 v[54:55], v3 offset:17664
    v_mfma_f32_16x16x32_bf16 v[240:243], v[64:67], a[8:11], v[240:243]
    s_waitcnt lgkmcnt(4)
    buffer_load_dwordx4 a[60:63], v7, s[12:15], s66 offen offset:1024 sc1
    v_mfma_f32_16x16x32_bf16 v[244:247], v[76:79], a[12:15], v[244:247]
    s_add_u32 s66, s66, s41
    ds_read_b64_tr_b16 v[56:57], v3 offset:16904
    ds_read_b64_tr_b16 v[58:59], v3 offset:17160
    v_mfma_f32_16x16x32_bf16 v[244:247], v[72:75], a[8:11], v[244:247]
    s_add_u32 m0, s62, 19008
    ds_read_b64_tr_b16 v[60:61], v3 offset:17416
    ds_read_b64_tr_b16 v[62:63], v3 offset:17672
    v_mfma_f32_16x16x32_bf16 v[228:231], v[72:75], a[0:3], v[228:231]
    buffer_load_dwordx4 v2, s[8:11], s65 offen  lds
    v_mfma_f32_16x16x32_bf16 v[228:231], v[76:79], a[4:7], v[228:231]
    s_waitcnt vmcnt(16) lgkmcnt(4)
    s_add_u32 s65, s65, 2048
    v_mfma_f32_16x16x32_bf16 v[216:219], v[48:51], a[16:19], v[216:219]
    buffer_load_dwordx4 a[64:67], v6, s[12:15], s66 offen offset:0 sc1
    v_mfma_f32_16x16x32_bf16 v[216:219], v[52:55], a[20:23], v[216:219]
    ds_read_b64_tr_b16 v[64:65], v3 offset:16960
    ds_read_b64_tr_b16 v[66:67], v3 offset:17216
    v_mfma_f32_16x16x32_bf16 v[232:235], v[52:55], a[28:31], v[232:235]
    ds_read_b64_tr_b16 v[68:69], v3 offset:17472
    ds_read_b64_tr_b16 v[70:71], v3 offset:17728
    v_mfma_f32_16x16x32_bf16 v[232:235], v[48:51], a[24:27], v[232:235]
    s_waitcnt lgkmcnt(4)
    buffer_load_dwordx4 a[68:71], v6, s[12:15], s66 offen offset:1024 sc1
    v_mfma_f32_16x16x32_bf16 v[236:239], v[60:63], a[28:31], v[236:239]
    ds_read_b64_tr_b16 v[72:73], v3 offset:16968
    ds_read_b64_tr_b16 v[74:75], v3 offset:17224
    v_mfma_f32_16x16x32_bf16 v[236:239], v[56:59], a[24:27], v[236:239]
    s_add_u32 m0, s62, 20040
    ds_read_b64_tr_b16 v[76:77], v3 offset:17480
    ds_read_b64_tr_b16 v[78:79], v3 offset:17736
    v_mfma_f32_16x16x32_bf16 v[220:223], v[56:59], a[16:19], v[220:223]
    buffer_load_dwordx4 v2, s[8:11], s65 offen  lds
    v_mfma_f32_16x16x32_bf16 v[220:223], v[60:63], a[20:23], v[220:223]
    s_waitcnt lgkmcnt(4)
    s_add_u32 s65, s65, 256000
    v_mfma_f32_16x16x32_bf16 v[224:227], v[64:67], a[16:19], v[224:227]
    buffer_load_dwordx4 a[72:75], v7, s[12:15], s66 offen offset:0 sc1
    v_mfma_f32_16x16x32_bf16 v[224:227], v[68:71], a[20:23], v[224:227]
    s_barrier
    ds_read_b64_tr_b16 v[48:49], v3 offset:33792
    ds_read_b64_tr_b16 v[50:51], v3 offset:34048
    v_mfma_f32_16x16x32_bf16 v[240:243], v[68:71], a[28:31], v[240:243]
    ds_read_b64_tr_b16 v[52:53], v3 offset:34304
    ds_read_b64_tr_b16 v[54:55], v3 offset:34560
    v_mfma_f32_16x16x32_bf16 v[240:243], v[64:67], a[24:27], v[240:243]
    s_waitcnt lgkmcnt(4)
    buffer_load_dwordx4 a[76:79], v7, s[12:15], s66 offen offset:1024 sc1
    v_mfma_f32_16x16x32_bf16 v[244:247], v[76:79], a[28:31], v[244:247]
    s_add_u32 s66, s66, 524288
    ds_read_b64_tr_b16 v[56:57], v3 offset:33800
    ds_read_b64_tr_b16 v[58:59], v3 offset:34056
    v_mfma_f32_16x16x32_bf16 v[244:247], v[72:75], a[24:27], v[244:247]
    ds_read_b64_tr_b16 v[60:61], v3 offset:34312
    ds_read_b64_tr_b16 v[62:63], v3 offset:34568
    v_mfma_f32_16x16x32_bf16 v[228:231], v[72:75], a[16:19], v[228:231]
    buffer_load_dwordx4 a[80:83], v6, s[12:15], s66 offen offset:0 sc1
    v_mfma_f32_16x16x32_bf16 v[228:231], v[76:79], a[20:23], v[228:231]
    s_waitcnt vmcnt(13) lgkmcnt(4)
    v_mfma_f32_16x16x32_bf16 v[216:219], v[48:51], a[32:35], v[216:219]
    buffer_load_dwordx4 a[84:87], v6, s[12:15], s66 offen offset:1024 sc1
    v_mfma_f32_16x16x32_bf16 v[216:219], v[52:55], a[36:39], v[216:219]
    ds_read_b64_tr_b16 v[64:65], v3 offset:33856
    ds_read_b64_tr_b16 v[66:67], v3 offset:34112
    v_mfma_f32_16x16x32_bf16 v[232:235], v[52:55], a[44:47], v[232:235]
    ds_read_b64_tr_b16 v[68:69], v3 offset:34368
    ds_read_b64_tr_b16 v[70:71], v3 offset:34624
    v_mfma_f32_16x16x32_bf16 v[232:235], v[48:51], a[40:43], v[232:235]
    s_waitcnt lgkmcnt(4)
    buffer_load_dwordx4 a[88:91], v7, s[12:15], s66 offen offset:0 sc1
    v_mfma_f32_16x16x32_bf16 v[236:239], v[60:63], a[44:47], v[236:239]
    ds_read_b64_tr_b16 v[72:73], v3 offset:33864
    ds_read_b64_tr_b16 v[74:75], v3 offset:34120
    v_mfma_f32_16x16x32_bf16 v[236:239], v[56:59], a[40:43], v[236:239]
    ds_read_b64_tr_b16 v[76:77], v3 offset:34376
    ds_read_b64_tr_b16 v[78:79], v3 offset:34632
    v_mfma_f32_16x16x32_bf16 v[220:223], v[56:59], a[32:35], v[220:223]
    buffer_load_dwordx4 a[92:95], v7, s[12:15], s66 offen offset:1024 sc1
    v_mfma_f32_16x16x32_bf16 v[220:223], v[60:63], a[36:39], v[220:223]
    s_waitcnt lgkmcnt(4)
    s_add_u32 s66, s66, 524288
    global_load_dword v249, v[250:251], off
    v_mfma_f32_16x16x32_bf16 v[224:227], v[64:67], a[32:35], v[224:227]
    v_mfma_f32_16x16x32_bf16 v[224:227], v[68:71], a[36:39], v[224:227]
    ds_read_b64_tr_b16 v[48:49], v3 offset:50688
    ds_read_b64_tr_b16 v[50:51], v3 offset:50944
    v_mfma_f32_16x16x32_bf16 v[240:243], v[68:71], a[44:47], v[240:243]
    ds_read_b64_tr_b16 v[52:53], v3 offset:51200
    ds_read_b64_tr_b16 v[54:55], v3 offset:51456
    v_mfma_f32_16x16x32_bf16 v[240:243], v[64:67], a[40:43], v[240:243]
    s_waitcnt lgkmcnt(4)
    v_mfma_f32_16x16x32_bf16 v[244:247], v[76:79], a[44:47], v[244:247]
    ds_read_b64_tr_b16 v[56:57], v3 offset:50696
    ds_read_b64_tr_b16 v[58:59], v3 offset:50952
    v_mfma_f32_16x16x32_bf16 v[244:247], v[72:75], a[40:43], v[244:247]
    ds_read_b64_tr_b16 v[60:61], v3 offset:51208
    ds_read_b64_tr_b16 v[62:63], v3 offset:51464
    v_mfma_f32_16x16x32_bf16 v[228:231], v[72:75], a[32:35], v[228:231]
    v_mfma_f32_16x16x32_bf16 v[228:231], v[76:79], a[36:39], v[228:231]
    s_waitcnt vmcnt(11) lgkmcnt(4)
    v_mfma_f32_16x16x32_bf16 v[216:219], v[48:51], a[48:51], v[216:219]
    v_mfma_f32_16x16x32_bf16 v[216:219], v[52:55], a[52:55], v[216:219]
    ds_read_b64_tr_b16 v[64:65], v3 offset:50752
    ds_read_b64_tr_b16 v[66:67], v3 offset:51008
    v_mfma_f32_16x16x32_bf16 v[232:235], v[52:55], a[60:63], v[232:235]
    ds_read_b64_tr_b16 v[68:69], v3 offset:51264
    ds_read_b64_tr_b16 v[70:71], v3 offset:51520
    v_mfma_f32_16x16x32_bf16 v[232:235], v[48:51], a[56:59], v[232:235]
    s_waitcnt lgkmcnt(4)
    v_mfma_f32_16x16x32_bf16 v[236:239], v[60:63], a[60:63], v[236:239]
    ds_read_b64_tr_b16 v[72:73], v3 offset:50760
    ds_read_b64_tr_b16 v[74:75], v3 offset:51016
    v_mfma_f32_16x16x32_bf16 v[236:239], v[56:59], a[56:59], v[236:239]
    ds_read_b64_tr_b16 v[76:77], v3 offset:51272
    ds_read_b64_tr_b16 v[78:79], v3 offset:51528
    v_mfma_f32_16x16x32_bf16 v[220:223], v[56:59], a[48:51], v[220:223]
    v_mfma_f32_16x16x32_bf16 v[220:223], v[60:63], a[52:55], v[220:223]
    s_waitcnt lgkmcnt(4)
    v_mfma_f32_16x16x32_bf16 v[224:227], v[64:67], a[48:51], v[224:227]
    v_mfma_f32_16x16x32_bf16 v[224:227], v[68:71], a[52:55], v[224:227]
    s_barrier
    ds_read_b64_tr_b16 v[48:49], v4 offset:0
    ds_read_b64_tr_b16 v[50:51], v4 offset:256
    v_mfma_f32_16x16x32_bf16 v[240:243], v[68:71], a[60:63], v[240:243]
    ds_read_b64_tr_b16 v[52:53], v4 offset:512
    ds_read_b64_tr_b16 v[54:55], v4 offset:768
    v_mfma_f32_16x16x32_bf16 v[240:243], v[64:67], a[56:59], v[240:243]
    s_waitcnt lgkmcnt(4)
    v_mfma_f32_16x16x32_bf16 v[244:247], v[76:79], a[60:63], v[244:247]
    ds_read_b64_tr_b16 v[56:57], v4 offset:8
    ds_read_b64_tr_b16 v[58:59], v4 offset:264
    v_mfma_f32_16x16x32_bf16 v[244:247], v[72:75], a[56:59], v[244:247]
    ds_read_b64_tr_b16 v[60:61], v4 offset:520
    ds_read_b64_tr_b16 v[62:63], v4 offset:776
    v_mfma_f32_16x16x32_bf16 v[228:231], v[72:75], a[48:51], v[228:231]
    v_mfma_f32_16x16x32_bf16 v[228:231], v[76:79], a[52:55], v[228:231]
    s_waitcnt vmcnt(5) lgkmcnt(4)
    v_mfma_f32_16x16x32_bf16 v[216:219], v[48:51], a[64:67], v[216:219]
    v_mfma_f32_16x16x32_bf16 v[216:219], v[52:55], a[68:71], v[216:219]
    ds_read_b64_tr_b16 v[64:65], v4 offset:64
    ds_read_b64_tr_b16 v[66:67], v4 offset:320
    v_mfma_f32_16x16x32_bf16 v[232:235], v[52:55], a[76:79], v[232:235]
    ds_read_b64_tr_b16 v[68:69], v4 offset:576
    ds_read_b64_tr_b16 v[70:71], v4 offset:832
    v_mfma_f32_16x16x32_bf16 v[232:235], v[48:51], a[72:75], v[232:235]
    s_waitcnt lgkmcnt(4)
    v_mfma_f32_16x16x32_bf16 v[236:239], v[60:63], a[76:79], v[236:239]
    ds_read_b64_tr_b16 v[72:73], v4 offset:72
    ds_read_b64_tr_b16 v[74:75], v4 offset:328
    v_mfma_f32_16x16x32_bf16 v[236:239], v[56:59], a[72:75], v[236:239]
    ds_read_b64_tr_b16 v[76:77], v4 offset:584
    ds_read_b64_tr_b16 v[78:79], v4 offset:840
    v_mfma_f32_16x16x32_bf16 v[220:223], v[56:59], a[64:67], v[220:223]
    v_mfma_f32_16x16x32_bf16 v[220:223], v[60:63], a[68:71], v[220:223]
    s_waitcnt lgkmcnt(4)
    v_mfma_f32_16x16x32_bf16 v[224:227], v[64:67], a[64:67], v[224:227]
    v_mfma_f32_16x16x32_bf16 v[224:227], v[68:71], a[68:71], v[224:227]
    s_barrier
    ds_read_b64_tr_b16 v[48:49], v4 offset:16896
    ds_read_b64_tr_b16 v[50:51], v4 offset:17152
    v_mfma_f32_16x16x32_bf16 v[240:243], v[68:71], a[76:79], v[240:243]
    ds_read_b64_tr_b16 v[52:53], v4 offset:17408
    ds_read_b64_tr_b16 v[54:55], v4 offset:17664
    v_mfma_f32_16x16x32_bf16 v[240:243], v[64:67], a[72:75], v[240:243]
    s_waitcnt lgkmcnt(4)
    v_mfma_f32_16x16x32_bf16 v[244:247], v[76:79], a[76:79], v[244:247]
    ds_read_b64_tr_b16 v[56:57], v4 offset:16904
    ds_read_b64_tr_b16 v[58:59], v4 offset:17160
    v_mfma_f32_16x16x32_bf16 v[244:247], v[72:75], a[72:75], v[244:247]
    ds_read_b64_tr_b16 v[60:61], v4 offset:17416
    ds_read_b64_tr_b16 v[62:63], v4 offset:17672
    v_mfma_f32_16x16x32_bf16 v[228:231], v[72:75], a[64:67], v[228:231]
    v_mfma_f32_16x16x32_bf16 v[228:231], v[76:79], a[68:71], v[228:231]
    s_waitcnt vmcnt(1) lgkmcnt(4)
    v_mfma_f32_16x16x32_bf16 v[216:219], v[48:51], a[80:83], v[216:219]
    v_mfma_f32_16x16x32_bf16 v[216:219], v[52:55], a[84:87], v[216:219]
    ds_read_b64_tr_b16 v[64:65], v4 offset:16960
    ds_read_b64_tr_b16 v[66:67], v4 offset:17216
    v_mfma_f32_16x16x32_bf16 v[232:235], v[52:55], a[92:95], v[232:235]
    ds_read_b64_tr_b16 v[68:69], v4 offset:17472
    ds_read_b64_tr_b16 v[70:71], v4 offset:17728
    v_mfma_f32_16x16x32_bf16 v[232:235], v[48:51], a[88:91], v[232:235]
    s_waitcnt lgkmcnt(4)
    v_mfma_f32_16x16x32_bf16 v[236:239], v[60:63], a[92:95], v[236:239]
    ds_read_b64_tr_b16 v[72:73], v4 offset:16968
    ds_read_b64_tr_b16 v[74:75], v4 offset:17224
    v_mfma_f32_16x16x32_bf16 v[236:239], v[56:59], a[88:91], v[236:239]
    ds_read_b64_tr_b16 v[76:77], v4 offset:17480
    ds_read_b64_tr_b16 v[78:79], v4 offset:17736
    v_mfma_f32_16x16x32_bf16 v[220:223], v[56:59], a[80:83], v[220:223]
    v_mfma_f32_16x16x32_bf16 v[220:223], v[60:63], a[84:87], v[220:223]
    s_waitcnt lgkmcnt(4)
    v_mfma_f32_16x16x32_bf16 v[224:227], v[64:67], a[80:83], v[224:227]
    v_mfma_f32_16x16x32_bf16 v[224:227], v[68:71], a[84:87], v[224:227]
    ds_read_b64_tr_b16 v[48:49], v5 offset:0
    ds_read_b64_tr_b16 v[50:51], v5 offset:256
    v_mfma_f32_16x16x32_bf16 v[240:243], v[68:71], a[92:95], v[240:243]
    ds_read_b64_tr_b16 v[52:53], v5 offset:512
    ds_read_b64_tr_b16 v[54:55], v5 offset:768
    v_mfma_f32_16x16x32_bf16 v[240:243], v[64:67], a[88:91], v[240:243]
    s_waitcnt lgkmcnt(4)
    v_mfma_f32_16x16x32_bf16 v[244:247], v[76:79], a[92:95], v[244:247]
    ds_read_b64_tr_b16 v[56:57], v5 offset:8
    ds_read_b64_tr_b16 v[58:59], v5 offset:264
    v_mfma_f32_16x16x32_bf16 v[244:247], v[72:75], a[88:91], v[244:247]
    ds_read_b64_tr_b16 v[60:61], v5 offset:520
    ds_read_b64_tr_b16 v[62:63], v5 offset:776
    v_mfma_f32_16x16x32_bf16 v[228:231], v[72:75], a[80:83], v[228:231]
    v_mfma_f32_16x16x32_bf16 v[228:231], v[76:79], a[84:87], v[228:231]
    s_waitcnt lgkmcnt(4)
    v_mfma_f32_16x16x32_bf16 v[16:19], v[48:51], a[0:3], v[16:19]
    s_xor_b32 s44, s67, 32768
    s_lshl_b32 s45, s3, 12
    s_add_u32 s44, s44, s45
    s_add_u32 s46, s67, s45
    v_cvt_pk_bf16_f32 v192, v216, v217
    v_cvt_pk_bf16_f32 v193, v218, v219
    v_cvt_pk_bf16_f32 v194, v220, v221
    v_cvt_pk_bf16_f32 v195, v222, v223
    v_mfma_f32_16x16x32_bf16 v[16:19], v[52:55], a[4:7], v[16:19]
    ds_read_b64_tr_b16 v[64:65], v5 offset:64
    ds_read_b64_tr_b16 v[66:67], v5 offset:320
    v_mfma_f32_16x16x32_bf16 v[32:35], v[52:55], a[12:15], v[32:35]
    ds_read_b64_tr_b16 v[68:69], v5 offset:576
    ds_read_b64_tr_b16 v[70:71], v5 offset:832
    v_mfma_f32_16x16x32_bf16 v[32:35], v[48:51], a[8:11], v[32:35]
    s_waitcnt lgkmcnt(4)
    buffer_store_dwordx4 v[192:195], v1, s[4:7], s44 offen offset:0 sc1
    v_cvt_pk_bf16_f32 v200, v232, v233
    v_cvt_pk_bf16_f32 v201, v234, v235
    v_cvt_pk_bf16_f32 v202, v236, v237
    v_cvt_pk_bf16_f32 v203, v238, v239
    v_mfma_f32_16x16x32_bf16 v[36:39], v[60:63], a[12:15], v[36:39]
    ds_read_b64_tr_b16 v[72:73], v5 offset:72
    ds_read_b64_tr_b16 v[74:75], v5 offset:328
    v_mfma_f32_16x16x32_bf16 v[36:39], v[56:59], a[8:11], v[36:39]
    ds_read_b64_tr_b16 v[76:77], v5 offset:584
    ds_read_b64_tr_b16 v[78:79], v5 offset:840
    v_mfma_f32_16x16x32_bf16 v[20:23], v[56:59], a[0:3], v[20:23]
    buffer_store_dwordx4 v[200:203], v1, s[4:7], s44 offen offset:2048 sc1
    v_cvt_pk_bf16_f32 v196, v224, v225
    v_cvt_pk_bf16_f32 v197, v226, v227
    v_cvt_pk_bf16_f32 v198, v228, v229
    v_cvt_pk_bf16_f32 v199, v230, v231
    v_mfma_f32_16x16x32_bf16 v[20:23], v[60:63], a[4:7], v[20:23]
    s_waitcnt lgkmcnt(4)
    buffer_store_dwordx4 v[196:199], v1, s[4:7], s44 offen offset:1024 sc1
    v_cvt_pk_bf16_f32 v204, v240, v241
    v_cvt_pk_bf16_f32 v205, v242, v243
    v_cvt_pk_bf16_f32 v206, v244, v245
    v_cvt_pk_bf16_f32 v207, v246, v247
    v_mfma_f32_16x16x32_bf16 v[24:27], v[64:67], a[0:3], v[24:27]
    buffer_store_dwordx4 v[204:207], v1, s[4:7], s44 offen offset:3072 sc1
    v_mfma_f32_16x16x32_bf16 v[24:27], v[68:71], a[4:7], v[24:27]
    ds_read_b64_tr_b16 v[48:49], v5 offset:16896
    ds_read_b64_tr_b16 v[50:51], v5 offset:17152
    v_mfma_f32_16x16x32_bf16 v[40:43], v[68:71], a[12:15], v[40:43]
    ds_read_b64_tr_b16 v[52:53], v5 offset:17408
    ds_read_b64_tr_b16 v[54:55], v5 offset:17664
    v_mfma_f32_16x16x32_bf16 v[40:43], v[64:67], a[8:11], v[40:43]
    s_waitcnt lgkmcnt(4)
    v_mfma_f32_16x16x32_bf16 v[44:47], v[76:79], a[12:15], v[44:47]
    ds_read_b64_tr_b16 v[56:57], v5 offset:16904
    ds_read_b64_tr_b16 v[58:59], v5 offset:17160
    v_mfma_f32_16x16x32_bf16 v[44:47], v[72:75], a[8:11], v[44:47]
    ds_read_b64_tr_b16 v[60:61], v5 offset:17416
    ds_read_b64_tr_b16 v[62:63], v5 offset:17672
    v_mfma_f32_16x16x32_bf16 v[28:31], v[72:75], a[0:3], v[28:31]
    v_mfma_f32_16x16x32_bf16 v[28:31], v[76:79], a[4:7], v[28:31]
    s_waitcnt lgkmcnt(4)
    v_mfma_f32_16x16x32_bf16 v[16:19], v[48:51], a[16:19], v[16:19]
    v_mfma_f32_16x16x32_bf16 v[16:19], v[52:55], a[20:23], v[16:19]
    ds_read_b64_tr_b16 v[64:65], v5 offset:16960
    ds_read_b64_tr_b16 v[66:67], v5 offset:17216
    v_mfma_f32_16x16x32_bf16 v[32:35], v[52:55], a[28:31], v[32:35]
    ds_read_b64_tr_b16 v[68:69], v5 offset:17472
    ds_read_b64_tr_b16 v[70:71], v5 offset:17728
    v_mfma_f32_16x16x32_bf16 v[32:35], v[48:51], a[24:27], v[32:35]
    s_waitcnt lgkmcnt(4)
    v_mfma_f32_16x16x32_bf16 v[36:39], v[60:63], a[28:31], v[36:39]
    ds_read_b64_tr_b16 v[72:73], v5 offset:16968
    ds_read_b64_tr_b16 v[74:75], v5 offset:17224
    v_mfma_f32_16x16x32_bf16 v[36:39], v[56:59], a[24:27], v[36:39]
    ds_read_b64_tr_b16 v[76:77], v5 offset:17480
    ds_read_b64_tr_b16 v[78:79], v5 offset:17736
    v_mfma_f32_16x16x32_bf16 v[20:23], v[56:59], a[16:19], v[20:23]
    v_mfma_f32_16x16x32_bf16 v[20:23], v[60:63], a[20:23], v[20:23]
    s_waitcnt lgkmcnt(4)
    v_mfma_f32_16x16x32_bf16 v[24:27], v[64:67], a[16:19], v[24:27]
    v_mfma_f32_16x16x32_bf16 v[24:27], v[68:71], a[20:23], v[24:27]
    ds_read_b64_tr_b16 v[48:49], v5 offset:33792
    ds_read_b64_tr_b16 v[50:51], v5 offset:34048
    v_mfma_f32_16x16x32_bf16 v[40:43], v[68:71], a[28:31], v[40:43]
    ds_read_b64_tr_b16 v[52:53], v5 offset:34304
    ds_read_b64_tr_b16 v[54:55], v5 offset:34560
    v_mfma_f32_16x16x32_bf16 v[40:43], v[64:67], a[24:27], v[40:43]
    s_waitcnt lgkmcnt(4)
    v_mfma_f32_16x16x32_bf16 v[44:47], v[76:79], a[28:31], v[44:47]
    ds_read_b64_tr_b16 v[56:57], v5 offset:33800
    ds_read_b64_tr_b16 v[58:59], v5 offset:34056
    v_mfma_f32_16x16x32_bf16 v[44:47], v[72:75], a[24:27], v[44:47]
    ds_read_b64_tr_b16 v[60:61], v5 offset:34312
    ds_read_b64_tr_b16 v[62:63], v5 offset:34568
    v_mfma_f32_16x16x32_bf16 v[28:31], v[72:75], a[16:19], v[28:31]
    v_mfma_f32_16x16x32_bf16 v[28:31], v[76:79], a[20:23], v[28:31]
    s_waitcnt lgkmcnt(4)
    v_mfma_f32_16x16x32_bf16 v[16:19], v[48:51], a[32:35], v[16:19]
    v_mfma_f32_16x16x32_bf16 v[16:19], v[52:55], a[36:39], v[16:19]
    ds_read_b64_tr_b16 v[64:65], v5 offset:33856
    ds_read_b64_tr_b16 v[66:67], v5 offset:34112
    v_mfma_f32_16x16x32_bf16 v[32:35], v[52:55], a[44:47], v[32:35]
    ds_read_b64_tr_b16 v[68:69], v5 offset:34368
    ds_read_b64_tr_b16 v[70:71], v5 offset:34624
    v_mfma_f32_16x16x32_bf16 v[32:35], v[48:51], a[40:43], v[32:35]
    s_waitcnt lgkmcnt(4)
    v_mfma_f32_16x16x32_bf16 v[36:39], v[60:63], a[44:47], v[36:39]
    ds_read_b64_tr_b16 v[72:73], v5 offset:33864
    ds_read_b64_tr_b16 v[74:75], v5 offset:34120
    v_mfma_f32_16x16x32_bf16 v[36:39], v[56:59], a[40:43], v[36:39]
    ds_read_b64_tr_b16 v[76:77], v5 offset:34376
    ds_read_b64_tr_b16 v[78:79], v5 offset:34632
    v_mfma_f32_16x16x32_bf16 v[20:23], v[56:59], a[32:35], v[20:23]
    v_mfma_f32_16x16x32_bf16 v[20:23], v[60:63], a[36:39], v[20:23]
    s_waitcnt lgkmcnt(4)
    v_mfma_f32_16x16x32_bf16 v[24:27], v[64:67], a[32:35], v[24:27]
    v_mfma_f32_16x16x32_bf16 v[24:27], v[68:71], a[36:39], v[24:27]
    ds_read_b64_tr_b16 v[48:49], v5 offset:50688
    ds_read_b64_tr_b16 v[50:51], v5 offset:50944
    v_mfma_f32_16x16x32_bf16 v[40:43], v[68:71], a[44:47], v[40:43]
    ds_read_b64_tr_b16 v[52:53], v5 offset:51200
    ds_read_b64_tr_b16 v[54:55], v5 offset:51456
    v_mfma_f32_16x16x32_bf16 v[40:43], v[64:67], a[40:43], v[40:43]
    s_waitcnt lgkmcnt(4)
    v_mfma_f32_16x16x32_bf16 v[44:47], v[76:79], a[44:47], v[44:47]
    ds_read_b64_tr_b16 v[56:57], v5 offset:50696
    ds_read_b64_tr_b16 v[58:59], v5 offset:50952
    v_mfma_f32_16x16x32_bf16 v[44:47], v[72:75], a[40:43], v[44:47]
    ds_read_b64_tr_b16 v[60:61], v5 offset:51208
    ds_read_b64_tr_b16 v[62:63], v5 offset:51464
    v_mfma_f32_16x16x32_bf16 v[28:31], v[72:75], a[32:35], v[28:31]
    v_mfma_f32_16x16x32_bf16 v[28:31], v[76:79], a[36:39], v[28:31]
    s_waitcnt lgkmcnt(4)
    v_mfma_f32_16x16x32_bf16 v[16:19], v[48:51], a[48:51], v[16:19]
    v_mfma_f32_16x16x32_bf16 v[16:19], v[52:55], a[52:55], v[16:19]
    ds_read_b64_tr_b16 v[64:65], v5 offset:50752
    ds_read_b64_tr_b16 v[66:67], v5 offset:51008
    v_mfma_f32_16x16x32_bf16 v[32:35], v[52:55], a[60:63], v[32:35]
    ds_read_b64_tr_b16 v[68:69], v5 offset:51264
    ds_read_b64_tr_b16 v[70:71], v5 offset:51520
    v_mfma_f32_16x16x32_bf16 v[32:35], v[48:51], a[56:59], v[32:35]
    s_waitcnt lgkmcnt(4)
    v_mfma_f32_16x16x32_bf16 v[36:39], v[60:63], a[60:63], v[36:39]
    ds_read_b64_tr_b16 v[72:73], v5 offset:50760
    ds_read_b64_tr_b16 v[74:75], v5 offset:51016
    v_mfma_f32_16x16x32_bf16 v[36:39], v[56:59], a[56:59], v[36:39]
    ds_read_b64_tr_b16 v[76:77], v5 offset:51272
    ds_read_b64_tr_b16 v[78:79], v5 offset:51528
    v_mfma_f32_16x16x32_bf16 v[20:23], v[56:59], a[48:51], v[20:23]
    v_mfma_f32_16x16x32_bf16 v[20:23], v[60:63], a[52:55], v[20:23]
    s_waitcnt lgkmcnt(4)
    v_mfma_f32_16x16x32_bf16 v[24:27], v[64:67], a[48:51], v[24:27]
    v_mfma_f32_16x16x32_bf16 v[24:27], v[68:71], a[52:55], v[24:27]
    ds_read_b64_tr_b16 v[48:49], v15 offset:0
    ds_read_b64_tr_b16 v[50:51], v15 offset:256
    v_mfma_f32_16x16x32_bf16 v[40:43], v[68:71], a[60:63], v[40:43]
    ds_read_b64_tr_b16 v[52:53], v15 offset:512
    ds_read_b64_tr_b16 v[54:55], v15 offset:768
    v_mfma_f32_16x16x32_bf16 v[40:43], v[64:67], a[56:59], v[40:43]
    s_waitcnt lgkmcnt(4)
    v_mfma_f32_16x16x32_bf16 v[44:47], v[76:79], a[60:63], v[44:47]
    ds_read_b64_tr_b16 v[56:57], v15 offset:8
    ds_read_b64_tr_b16 v[58:59], v15 offset:264
    v_mfma_f32_16x16x32_bf16 v[44:47], v[72:75], a[56:59], v[44:47]
    ds_read_b64_tr_b16 v[60:61], v15 offset:520
    ds_read_b64_tr_b16 v[62:63], v15 offset:776
    v_mfma_f32_16x16x32_bf16 v[28:31], v[72:75], a[48:51], v[28:31]
    v_mfma_f32_16x16x32_bf16 v[28:31], v[76:79], a[52:55], v[28:31]
    s_waitcnt lgkmcnt(4)
    v_mfma_f32_16x16x32_bf16 v[16:19], v[48:51], a[64:67], v[16:19]
    v_mfma_f32_16x16x32_bf16 v[16:19], v[52:55], a[68:71], v[16:19]
    ds_read_b64_tr_b16 v[64:65], v15 offset:64
    ds_read_b64_tr_b16 v[66:67], v15 offset:320
    v_mfma_f32_16x16x32_bf16 v[32:35], v[52:55], a[76:79], v[32:35]
    ds_read_b64_tr_b16 v[68:69], v15 offset:576
    ds_read_b64_tr_b16 v[70:71], v15 offset:832
    v_mfma_f32_16x16x32_bf16 v[32:35], v[48:51], a[72:75], v[32:35]
    s_waitcnt lgkmcnt(4)
    v_mfma_f32_16x16x32_bf16 v[36:39], v[60:63], a[76:79], v[36:39]
    ds_read_b64_tr_b16 v[72:73], v15 offset:72
    ds_read_b64_tr_b16 v[74:75], v15 offset:328
    v_mfma_f32_16x16x32_bf16 v[36:39], v[56:59], a[72:75], v[36:39]
    ds_read_b64_tr_b16 v[76:77], v15 offset:584
    ds_read_b64_tr_b16 v[78:79], v15 offset:840
    v_mfma_f32_16x16x32_bf16 v[20:23], v[56:59], a[64:67], v[20:23]
    v_mfma_f32_16x16x32_bf16 v[20:23], v[60:63], a[68:71], v[20:23]
    s_waitcnt lgkmcnt(4)
    v_mfma_f32_16x16x32_bf16 v[24:27], v[64:67], a[64:67], v[24:27]
    buffer_load_dwordx4 v[216:219], v1, s[4:7], s46 offen offset:0 sc1
    v_mfma_f32_16x16x32_bf16 v[24:27], v[68:71], a[68:71], v[24:27]
    ds_read_b64_tr_b16 v[48:49], v15 offset:16896
    ds_read_b64_tr_b16 v[50:51], v15 offset:17152
    v_mfma_f32_16x16x32_bf16 v[40:43], v[68:71], a[76:79], v[40:43]
    ds_read_b64_tr_b16 v[52:53], v15 offset:17408
    ds_read_b64_tr_b16 v[54:55], v15 offset:17664
    v_mfma_f32_16x16x32_bf16 v[40:43], v[64:67], a[72:75], v[40:43]
    s_waitcnt lgkmcnt(4)
    buffer_load_dwordx4 v[220:223], v1, s[4:7], s46 offen offset:1024 sc1
    v_mfma_f32_16x16x32_bf16 v[44:47], v[76:79], a[76:79], v[44:47]
    ds_read_b64_tr_b16 v[56:57], v15 offset:16904
    ds_read_b64_tr_b16 v[58:59], v15 offset:17160
    v_mfma_f32_16x16x32_bf16 v[44:47], v[72:75], a[72:75], v[44:47]
    ds_read_b64_tr_b16 v[60:61], v15 offset:17416
    ds_read_b64_tr_b16 v[62:63], v15 offset:17672
    v_mfma_f32_16x16x32_bf16 v[28:31], v[72:75], a[64:67], v[28:31]
    buffer_load_dwordx4 v[224:227], v1, s[4:7], s46 offen offset:2048 sc1
    v_mfma_f32_16x16x32_bf16 v[28:31], v[76:79], a[68:71], v[28:31]
    s_waitcnt lgkmcnt(4)
    v_mfma_f32_16x16x32_bf16 v[16:19], v[48:51], a[80:83], v[16:19]
    buffer_load_dwordx4 v[228:231], v1, s[4:7], s46 offen offset:3072 sc1
    v_mfma_f32_16x16x32_bf16 v[16:19], v[52:55], a[84:87], v[16:19]
    ds_read_b64_tr_b16 v[64:65], v15 offset:16960
    ds_read_b64_tr_b16 v[66:67], v15 offset:17216
    v_mfma_f32_16x16x32_bf16 v[32:35], v[52:55], a[92:95], v[32:35]
    ds_read_b64_tr_b16 v[68:69], v15 offset:17472
    ds_read_b64_tr_b16 v[70:71], v15 offset:17728
    v_mfma_f32_16x16x32_bf16 v[32:35], v[48:51], a[88:91], v[32:35]
    s_waitcnt lgkmcnt(4)
    v_mfma_f32_16x16x32_bf16 v[36:39], v[60:63], a[92:95], v[36:39]
    ds_read_b64_tr_b16 v[72:73], v15 offset:16968
    ds_read_b64_tr_b16 v[74:75], v15 offset:17224
    v_mfma_f32_16x16x32_bf16 v[36:39], v[56:59], a[88:91], v[36:39]
    ds_read_b64_tr_b16 v[76:77], v15 offset:17480
    ds_read_b64_tr_b16 v[78:79], v15 offset:17736
    v_mfma_f32_16x16x32_bf16 v[20:23], v[56:59], a[80:83], v[20:23]
    v_mfma_f32_16x16x32_bf16 v[20:23], v[60:63], a[84:87], v[20:23]
    s_waitcnt lgkmcnt(4)
    v_mfma_f32_16x16x32_bf16 v[24:27], v[64:67], a[80:83], v[24:27]
    v_mfma_f32_16x16x32_bf16 v[24:27], v[68:71], a[84:87], v[24:27]
    v_mfma_f32_16x16x32_bf16 v[40:43], v[68:71], a[92:95], v[40:43]
    v_mfma_f32_16x16x32_bf16 v[40:43], v[64:67], a[88:91], v[40:43]
    s_waitcnt lgkmcnt(0)
    v_mfma_f32_16x16x32_bf16 v[44:47], v[76:79], a[92:95], v[44:47]
    v_mfma_f32_16x16x32_bf16 v[44:47], v[72:75], a[88:91], v[44:47]
    v_mfma_f32_16x16x32_bf16 v[28:31], v[72:75], a[80:83], v[28:31]
    v_mfma_f32_16x16x32_bf16 v[28:31], v[76:79], a[84:87], v[28:31]
L_code_tail:
    v_lshl_add_u32 v2, v10, 14, v1
    v_lshlrev_b32 v9, 4, v12
    v_lshl_add_u32 v8, v13, 11, v9
    s_lshl_b32 s44, s57, 7
    s_lshl_b32 s45, s56, 16
    s_add_u32 s45, s45, s44
    s_add_u32 s24, s92, s45
    s_addc_u32 s25, s93, 0
    s_and_b32 s25, s25, 0xffff
    s_mov_b32 s26, 63616
    s_mov_b32 s27, 0x20000
    v_pk_fma_f32 v[80:81], v[16:17], v[112:113], v[80:81]
    v_pk_fma_f32 v[82:83], v[18:19], v[114:115], v[82:83]
    v_pk_fma_f32 v[84:85], v[20:21], v[116:117], v[84:85]
    v_pk_fma_f32 v[86:87], v[22:23], v[118:119], v[86:87]
    v_pk_fma_f32 v[88:89], v[24:25], v[120:121], v[88:89]
    v_pk_fma_f32 v[90:91], v[26:27], v[122:123], v[90:91]
    v_pk_fma_f32 v[92:93], v[28:29], v[124:125], v[92:93]
    v_pk_fma_f32 v[94:95], v[30:31], v[126:127], v[94:95]
    v_pk_fma_f32 v[96:97], v[32:33], v[112:113], v[96:97]
    v_pk_fma_f32 v[98:99], v[34:35], v[114:115], v[98:99]
    v_pk_fma_f32 v[100:101], v[36:37], v[116:117], v[100:101]
    v_pk_fma_f32 v[102:103], v[38:39], v[118:119], v[102:103]
    v_pk_fma_f32 v[104:105], v[40:41], v[120:121], v[104:105]
    v_pk_fma_f32 v[106:107], v[42:43], v[122:123], v[106:107]
    v_pk_fma_f32 v[108:109], v[44:45], v[124:125], v[108:109]
    v_pk_fma_f32 v[110:111], v[46:47], v[126:127], v[110:111]
    v_lshrrev_b32 v213, 5, v11
    v_lshl_add_u32 v212, v213, 24, v1
    v_mov_b32 v211, v14
    s_lshl_b32 s44, s3, 9
    s_add_u32 s44, s44, 24576
    s_add_u32 s45, s44, s67
    s_mov_b32 s48, 0
    s_waitcnt vmcnt(0)
    s_branch L_chk_32
L_poll_30:
    buffer_load_dwordx4 v[216:219], v1, s[4:7], s46 offen offset:0 sc1
    buffer_load_dwordx4 v[220:223], v1, s[4:7], s46 offen offset:1024 sc1
    buffer_load_dwordx4 v[224:227], v1, s[4:7], s46 offen offset:2048 sc1
    buffer_load_dwordx4 v[228:231], v1, s[4:7], s46 offen offset:3072 sc1
    s_waitcnt vmcnt(0)
L_chk_32:
    v_max_u32 v214, v216, v217
    v_max3_u32 v214, v214, v218, v219
    v_max3_u32 v214, v214, v220, v221
    v_max3_u32 v214, v214, v222, v223
    v_max3_u32 v214, v214, v224, v225
    v_max3_u32 v214, v214, v226, v227
    v_max3_u32 v214, v214, v228, v229
    v_max3_u32 v214, v214, v230, v231
    v_cmp_eq_u32 vcc, -1, v214
    s_add_u32 s48, s48, 1
    s_cbranch_vccz L_gotex_31
    s_cmp_lt_u32 s48, 65536
    s_cbranch_scc1 L_poll_30
L_gotex_31:
    v_lshlrev_b32 v192, 16, v216
    v_and_b32 v193, 0xffff0000, v216
    v_pk_fma_f32 v[80:81], v[192:193], v[112:113], v[80:81]
    v_lshlrev_b32 v194, 16, v217
    v_and_b32 v195, 0xffff0000, v217
    v_pk_fma_f32 v[82:83], v[194:195], v[114:115], v[82:83]
    v_lshlrev_b32 v192, 16, v218
    v_and_b32 v193, 0xffff0000, v218
    v_pk_fma_f32 v[84:85], v[192:193], v[116:117], v[84:85]
    v_lshlrev_b32 v194, 16, v219
    v_and_b32 v195, 0xffff0000, v219
    v_pk_fma_f32 v[86:87], v[194:195], v[118:119], v[86:87]
    v_lshlrev_b32 v192, 16, v220
    v_and_b32 v193, 0xffff0000, v220
    v_pk_fma_f32 v[88:89], v[192:193], v[120:121], v[88:89]
    v_lshlrev_b32 v194, 16, v221
    v_and_b32 v195, 0xffff0000, v221
    v_pk_fma_f32 v[90:91], v[194:195], v[122:123], v[90:91]
    v_lshlrev_b32 v192, 16, v222
    v_and_b32 v193, 0xffff0000, v222
    v_pk_fma_f32 v[92:93], v[192:193], v[124:125], v[92:93]
    v_lshlrev_b32 v194, 16, v223
    v_and_b32 v195, 0xffff0000, v223
    v_pk_fma_f32 v[94:95], v[194:195], v[126:127], v[94:95]
    v_lshlrev_b32 v192, 16, v224
    v_and_b32 v193, 0xffff0000, v224
    v_pk_fma_f32 v[96:97], v[192:193], v[112:113], v[96:97]
    v_lshlrev_b32 v194, 16, v225
    v_and_b32 v195, 0xffff0000, v225
    v_pk_fma_f32 v[98:99], v[194:195], v[114:115], v[98:99]
    v_lshlrev_b32 v192, 16, v226
    v_and_b32 v193, 0xffff0000, v226
    v_pk_fma_f32 v[100:101], v[192:193], v[116:117], v[100:101]
    v_lshlrev_b32 v194, 16, v227
    v_and_b32 v195, 0xffff0000, v227
    v_pk_fma_f32 v[102:103], v[194:195], v[118:119], v[102:103]
    v_lshlrev_b32 v192, 16, v228
    v_and_b32 v193, 0xffff0000, v228
    v_pk_fma_f32 v[104:105], v[192:193], v[120:121], v[104:105]
    v_lshlrev_b32 v194, 16, v229
    v_and_b32 v195, 0xffff0000, v229
    v_pk_fma_f32 v[106:107], v[194:195], v[122:123], v[106:107]
    v_lshlrev_b32 v192, 16, v230
    v_and_b32 v193, 0xffff0000, v230
    v_pk_fma_f32 v[108:109], v[192:193], v[124:125], v[108:109]
    v_lshlrev_b32 v194, 16, v231
    v_and_b32 v195, 0xffff0000, v231
    v_pk_fma_f32 v[110:111], v[194:195], v[126:127], v[110:111]
    v_pk_mul_f32 v[196:197], v[80:81], v[176:177]
    v_pk_mul_f32 v[198:199], v[96:97], v[176:177]
    v_pk_add_f32 v[192:193], v[80:81], v[82:83]
    v_pk_fma_f32 v[196:197], v[82:83], v[178:179], v[196:197]
    v_pk_add_f32 v[194:195], v[96:97], v[98:99]
    v_pk_fma_f32 v[198:199], v[98:99], v[178:179], v[198:199]
    v_pk_add_f32 v[192:193], v[192:193], v[84:85]
    v_pk_fma_f32 v[196:197], v[84:85], v[180:181], v[196:197]
    v_pk_add_f32 v[194:195], v[194:195], v[100:101]
    v_pk_fma_f32 v[198:199], v[100:101], v[180:181], v[198:199]
    v_pk_add_f32 v[192:193], v[192:193], v[86:87]
    v_pk_fma_f32 v[196:197], v[86:87], v[182:183], v[196:197]
    v_pk_add_f32 v[194:195], v[194:195], v[102:103]
    v_pk_fma_f32 v[198:199], v[102:103], v[182:183], v[198:199]
    v_pk_add_f32 v[192:193], v[192:193], v[88:89]
    v_pk_fma_f32 v[196:197], v[88:89], v[184:185], v[196:197]
    v_pk_add_f32 v[194:195], v[194:195], v[104:105]
    v_pk_fma_f32 v[198:199], v[104:105], v[184:185], v[198:199]
    v_pk_add_f32 v[192:193], v[192:193], v[90:91]
    v_pk_fma_f32 v[196:197], v[90:91], v[186:187], v[196:197]
    v_pk_add_f32 v[194:195], v[194:195], v[106:107]
    v_pk_fma_f32 v[198:199], v[106:107], v[186:187], v[198:199]
    v_pk_add_f32 v[192:193], v[192:193], v[92:93]
    v_pk_fma_f32 v[196:197], v[92:93], v[188:189], v[196:197]
    v_pk_add_f32 v[194:195], v[194:195], v[108:109]
    v_pk_fma_f32 v[198:199], v[108:109], v[188:189], v[198:199]
    v_pk_add_f32 v[192:193], v[192:193], v[94:95]
    v_pk_fma_f32 v[196:197], v[94:95], v[190:191], v[196:197]
    v_pk_add_f32 v[194:195], v[194:195], v[110:111]
    v_pk_fma_f32 v[198:199], v[110:111], v[190:191], v[198:199]
    v_add_f32 v192, v192, v193
    v_add_f32 v194, v194, v195
    v_add_f32 v196, v196, v197
    v_add_f32 v198, v198, v199
    v_mul_f32 v193, 0xbd800000, v192
    v_mul_f32 v195, 0xbd800000, v194
    v_pk_add_f32 v[204:205], v[80:81], v[192:193] op_sel:[0,1] op_sel_hi:[1,1]
    v_pk_add_f32 v[206:207], v[96:97], v[194:195] op_sel:[0,1] op_sel_hi:[1,1]
    v_pk_mul_f32 v[200:201], v[204:205], v[204:205]
    v_pk_mul_f32 v[202:203], v[206:207], v[206:207]
    v_pk_add_f32 v[204:205], v[82:83], v[192:193] op_sel:[0,1] op_sel_hi:[1,1]
    v_pk_add_f32 v[206:207], v[98:99], v[194:195] op_sel:[0,1] op_sel_hi:[1,1]
    v_pk_fma_f32 v[200:201], v[204:205], v[204:205], v[200:201]
    v_pk_fma_f32 v[202:203], v[206:207], v[206:207], v[202:203]
    v_pk_add_f32 v[204:205], v[84:85], v[192:193] op_sel:[0,1] op_sel_hi:[1,1]
    v_pk_add_f32 v[206:207], v[100:101], v[194:195] op_sel:[0,1] op_sel_hi:[1,1]
    v_pk_fma_f32 v[200:201], v[204:205], v[204:205], v[200:201]
    v_pk_fma_f32 v[202:203], v[206:207], v[206:207], v[202:203]
    v_pk_add_f32 v[204:205], v[86:87], v[192:193] op_sel:[0,1] op_sel_hi:[1,1]
    v_pk_add_f32 v[206:207], v[102:103], v[194:195] op_sel:[0,1] op_sel_hi:[1,1]
    v_pk_fma_f32 v[200:201], v[204:205], v[204:205], v[200:201]
    v_pk_fma_f32 v[202:203], v[206:207], v[206:207], v[202:203]
    v_pk_add_f32 v[204:205], v[88:89], v[192:193] op_sel:[0,1] op_sel_hi:[1,1]
    v_pk_add_f32 v[206:207], v[104:105], v[194:195] op_sel:[0,1] op_sel_hi:[1,1]
    v_pk_fma_f32 v[200:201], v[204:205], v[204:205], v[200:201]
    v_pk_fma_f32 v[202:203], v[206:207], v[206:207], v[202:203]
    v_pk_add_f32 v[204:205], v[90:91], v[192:193] op_sel:[0,1] op_sel_hi:[1,1]
    v_pk_add_f32 v[206:207], v[106:107], v[194:195] op_sel:[0,1] op_sel_hi:[1,1]
    v_pk_fma_f32 v[200:201], v[204:205], v[204:205], v[200:201]
    v_pk_fma_f32 v[202:203], v[206:207], v[206:207], v[202:203]
    v_pk_add_f32 v[204:205], v[92:93], v[192:193] op_sel:[0,1] op_sel_hi:[1,1]
    v_pk_add_f32 v[206:207], v[108:109], v[194:195] op_sel:[0,1] op_sel_hi:[1,1]
    v_pk_fma_f32 v[200:201], v[204:205], v[204:205], v[200:201]
    v_pk_fma_f32 v[202:203], v[206:207], v[206:207], v[202:203]
    v_pk_add_f32 v[204:205], v[94:95], v[192:193] op_sel:[0,1] op_sel_hi:[1,1]
    v_pk_add_f32 v[206:207], v[110:111], v[194:195] op_sel:[0,1] op_sel_hi:[1,1]
    v_pk_fma_f32 v[200:201], v[204:205], v[204:205], v[200:201]
    v_pk_fma_f32 v[202:203], v[206:207], v[206:207], v[202:203]
    v_add_f32 v200, v200, v201
    v_add_f32 v202, v202, v203
    v_permlane16_swap_b32 v192, v194
    v_permlane16_swap_b32 v196, v198
    v_permlane16_swap_b32 v200, v202
    v_sub_f32 v193, v192, v194
    v_add_f32 v192, v192, v194
    v_add_f32 v196, v196, v198
    v_add_f32 v200, v200, v202
    v_mul_f32 v193, v193, v193
    v_fmac_f32 v200, 0x3d000000, v193
    v_mov_b32 v194, v192
    v_mov_b32 v198, v196
    v_mov_b32 v202, v200
    v_permlane32_swap_b32 v192, v194
    v_permlane32_swap_b32 v196, v198
    v_permlane32_swap_b32 v200, v202
    v_sub_f32 v193, v192, v194
    v_add_f32 v208, v192, v194
    v_add_f32 v210, v196, v198
    v_add_f32 v209, v200, v202
    v_mul_f32 v193, v193, v193
    v_fmac_f32 v209, 0x3c800000, v193
    v_mul_f32 v208, 0xbc800000, v208
    buffer_store_dwordx4 v[208:211], v212, s[4:7], s45 offen sc1
    s_and_b32 s45, s67, 4294475775
    s_add_u32 s44, s44, s45
    s_add_u32 s45, s44, 131072
    s_add_u32 s46, s44, 262144
    s_add_u32 s47, s44, 393216
    v_and_b32 v215, 0x1ff, v1
    v_lshl_add_u32 v213, v213, 15, v215
    v_add_u32 v215, 65536, v213
    v_lshlrev_b32 v3, 8, v12
    v_lshl_add_u32 v3, v13, 3, v3
    v_lshl_add_u32 v3, v10, 14, v3
    s_nop 0
    s_barrier
    ds_write_b128 v2, a[144:147] offset:0
    ds_write_b128 v2, a[148:151] offset:1024
    ds_write_b128 v2, a[156:159] offset:2048
    ds_write_b128 v2, a[160:163] offset:3072
    ds_write_b128 v2, a[168:171] offset:4096
    ds_write_b128 v2, a[172:175] offset:5120
    ds_write_b128 v2, a[180:183] offset:6144
    ds_write_b128 v2, a[184:187] offset:7168
    ds_write_b128 v2, a[192:195] offset:8192
    ds_write_b128 v2, a[196:199] offset:9216
    ds_write_b128 v2, a[204:207] offset:10240
    ds_write_b128 v2, a[208:211] offset:11264
    s_waitcnt lgkmcnt(8)
    ds_write_b128 v2, a[216:219] offset:12288
    ds_write_b128 v2, a[220:223] offset:13312
    ds_write_b128 v2, a[228:231] offset:14336
    ds_write_b128 v2, a[232:235] offset:15360
    s_waitcnt vmcnt(0)
    buffer_load_dwordx4 v[216:219], v213, s[4:7], s44 offen sc1
    buffer_load_dwordx4 v[220:223], v215, s[4:7], s44 offen sc1
    buffer_load_dwordx4 v[224:227], v213, s[4:7], s45 offen sc1
    buffer_load_dwordx4 v[228:231], v215, s[4:7], s45 offen sc1
    buffer_load_dwordx4 v[232:235], v213, s[4:7], s46 offen sc1
    buffer_load_dwordx4 v[236:239], v215, s[4:7], s46 offen sc1
    buffer_load_dwordx4 v[240:243], v213, s[4:7], s47 offen sc1
    buffer_load_dwordx4 v[244:247], v215, s[4:7], s47 offen sc1
    s_waitcnt lgkmcnt(0)
    ds_read_b64_tr_b16 a[144:145], v3 offset:0
    ds_read_b64_tr_b16 a[146:147], v3 offset:128
    ds_read_b64_tr_b16 a[148:149], v3 offset:1024
    ds_read_b64_tr_b16 a[150:151], v3 offset:1152
    ds_read_b64_tr_b16 a[156:157], v3 offset:2048
    ds_read_b64_tr_b16 a[158:159], v3 offset:2176
    ds_read_b64_tr_b16 a[160:161], v3 offset:3072
    ds_read_b64_tr_b16 a[162:163], v3 offset:3200
    ds_read_b64_tr_b16 a[168:169], v3 offset:4096
    ds_read_b64_tr_b16 a[170:171], v3 offset:4224
    ds_read_b64_tr_b16 a[172:173], v3 offset:5120
    ds_read_b64_tr_b16 a[174:175], v3 offset:5248
    s_waitcnt lgkmcnt(8)
    ds_read_b64_tr_b16 a[180:181], v3 offset:6144
    ds_read_b64_tr_b16 a[182:183], v3 offset:6272
    ds_read_b64_tr_b16 a[184:185], v3 offset:7168
    ds_read_b64_tr_b16 a[186:187], v3 offset:7296
    s_waitcnt lgkmcnt(8)
    ds_read_b64_tr_b16 a[192:193], v3 offset:8192
    ds_read_b64_tr_b16 a[194:195], v3 offset:8320
    ds_read_b64_tr_b16 a[196:197], v3 offset:9216
    ds_read_b64_tr_b16 a[198:199], v3 offset:9344
    s_waitcnt lgkmcnt(8)
    ds_read_b64_tr_b16 a[204:205], v3 offset:10240
    ds_read_b64_tr_b16 a[206:207], v3 offset:10368
    ds_read_b64_tr_b16 a[208:209], v3 offset:11264
    ds_read_b64_tr_b16 a[210:211], v3 offset:11392
    s_waitcnt lgkmcnt(8)
    ds_read_b64_tr_b16 a[216:217], v3 offset:12288
    ds_read_b64_tr_b16 a[218:219], v3 offset:12416
    ds_read_b64_tr_b16 a[220:221], v3 offset:13312
    ds_read_b64_tr_b16 a[222:223], v3 offset:13440
    s_waitcnt lgkmcnt(8)
    ds_read_b64_tr_b16 a[228:229], v3 offset:14336
    ds_read_b64_tr_b16 a[230:231], v3 offset:14464
    ds_read_b64_tr_b16 a[232:233], v3 offset:15360
    ds_read_b64_tr_b16 a[234:235], v3 offset:15488
    s_lshl_b32 s61, s56, 5
    s_sub_u32 s61, 2047, s61
    v_and_b32 v207, 31, v11
    v_sub_u32 v207, s61, v207
    s_lshl_b32 s61, s56, 7
    s_add_u32 s61, s61, 98304
    v_lshrrev_b32 v4, 3, v11
    v_or_b32 v4, s57, v4
    v_lshl_add_u32 v4, v4, 24, v1
    v_mov_b32 v209, s60
    v_mov_b32 v211, s60
    s_mov_b32 s62, 0xfffff800
    s_mov_b32 s48, 0
    s_waitcnt vmcnt(0)
    s_branch L_chk_35
L_poll_33:
    buffer_load_dwordx4 v[216:219], v213, s[4:7], s44 offen sc1
    buffer_load_dwordx4 v[220:223], v215, s[4:7], s44 offen sc1
    buffer_load_dwordx4 v[224:227], v213, s[4:7], s45 offen sc1
    buffer_load_dwordx4 v[228:231], v215, s[4:7], s45 offen sc1
    buffer_load_dwordx4 v[232:235], v213, s[4:7], s46 offen sc1
    buffer_load_dwordx4 v[236:239], v215, s[4:7], s46 offen sc1
    buffer_load_dwordx4 v[240:243], v213, s[4:7], s47 offen sc1
    buffer_load_dwordx4 v[244:247], v215, s[4:7], s47 offen sc1
    s_waitcnt vmcnt(0)
L_chk_35:
    v_max_u32 v214, v216, v217
    v_max3_u32 v214, v214, v218, v219
    v_max3_u32 v214, v214, v220, v221
    v_max3_u32 v214, v214, v222, v223
    v_max3_u32 v214, v214, v224, v225
    v_max3_u32 v214, v214, v226, v227
    v_max3_u32 v214, v214, v228, v229
    v_max3_u32 v214, v214, v230, v231
    v_max3_u32 v214, v214, v232, v233
    v_max3_u32 v214, v214, v234, v235
    v_max3_u32 v214, v214, v236, v237
    v_max3_u32 v214, v214, v238, v239
    v_max3_u32 v214, v214, v240, v241
    v_max3_u32 v214, v214, v242, v243
    v_max3_u32 v214, v214, v244, v245
    v_max3_u32 v214, v214, v246, v247
    v_cmp_eq_u32 vcc, -1, v214
    s_add_u32 s48, s48, 1
    s_cbranch_vccz L_gotst_34
    s_cmp_lt_u32 s48, 65536
    s_cbranch_scc1 L_poll_33
L_gotst_34:
    v_pk_add_f32 v[192:193], v[216:217], v[220:221]
    v_pk_add_f32 v[192:193], v[192:193], v[224:225]
    v_pk_add_f32 v[192:193], v[192:193], v[228:229]
    v_pk_add_f32 v[192:193], v[192:193], v[232:233]
    v_pk_add_f32 v[192:193], v[192:193], v[236:237]
    v_pk_add_f32 v[192:193], v[192:193], v[240:241]
    v_pk_add_f32 v[192:193], v[192:193], v[244:245]
    v_pk_add_f32 v[194:195], v[218:219], v[222:223]
    v_pk_add_f32 v[194:195], v[194:195], v[226:227]
    v_pk_add_f32 v[194:195], v[194:195], v[230:231]
    v_pk_add_f32 v[194:195], v[194:195], v[234:235]
    v_pk_add_f32 v[194:195], v[194:195], v[238:239]
    v_pk_add_f32 v[194:195], v[194:195], v[242:243]
    v_pk_add_f32 v[194:195], v[194:195], v[246:247]
    v_mov_b32 v196, v192
    v_mov_b32 v197, v193
    v_mov_b32 v198, v194
    v_mov_b32 v199, v195
    v_permlane32_swap_b32 v192, v196
    v_permlane32_swap_b32 v193, v197
    v_permlane32_swap_b32 v194, v198
    v_permlane32_swap_b32 v195, v199
    v_pk_add_f32 v[192:193], v[192:193], v[196:197]
    v_pk_add_f32 v[194:195], v[194:195], v[198:199]
    v_mul_f32 v192, 0x3d800000, v192
    v_sub_f32 v202, v216, v192
    v_mul_f32 v200, v202, v202
    v_sub_f32 v202, v220, v192
    v_fmac_f32 v200, v202, v202
    v_sub_f32 v202, v224, v192
    v_fmac_f32 v200, v202, v202
    v_sub_f32 v202, v228, v192
    v_fmac_f32 v200, v202, v202
    v_sub_f32 v202, v232, v192
    v_fmac_f32 v200, v202, v202
    v_sub_f32 v202, v236, v192
    v_fmac_f32 v200, v202, v202
    v_sub_f32 v202, v240, v192
    v_fmac_f32 v200, v202, v202
    v_sub_f32 v202, v244, v192
    v_fmac_f32 v200, v202, v202
    v_mov_b32 v201, v200
    v_mov_b32_dpp v204, v195 quad_perm:[0,0,2,2] row_mask:0xf bank_mask:0xf
    v_mov_b32_dpp v205, v195 quad_perm:[1,1,3,3] row_mask:0xf bank_mask:0xf
    v_permlane32_swap_b32 v200, v201
    v_add_f32 v200, v200, v201
    v_fmac_f32 v193, 0x42800000, v200
    v_mul_f32 v193, 0x3a800000, v193
    v_cvt_pk_bf16_f32 v193, v192, v193
    v_lshlrev_b32 v192, 16, v193
    v_and_b32 v193, 0xffff0000, v193
    v_add_f32 v193, 0x3727c5ac, v193
    v_cvt_pk_bf16_f32 v193, v193, v193
    v_lshlrev_b32 v193, 16, v193
    v_sqrt_f32 v193, v193
    v_fmac_f32 v194, v192, v204
    v_cvt_pk_bf16_f32 v193, v193, v193
    v_lshlrev_b32 v193, 16, v193
    v_rcp_f32 v193, v193
    s_nop 0
    v_fma_f32 v206, v194, v193, v205
    v_ashrrev_i32 v200, 31, v206
    v_or_b32 v200, 0x80000000, v200
    v_xor_b32 v206, v206, v200
    v_and_or_b32 v206, v206, s62, v207
    v_mov_b32 v207, v206
    v_mul_f32 v192, v192, v193
    v_mov_b32 v197, v193
    v_permlane16_swap_b32 v206, v207
    v_max_u32 v208, v206, v207
    v_min_u32 v210, v206, v207
    s_nop 1
    v_min_u32_dpp v200, v208, v208 row_ror:8 row_mask:0xf bank_mask:0xf
    v_max_u32_dpp v208, v208, v208 row_ror:8 row_mask:0xf bank_mask:0xf
    v_max_u32_dpp v201, v210, v210 row_ror:8 row_mask:0xf bank_mask:0xf
    v_max_u32 v210, v200, v201
    v_min_u32_dpp v200, v208, v208 row_ror:4 row_mask:0xf bank_mask:0xf
    v_max_u32_dpp v208, v208, v208 row_ror:4 row_mask:0xf bank_mask:0xf
    v_max_u32_dpp v201, v210, v210 row_ror:4 row_mask:0xf bank_mask:0xf
    v_max_u32 v210, v200, v201
    v_min_u32_dpp v200, v208, v208 row_ror:2 row_mask:0xf bank_mask:0xf
    v_max_u32_dpp v208, v208, v208 row_ror:2 row_mask:0xf bank_mask:0xf
    v_max_u32_dpp v201, v210, v210 row_ror:2 row_mask:0xf bank_mask:0xf
    v_max_u32 v210, v200, v201
    v_min_u32_dpp v200, v208, v208 row_ror:1 row_mask:0xf bank_mask:0xf
    v_max_u32_dpp v208, v208, v208 row_ror:1 row_mask:0xf bank_mask:0xf
    v_max_u32_dpp v201, v210, v210 row_ror:1 row_mask:0xf bank_mask:0xf
    v_max_u32 v210, v200, v201
    buffer_store_dwordx4 v[208:211], v4, s[4:7], s61 offen sc1
    v_mov_b32 v196, v192
    v_mov_b32 v200, 0x7f000000
    v_add_u32 v202, 128, v9
    v_permlane16_swap_b32 v192, v196
    v_permlane16_swap_b32 v193, v197
    v_cmp_eq_u32 vcc, v206, v208
    v_cmp_eq_u32 s[50:51], v206, v210
    s_nop 0
    v_cndmask_b32 v212, v200, v9, vcc
    v_cndmask_b32 v212, v212, v202, s[50:51]
    v_cmp_eq_u32 vcc, v207, v208
    v_cmp_eq_u32 s[50:51], v207, v210
    s_nop 0
    v_cndmask_b32 v213, v200, v9, vcc
    v_cndmask_b32 v213, v213, v202, s[50:51]
    v_pk_fma_f32 v[16:17], v[80:81], v[192:193], v[192:193] op_sel:[0,1,0] op_sel_hi:[1,1,0]
    v_pk_fma_f32 v[18:19], v[82:83], v[192:193], v[192:193] op_sel:[0,1,0] op_sel_hi:[1,1,0]
    v_pk_fma_f32 v[20:21], v[84:85], v[192:193], v[192:193] op_sel:[0,1,0] op_sel_hi:[1,1,0]
    v_pk_fma_f32 v[22:23], v[86:87], v[192:193], v[192:193] op_sel:[0,1,0] op_sel_hi:[1,1,0]
    v_pk_fma_f32 v[24:25], v[88:89], v[192:193], v[192:193] op_sel:[0,1,0] op_sel_hi:[1,1,0]
    v_pk_fma_f32 v[26:27], v[90:91], v[192:193], v[192:193] op_sel:[0,1,0] op_sel_hi:[1,1,0]
    v_pk_fma_f32 v[28:29], v[92:93], v[192:193], v[192:193] op_sel:[0,1,0] op_sel_hi:[1,1,0]
    v_pk_fma_f32 v[30:31], v[94:95], v[192:193], v[192:193] op_sel:[0,1,0] op_sel_hi:[1,1,0]
    v_pk_fma_f32 v[16:17], v[16:17], v[128:129], v[144:145]
    v_pk_fma_f32 v[18:19], v[18:19], v[130:131], v[146:147]
    v_pk_fma_f32 v[20:21], v[20:21], v[132:133], v[148:149]
    v_pk_fma_f32 v[22:23], v[22:23], v[134:135], v[150:151]
    v_pk_fma_f32 v[24:25], v[24:25], v[136:137], v[152:153]
    v_pk_fma_f32 v[26:27], v[26:27], v[138:139], v[154:155]
    v_pk_fma_f32 v[28:29], v[28:29], v[140:141], v[156:157]
    v_pk_fma_f32 v[30:31], v[30:31], v[142:143], v[158:159]
    v_cvt_pk_bf16_f32 v216, v16, v17
    v_cvt_pk_bf16_f32 v217, v18, v19
    v_cvt_pk_bf16_f32 v218, v20, v21
    v_cvt_pk_bf16_f32 v219, v22, v23
    v_cvt_pk_bf16_f32 v220, v24, v25
    v_cvt_pk_bf16_f32 v221, v26, v27
    v_cvt_pk_bf16_f32 v222, v28, v29
    v_cvt_pk_bf16_f32 v223, v30, v31
    v_pk_fma_f32 v[32:33], v[96:97], v[196:197], v[196:197] op_sel:[0,1,0] op_sel_hi:[1,1,0]
    v_pk_fma_f32 v[34:35], v[98:99], v[196:197], v[196:197] op_sel:[0,1,0] op_sel_hi:[1,1,0]
    v_pk_fma_f32 v[36:37], v[100:101], v[196:197], v[196:197] op_sel:[0,1,0] op_sel_hi:[1,1,0]
    v_pk_fma_f32 v[38:39], v[102:103], v[196:197], v[196:197] op_sel:[0,1,0] op_sel_hi:[1,1,0]
    v_pk_fma_f32 v[40:41], v[104:105], v[196:197], v[196:197] op_sel:[0,1,0] op_sel_hi:[1,1,0]
    v_pk_fma_f32 v[42:43], v[106:107], v[196:197], v[196:197] op_sel:[0,1,0] op_sel_hi:[1,1,0]
    v_pk_fma_f32 v[44:45], v[108:109], v[196:197], v[196:197] op_sel:[0,1,0] op_sel_hi:[1,1,0]
    v_pk_fma_f32 v[46:47], v[110:111], v[196:197], v[196:197] op_sel:[0,1,0] op_sel_hi:[1,1,0]
    v_pk_fma_f32 v[32:33], v[32:33], v[128:129], v[144:145]
    v_pk_fma_f32 v[34:35], v[34:35], v[130:131], v[146:147]
    v_pk_fma_f32 v[36:37], v[36:37], v[132:133], v[148:149]
    v_pk_fma_f32 v[38:39], v[38:39], v[134:135], v[150:151]
    v_pk_fma_f32 v[40:41], v[40:41], v[136:137], v[152:153]
    v_pk_fma_f32 v[42:43], v[42:43], v[138:139], v[154:155]
    v_pk_fma_f32 v[44:45], v[44:45], v[140:141], v[156:157]
    v_pk_fma_f32 v[46:47], v[46:47], v[142:143], v[158:159]
    v_cvt_pk_bf16_f32 v224, v32, v33
    v_cvt_pk_bf16_f32 v225, v34, v35
    v_cvt_pk_bf16_f32 v226, v36, v37
    v_cvt_pk_bf16_f32 v227, v38, v39
    v_cvt_pk_bf16_f32 v228, v40, v41
    v_cvt_pk_bf16_f32 v229, v42, v43
    v_cvt_pk_bf16_f32 v230, v44, v45
    v_cvt_pk_bf16_f32 v231, v46, v47
    s_lshl_b32 s44, s3, 8
    s_add_u32 s44, s44, s67
    s_add_u32 s47, s44, 26624
    buffer_store_dwordx4 v[216:219], v212, s[4:7], s47 offen offset:0 sc1
    buffer_store_dwordx4 v[220:223], v212, s[4:7], s47 offen offset:64 sc1
    buffer_store_dwordx4 v[224:227], v213, s[4:7], s47 offen offset:0 sc1
    buffer_store_dwordx4 v[228:231], v213, s[4:7], s47 offen offset:64 sc1
    s_lshl_b32 s45, s3, 11
    s_add_u32 s45, s45, 98304
    v_lshlrev_b32 v14, 7, v13
    s_mov_b32 s61, s47
    s_mov_b32 s62, 32768
    v_pk_fma_f32 v[16:17], v[16:17], v[160:161], v[80:81]
    v_pk_fma_f32 v[18:19], v[18:19], v[162:163], v[82:83]
    v_pk_fma_f32 v[20:21], v[20:21], v[164:165], v[84:85]
    v_pk_fma_f32 v[22:23], v[22:23], v[166:167], v[86:87]
    v_pk_fma_f32 v[24:25], v[24:25], v[168:169], v[88:89]
    v_pk_fma_f32 v[26:27], v[26:27], v[170:171], v[90:91]
    v_pk_fma_f32 v[28:29], v[28:29], v[172:173], v[92:93]
    v_pk_fma_f32 v[30:31], v[30:31], v[174:175], v[94:95]
    v_cvt_pk_bf16_f32 v232, v16, v17
    v_cvt_pk_bf16_f32 v233, v18, v19
    v_cvt_pk_bf16_f32 v234, v20, v21
    v_cvt_pk_bf16_f32 v235, v22, v23
    v_cvt_pk_bf16_f32 v236, v24, v25
    v_cvt_pk_bf16_f32 v237, v26, v27
    v_cvt_pk_bf16_f32 v238, v28, v29
    v_cvt_pk_bf16_f32 v239, v30, v31
    v_pk_fma_f32 v[32:33], v[32:33], v[160:161], v[96:97]
    v_pk_fma_f32 v[34:35], v[34:35], v[162:163], v[98:99]
    v_pk_fma_f32 v[36:37], v[36:37], v[164:165], v[100:101]
    v_pk_fma_f32 v[38:39], v[38:39], v[166:167], v[102:103]
    v_pk_fma_f32 v[40:41], v[40:41], v[168:169], v[104:105]
    v_pk_fma_f32 v[42:43], v[42:43], v[170:171], v[106:107]
    v_pk_fma_f32 v[44:45], v[44:45], v[172:173], v[108:109]
    v_pk_fma_f32 v[46:47], v[46:47], v[174:175], v[110:111]
    v_cvt_pk_bf16_f32 v240, v32, v33
    v_cvt_pk_bf16_f32 v241, v34, v35
    v_cvt_pk_bf16_f32 v242, v36, v37
    v_cvt_pk_bf16_f32 v243, v38, v39
    v_cvt_pk_bf16_f32 v244, v40, v41
    v_cvt_pk_bf16_f32 v245, v42, v43
    v_cvt_pk_bf16_f32 v246, v44, v45
    v_cvt_pk_bf16_f32 v247, v46, v47
    buffer_store_dwordx4 v[232:235], v212, s[4:7], s61 offen offset:1024 sc1
    buffer_store_dwordx4 v[236:239], v212, s[4:7], s61 offen offset:1088 sc1
    buffer_store_dwordx4 v[240:243], v213, s[4:7], s61 offen offset:1024 sc1
    buffer_store_dwordx4 v[244:247], v213, s[4:7], s61 offen offset:1088 sc1
    s_waitcnt lgkmcnt(0)
    ds_write_b128 v2, a[152:155] offset:0
    ds_write_b128 v2, a[164:167] offset:1024
    ds_write_b128 v2, a[176:179] offset:2048
    ds_write_b128 v2, a[188:191] offset:3072
    ds_write_b128 v2, a[200:203] offset:4096
    ds_write_b128 v2, a[212:215] offset:5120
    ds_write_b128 v2, a[224:227] offset:6144
    ds_write_b128 v2, a[236:239] offset:7168
    buffer_load_dwordx4 v[144:147], v14, s[4:7], s45 offen sc1
    v_lshrrev_b32 v3, 2, v11
    v_lshlrev_b32 v3, 9, v3
    v_and_b32 v4, 3, v11
    v_lshl_add_u32 v3, v4, 3, v3
    v_lshl_add_u32 v3, v10, 14, v3
    s_waitcnt lgkmcnt(0)
    ds_read_b64_tr_b16 a[152:153], v3 offset:0
    ds_read_b64_tr_b16 a[154:155], v3 offset:32
    ds_read_b64_tr_b16 a[164:165], v3 offset:64
    ds_read_b64_tr_b16 a[166:167], v3 offset:96
    ds_read_b64_tr_b16 a[176:177], v3 offset:128
    ds_read_b64_tr_b16 a[178:179], v3 offset:160
    ds_read_b64_tr_b16 a[188:189], v3 offset:192
    ds_read_b64_tr_b16 a[190:191], v3 offset:224
    ds_read_b64_tr_b16 a[200:201], v3 offset:256
    ds_read_b64_tr_b16 a[202:203], v3 offset:288
    ds_read_b64_tr_b16 a[212:213], v3 offset:320
    ds_read_b64_tr_b16 a[214:215], v3 offset:352
    s_waitcnt lgkmcnt(8)
    ds_read_b64_tr_b16 a[224:225], v3 offset:384
    ds_read_b64_tr_b16 a[226:227], v3 offset:416
    ds_read_b64_tr_b16 a[236:237], v3 offset:448
    ds_read_b64_tr_b16 a[238:239], v3 offset:480
    v_lshlrev_b32 v2, 4, v10
    v_add_u32 v2, 135168, v2
    v_lshlrev_b32 v3, 4, v4
    v_add_u32 v3, 135168, v3
    v_and_b32 v5, 1, v11
    v_cmp_eq_u32 s[32:33], 1, v5
    v_lshl_add_u32 v15, v5, 7, v9
    v_bfe_u32 v7, v11, 1, 3
    v_lshlrev_b32 v5, 12, v5
    v_lshl_add_u32 v5, v7, 6, v5
    v_add_u32 v5, v5, v9
    s_lshl_b32 s28, s3, 17
    s_add_u32 s28, s28, 8415232
    s_add_u32 s29, s28, 32768
    s_add_u32 s30, s28, 65536
    s_add_u32 s31, s28, 98304
    s_lshl_b32 s44, s3, 10
    s_add_u32 s44, s44, s67
    s_add_u32 s44, s44, 16384
    v_cmp_eq_u32 s[8:9], 0, v7
    v_cmp_eq_u32 s[10:11], 1, v7
    v_cmp_eq_u32 s[12:13], 2, v7
    v_cmp_eq_u32 s[14:15], 3, v7
    v_cmp_eq_u32 s[16:17], 4, v7
    v_cmp_eq_u32 s[18:19], 5, v7
    v_cmp_eq_u32 s[20:21], 6, v7
    v_cmp_eq_u32 s[22:23], 7, v7
    s_mov_b32 s48, 0
    s_waitcnt vmcnt(0)
    s_branch L_chk_41
L_poll_39:
    buffer_load_dwordx4 v[144:147], v14, s[4:7], s45 offen sc1
    s_waitcnt vmcnt(0)
L_chk_41:
    v_xor_b32 v148, s60, v145
    v_xor_b32 v149, s60, v147
    v_or_b32 v148, v148, v149
    v_cmp_ne_u32 vcc, 0, v148
    s_add_u32 s48, s48, 1
    s_cbranch_vccz L_gotkeys_40
    s_cmp_lt_u32 s48, 65536
    s_cbranch_scc1 L_poll_39
L_gotkeys_40:
    v_min_u32_dpp v148, v144, v144 row_ror:8 row_mask:0xf bank_mask:0xf
    v_max_u32_dpp v144, v144, v144 row_ror:8 row_mask:0xf bank_mask:0xf
    v_max_u32_dpp v149, v146, v146 row_ror:8 row_mask:0xf bank_mask:0xf
    v_max_u32 v146, v148, v149
    v_min_u32_dpp v148, v144, v144 row_ror:4 row_mask:0xf bank_mask:0xf
    v_max_u32_dpp v144, v144, v144 row_ror:4 row_mask:0xf bank_mask:0xf
    v_max_u32_dpp v149, v146, v146 row_ror:4 row_mask:0xf bank_mask:0xf
    v_max_u32 v146, v148, v149
    v_min_u32_dpp v148, v144, v144 row_ror:2 row_mask:0xf bank_mask:0xf
    v_max_u32_dpp v144, v144, v144 row_ror:2 row_mask:0xf bank_mask:0xf
    v_max_u32_dpp v149, v146, v146 row_ror:2 row_mask:0xf bank_mask:0xf
    v_max_u32 v146, v148, v149
    v_min_u32_dpp v148, v144, v144 row_ror:1 row_mask:0xf bank_mask:0xf
    v_max_u32_dpp v144, v144, v144 row_ror:1 row_mask:0xf bank_mask:0xf
    v_max_u32_dpp v149, v146, v146 row_ror:1 row_mask:0xf bank_mask:0xf
    v_max_u32 v146, v148, v149
    ds_write_b128 v2, v[144:147]
    s_waitcnt lgkmcnt(0)
    s_barrier
    ds_read_b128 v[144:147], v3
    s_cmp_ge_u32 s2, 224
    s_waitcnt lgkmcnt(0)
    v_min_u32_dpp v148, v144, v144 quad_perm:[1,0,3,2] row_mask:0xf bank_mask:0xf
    v_max_u32_dpp v144, v144, v144 quad_perm:[1,0,3,2] row_mask:0xf bank_mask:0xf
    v_max_u32_dpp v149, v146, v146 quad_perm:[1,0,3,2] row_mask:0xf bank_mask:0xf
    v_max_u32 v146, v148, v149
    v_min_u32_dpp v148, v144, v144 quad_perm:[2,3,0,1] row_mask:0xf bank_mask:0xf
    v_max_u32_dpp v144, v144, v144 quad_perm:[2,3,0,1] row_mask:0xf bank_mask:0xf
    v_max_u32_dpp v149, v146, v146 quad_perm:[2,3,0,1] row_mask:0xf bank_mask:0xf
    v_max_u32 v146, v148, v149
    s_cbranch_scc1 L_nomoe_42
    v_xor_b32 v148, v144, v146
    v_and_b32 v148, 0x7e0, v148
    v_cmp_eq_u32 vcc, 0, v148
    v_cndmask_b32 v145, v144, v146, s[32:33]
    v_not_b32 v149, v145
    v_cndmask_b32 v6, v9, v15, vcc
    v_bfe_u32 v148, v149, 7, 4
    v_bfe_u32 v149, v149, 5, 2
    v_lshl_add_u32 v6, v148, 19, v6
    v_lshl_add_u32 v6, v149, 8, v6
    buffer_load_dwordx4 v[112:115], v6, s[4:7], s28 offen offset:0 sc1
    buffer_load_dwordx4 v[116:119], v6, s[4:7], s28 offen offset:64 sc1
    buffer_load_dwordx4 v[120:123], v6, s[4:7], s29 offen offset:0 sc1
    buffer_load_dwordx4 v[124:127], v6, s[4:7], s29 offen offset:64 sc1
    buffer_load_dwordx4 v[128:131], v6, s[4:7], s30 offen offset:0 sc1
    buffer_load_dwordx4 v[132:135], v6, s[4:7], s30 offen offset:64 sc1
    buffer_load_dwordx4 v[136:139], v6, s[4:7], s31 offen offset:0 sc1
    buffer_load_dwordx4 v[140:143], v6, s[4:7], s31 offen offset:64 sc1
    v_mov_b32 v4, 0x7f000000
    v_cmp_eq_u32 vcc, v144, v206
    v_cmp_eq_u32 s[50:51], v146, v206
    s_or_b64 vcc, vcc, s[50:51]
    s_nop 0
    v_cndmask_b32 v212, v8, v4, vcc
    v_cmp_eq_u32 vcc, v144, v207
    v_cmp_eq_u32 s[50:51], v146, v207
    s_or_b64 vcc, vcc, s[50:51]
    s_nop 0
    v_cndmask_b32 v213, v8, v4, vcc
    v_readlane_b32 s63, v144, 0
    v_readlane_b32 s64, v146, 0
    v_readlane_b32 s65, v6, 0
    v_readlane_b32 s66, v6, 1
    v_lshl_add_u32 v2, v10, 11, v1
    v_add_u32 v2, 100352, v2
    v_add_u32 v3, 100352, v1
    s_mov_b32 s48, 0
    s_nop 0
    s_branch L_chk_45
L_poll_43:
    buffer_load_dwordx4 v[112:115], v6, s[4:7], s28 offen offset:0 sc1
    buffer_load_dwordx4 v[116:119], v6, s[4:7], s28 offen offset:64 sc1
    buffer_load_dwordx4 v[120:123], v6, s[4:7], s29 offen offset:0 sc1
    buffer_load_dwordx4 v[124:127], v6, s[4:7], s29 offen offset:64 sc1
    buffer_load_dwordx4 v[128:131], v6, s[4:7], s30 offen offset:0 sc1
    buffer_load_dwordx4 v[132:135], v6, s[4:7], s30 offen offset:64 sc1
    buffer_load_dwordx4 v[136:139], v6, s[4:7], s31 offen offset:0 sc1
    buffer_load_dwordx4 v[140:143], v6, s[4:7], s31 offen offset:64 sc1
    s_waitcnt vmcnt(0)
L_chk_45:
    s_waitcnt vmcnt(7)
    v_mfma_f32_16x16x32_bf16 v[152:155], a[144:147], v[112:115], 0
    v_max_u32 v148, v112, v113
    v_mfma_f32_16x16x32_bf16 v[156:159], a[148:151], v[112:115], 0
    v_max3_u32 v148, v148, v114, v115
    s_waitcnt vmcnt(6)
    v_mfma_f32_16x16x32_bf16 v[152:155], a[156:159], v[116:119], v[152:155]
    v_max3_u32 v148, v148, v116, v117
    v_mfma_f32_16x16x32_bf16 v[156:159], a[160:163], v[116:119], v[156:159]
    v_max3_u32 v148, v148, v118, v119
    s_waitcnt vmcnt(5)
    v_mfma_f32_16x16x32_bf16 v[152:155], a[168:171], v[120:123], v[152:155]
    v_max3_u32 v148, v148, v120, v121
    v_mfma_f32_16x16x32_bf16 v[156:159], a[172:175], v[120:123], v[156:159]
    v_max3_u32 v148, v148, v122, v123
    s_waitcnt vmcnt(4)
    v_mfma_f32_16x16x32_bf16 v[152:155], a[180:183], v[124:127], v[152:155]
    v_max3_u32 v148, v148, v124, v125
    v_mfma_f32_16x16x32_bf16 v[156:159], a[184:187], v[124:127], v[156:159]
    v_max3_u32 v148, v148, v126, v127
    s_waitcnt vmcnt(3)
    v_mfma_f32_16x16x32_bf16 v[152:155], a[192:195], v[128:131], v[152:155]
    v_max3_u32 v148, v148, v128, v129
    v_mfma_f32_16x16x32_bf16 v[156:159], a[196:199], v[128:131], v[156:159]
    v_max3_u32 v148, v148, v130, v131
    s_waitcnt vmcnt(2)
    v_mfma_f32_16x16x32_bf16 v[152:155], a[204:207], v[132:135], v[152:155]
    v_max3_u32 v148, v148, v132, v133
    v_mfma_f32_16x16x32_bf16 v[156:159], a[208:211], v[132:135], v[156:159]
    v_max3_u32 v148, v148, v134, v135
    s_waitcnt vmcnt(1)
    v_mfma_f32_16x16x32_bf16 v[152:155], a[216:219], v[136:139], v[152:155]
    v_max3_u32 v148, v148, v136, v137
    v_mfma_f32_16x16x32_bf16 v[156:159], a[220:223], v[136:139], v[156:159]
    v_max3_u32 v148, v148, v138, v139
    s_waitcnt vmcnt(0)
    v_mfma_f32_16x16x32_bf16 v[152:155], a[228:231], v[140:143], v[152:155]
    v_max3_u32 v148, v148, v140, v141
    v_mfma_f32_16x16x32_bf16 v[156:159], a[232:235], v[140:143], v[156:159]
    v_max3_u32 v148, v148, v142, v143
    v_cmp_eq_u32 vcc, -1, v148
    s_add_u32 s48, s48, 1
    s_cbranch_vccz L_gotrows_44
    s_cmp_lt_u32 s48, 65536
    s_cbranch_scc1 L_poll_43
L_gotrows_44:
    s_nop 1
    ds_write_b128 v2, v[152:155]
    s_nop 0
    ds_write_b128 v2, v[156:159] offset:1024
    s_cmp_ge_u32 s2, 64
    s_cbranch_scc1 L_noearly_46
    buffer_store_dwordx4 v[232:235], v212, s[24:27], 0 offen offset:0 sc1
    buffer_store_dwordx4 v[236:239], v212, s[24:27], 0 offen offset:64 sc1
    buffer_store_dwordx4 v[240:243], v213, s[24:27], s62 offen offset:0 sc1
    buffer_store_dwordx4 v[244:247], v213, s[24:27], s62 offen offset:64 sc1
L_noearly_46:
    s_waitcnt lgkmcnt(0)
    s_barrier
    ds_read_b128 v[160:163], v3 offset:0
    ds_read_b128 v[164:167], v3 offset:1024
    ds_read_b128 v[168:171], v3 offset:2048
    ds_read_b128 v[172:175], v3 offset:3072
    ds_read_b128 v[176:179], v3 offset:4096
    ds_read_b128 v[180:183], v3 offset:5120
    ds_read_b128 v[184:187], v3 offset:6144
    ds_read_b128 v[188:191], v3 offset:7168
    s_waitcnt lgkmcnt(0)
    v_pk_add_f32 v[160:161], v[160:161], v[168:169]
    v_pk_add_f32 v[176:177], v[176:177], v[184:185]
    v_pk_add_f32 v[162:163], v[162:163], v[170:171]
    v_pk_add_f32 v[178:179], v[178:179], v[186:187]
    v_pk_add_f32 v[164:165], v[164:165], v[172:173]
    v_pk_add_f32 v[180:181], v[180:181], v[188:189]
    v_pk_add_f32 v[166:167], v[166:167], v[174:175]
    v_pk_add_f32 v[182:183], v[182:183], v[190:191]
    v_pk_add_f32 v[160:161], v[160:161], v[176:177]
    v_pk_add_f32 v[162:163], v[162:163], v[178:179]
    v_pk_add_f32 v[164:165], v[164:165], v[180:181]
    v_pk_add_f32 v[166:167], v[166:167], v[182:183]
    v_mul_f32 v168, 0xbfb8aa3b, v160
    v_mul_f32 v169, 0xbfb8aa3b, v161
    v_mul_f32 v170, 0xbfb8aa3b, v162
    v_mul_f32 v171, 0xbfb8aa3b, v163
    v_exp_f32 v168, v168
    v_exp_f32 v169, v169
    v_exp_f32 v170, v170
    v_exp_f32 v171, v171
    v_add_f32 v168, 1.0, v168
    v_add_f32 v169, 1.0, v169
    v_add_f32 v170, 1.0, v170
    v_add_f32 v171, 1.0, v171
    v_rcp_f32 v168, v168
    v_rcp_f32 v169, v169
    v_rcp_f32 v170, v170
    v_rcp_f32 v171, v171
    v_mul_f32 v160, v160, v168
    v_mul_f32 v161, v161, v169
    v_mul_f32 v162, v162, v170
    v_mul_f32 v163, v163, v171
    v_pk_mul_f32 v[160:161], v[160:161], v[164:165]
    v_pk_mul_f32 v[162:163], v[162:163], v[166:167]
    v_cvt_pk_bf16_f32 v168, v160, v161
    v_cvt_pk_bf16_f32 v169, v162, v163
    v_cndmask_b32 v112, 0, v168, s[8:9]
    v_cndmask_b32 v113, 0, v169, s[8:9]
    v_cndmask_b32 v114, 0, v168, s[10:11]
    v_cndmask_b32 v115, 0, v169, s[10:11]
    v_cndmask_b32 v116, 0, v168, s[12:13]
    v_cndmask_b32 v117, 0, v169, s[12:13]
    v_mfma_f32_16x16x32_bf16 v[152:155], a[152:155], v[112:115], 0
    v_cndmask_b32 v118, 0, v168, s[14:15]
    v_cndmask_b32 v119, 0, v169, s[14:15]
    v_mfma_f32_16x16x32_bf16 v[156:159], a[200:203], v[112:115], 0
    v_cndmask_b32 v120, 0, v168, s[16:17]
    v_cndmask_b32 v121, 0, v169, s[16:17]
    v_mfma_f32_16x16x32_bf16 v[152:155], a[164:167], v[116:119], v[152:155]
    v_cndmask_b32 v122, 0, v168, s[18:19]
    v_cndmask_b32 v123, 0, v169, s[18:19]
    v_mfma_f32_16x16x32_bf16 v[156:159], a[212:215], v[116:119], v[156:159]
    v_cndmask_b32 v124, 0, v168, s[20:21]
    v_cndmask_b32 v125, 0, v169, s[20:21]
    v_mfma_f32_16x16x32_bf16 v[152:155], a[176:179], v[120:123], v[152:155]
    v_cndmask_b32 v126, 0, v168, s[22:23]
    v_cndmask_b32 v127, 0, v169, s[22:23]
    v_mfma_f32_16x16x32_bf16 v[156:159], a[224:227], v[120:123], v[156:159]
    s_nop 0
    v_mfma_f32_16x16x32_bf16 v[152:155], a[188:191], v[124:127], v[152:155]
    v_mfma_f32_16x16x32_bf16 v[156:159], a[236:239], v[124:127], v[156:159]
    s_nop 6
    buffer_store_dwordx4 v[152:155], v5, s[4:7], s44 offen sc1
    buffer_store_dwordx4 v[156:159], v5, s[4:7], s44 offen offset:512 sc1
    s_cmp_lt_u32 s2, 64
    s_cbranch_scc1 L_dofin_37
    s_branch L_onlyout_38
L_nomoe_42:
    s_xor_b32 s44, s2, 255
    v_or_b32 v5, s44, v0
    v_min_u32 v5, 64, v5
    v_lshlrev_b32 v5, 24, v5
    v_mov_b32 v6, s60
    s_mov_b32 s44, 45056
    buffer_store_dword v6, v5, s[4:7], s44 offen sc1
    v_mov_b32 v4, 0x7f000000
    v_cmp_eq_u32 vcc, v144, v206
    v_cmp_eq_u32 s[50:51], v146, v206
    s_or_b64 vcc, vcc, s[50:51]
    s_nop 0
    v_cndmask_b32 v212, v8, v4, vcc
    v_cmp_eq_u32 vcc, v144, v207
    v_cmp_eq_u32 s[50:51], v146, v207
    s_or_b64 vcc, vcc, s[50:51]
    s_nop 0
    v_cndmask_b32 v213, v8, v4, vcc
L_onlyout_38:
    buffer_store_dwordx4 v[232:235], v212, s[24:27], 0 offen offset:0 sc1
    buffer_store_dwordx4 v[236:239], v212, s[24:27], 0 offen offset:64 sc1
    buffer_store_dwordx4 v[240:243], v213, s[24:27], s62 offen offset:0 sc1
    buffer_store_dwordx4 v[244:247], v213, s[24:27], s62 offen offset:64 sc1
    s_branch L_end_36
L_dofin_37:
    s_cmp_lt_u32 s2, 32
    s_cselect_b32 s63, s63, s64
    s_cselect_b32 s65, s65, s66
    s_bfe_u32 s44, s2, 0x40001
    s_lshl_b32 s44, s44, 15
    s_add_u32 s65, s65, s44
    s_and_b32 s44, s2, 1
    s_lshl_b32 s44, s44, 6
    s_add_u32 s65, s65, s44
    s_add_u32 s65, s65, 8416256
    s_and_b32 s45, s2, 31
    s_lshl_b32 s45, s45, 6
    s_lshl_b32 s66, s45, 1
    s_add_u32 s66, s66, 405504
    s_add_u32 s46, s66, 16384
    s_not_b32 s44, s63
    s_and_b32 s44, s44, 2047
    s_lshl_b32 s44, s44, 11
    s_add_u32 s44, s44, s45
    v_and_b32 v2, 7, v0
    v_lshlrev_b32 v3, 3, v2
    v_lshlrev_b32 v4, 4, v2
    v_lshrrev_b32 v5, 3, v0
    v_lshl_add_u32 v5, v5, 15, v4
    s_mov_b32 s28, s92
    s_and_b32 s29, s93, 0xffff
    s_mov_b32 s30, 4194304
    s_mov_b32 s31, 0x20000
    s_mov_b32 s64, s44
    s_lshl_b32 s8, s2, 7
    s_add_u32 s8, s8, 8404992
    s_add_u32 s9, s8, 1048576
    s_add_u32 s10, s8, 2097152
    s_add_u32 s11, s8, 3145728
    s_add_u32 s12, s8, 4194304
    s_add_u32 s13, s8, 5242880
    s_add_u32 s14, s8, 6291456
    s_ashr_i32 s45, s63, 31
    s_not_b32 s45, s45
    s_or_b32 s45, s45, 0x80000000
    s_xor_b32 s44, s63, s45
    s_and_b32 s44, s44, 0xfffff800
    v_mov_b32 v60, s44
    v_cvt_pk_bf16_f32 v60, v60, v60
    v_lshlrev_b32 v60, 16, v60
    v_mul_f32 v60, 0xbfb8aa3b, v60
    v_exp_f32 v60, v60
    buffer_load_dwordx4 v[64:67], v4, s[4:7], s66 offen sc1
    buffer_load_dwordx4 v[68:71], v4, s[4:7], s46 offen sc1
    v_add_f32 v60, 1.0, v60
    v_rcp_f32 v60, v60
    s_nop 0
    v_cvt_pk_bf16_f32 v60, v60, v60
    v_lshlrev_b32 v60, 16, v60
    s_waitcnt vmcnt(0)
    s_mov_b32 s48, 0
L_poll_47:
    buffer_load_dwordx4 v[16:19], v5, s[4:7], s8 offen sc1
    buffer_load_dwordx4 v[20:23], v5, s[4:7], s9 offen sc1
    buffer_load_dwordx4 v[24:27], v5, s[4:7], s10 offen sc1
    buffer_load_dwordx4 v[28:31], v5, s[4:7], s11 offen sc1
    buffer_load_dwordx4 v[32:35], v5, s[4:7], s12 offen sc1
    buffer_load_dwordx4 v[36:39], v5, s[4:7], s13 offen sc1
    buffer_load_dwordx4 v[40:43], v5, s[4:7], s14 offen sc1
    buffer_load_dwordx2 v[44:45], v3, s[4:7], s65 offen sc1
    s_waitcnt vmcnt(0)
    v_max_u32 v50, v16, v17
    v_max3_u32 v50, v50, v18, v19
    v_max3_u32 v50, v50, v20, v21
    v_max3_u32 v50, v50, v22, v23
    v_max3_u32 v50, v50, v24, v25
    v_max3_u32 v50, v50, v26, v27
    v_max3_u32 v50, v50, v28, v29
    v_max3_u32 v50, v50, v30, v31
    v_max3_u32 v50, v50, v32, v33
    v_max3_u32 v50, v50, v34, v35
    v_max3_u32 v50, v50, v36, v37
    v_max3_u32 v50, v50, v38, v39
    v_max3_u32 v50, v50, v40, v41
    v_max3_u32 v50, v50, v42, v43
    v_max3_u32 v50, v50, v44, v45
    v_cmp_eq_u32 vcc, -1, v50
    s_add_u32 s48, s48, 1
    s_cbranch_vccz L_goty_48
    s_cmp_lt_u32 s48, 65536
    s_cbranch_scc1 L_poll_47
L_goty_48:
    v_pk_add_f32 v[16:17], v[16:17], v[20:21]
    v_pk_add_f32 v[18:19], v[18:19], v[22:23]
    v_pk_add_f32 v[16:17], v[16:17], v[24:25]
    v_pk_add_f32 v[18:19], v[18:19], v[26:27]
    v_pk_add_f32 v[16:17], v[16:17], v[28:29]
    v_pk_add_f32 v[18:19], v[18:19], v[30:31]
    v_pk_add_f32 v[16:17], v[16:17], v[32:33]
    v_pk_add_f32 v[18:19], v[18:19], v[34:35]
    v_pk_add_f32 v[16:17], v[16:17], v[36:37]
    v_pk_add_f32 v[18:19], v[18:19], v[38:39]
    v_pk_add_f32 v[16:17], v[16:17], v[40:41]
    v_pk_add_f32 v[18:19], v[18:19], v[42:43]
    s_nop 1
    v_add_f32_dpp v16, v16, v16 row_ror:8 row_mask:0xf bank_mask:0xf
    v_add_f32_dpp v17, v17, v17 row_ror:8 row_mask:0xf bank_mask:0xf
    v_add_f32_dpp v18, v18, v18 row_ror:8 row_mask:0xf bank_mask:0xf
    v_add_f32_dpp v19, v19, v19 row_ror:8 row_mask:0xf bank_mask:0xf
    v_mov_b32 v20, v16
    v_mov_b32 v21, v17
    v_mov_b32 v22, v18
    v_mov_b32 v23, v19
    v_permlane16_swap_b32 v16, v20
    v_permlane16_swap_b32 v17, v21
    v_permlane16_swap_b32 v18, v22
    v_permlane16_swap_b32 v19, v23
    v_add_f32 v16, v16, v20
    v_add_f32 v17, v17, v21
    v_add_f32 v18, v18, v22
    v_add_f32 v19, v19, v23
    v_mov_b32 v20, v16
    v_mov_b32 v21, v17
    v_mov_b32 v22, v18
    v_mov_b32 v23, v19
    v_permlane32_swap_b32 v16, v20
    v_permlane32_swap_b32 v17, v21
    v_permlane32_swap_b32 v18, v22
    v_permlane32_swap_b32 v19, v23
    v_add_f32 v16, v16, v20
    v_add_f32 v17, v17, v21
    v_add_f32 v18, v18, v22
    v_add_f32 v19, v19, v23
    v_lshl_add_u32 v6, v10, 7, v4
    ds_write_b128 v6, v[16:19]
    s_waitcnt lgkmcnt(0)
    s_barrier
    s_cmp_lg_u32 s3, 0
    s_cbranch_scc1 L_end_36
    ds_read_b128 v[16:19], v4 offset:0
    ds_read_b128 v[20:23], v4 offset:128
    ds_read_b128 v[24:27], v4 offset:256
    ds_read_b128 v[28:31], v4 offset:384
    v_lshrrev_b32 v6, 3, v11
    v_lshl_add_u32 v3, v6, 24, v3
    s_waitcnt lgkmcnt(0)
    v_pk_add_f32 v[16:17], v[16:17], v[20:21]
    v_pk_add_f32 v[24:25], v[24:25], v[28:29]
    v_pk_add_f32 v[16:17], v[16:17], v[24:25]
    v_pk_mul_f32 v[16:17], v[16:17], v[60:61] op_sel_hi:[1,0]
    v_pk_add_f32 v[52:53], v[64:65], v[68:69]
    v_cvt_pk_bf16_f32 v53, v52, v53
    v_lshlrev_b32 v52, 16, v53
    v_and_b32 v53, 0xffff0000, v53
    v_lshlrev_b32 v54, 16, v44
    v_and_b32 v55, 0xffff0000, v44
    v_pk_fma_f32 v[16:17], v[16:17], v[52:53], v[54:55]
    v_cvt_pk_bf16_f32 v56, v16, v17
    v_pk_add_f32 v[18:19], v[18:19], v[22:23]
    v_pk_add_f32 v[26:27], v[26:27], v[30:31]
    v_pk_add_f32 v[18:19], v[18:19], v[26:27]
    v_pk_mul_f32 v[18:19], v[18:19], v[60:61] op_sel_hi:[1,0]
    v_pk_add_f32 v[52:53], v[66:67], v[70:71]
    v_cvt_pk_bf16_f32 v53, v52, v53
    v_lshlrev_b32 v52, 16, v53
    v_and_b32 v53, 0xffff0000, v53
    v_lshlrev_b32 v54, 16, v45
    v_and_b32 v55, 0xffff0000, v45
    v_pk_fma_f32 v[18:19], v[18:19], v[52:53], v[54:55]
    v_cvt_pk_bf16_f32 v57, v18, v19
    buffer_store_dwordx2 v[56:57], v3, s[28:31], s64 offen sc1
L_end_36:
    s_endpgm
L_slowgate_25:
    s_mov_b32 s48, 0
L_poll_50:
    buffer_load_dword v254, v248, s[4:7], s63 offen sc1
    s_waitcnt vmcnt(0)
    v_cmp_ne_u32 vcc, s60, v254
    s_add_u32 s48, s48, 1
    s_cbranch_vccz L_gotgate_51
    s_cmp_lt_u32 s48, 65536
    s_cbranch_scc1 L_poll_50
L_gotgate_51:
    s_branch L_gateback_26
L_slowgate_28:
    s_mov_b32 s48, 0
L_poll_53:
    buffer_load_dword v254, v248, s[4:7], s63 offen sc1
    s_waitcnt vmcnt(0)
    v_cmp_ne_u32 vcc, s60, v254
    s_add_u32 s48, s48, 1
    s_cbranch_vccz L_gotgate_54
    s_cmp_lt_u32 s48, 65536
    s_cbranch_scc1 L_poll_53
L_gotgate_54:
    s_branch L_gateback_29
L_code_hi:
L_slowf1_14:
    s_mov_b32 s48, 0
L_poll_56:
    buffer_load_dword v253, v229, s[4:7], 0 offen sc1
    s_waitcnt vmcnt(0)
    v_cmp_ne_u32 vcc, s60, v253
    s_add_u32 s48, s48, 1
    s_cbranch_vccz L_gotf1_57
    s_cmp_lt_u32 s48, 65536
    s_cbranch_scc1 L_poll_56
L_gotf1_57:
    s_branch L_backf1_15
L_safe_18:
    s_waitcnt vmcnt(0) lgkmcnt(0)
    s_barrier
    v_mov_b32 v96, 0xff800000
    v_mov_b32 v100, 0xff800000
    v_mov_b32 v104, 0xff800000
    v_mov_b32 v108, 0xff800000
    s_mov_b32 s63, 0
    s_mov_b32 s64, 0
    s_lshl_b32 s67, s58, 17
    s_add_u32 s65, s67, 1048576
L_maxloop_59:
    s_add_u32 m0, s61, 0
    s_nop 0
    buffer_load_dwordx4 v3, s[16:19], s63 offen offset:0  lds
    s_add_u32 m0, s61, 32
    s_nop 0
    buffer_load_dwordx4 v3, s[16:19], s63 offen offset:1024  lds
    s_add_u32 m0, s61, 64
    s_nop 0
    buffer_load_dwordx4 v3, s[16:19], s63 offen offset:2048  lds
    s_add_u32 m0, s61, 96
    s_nop 0
    buffer_load_dwordx4 v3, s[16:19], s63 offen offset:3072  lds
    s_add_u32 s63, s63, 16384
    s_waitcnt vmcnt(0)
    s_barrier
    ds_read_b128 v[176:179], v5 offset:0
    ds_read_b128 v[180:183], v5 offset:64
    ds_read_b128 v[184:187], v5 offset:128
    ds_read_b128 v[188:191], v5 offset:192
    s_waitcnt lgkmcnt(0)
    v_mfma_f32_16x16x32_bf16 v[80:83], v[176:179], v[16:19], 0
    v_mfma_f32_16x16x32_bf16 v[80:83], v[180:183], v[20:23], v[80:83]
    v_mfma_f32_16x16x32_bf16 v[80:83], v[184:187], v[24:27], v[80:83]
    v_mfma_f32_16x16x32_bf16 v[80:83], v[188:191], v[28:31], v[80:83]
    v_mfma_f32_16x16x32_bf16 v[84:87], v[188:191], v[44:47], 0
    v_mfma_f32_16x16x32_bf16 v[84:87], v[184:187], v[40:43], v[84:87]
    v_mfma_f32_16x16x32_bf16 v[84:87], v[180:183], v[36:39], v[84:87]
    v_mfma_f32_16x16x32_bf16 v[84:87], v[176:179], v[32:35], v[84:87]
    v_mfma_f32_16x16x32_bf16 v[88:91], v[176:179], v[48:51], 0
    v_mfma_f32_16x16x32_bf16 v[88:91], v[180:183], v[52:55], v[88:91]
    v_mfma_f32_16x16x32_bf16 v[88:91], v[184:187], v[56:59], v[88:91]
    v_mfma_f32_16x16x32_bf16 v[88:91], v[188:191], v[60:63], v[88:91]
    v_mfma_f32_16x16x32_bf16 v[92:95], v[188:191], v[76:79], 0
    v_mfma_f32_16x16x32_bf16 v[92:95], v[184:187], v[72:75], v[92:95]
    v_mfma_f32_16x16x32_bf16 v[92:95], v[180:183], v[68:71], v[92:95]
    v_mfma_f32_16x16x32_bf16 v[92:95], v[176:179], v[64:67], v[92:95]
    s_nop 7
    v_max3_f32 v96, v96, v80, v81
    v_max3_f32 v96, v96, v82, v83
    v_max3_f32 v100, v100, v84, v85
    v_max3_f32 v100, v100, v86, v87
    v_max3_f32 v104, v104, v88, v89
    v_max3_f32 v104, v104, v90, v91
    v_max3_f32 v108, v108, v92, v93
    v_max3_f32 v108, v108, v94, v95
    ds_read_b128 v[192:195], v5 offset:256
    ds_read_b128 v[196:199], v5 offset:320
    ds_read_b128 v[200:203], v5 offset:384
    ds_read_b128 v[204:207], v5 offset:448
    s_waitcnt lgkmcnt(0)
    v_mfma_f32_16x16x32_bf16 v[80:83], v[192:195], v[16:19], 0
    v_mfma_f32_16x16x32_bf16 v[80:83], v[196:199], v[20:23], v[80:83]
    v_mfma_f32_16x16x32_bf16 v[80:83], v[200:203], v[24:27], v[80:83]
    v_mfma_f32_16x16x32_bf16 v[80:83], v[204:207], v[28:31], v[80:83]
    v_mfma_f32_16x16x32_bf16 v[84:87], v[204:207], v[44:47], 0
    v_mfma_f32_16x16x32_bf16 v[84:87], v[200:203], v[40:43], v[84:87]
    v_mfma_f32_16x16x32_bf16 v[84:87], v[196:199], v[36:39], v[84:87]
    v_mfma_f32_16x16x32_bf16 v[84:87], v[192:195], v[32:35], v[84:87]
    v_mfma_f32_16x16x32_bf16 v[88:91], v[192:195], v[48:51], 0
    v_mfma_f32_16x16x32_bf16 v[88:91], v[196:199], v[52:55], v[88:91]
    v_mfma_f32_16x16x32_bf16 v[88:91], v[200:203], v[56:59], v[88:91]
    v_mfma_f32_16x16x32_bf16 v[88:91], v[204:207], v[60:63], v[88:91]
    v_mfma_f32_16x16x32_bf16 v[92:95], v[204:207], v[76:79], 0
    v_mfma_f32_16x16x32_bf16 v[92:95], v[200:203], v[72:75], v[92:95]
    v_mfma_f32_16x16x32_bf16 v[92:95], v[196:199], v[68:71], v[92:95]
    v_mfma_f32_16x16x32_bf16 v[92:95], v[192:195], v[64:67], v[92:95]
    s_nop 7
    v_max3_f32 v96, v96, v80, v81
    v_max3_f32 v96, v96, v82, v83
    v_max3_f32 v100, v100, v84, v85
    v_max3_f32 v100, v100, v86, v87
    v_max3_f32 v104, v104, v88, v89
    v_max3_f32 v104, v104, v90, v91
    v_max3_f32 v108, v108, v92, v93
    v_max3_f32 v108, v108, v94, v95
    ds_read_b128 v[176:179], v5 offset:512
    ds_read_b128 v[180:183], v5 offset:576
    ds_read_b128 v[184:187], v5 offset:640
    ds_read_b128 v[188:191], v5 offset:704
    s_waitcnt lgkmcnt(0)
    v_mfma_f32_16x16x32_bf16 v[80:83], v[176:179], v[16:19], 0
    v_mfma_f32_16x16x32_bf16 v[80:83], v[180:183], v[20:23], v[80:83]
    v_mfma_f32_16x16x32_bf16 v[80:83], v[184:187], v[24:27], v[80:83]
    v_mfma_f32_16x16x32_bf16 v[80:83], v[188:191], v[28:31], v[80:83]
    v_mfma_f32_16x16x32_bf16 v[84:87], v[188:191], v[44:47], 0
    v_mfma_f32_16x16x32_bf16 v[84:87], v[184:187], v[40:43], v[84:87]
    v_mfma_f32_16x16x32_bf16 v[84:87], v[180:183], v[36:39], v[84:87]
    v_mfma_f32_16x16x32_bf16 v[84:87], v[176:179], v[32:35], v[84:87]
    v_mfma_f32_16x16x32_bf16 v[88:91], v[176:179], v[48:51], 0
    v_mfma_f32_16x16x32_bf16 v[88:91], v[180:183], v[52:55], v[88:91]
    v_mfma_f32_16x16x32_bf16 v[88:91], v[184:187], v[56:59], v[88:91]
    v_mfma_f32_16x16x32_bf16 v[88:91], v[188:191], v[60:63], v[88:91]
    v_mfma_f32_16x16x32_bf16 v[92:95], v[188:191], v[76:79], 0
    v_mfma_f32_16x16x32_bf16 v[92:95], v[184:187], v[72:75], v[92:95]
    v_mfma_f32_16x16x32_bf16 v[92:95], v[180:183], v[68:71], v[92:95]
    v_mfma_f32_16x16x32_bf16 v[92:95], v[176:179], v[64:67], v[92:95]
    s_nop 7
    v_max3_f32 v96, v96, v80, v81
    v_max3_f32 v96, v96, v82, v83
    v_max3_f32 v100, v100, v84, v85
    v_max3_f32 v100, v100, v86, v87
    v_max3_f32 v104, v104, v88, v89
    v_max3_f32 v104, v104, v90, v91
    v_max3_f32 v108, v108, v92, v93
    v_max3_f32 v108, v108, v94, v95
    ds_read_b128 v[192:195], v5 offset:768
    ds_read_b128 v[196:199], v5 offset:832
    ds_read_b128 v[200:203], v5 offset:896
    ds_read_b128 v[204:207], v5 offset:960
    s_waitcnt lgkmcnt(0)
    v_mfma_f32_16x16x32_bf16 v[80:83], v[192:195], v[16:19], 0
    v_mfma_f32_16x16x32_bf16 v[80:83], v[196:199], v[20:23], v[80:83]
    v_mfma_f32_16x16x32_bf16 v[80:83], v[200:203], v[24:27], v[80:83]
    v_mfma_f32_16x16x32_bf16 v[80:83], v[204:207], v[28:31], v[80:83]
    v_mfma_f32_16x16x32_bf16 v[84:87], v[204:207], v[44:47], 0
    v_mfma_f32_16x16x32_bf16 v[84:87], v[200:203], v[40:43], v[84:87]
    v_mfma_f32_16x16x32_bf16 v[84:87], v[196:199], v[36:39], v[84:87]
    v_mfma_f32_16x16x32_bf16 v[84:87], v[192:195], v[32:35], v[84:87]
    v_mfma_f32_16x16x32_bf16 v[88:91], v[192:195], v[48:51], 0
    v_mfma_f32_16x16x32_bf16 v[88:91], v[196:199], v[52:55], v[88:91]
    v_mfma_f32_16x16x32_bf16 v[88:91], v[200:203], v[56:59], v[88:91]
    v_mfma_f32_16x16x32_bf16 v[88:91], v[204:207], v[60:63], v[88:91]
    v_mfma_f32_16x16x32_bf16 v[92:95], v[204:207], v[76:79], 0
    v_mfma_f32_16x16x32_bf16 v[92:95], v[200:203], v[72:75], v[92:95]
    v_mfma_f32_16x16x32_bf16 v[92:95], v[196:199], v[68:71], v[92:95]
    v_mfma_f32_16x16x32_bf16 v[92:95], v[192:195], v[64:67], v[92:95]
    s_nop 7
    v_max3_f32 v96, v96, v80, v81
    v_max3_f32 v96, v96, v82, v83
    v_max3_f32 v100, v100, v84, v85
    v_max3_f32 v100, v100, v86, v87
    v_max3_f32 v104, v104, v88, v89
    v_max3_f32 v104, v104, v90, v91
    v_max3_f32 v108, v108, v92, v93
    v_max3_f32 v108, v108, v94, v95
    s_barrier
    s_cmp_lt_u32 s63, 524288
    s_cbranch_scc1 L_maxloop_59
    v_mov_b32 v97, v96
    v_mov_b32 v101, v100
    v_mov_b32 v105, v104
    v_mov_b32 v109, v108
    v_permlane16_swap_b32 v96, v97
    v_permlane16_swap_b32 v100, v101
    v_permlane16_swap_b32 v104, v105
    v_permlane16_swap_b32 v108, v109
    v_max_f32 v96, v96, v97
    v_max_f32 v100, v100, v101
    v_max_f32 v104, v104, v105
    v_max_f32 v108, v108, v109
    v_mov_b32 v97, v96
    v_mov_b32 v101, v100
    v_mov_b32 v105, v104
    v_mov_b32 v109, v108
    v_permlane32_swap_b32 v96, v97
    v_permlane32_swap_b32 v100, v101
    v_permlane32_swap_b32 v104, v105
    v_permlane32_swap_b32 v108, v109
    v_max_f32 v96, v96, v97
    v_max_f32 v100, v100, v101
    v_max_f32 v104, v104, v105
    v_max_f32 v108, v108, v109
    v_sub_f32 v96, 0, v96
    v_mov_b32 v97, v96
    v_mov_b32 v98, v96
    v_mov_b32 v99, v96
    v_sub_f32 v100, 0, v100
    v_mov_b32 v101, v100
    v_mov_b32 v102, v100
    v_mov_b32 v103, v100
    v_sub_f32 v104, 0, v104
    v_mov_b32 v105, v104
    v_mov_b32 v106, v104
    v_mov_b32 v107, v104
    v_sub_f32 v108, 0, v108
    v_mov_b32 v109, v108
    v_mov_b32 v110, v108
    v_mov_b32 v111, v108
    v_accvgpr_write_b32 a0, 0
    v_accvgpr_write_b32 a1, 0
    v_accvgpr_write_b32 a2, 0
    v_accvgpr_write_b32 a3, 0
    v_accvgpr_write_b32 a4, 0
    v_accvgpr_write_b32 a5, 0
    v_accvgpr_write_b32 a6, 0
    v_accvgpr_write_b32 a7, 0
    v_accvgpr_write_b32 a8, 0
    v_accvgpr_write_b32 a9, 0
    v_accvgpr_write_b32 a10, 0
    v_accvgpr_write_b32 a11, 0
    v_accvgpr_write_b32 a12, 0
    v_accvgpr_write_b32 a13, 0
    v_accvgpr_write_b32 a14, 0
    v_accvgpr_write_b32 a15, 0
    v_accvgpr_write_b32 a16, 0
    v_accvgpr_write_b32 a17, 0
    v_accvgpr_write_b32 a18, 0
    v_accvgpr_write_b32 a19, 0
    v_accvgpr_write_b32 a20, 0
    v_accvgpr_write_b32 a21, 0
    v_accvgpr_write_b32 a22, 0
    v_accvgpr_write_b32 a23, 0
    v_accvgpr_write_b32 a24, 0
    v_accvgpr_write_b32 a25, 0
    v_accvgpr_write_b32 a26, 0
    v_accvgpr_write_b32 a27, 0
    v_accvgpr_write_b32 a28, 0
    v_accvgpr_write_b32 a29, 0
    v_accvgpr_write_b32 a30, 0
    v_accvgpr_write_b32 a31, 0
    v_accvgpr_write_b32 a32, 0
    v_accvgpr_write_b32 a33, 0
    v_accvgpr_write_b32 a34, 0
    v_accvgpr_write_b32 a35, 0
    v_accvgpr_write_b32 a36, 0
    v_accvgpr_write_b32 a37, 0
    v_accvgpr_write_b32 a38, 0
    v_accvgpr_write_b32 a39, 0
    v_accvgpr_write_b32 a40, 0
    v_accvgpr_write_b32 a41, 0
    v_accvgpr_write_b32 a42, 0
    v_accvgpr_write_b32 a43, 0
    v_accvgpr_write_b32 a44, 0
    v_accvgpr_write_b32 a45, 0
    v_accvgpr_write_b32 a46, 0
    v_accvgpr_write_b32 a47, 0
    v_accvgpr_write_b32 a48, 0
    v_accvgpr_write_b32 a49, 0
    v_accvgpr_write_b32 a50, 0
    v_accvgpr_write_b32 a51, 0
    v_accvgpr_write_b32 a52, 0
    v_accvgpr_write_b32 a53, 0
    v_accvgpr_write_b32 a54, 0
    v_accvgpr_write_b32 a55, 0
    v_accvgpr_write_b32 a56, 0
    v_accvgpr_write_b32 a57, 0
    v_accvgpr_write_b32 a58, 0
    v_accvgpr_write_b32 a59, 0
    v_accvgpr_write_b32 a60, 0
    v_accvgpr_write_b32 a61, 0
    v_accvgpr_write_b32 a62, 0
    v_accvgpr_write_b32 a63, 0
    v_accvgpr_write_b32 a64, 0
    v_accvgpr_write_b32 a65, 0
    v_accvgpr_write_b32 a66, 0
    v_accvgpr_write_b32 a67, 0
    v_accvgpr_write_b32 a68, 0
    v_accvgpr_write_b32 a69, 0
    v_accvgpr_write_b32 a70, 0
    v_accvgpr_write_b32 a71, 0
    v_accvgpr_write_b32 a72, 0
    v_accvgpr_write_b32 a73, 0
    v_accvgpr_write_b32 a74, 0
    v_accvgpr_write_b32 a75, 0
    v_accvgpr_write_b32 a76, 0
    v_accvgpr_write_b32 a77, 0
    v_accvgpr_write_b32 a78, 0
    v_accvgpr_write_b32 a79, 0
    v_accvgpr_write_b32 a80, 0
    v_accvgpr_write_b32 a81, 0
    v_accvgpr_write_b32 a82, 0
    v_accvgpr_write_b32 a83, 0
    v_accvgpr_write_b32 a84, 0
    v_accvgpr_write_b32 a85, 0
    v_accvgpr_write_b32 a86, 0
    v_accvgpr_write_b32 a87, 0
    v_accvgpr_write_b32 a88, 0
    v_accvgpr_write_b32 a89, 0
    v_accvgpr_write_b32 a90, 0
    v_accvgpr_write_b32 a91, 0
    v_accvgpr_write_b32 a92, 0
    v_accvgpr_write_b32 a93, 0
    v_accvgpr_write_b32 a94, 0
    v_accvgpr_write_b32 a95, 0
    v_accvgpr_write_b32 a96, 0
    v_accvgpr_write_b32 a97, 0
    v_accvgpr_write_b32 a98, 0
    v_accvgpr_write_b32 a99, 0
    v_accvgpr_write_b32 a100, 0
    v_accvgpr_write_b32 a101, 0
    v_accvgpr_write_b32 a102, 0
    v_accvgpr_write_b32 a103, 0
    v_accvgpr_write_b32 a104, 0
    v_accvgpr_write_b32 a105, 0
    v_accvgpr_write_b32 a106, 0
    v_accvgpr_write_b32 a107, 0
    v_accvgpr_write_b32 a108, 0
    v_accvgpr_write_b32 a109, 0
    v_accvgpr_write_b32 a110, 0
    v_accvgpr_write_b32 a111, 0
    v_accvgpr_write_b32 a112, 0
    v_accvgpr_write_b32 a113, 0
    v_accvgpr_write_b32 a114, 0
    v_accvgpr_write_b32 a115, 0
    v_accvgpr_write_b32 a116, 0
    v_accvgpr_write_b32 a117, 0
    v_accvgpr_write_b32 a118, 0
    v_accvgpr_write_b32 a119, 0
    v_accvgpr_write_b32 a120, 0
    v_accvgpr_write_b32 a121, 0
    v_accvgpr_write_b32 a122, 0
    v_accvgpr_write_b32 a123, 0
    v_accvgpr_write_b32 a124, 0
    v_accvgpr_write_b32 a125, 0
    v_accvgpr_write_b32 a126, 0
    v_accvgpr_write_b32 a127, 0
    v_accvgpr_write_b32 a128, 0
    v_accvgpr_write_b32 a129, 0
    v_accvgpr_write_b32 a130, 0
    v_accvgpr_write_b32 a131, 0
    v_accvgpr_write_b32 a132, 0
    v_accvgpr_write_b32 a133, 0
    v_accvgpr_write_b32 a134, 0
    v_accvgpr_write_b32 a135, 0
    v_accvgpr_write_b32 a136, 0
    v_accvgpr_write_b32 a137, 0
    v_accvgpr_write_b32 a138, 0
    v_accvgpr_write_b32 a139, 0
    v_accvgpr_write_b32 a140, 0
    v_accvgpr_write_b32 a141, 0
    v_accvgpr_write_b32 a142, 0
    v_accvgpr_write_b32 a143, 0
    s_mov_b32 s63, 0
    s_add_u32 m0, s61, 0
    s_nop 0
    buffer_load_dwordx4 v3, s[16:19], s63 offen offset:0  lds
    s_add_u32 m0, s61, 32
    s_nop 0
    buffer_load_dwordx4 v3, s[16:19], s63 offen offset:1024  lds
    s_add_u32 m0, s61, 64
    s_nop 0
    buffer_load_dwordx4 v3, s[16:19], s63 offen offset:2048  lds
    s_add_u32 m0, s61, 96
    s_nop 0
    buffer_load_dwordx4 v3, s[16:19], s63 offen offset:3072  lds
    s_add_u32 s63, s63, 16384
    s_add_u32 m0, s61, 16896
    s_nop 0
    buffer_load_dwordx4 v3, s[16:19], s63 offen offset:0  lds
    s_add_u32 m0, s61, 16928
    s_nop 0
    buffer_load_dwordx4 v3, s[16:19], s63 offen offset:1024  lds
    s_add_u32 m0, s61, 16960
    s_nop 0
    buffer_load_dwordx4 v3, s[16:19], s63 offen offset:2048  lds
    s_add_u32 m0, s61, 16992
    s_nop 0
    buffer_load_dwordx4 v3, s[16:19], s63 offen offset:3072  lds
    s_add_u32 s63, s63, 16384
    s_add_u32 m0, s61, 67584
    s_nop 0
    buffer_load_dwordx4 v3, s[20:23], s64 offen offset:0  lds
    s_add_u32 m0, s61, 67616
    s_nop 0
    buffer_load_dwordx4 v3, s[20:23], s64 offen offset:1024  lds
    s_add_u32 m0, s61, 67648
    s_nop 0
    buffer_load_dwordx4 v3, s[20:23], s64 offen offset:2048  lds
    s_add_u32 m0, s61, 67680
    s_nop 0
    buffer_load_dwordx4 v3, s[20:23], s64 offen offset:3072  lds
    s_add_u32 s64, s64, 16384
    s_add_u32 m0, s61, 33792
    s_nop 0
    buffer_load_dwordx4 v3, s[16:19], s63 offen offset:0  lds
    s_add_u32 m0, s61, 33824
    s_nop 0
    buffer_load_dwordx4 v3, s[16:19], s63 offen offset:1024  lds
    s_add_u32 m0, s61, 33856
    s_nop 0
    buffer_load_dwordx4 v3, s[16:19], s63 offen offset:2048  lds
    s_add_u32 m0, s61, 33888
    s_nop 0
    buffer_load_dwordx4 v3, s[16:19], s63 offen offset:3072  lds
    s_add_u32 s63, s63, 16384
    s_add_u32 m0, s61, 84480
    s_nop 0
    buffer_load_dwordx4 v3, s[20:23], s64 offen offset:0  lds
    s_add_u32 m0, s61, 84512
    s_nop 0
    buffer_load_dwordx4 v3, s[20:23], s64 offen offset:1024  lds
    s_add_u32 m0, s61, 84544
    s_nop 0
    buffer_load_dwordx4 v3, s[20:23], s64 offen offset:2048  lds
    s_add_u32 m0, s61, 84576
    s_nop 0
    buffer_load_dwordx4 v3, s[20:23], s64 offen offset:3072  lds
    s_add_u32 s64, s64, 16384
    s_waitcnt vmcnt(16)
    s_barrier
    ds_read_b128 v[176:179], v5 offset:0
    ds_read_b128 v[180:183], v5 offset:64
    ds_read_b128 v[184:187], v5 offset:128
    ds_read_b128 v[188:191], v5 offset:192
    ds_read_b128 v[192:195], v5 offset:256
    s_waitcnt lgkmcnt(1)
    v_mfma_f32_16x16x32_bf16 v[80:83], v[176:179], v[16:19], v[96:99]
    v_mfma_f32_16x16x32_bf16 v[80:83], v[180:183], v[20:23], v[80:83]
    v_mfma_f32_16x16x32_bf16 v[80:83], v[184:187], v[24:27], v[80:83]
    v_mfma_f32_16x16x32_bf16 v[80:83], v[188:191], v[28:31], v[80:83]
    ds_read_b128 v[196:199], v5 offset:320
    v_mfma_f32_16x16x32_bf16 v[84:87], v[188:191], v[44:47], v[100:103]
    v_mfma_f32_16x16x32_bf16 v[84:87], v[184:187], v[40:43], v[84:87]
    v_mfma_f32_16x16x32_bf16 v[84:87], v[180:183], v[36:39], v[84:87]
    v_mfma_f32_16x16x32_bf16 v[84:87], v[176:179], v[32:35], v[84:87]
    ds_read_b128 v[200:203], v5 offset:384
    s_nop 1
    v_mfma_f32_16x16x32_bf16 v[88:91], v[176:179], v[48:51], v[104:107]
    v_exp_f32 v80, v80
    v_mfma_f32_16x16x32_bf16 v[88:91], v[180:183], v[52:55], v[88:91]
    v_exp_f32 v81, v81
    v_mfma_f32_16x16x32_bf16 v[88:91], v[184:187], v[56:59], v[88:91]
    v_exp_f32 v82, v82
    v_mfma_f32_16x16x32_bf16 v[88:91], v[188:191], v[60:63], v[88:91]
    ds_read_b128 v[204:207], v5 offset:448
    v_exp_f32 v83, v83
    v_mfma_f32_16x16x32_bf16 v[92:95], v[188:191], v[76:79], v[108:111]
    v_cvt_pk_bf16_f32 v112, v80, v81
    v_cvt_pk_bf16_f32 v113, v82, v83
    v_exp_f32 v84, v84
    v_mfma_f32_16x16x32_bf16 v[92:95], v[184:187], v[72:75], v[92:95]
    v_exp_f32 v85, v85
    v_mfma_f32_16x16x32_bf16 v[92:95], v[180:183], v[68:71], v[92:95]
    v_exp_f32 v86, v86
    v_mfma_f32_16x16x32_bf16 v[92:95], v[176:179], v[64:67], v[92:95]
    ds_read_b128 v[176:179], v5 offset:512
    v_exp_f32 v87, v87
    s_waitcnt lgkmcnt(1)
    v_mfma_f32_16x16x32_bf16 v[80:83], v[192:195], v[16:19], v[96:99]
    v_cvt_pk_bf16_f32 v120, v84, v85
    v_cvt_pk_bf16_f32 v121, v86, v87
    v_exp_f32 v88, v88
    v_mfma_f32_16x16x32_bf16 v[80:83], v[196:199], v[20:23], v[80:83]
    v_exp_f32 v89, v89
    v_mfma_f32_16x16x32_bf16 v[80:83], v[200:203], v[24:27], v[80:83]
    v_exp_f32 v90, v90
    v_mfma_f32_16x16x32_bf16 v[80:83], v[204:207], v[28:31], v[80:83]
    ds_read_b128 v[180:183], v5 offset:576
    v_exp_f32 v91, v91
    v_mfma_f32_16x16x32_bf16 v[84:87], v[204:207], v[44:47], v[100:103]
    v_cvt_pk_bf16_f32 v128, v88, v89
    v_cvt_pk_bf16_f32 v129, v90, v91
    v_exp_f32 v92, v92
    v_mfma_f32_16x16x32_bf16 v[84:87], v[200:203], v[40:43], v[84:87]
    v_exp_f32 v93, v93
    v_mfma_f32_16x16x32_bf16 v[84:87], v[196:199], v[36:39], v[84:87]
    v_exp_f32 v94, v94
    v_mfma_f32_16x16x32_bf16 v[84:87], v[192:195], v[32:35], v[84:87]
    ds_read_b128 v[184:187], v5 offset:640
    v_exp_f32 v95, v95
    v_mfma_f32_16x16x32_bf16 v[88:91], v[192:195], v[48:51], v[104:107]
    v_cvt_pk_bf16_f32 v136, v92, v93
    v_cvt_pk_bf16_f32 v137, v94, v95
    v_exp_f32 v80, v80
    v_mfma_f32_16x16x32_bf16 v[88:91], v[196:199], v[52:55], v[88:91]
    v_exp_f32 v81, v81
    v_mfma_f32_16x16x32_bf16 v[88:91], v[200:203], v[56:59], v[88:91]
    v_exp_f32 v82, v82
    v_mfma_f32_16x16x32_bf16 v[88:91], v[204:207], v[60:63], v[88:91]
    ds_read_b128 v[188:191], v5 offset:704
    v_exp_f32 v83, v83
    v_mfma_f32_16x16x32_bf16 v[92:95], v[204:207], v[76:79], v[108:111]
    v_cvt_pk_bf16_f32 v114, v80, v81
    v_cvt_pk_bf16_f32 v115, v82, v83
    v_exp_f32 v84, v84
    v_mfma_f32_16x16x32_bf16 v[92:95], v[200:203], v[72:75], v[92:95]
    v_exp_f32 v85, v85
    v_mfma_f32_16x16x32_bf16 v[92:95], v[196:199], v[68:71], v[92:95]
    v_exp_f32 v86, v86
    v_mfma_f32_16x16x32_bf16 v[92:95], v[192:195], v[64:67], v[92:95]
    ds_read_b128 v[192:195], v5 offset:768
    v_exp_f32 v87, v87
    s_waitcnt lgkmcnt(1)
    v_mfma_f32_16x16x32_bf16 v[80:83], v[176:179], v[16:19], v[96:99]
    v_cvt_pk_bf16_f32 v122, v84, v85
    v_cvt_pk_bf16_f32 v123, v86, v87
    v_exp_f32 v88, v88
    v_mfma_f32_16x16x32_bf16 v[80:83], v[180:183], v[20:23], v[80:83]
    v_exp_f32 v89, v89
    v_mfma_f32_16x16x32_bf16 v[80:83], v[184:187], v[24:27], v[80:83]
    v_exp_f32 v90, v90
    v_mfma_f32_16x16x32_bf16 v[80:83], v[188:191], v[28:31], v[80:83]
    ds_read_b128 v[196:199], v5 offset:832
    v_exp_f32 v91, v91
    v_mfma_f32_16x16x32_bf16 v[84:87], v[188:191], v[44:47], v[100:103]
    v_cvt_pk_bf16_f32 v130, v88, v89
    v_cvt_pk_bf16_f32 v131, v90, v91
    v_exp_f32 v92, v92
    v_mfma_f32_16x16x32_bf16 v[84:87], v[184:187], v[40:43], v[84:87]
    v_exp_f32 v93, v93
    v_mfma_f32_16x16x32_bf16 v[84:87], v[180:183], v[36:39], v[84:87]
    v_exp_f32 v94, v94
    v_mfma_f32_16x16x32_bf16 v[84:87], v[176:179], v[32:35], v[84:87]
    ds_read_b128 v[200:203], v5 offset:896
    v_exp_f32 v95, v95
    v_mfma_f32_16x16x32_bf16 v[88:91], v[176:179], v[48:51], v[104:107]
    v_cvt_pk_bf16_f32 v138, v92, v93
    v_cvt_pk_bf16_f32 v139, v94, v95
    v_exp_f32 v80, v80
    v_mfma_f32_16x16x32_bf16 v[88:91], v[180:183], v[52:55], v[88:91]
    v_exp_f32 v81, v81
    v_mfma_f32_16x16x32_bf16 v[88:91], v[184:187], v[56:59], v[88:91]
    v_exp_f32 v82, v82
    v_mfma_f32_16x16x32_bf16 v[88:91], v[188:191], v[60:63], v[88:91]
    ds_read_b128 v[204:207], v5 offset:960
    v_exp_f32 v83, v83
    s_waitcnt vmcnt(8)
    s_barrier
    v_mfma_f32_16x16x32_bf16 v[92:95], v[188:191], v[76:79], v[108:111]
    s_add_u32 m0, s61, 50688
    v_cvt_pk_bf16_f32 v116, v80, v81
    v_cvt_pk_bf16_f32 v117, v82, v83
    v_exp_f32 v84, v84
    v_mfma_f32_16x16x32_bf16 v[92:95], v[184:187], v[72:75], v[92:95]
    buffer_load_dwordx4 v3, s[16:19], s63 offen offset:0  lds
    v_exp_f32 v85, v85
    v_mfma_f32_16x16x32_bf16 v[92:95], v[180:183], v[68:71], v[92:95]
    v_exp_f32 v86, v86
    v_mfma_f32_16x16x32_bf16 v[92:95], v[176:179], v[64:67], v[92:95]
    ds_read_b128 v[176:179], v5 offset:16896
    v_exp_f32 v87, v87
    s_waitcnt lgkmcnt(1)
    v_mfma_f32_16x16x32_bf16 v[80:83], v[192:195], v[16:19], v[96:99]
    v_cvt_pk_bf16_f32 v124, v84, v85
    v_cvt_pk_bf16_f32 v125, v86, v87
    v_exp_f32 v88, v88
    v_mfma_f32_16x16x32_bf16 v[80:83], v[196:199], v[20:23], v[80:83]
    v_exp_f32 v89, v89
    v_mfma_f32_16x16x32_bf16 v[80:83], v[200:203], v[24:27], v[80:83]
    v_exp_f32 v90, v90
    v_mfma_f32_16x16x32_bf16 v[80:83], v[204:207], v[28:31], v[80:83]
    ds_read_b128 v[180:183], v5 offset:16960
    v_exp_f32 v91, v91
    v_mfma_f32_16x16x32_bf16 v[84:87], v[204:207], v[44:47], v[100:103]
    s_add_u32 m0, s61, 50720
    v_cvt_pk_bf16_f32 v132, v88, v89
    v_cvt_pk_bf16_f32 v133, v90, v91
    v_exp_f32 v92, v92
    v_mfma_f32_16x16x32_bf16 v[84:87], v[200:203], v[40:43], v[84:87]
    buffer_load_dwordx4 v3, s[16:19], s63 offen offset:1024  lds
    v_exp_f32 v93, v93
    v_mfma_f32_16x16x32_bf16 v[84:87], v[196:199], v[36:39], v[84:87]
    v_exp_f32 v94, v94
    v_mfma_f32_16x16x32_bf16 v[84:87], v[192:195], v[32:35], v[84:87]
    ds_read_b128 v[184:187], v5 offset:17024
    v_exp_f32 v95, v95
    v_mfma_f32_16x16x32_bf16 v[88:91], v[192:195], v[48:51], v[104:107]
    ds_read_b64_tr_b16 v[208:209], v4 offset:0
    ds_read_b64_tr_b16 v[210:211], v4 offset:256
    v_cvt_pk_bf16_f32 v140, v92, v93
    v_cvt_pk_bf16_f32 v141, v94, v95
    v_exp_f32 v80, v80
    v_mfma_f32_16x16x32_bf16 v[88:91], v[196:199], v[52:55], v[88:91]
    v_exp_f32 v81, v81
    v_mfma_f32_16x16x32_bf16 v[88:91], v[200:203], v[56:59], v[88:91]
    v_exp_f32 v82, v82
    v_mfma_f32_16x16x32_bf16 v[88:91], v[204:207], v[60:63], v[88:91]
    ds_read_b128 v[188:191], v5 offset:17088
    v_exp_f32 v83, v83
    v_mfma_f32_16x16x32_bf16 v[92:95], v[204:207], v[76:79], v[108:111]
    s_add_u32 m0, s61, 50752
    ds_read_b64_tr_b16 v[212:213], v4 offset:512
    ds_read_b64_tr_b16 v[214:215], v4 offset:768
    v_cvt_pk_bf16_f32 v118, v80, v81
    v_cvt_pk_bf16_f32 v119, v82, v83
    v_exp_f32 v84, v84
    v_mfma_f32_16x16x32_bf16 v[92:95], v[200:203], v[72:75], v[92:95]
    buffer_load_dwordx4 v3, s[16:19], s63 offen offset:2048  lds
    v_exp_f32 v85, v85
    v_mfma_f32_16x16x32_bf16 v[92:95], v[196:199], v[68:71], v[92:95]
    v_exp_f32 v86, v86
    v_mfma_f32_16x16x32_bf16 v[92:95], v[192:195], v[64:67], v[92:95]
    ds_read_b128 v[192:195], v5 offset:17152
    v_exp_f32 v87, v87
    s_waitcnt lgkmcnt(3)
    s_nop 0
    v_cvt_pk_bf16_f32 v126, v84, v85
    v_cvt_pk_bf16_f32 v127, v86, v87
    v_exp_f32 v88, v88
    v_exp_f32 v89, v89
    v_exp_f32 v90, v90
    v_exp_f32 v91, v91
    s_mov_b32 s49, 0
    .p2align 3
L_attn_60:
    v_mfma_f32_16x16x32_bf16 v[80:83], v[176:179], v[16:19], v[96:99]
    v_exp_f32 v92, v92
    v_mfma_f32_16x16x32_bf16 v[80:83], v[180:183], v[20:23], v[80:83]
    v_cvt_pk_bf16_f32 v134, v88, v89
    v_cvt_pk_bf16_f32 v135, v90, v91
    v_mfma_f32_16x16x32_bf16 v[80:83], v[184:187], v[24:27], v[80:83]
    v_exp_f32 v93, v93
    v_mfma_f32_16x16x32_bf16 v[80:83], v[188:191], v[28:31], v[80:83]
    s_waitcnt lgkmcnt(1)
    ds_read_b64_tr_b16 v[216:217], v4 offset:32
    ds_read_b64_tr_b16 v[218:219], v4 offset:288
    v_mfma_f32_16x16x32_bf16 v[84:87], v[188:191], v[44:47], v[100:103]
    v_exp_f32 v94, v94
    v_mfma_f32_16x16x32_bf16 v[84:87], v[184:187], v[40:43], v[84:87]
    ds_read_b128 v[196:199], v5 offset:17216
    v_mfma_f32_16x16x32_bf16 v[84:87], v[180:183], v[36:39], v[84:87]
    v_exp_f32 v95, v95
    v_mfma_f32_16x16x32_bf16 v[84:87], v[176:179], v[32:35], v[84:87]
    v_mfma_f32_16x16x32_bf16 a[0:3], v[208:211], v[112:115], a[0:3]
    v_exp_f32 v80, v80
    v_mfma_f32_16x16x32_bf16 a[0:3], v[212:215], v[116:119], a[0:3]
    v_cvt_pk_bf16_f32 v142, v92, v93
    v_cvt_pk_bf16_f32 v143, v94, v95
    v_mfma_f32_16x16x32_bf16 a[32:35], v[208:211], v[120:123], a[32:35]
    v_exp_f32 v81, v81
    v_mfma_f32_16x16x32_bf16 a[32:35], v[212:215], v[124:127], a[32:35]
    ds_read_b64_tr_b16 v[220:221], v4 offset:544
    ds_read_b64_tr_b16 v[222:223], v4 offset:800
    v_mfma_f32_16x16x32_bf16 a[64:67], v[208:211], v[128:131], a[64:67]
    v_exp_f32 v82, v82
    v_mfma_f32_16x16x32_bf16 a[64:67], v[212:215], v[132:135], a[64:67]
    ds_read_b128 v[200:203], v5 offset:17280
    v_mfma_f32_16x16x32_bf16 a[96:99], v[208:211], v[136:139], a[96:99]
    s_add_u32 m0, s61, 50784
    v_exp_f32 v83, v83
    v_mfma_f32_16x16x32_bf16 a[96:99], v[212:215], v[140:143], a[96:99]
    buffer_load_dwordx4 v3, s[16:19], s63 offen offset:3072  lds
    s_add_u32 s63, s63, 16384
    v_mfma_f32_16x16x32_bf16 v[88:91], v[176:179], v[48:51], v[104:107]
    v_exp_f32 v84, v84
    v_mfma_f32_16x16x32_bf16 v[88:91], v[180:183], v[52:55], v[88:91]
    v_cvt_pk_bf16_f32 v144, v80, v81
    v_cvt_pk_bf16_f32 v145, v82, v83
    v_mfma_f32_16x16x32_bf16 v[88:91], v[184:187], v[56:59], v[88:91]
    v_exp_f32 v85, v85
    v_mfma_f32_16x16x32_bf16 v[88:91], v[188:191], v[60:63], v[88:91]
    s_waitcnt lgkmcnt(1)
    ds_read_b64_tr_b16 v[208:209], v4 offset:64
    ds_read_b64_tr_b16 v[210:211], v4 offset:320
    v_mfma_f32_16x16x32_bf16 v[92:95], v[188:191], v[76:79], v[108:111]
    v_exp_f32 v86, v86
    v_mfma_f32_16x16x32_bf16 v[92:95], v[184:187], v[72:75], v[92:95]
    ds_read_b128 v[204:207], v5 offset:17344
    v_mfma_f32_16x16x32_bf16 v[92:95], v[180:183], v[68:71], v[92:95]
    v_exp_f32 v87, v87
    v_mfma_f32_16x16x32_bf16 v[92:95], v[176:179], v[64:67], v[92:95]
    v_mfma_f32_16x16x32_bf16 a[4:7], v[216:219], v[112:115], a[4:7]
    v_exp_f32 v88, v88
    v_mfma_f32_16x16x32_bf16 a[4:7], v[220:223], v[116:119], a[4:7]
    v_cvt_pk_bf16_f32 v152, v84, v85
    v_cvt_pk_bf16_f32 v153, v86, v87
    v_mfma_f32_16x16x32_bf16 a[36:39], v[216:219], v[120:123], a[36:39]
    v_exp_f32 v89, v89
    v_mfma_f32_16x16x32_bf16 a[36:39], v[220:223], v[124:127], a[36:39]
    ds_read_b64_tr_b16 v[212:213], v4 offset:576
    ds_read_b64_tr_b16 v[214:215], v4 offset:832
    v_mfma_f32_16x16x32_bf16 a[68:71], v[216:219], v[128:131], a[68:71]
    v_exp_f32 v90, v90
    v_mfma_f32_16x16x32_bf16 a[68:71], v[220:223], v[132:135], a[68:71]
    ds_read_b128 v[176:179], v5 offset:17408
    v_mfma_f32_16x16x32_bf16 a[100:103], v[216:219], v[136:139], a[100:103]
    s_add_u32 m0, s61, 101376
    v_exp_f32 v91, v91
    v_mfma_f32_16x16x32_bf16 a[100:103], v[220:223], v[140:143], a[100:103]
    buffer_load_dwordx4 v3, s[20:23], s64 offen offset:0  lds
    v_smfmac_f32_16x16x64_bf16 a[128:131], v[224:227], v[112:119], v228
    s_waitcnt lgkmcnt(3)
    v_mfma_f32_16x16x32_bf16 v[80:83], v[192:195], v[16:19], v[96:99]
    v_exp_f32 v92, v92
    v_mfma_f32_16x16x32_bf16 v[80:83], v[196:199], v[20:23], v[80:83]
    v_cvt_pk_bf16_f32 v160, v88, v89
    v_cvt_pk_bf16_f32 v161, v90, v91
    v_mfma_f32_16x16x32_bf16 v[80:83], v[200:203], v[24:27], v[80:83]
    v_exp_f32 v93, v93
    v_mfma_f32_16x16x32_bf16 v[80:83], v[204:207], v[28:31], v[80:83]
    s_waitcnt lgkmcnt(1)
    ds_read_b64_tr_b16 v[216:217], v4 offset:96
    ds_read_b64_tr_b16 v[218:219], v4 offset:352
    v_mfma_f32_16x16x32_bf16 v[84:87], v[204:207], v[44:47], v[100:103]
    v_exp_f32 v94, v94
    v_mfma_f32_16x16x32_bf16 v[84:87], v[200:203], v[40:43], v[84:87]
    ds_read_b128 v[180:183], v5 offset:17472
    v_mfma_f32_16x16x32_bf16 v[84:87], v[196:199], v[36:39], v[84:87]
    v_exp_f32 v95, v95
    v_mfma_f32_16x16x32_bf16 v[84:87], v[192:195], v[32:35], v[84:87]
    v_mfma_f32_16x16x32_bf16 a[8:11], v[208:211], v[112:115], a[8:11]
    v_exp_f32 v80, v80
    v_mfma_f32_16x16x32_bf16 a[8:11], v[212:215], v[116:119], a[8:11]
    v_cvt_pk_bf16_f32 v168, v92, v93
    v_cvt_pk_bf16_f32 v169, v94, v95
    v_mfma_f32_16x16x32_bf16 a[40:43], v[208:211], v[120:123], a[40:43]
    v_exp_f32 v81, v81
    v_mfma_f32_16x16x32_bf16 a[40:43], v[212:215], v[124:127], a[40:43]
    ds_read_b64_tr_b16 v[220:221], v4 offset:608
    ds_read_b64_tr_b16 v[222:223], v4 offset:864
    v_mfma_f32_16x16x32_bf16 a[72:75], v[208:211], v[128:131], a[72:75]
    v_exp_f32 v82, v82
    v_mfma_f32_16x16x32_bf16 a[72:75], v[212:215], v[132:135], a[72:75]
    ds_read_b128 v[184:187], v5 offset:17536
    v_mfma_f32_16x16x32_bf16 a[104:107], v[208:211], v[136:139], a[104:107]
    s_add_u32 m0, s61, 101408
    v_exp_f32 v83, v83
    v_mfma_f32_16x16x32_bf16 a[104:107], v[212:215], v[140:143], a[104:107]
    buffer_load_dwordx4 v3, s[20:23], s64 offen offset:1024  lds
    v_mfma_f32_16x16x32_bf16 v[88:91], v[192:195], v[48:51], v[104:107]
    v_exp_f32 v84, v84
    v_mfma_f32_16x16x32_bf16 v[88:91], v[196:199], v[52:55], v[88:91]
    v_cvt_pk_bf16_f32 v146, v80, v81
    v_cvt_pk_bf16_f32 v147, v82, v83
    v_mfma_f32_16x16x32_bf16 v[88:91], v[200:203], v[56:59], v[88:91]
    v_exp_f32 v85, v85
    v_mfma_f32_16x16x32_bf16 v[88:91], v[204:207], v[60:63], v[88:91]
    s_waitcnt lgkmcnt(1)
    ds_read_b64_tr_b16 v[208:209], v4 offset:128
    ds_read_b64_tr_b16 v[210:211], v4 offset:384
    v_mfma_f32_16x16x32_bf16 v[92:95], v[204:207], v[76:79], v[108:111]
    v_exp_f32 v86, v86
    v_mfma_f32_16x16x32_bf16 v[92:95], v[200:203], v[72:75], v[92:95]
    ds_read_b128 v[188:191], v5 offset:17600
    v_mfma_f32_16x16x32_bf16 v[92:95], v[196:199], v[68:71], v[92:95]
    v_exp_f32 v87, v87
    v_mfma_f32_16x16x32_bf16 v[92:95], v[192:195], v[64:67], v[92:95]
    v_mfma_f32_16x16x32_bf16 a[12:15], v[216:219], v[112:115], a[12:15]
    v_exp_f32 v88, v88
    v_mfma_f32_16x16x32_bf16 a[12:15], v[220:223], v[116:119], a[12:15]
    v_cvt_pk_bf16_f32 v154, v84, v85
    v_cvt_pk_bf16_f32 v155, v86, v87
    v_mfma_f32_16x16x32_bf16 a[44:47], v[216:219], v[120:123], a[44:47]
    v_exp_f32 v89, v89
    v_mfma_f32_16x16x32_bf16 a[44:47], v[220:223], v[124:127], a[44:47]
    ds_read_b64_tr_b16 v[212:213], v4 offset:640
    ds_read_b64_tr_b16 v[214:215], v4 offset:896
    v_mfma_f32_16x16x32_bf16 a[76:79], v[216:219], v[128:131], a[76:79]
    v_exp_f32 v90, v90
    v_mfma_f32_16x16x32_bf16 a[76:79], v[220:223], v[132:135], a[76:79]
    ds_read_b128 v[192:195], v5 offset:17664
    v_mfma_f32_16x16x32_bf16 a[108:111], v[216:219], v[136:139], a[108:111]
    s_add_u32 m0, s61, 101440
    v_exp_f32 v91, v91
    v_mfma_f32_16x16x32_bf16 a[108:111], v[220:223], v[140:143], a[108:111]
    buffer_load_dwordx4 v3, s[20:23], s64 offen offset:2048  lds
    v_smfmac_f32_16x16x64_bf16 a[132:135], v[224:227], v[120:127], v228
    s_waitcnt lgkmcnt(3)
    v_mfma_f32_16x16x32_bf16 v[80:83], v[176:179], v[16:19], v[96:99]
    v_exp_f32 v92, v92
    v_mfma_f32_16x16x32_bf16 v[80:83], v[180:183], v[20:23], v[80:83]
    v_cvt_pk_bf16_f32 v162, v88, v89
    v_cvt_pk_bf16_f32 v163, v90, v91
    v_mfma_f32_16x16x32_bf16 v[80:83], v[184:187], v[24:27], v[80:83]
    v_exp_f32 v93, v93
    v_mfma_f32_16x16x32_bf16 v[80:83], v[188:191], v[28:31], v[80:83]
    s_waitcnt lgkmcnt(1)
    ds_read_b64_tr_b16 v[216:217], v4 offset:160
    ds_read_b64_tr_b16 v[218:219], v4 offset:416
    v_mfma_f32_16x16x32_bf16 v[84:87], v[188:191], v[44:47], v[100:103]
    v_exp_f32 v94, v94
    v_mfma_f32_16x16x32_bf16 v[84:87], v[184:187], v[40:43], v[84:87]
    ds_read_b128 v[196:199], v5 offset:17728
    v_mfma_f32_16x16x32_bf16 v[84:87], v[180:183], v[36:39], v[84:87]
    v_exp_f32 v95, v95
    v_mfma_f32_16x16x32_bf16 v[84:87], v[176:179], v[32:35], v[84:87]
    v_mfma_f32_16x16x32_bf16 a[16:19], v[208:211], v[112:115], a[16:19]
    v_exp_f32 v80, v80
    v_mfma_f32_16x16x32_bf16 a[16:19], v[212:215], v[116:119], a[16:19]
    v_cvt_pk_bf16_f32 v170, v92, v93
    v_cvt_pk_bf16_f32 v171, v94, v95
    v_mfma_f32_16x16x32_bf16 a[48:51], v[208:211], v[120:123], a[48:51]
    v_exp_f32 v81, v81
    v_mfma_f32_16x16x32_bf16 a[48:51], v[212:215], v[124:127], a[48:51]
    ds_read_b64_tr_b16 v[220:221], v4 offset:672
    ds_read_b64_tr_b16 v[222:223], v4 offset:928
    v_mfma_f32_16x16x32_bf16 a[80:83], v[208:211], v[128:131], a[80:83]
    v_exp_f32 v82, v82
    v_mfma_f32_16x16x32_bf16 a[80:83], v[212:215], v[132:135], a[80:83]
    ds_read_b128 v[200:203], v5 offset:17792
    v_mfma_f32_16x16x32_bf16 a[112:115], v[208:211], v[136:139], a[112:115]
    s_add_u32 m0, s61, 101472
    v_exp_f32 v83, v83
    v_mfma_f32_16x16x32_bf16 a[112:115], v[212:215], v[140:143], a[112:115]
    buffer_load_dwordx4 v3, s[20:23], s64 offen offset:3072  lds
    s_add_u32 s64, s64, 16384
    v_mfma_f32_16x16x32_bf16 v[88:91], v[176:179], v[48:51], v[104:107]
    v_exp_f32 v84, v84
    v_mfma_f32_16x16x32_bf16 v[88:91], v[180:183], v[52:55], v[88:91]
    v_cvt_pk_bf16_f32 v148, v80, v81
    v_cvt_pk_bf16_f32 v149, v82, v83
    v_mfma_f32_16x16x32_bf16 v[88:91], v[184:187], v[56:59], v[88:91]
    v_exp_f32 v85, v85
    v_mfma_f32_16x16x32_bf16 v[88:91], v[188:191], v[60:63], v[88:91]
    s_waitcnt lgkmcnt(1)
    ds_read_b64_tr_b16 v[208:209], v4 offset:192
    ds_read_b64_tr_b16 v[210:211], v4 offset:448
    v_mfma_f32_16x16x32_bf16 v[92:95], v[188:191], v[76:79], v[108:111]
    v_exp_f32 v86, v86
    v_mfma_f32_16x16x32_bf16 v[92:95], v[184:187], v[72:75], v[92:95]
    ds_read_b128 v[204:207], v5 offset:17856
    v_mfma_f32_16x16x32_bf16 v[92:95], v[180:183], v[68:71], v[92:95]
    v_exp_f32 v87, v87
    v_mfma_f32_16x16x32_bf16 v[92:95], v[176:179], v[64:67], v[92:95]
    s_waitcnt vmcnt(8)
    s_barrier
    v_mfma_f32_16x16x32_bf16 a[20:23], v[216:219], v[112:115], a[20:23]
    v_exp_f32 v88, v88
    v_mfma_f32_16x16x32_bf16 a[20:23], v[220:223], v[116:119], a[20:23]
    v_cvt_pk_bf16_f32 v156, v84, v85
    v_cvt_pk_bf16_f32 v157, v86, v87
    v_mfma_f32_16x16x32_bf16 a[52:55], v[216:219], v[120:123], a[52:55]
    v_exp_f32 v89, v89
    v_mfma_f32_16x16x32_bf16 a[52:55], v[220:223], v[124:127], a[52:55]
    ds_read_b64_tr_b16 v[212:213], v4 offset:704
    ds_read_b64_tr_b16 v[214:215], v4 offset:960
    v_mfma_f32_16x16x32_bf16 a[84:87], v[216:219], v[128:131], a[84:87]
    v_exp_f32 v90, v90
    v_mfma_f32_16x16x32_bf16 a[84:87], v[220:223], v[132:135], a[84:87]
    ds_read_b128 v[176:179], v5 offset:33792
    v_mfma_f32_16x16x32_bf16 a[116:119], v[216:219], v[136:139], a[116:119]
    s_add_u32 m0, s61, 0
    v_exp_f32 v91, v91
    v_mfma_f32_16x16x32_bf16 a[116:119], v[220:223], v[140:143], a[116:119]
    buffer_load_dwordx4 v3, s[16:19], s63 offen offset:0  lds
    v_smfmac_f32_16x16x64_bf16 a[136:139], v[224:227], v[128:135], v228
    s_waitcnt lgkmcnt(3)
    v_mfma_f32_16x16x32_bf16 v[80:83], v[192:195], v[16:19], v[96:99]
    v_exp_f32 v92, v92
    v_mfma_f32_16x16x32_bf16 v[80:83], v[196:199], v[20:23], v[80:83]
    v_cvt_pk_bf16_f32 v164, v88, v89
    v_cvt_pk_bf16_f32 v165, v90, v91
    v_mfma_f32_16x16x32_bf16 v[80:83], v[200:203], v[24:27], v[80:83]
    v_exp_f32 v93, v93
    v_mfma_f32_16x16x32_bf16 v[80:83], v[204:207], v[28:31], v[80:83]
    s_waitcnt lgkmcnt(1)
    ds_read_b64_tr_b16 v[216:217], v4 offset:224
    ds_read_b64_tr_b16 v[218:219], v4 offset:480
    v_mfma_f32_16x16x32_bf16 v[84:87], v[204:207], v[44:47], v[100:103]
    v_exp_f32 v94, v94
    v_mfma_f32_16x16x32_bf16 v[84:87], v[200:203], v[40:43], v[84:87]
    ds_read_b128 v[180:183], v5 offset:33856
    v_mfma_f32_16x16x32_bf16 v[84:87], v[196:199], v[36:39], v[84:87]
    v_exp_f32 v95, v95
    v_mfma_f32_16x16x32_bf16 v[84:87], v[192:195], v[32:35], v[84:87]
    v_mfma_f32_16x16x32_bf16 a[24:27], v[208:211], v[112:115], a[24:27]
    v_exp_f32 v80, v80
    v_mfma_f32_16x16x32_bf16 a[24:27], v[212:215], v[116:119], a[24:27]
    v_cvt_pk_bf16_f32 v172, v92, v93
    v_cvt_pk_bf16_f32 v173, v94, v95
    v_mfma_f32_16x16x32_bf16 a[56:59], v[208:211], v[120:123], a[56:59]
    v_exp_f32 v81, v81
    v_mfma_f32_16x16x32_bf16 a[56:59], v[212:215], v[124:127], a[56:59]
    ds_read_b64_tr_b16 v[220:221], v4 offset:736
    ds_read_b64_tr_b16 v[222:223], v4 offset:992
    v_mfma_f32_16x16x32_bf16 a[88:91], v[208:211], v[128:131], a[88:91]
    v_exp_f32 v82, v82
    v_mfma_f32_16x16x32_bf16 a[88:91], v[212:215], v[132:135], a[88:91]
    ds_read_b128 v[184:187], v5 offset:33920
    v_mfma_f32_16x16x32_bf16 a[120:123], v[208:211], v[136:139], a[120:123]
    s_add_u32 m0, s61, 32
    v_exp_f32 v83, v83
    v_mfma_f32_16x16x32_bf16 a[120:123], v[212:215], v[140:143], a[120:123]
    buffer_load_dwordx4 v3, s[16:19], s63 offen offset:1024  lds
    v_mfma_f32_16x16x32_bf16 v[88:91], v[192:195], v[48:51], v[104:107]
    v_exp_f32 v84, v84
    v_mfma_f32_16x16x32_bf16 v[88:91], v[196:199], v[52:55], v[88:91]
    v_cvt_pk_bf16_f32 v150, v80, v81
    v_cvt_pk_bf16_f32 v151, v82, v83
    v_mfma_f32_16x16x32_bf16 v[88:91], v[200:203], v[56:59], v[88:91]
    v_exp_f32 v85, v85
    v_mfma_f32_16x16x32_bf16 v[88:91], v[204:207], v[60:63], v[88:91]
    s_waitcnt lgkmcnt(1)
    ds_read_b64_tr_b16 v[208:209], v4 offset:16896
    ds_read_b64_tr_b16 v[210:211], v4 offset:17152
    v_mfma_f32_16x16x32_bf16 v[92:95], v[204:207], v[76:79], v[108:111]
    v_exp_f32 v86, v86
    v_mfma_f32_16x16x32_bf16 v[92:95], v[200:203], v[72:75], v[92:95]
    ds_read_b128 v[188:191], v5 offset:33984
    v_mfma_f32_16x16x32_bf16 v[92:95], v[196:199], v[68:71], v[92:95]
    v_exp_f32 v87, v87
    v_mfma_f32_16x16x32_bf16 v[92:95], v[192:195], v[64:67], v[92:95]
    v_mfma_f32_16x16x32_bf16 a[28:31], v[216:219], v[112:115], a[28:31]
    v_exp_f32 v88, v88
    v_mfma_f32_16x16x32_bf16 a[28:31], v[220:223], v[116:119], a[28:31]
    v_cvt_pk_bf16_f32 v158, v84, v85
    v_cvt_pk_bf16_f32 v159, v86, v87
    v_mfma_f32_16x16x32_bf16 a[60:63], v[216:219], v[120:123], a[60:63]
    v_exp_f32 v89, v89
    v_mfma_f32_16x16x32_bf16 a[60:63], v[220:223], v[124:127], a[60:63]
    ds_read_b64_tr_b16 v[212:213], v4 offset:17408
    ds_read_b64_tr_b16 v[214:215], v4 offset:17664
    v_mfma_f32_16x16x32_bf16 a[92:95], v[216:219], v[128:131], a[92:95]
    v_exp_f32 v90, v90
    v_mfma_f32_16x16x32_bf16 a[92:95], v[220:223], v[132:135], a[92:95]
    ds_read_b128 v[192:195], v5 offset:34048
    v_mfma_f32_16x16x32_bf16 a[124:127], v[216:219], v[136:139], a[124:127]
    s_add_u32 m0, s61, 64
    v_exp_f32 v91, v91
    v_mfma_f32_16x16x32_bf16 a[124:127], v[220:223], v[140:143], a[124:127]
    buffer_load_dwordx4 v3, s[16:19], s63 offen offset:2048  lds
    v_smfmac_f32_16x16x64_bf16 a[140:143], v[224:227], v[136:143], v228
    s_waitcnt lgkmcnt(3)
    v_mfma_f32_16x16x32_bf16 v[80:83], v[176:179], v[16:19], v[96:99]
    v_exp_f32 v92, v92
    v_mfma_f32_16x16x32_bf16 v[80:83], v[180:183], v[20:23], v[80:83]
    v_cvt_pk_bf16_f32 v166, v88, v89
    v_cvt_pk_bf16_f32 v167, v90, v91
    v_mfma_f32_16x16x32_bf16 v[80:83], v[184:187], v[24:27], v[80:83]
    v_exp_f32 v93, v93
    v_mfma_f32_16x16x32_bf16 v[80:83], v[188:191], v[28:31], v[80:83]
    s_waitcnt lgkmcnt(1)
    ds_read_b64_tr_b16 v[216:217], v4 offset:16928
    ds_read_b64_tr_b16 v[218:219], v4 offset:17184
    v_mfma_f32_16x16x32_bf16 v[84:87], v[188:191], v[44:47], v[100:103]
    v_exp_f32 v94, v94
    v_mfma_f32_16x16x32_bf16 v[84:87], v[184:187], v[40:43], v[84:87]
    ds_read_b128 v[196:199], v5 offset:34112
    v_mfma_f32_16x16x32_bf16 v[84:87], v[180:183], v[36:39], v[84:87]
    v_exp_f32 v95, v95
    v_mfma_f32_16x16x32_bf16 v[84:87], v[176:179], v[32:35], v[84:87]
    v_mfma_f32_16x16x32_bf16 a[0:3], v[208:211], v[144:147], a[0:3]
    v_exp_f32 v80, v80
    v_mfma_f32_16x16x32_bf16 a[0:3], v[212:215], v[148:151], a[0:3]
    v_cvt_pk_bf16_f32 v174, v92, v93
    v_cvt_pk_bf16_f32 v175, v94, v95
    v_mfma_f32_16x16x32_bf16 a[32:35], v[208:211], v[152:155], a[32:35]
    v_exp_f32 v81, v81
    v_mfma_f32_16x16x32_bf16 a[32:35], v[212:215], v[156:159], a[32:35]
    ds_read_b64_tr_b16 v[220:221], v4 offset:17440
    ds_read_b64_tr_b16 v[222:223], v4 offset:17696
    v_mfma_f32_16x16x32_bf16 a[64:67], v[208:211], v[160:163], a[64:67]
    v_exp_f32 v82, v82
    v_mfma_f32_16x16x32_bf16 a[64:67], v[212:215], v[164:167], a[64:67]
    ds_read_b128 v[200:203], v5 offset:34176
    v_mfma_f32_16x16x32_bf16 a[96:99], v[208:211], v[168:171], a[96:99]
    s_add_u32 m0, s61, 96
    v_exp_f32 v83, v83
    v_mfma_f32_16x16x32_bf16 a[96:99], v[212:215], v[172:175], a[96:99]
    buffer_load_dwordx4 v3, s[16:19], s63 offen offset:3072  lds
    s_add_u32 s63, s63, 16384
    v_mfma_f32_16x16x32_bf16 v[88:91], v[176:179], v[48:51], v[104:107]
    v_exp_f32 v84, v84
    v_mfma_f32_16x16x32_bf16 v[88:91], v[180:183], v[52:55], v[88:91]
    v_cvt_pk_bf16_f32 v112, v80, v81
    v_cvt_pk_bf16_f32 v113, v82, v83
    v_mfma_f32_16x16x32_bf16 v[88:91], v[184:187], v[56:59], v[88:91]
    v_exp_f32 v85, v85
    v_mfma_f32_16x16x32_bf16 v[88:91], v[188:191], v[60:63], v[88:91]
    s_waitcnt lgkmcnt(1)
    ds_read_b64_tr_b16 v[208:209], v4 offset:16960
    ds_read_b64_tr_b16 v[210:211], v4 offset:17216
    v_mfma_f32_16x16x32_bf16 v[92:95], v[188:191], v[76:79], v[108:111]
    v_exp_f32 v86, v86
    v_mfma_f32_16x16x32_bf16 v[92:95], v[184:187], v[72:75], v[92:95]
    ds_read_b128 v[204:207], v5 offset:34240
    v_mfma_f32_16x16x32_bf16 v[92:95], v[180:183], v[68:71], v[92:95]
    v_exp_f32 v87, v87
    v_mfma_f32_16x16x32_bf16 v[92:95], v[176:179], v[64:67], v[92:95]
    v_mfma_f32_16x16x32_bf16 a[4:7], v[216:219], v[144:147], a[4:7]
    v_exp_f32 v88, v88
    v_mfma_f32_16x16x32_bf16 a[4:7], v[220:223], v[148:151], a[4:7]
    v_cvt_pk_bf16_f32 v120, v84, v85
    v_cvt_pk_bf16_f32 v121, v86, v87
    v_mfma_f32_16x16x32_bf16 a[36:39], v[216:219], v[152:155], a[36:39]
    v_exp_f32 v89, v89
    v_mfma_f32_16x16x32_bf16 a[36:39], v[220:223], v[156:159], a[36:39]
    ds_read_b64_tr_b16 v[212:213], v4 offset:17472
    ds_read_b64_tr_b16 v[214:215], v4 offset:17728
    v_mfma_f32_16x16x32_bf16 a[68:71], v[216:219], v[160:163], a[68:71]
    v_exp_f32 v90, v90
    v_mfma_f32_16x16x32_bf16 a[68:71], v[220:223], v[164:167], a[68:71]
    ds_read_b128 v[176:179], v5 offset:34304
    v_mfma_f32_16x16x32_bf16 a[100:103], v[216:219], v[168:171], a[100:103]
    s_add_u32 m0, s61, 118272
    v_exp_f32 v91, v91
    v_mfma_f32_16x16x32_bf16 a[100:103], v[220:223], v[172:175], a[100:103]
    buffer_load_dwordx4 v3, s[20:23], s64 offen offset:0  lds
    v_smfmac_f32_16x16x64_bf16 a[128:131], v[224:227], v[144:151], v228
    s_waitcnt lgkmcnt(3)
    v_mfma_f32_16x16x32_bf16 v[80:83], v[192:195], v[16:19], v[96:99]
    v_exp_f32 v92, v92
    v_mfma_f32_16x16x32_bf16 v[80:83], v[196:199], v[20:23], v[80:83]
    v_cvt_pk_bf16_f32 v128, v88, v89
    v_cvt_pk_bf16_f32 v129, v90, v91
    v_mfma_f32_16x16x32_bf16 v[80:83], v[200:203], v[24:27], v[80:83]
    v_exp_f32 v93, v93
    v_mfma_f32_16x16x32_bf16 v[80:83], v[204:207], v[28:31], v[80:83]
    s_waitcnt lgkmcnt(1)
    ds_read_b64_tr_b16 v[216:217], v4 offset:16992
    ds_read_b64_tr_b16 v[218:219], v4 offset:17248
    v_mfma_f32_16x16x32_bf16 v[84:87], v[204:207], v[44:47], v[100:103]
    v_exp_f32 v94, v94
    v_mfma_f32_16x16x32_bf16 v[84:87], v[200:203], v[40:43], v[84:87]
    ds_read_b128 v[180:183], v5 offset:34368
    v_mfma_f32_16x16x32_bf16 v[84:87], v[196:199], v[36:39], v[84:87]
    v_exp_f32 v95, v95
    v_mfma_f32_16x16x32_bf16 v[84:87], v[192:195], v[32:35], v[84:87]
    v_mfma_f32_16x16x32_bf16 a[8:11], v[208:211], v[144:147], a[8:11]
    v_exp_f32 v80, v80
    v_mfma_f32_16x16x32_bf16 a[8:11], v[212:215], v[148:151], a[8:11]
    v_cvt_pk_bf16_f32 v136, v92, v93
    v_cvt_pk_bf16_f32 v137, v94, v95
    v_mfma_f32_16x16x32_bf16 a[40:43], v[208:211], v[152:155], a[40:43]
    v_exp_f32 v81, v81
    v_mfma_f32_16x16x32_bf16 a[40:43], v[212:215], v[156:159], a[40:43]
    ds_read_b64_tr_b16 v[220:221], v4 offset:17504
    ds_read_b64_tr_b16 v[222:223], v4 offset:17760
    v_mfma_f32_16x16x32_bf16 a[72:75], v[208:211], v[160:163], a[72:75]
    v_exp_f32 v82, v82
    v_mfma_f32_16x16x32_bf16 a[72:75], v[212:215], v[164:167], a[72:75]
    ds_read_b128 v[184:187], v5 offset:34432
    v_mfma_f32_16x16x32_bf16 a[104:107], v[208:211], v[168:171], a[104:107]
    s_add_u32 m0, s61, 118304
    v_exp_f32 v83, v83
    v_mfma_f32_16x16x32_bf16 a[104:107], v[212:215], v[172:175], a[104:107]
    buffer_load_dwordx4 v3, s[20:23], s64 offen offset:1024  lds
    v_mfma_f32_16x16x32_bf16 v[88:91], v[192:195], v[48:51], v[104:107]
    v_exp_f32 v84, v84
    v_mfma_f32_16x16x32_bf16 v[88:91], v[196:199], v[52:55], v[88:91]
    v_cvt_pk_bf16_f32 v114, v80, v81
    v_cvt_pk_bf16_f32 v115, v82, v83
    v_mfma_f32_16x16x32_bf16 v[88:91], v[200:203], v[56:59], v[88:91]
    v_exp_f32 v85, v85
    v_mfma_f32_16x16x32_bf16 v[88:91], v[204:207], v[60:63], v[88:91]
    s_waitcnt lgkmcnt(1)
    ds_read_b64_tr_b16 v[208:209], v4 offset:17024
    ds_read_b64_tr_b16 v[210:211], v4 offset:17280
    v_mfma_f32_16x16x32_bf16 v[92:95], v[204:207], v[76:79], v[108:111]
    v_exp_f32 v86, v86
    v_mfma_f32_16x16x32_bf16 v[92:95], v[200:203], v[72:75], v[92:95]
    ds_read_b128 v[188:191], v5 offset:34496
    v_mfma_f32_16x16x32_bf16 v[92:95], v[196:199], v[68:71], v[92:95]
    v_exp_f32 v87, v87
    v_mfma_f32_16x16x32_bf16 v[92:95], v[192:195], v[64:67], v[92:95]
    v_mfma_f32_16x16x32_bf16 a[12:15], v[216:219], v[144:147], a[12:15]
    v_exp_f32 v88, v88
    v_mfma_f32_16x16x32_bf16 a[12:15], v[220:223], v[148:151], a[12:15]
    v_cvt_pk_bf16_f32 v122, v84, v85
    v_cvt_pk_bf16_f32 v123, v86, v87
    v_mfma_f32_16x16x32_bf16 a[44:47], v[216:219], v[152:155], a[44:47]
    v_exp_f32 v89, v89
    v_mfma_f32_16x16x32_bf16 a[44:47], v[220:223], v[156:159], a[44:47]
    ds_read_b64_tr_b16 v[212:213], v4 offset:17536
    ds_read_b64_tr_b16 v[214:215], v4 offset:17792
    v_mfma_f32_16x16x32_bf16 a[76:79], v[216:219], v[160:163], a[76:79]
    v_exp_f32 v90, v90
    v_mfma_f32_16x16x32_bf16 a[76:79], v[220:223], v[164:167], a[76:79]
    ds_read_b128 v[192:195], v5 offset:34560
    v_mfma_f32_16x16x32_bf16 a[108:111], v[216:219], v[168:171], a[108:111]
    s_add_u32 m0, s61, 118336
    v_exp_f32 v91, v91
    v_mfma_f32_16x16x32_bf16 a[108:111], v[220:223], v[172:175], a[108:111]
    buffer_load_dwordx4 v3, s[20:23], s64 offen offset:2048  lds
    v_smfmac_f32_16x16x64_bf16 a[132:135], v[224:227], v[152:159], v228
    s_waitcnt lgkmcnt(3)
    v_mfma_f32_16x16x32_bf16 v[80:83], v[176:179], v[16:19], v[96:99]
    v_exp_f32 v92, v92
    v_mfma_f32_16x16x32_bf16 v[80:83], v[180:183], v[20:23], v[80:83]
    v_cvt_pk_bf16_f32 v130, v88, v89
    v_cvt_pk_bf16_f32 v131, v90, v91
    v_mfma_f32_16x16x32_bf16 v[80:83], v[184:187], v[24:27], v[80:83]
    v_exp_f32 v93, v93
    v_mfma_f32_16x16x32_bf16 v[80:83], v[188:191], v[28:31], v[80:83]
    s_waitcnt lgkmcnt(1)
    ds_read_b64_tr_b16 v[216:217], v4 offset:17056
    ds_read_b64_tr_b16 v[218:219], v4 offset:17312
    v_mfma_f32_16x16x32_bf16 v[84:87], v[188:191], v[44:47], v[100:103]
    v_exp_f32 v94, v94
    v_mfma_f32_16x16x32_bf16 v[84:87], v[184:187], v[40:43], v[84:87]
    ds_read_b128 v[196:199], v5 offset:34624
    v_mfma_f32_16x16x32_bf16 v[84:87], v[180:183], v[36:39], v[84:87]
    v_exp_f32 v95, v95
    v_mfma_f32_16x16x32_bf16 v[84:87], v[176:179], v[32:35], v[84:87]
    v_mfma_f32_16x16x32_bf16 a[16:19], v[208:211], v[144:147], a[16:19]
    v_exp_f32 v80, v80
    v_mfma_f32_16x16x32_bf16 a[16:19], v[212:215], v[148:151], a[16:19]
    v_cvt_pk_bf16_f32 v138, v92, v93
    v_cvt_pk_bf16_f32 v139, v94, v95
    v_mfma_f32_16x16x32_bf16 a[48:51], v[208:211], v[152:155], a[48:51]
    v_exp_f32 v81, v81
    v_mfma_f32_16x16x32_bf16 a[48:51], v[212:215], v[156:159], a[48:51]
    ds_read_b64_tr_b16 v[220:221], v4 offset:17568
    ds_read_b64_tr_b16 v[222:223], v4 offset:17824
    v_mfma_f32_16x16x32_bf16 a[80:83], v[208:211], v[160:163], a[80:83]
    v_exp_f32 v82, v82
    v_mfma_f32_16x16x32_bf16 a[80:83], v[212:215], v[164:167], a[80:83]
    ds_read_b128 v[200:203], v5 offset:34688
    v_mfma_f32_16x16x32_bf16 a[112:115], v[208:211], v[168:171], a[112:115]
    s_add_u32 m0, s61, 118368
    v_exp_f32 v83, v83
    v_mfma_f32_16x16x32_bf16 a[112:115], v[212:215], v[172:175], a[112:115]
    buffer_load_dwordx4 v3, s[20:23], s64 offen offset:3072  lds
    s_add_u32 s64, s64, 16384
    v_mfma_f32_16x16x32_bf16 v[88:91], v[176:179], v[48:51], v[104:107]
    v_exp_f32 v84, v84
    v_mfma_f32_16x16x32_bf16 v[88:91], v[180:183], v[52:55], v[88:91]
    v_cvt_pk_bf16_f32 v116, v80, v81
    v_cvt_pk_bf16_f32 v117, v82, v83
    v_mfma_f32_16x16x32_bf16 v[88:91], v[184:187], v[56:59], v[88:91]
    v_exp_f32 v85, v85
    v_mfma_f32_16x16x32_bf16 v[88:91], v[188:191], v[60:63], v[88:91]
    s_waitcnt lgkmcnt(1)
    ds_read_b64_tr_b16 v[208:209], v4 offset:17088
    ds_read_b64_tr_b16 v[210:211], v4 offset:17344
    v_mfma_f32_16x16x32_bf16 v[92:95], v[188:191], v[76:79], v[108:111]
    v_exp_f32 v86, v86
    v_mfma_f32_16x16x32_bf16 v[92:95], v[184:187], v[72:75], v[92:95]
    ds_read_b128 v[204:207], v5 offset:34752
    v_mfma_f32_16x16x32_bf16 v[92:95], v[180:183], v[68:71], v[92:95]
    v_exp_f32 v87, v87
    v_mfma_f32_16x16x32_bf16 v[92:95], v[176:179], v[64:67], v[92:95]
    s_waitcnt vmcnt(8)
    s_barrier
    v_mfma_f32_16x16x32_bf16 a[20:23], v[216:219], v[144:147], a[20:23]
    v_exp_f32 v88, v88
    v_mfma_f32_16x16x32_bf16 a[20:23], v[220:223], v[148:151], a[20:23]
    v_cvt_pk_bf16_f32 v124, v84, v85
    v_cvt_pk_bf16_f32 v125, v86, v87
    v_mfma_f32_16x16x32_bf16 a[52:55], v[216:219], v[152:155], a[52:55]
    v_exp_f32 v89, v89
    v_mfma_f32_16x16x32_bf16 a[52:55], v[220:223], v[156:159], a[52:55]
    ds_read_b64_tr_b16 v[212:213], v4 offset:17600
    ds_read_b64_tr_b16 v[214:215], v4 offset:17856
    v_mfma_f32_16x16x32_bf16 a[84:87], v[216:219], v[160:163], a[84:87]
    v_exp_f32 v90, v90
    v_mfma_f32_16x16x32_bf16 a[84:87], v[220:223], v[164:167], a[84:87]
    ds_read_b128 v[176:179], v5 offset:50688
    v_mfma_f32_16x16x32_bf16 a[116:119], v[216:219], v[168:171], a[116:119]
    s_add_u32 m0, s61, 16896
    v_exp_f32 v91, v91
    v_mfma_f32_16x16x32_bf16 a[116:119], v[220:223], v[172:175], a[116:119]
    buffer_load_dwordx4 v3, s[16:19], s63 offen offset:0  lds
    v_smfmac_f32_16x16x64_bf16 a[136:139], v[224:227], v[160:167], v228
    s_waitcnt lgkmcnt(3)
    v_mfma_f32_16x16x32_bf16 v[80:83], v[192:195], v[16:19], v[96:99]
    v_exp_f32 v92, v92
    v_mfma_f32_16x16x32_bf16 v[80:83], v[196:199], v[20:23], v[80:83]
    v_cvt_pk_bf16_f32 v132, v88, v89
    v_cvt_pk_bf16_f32 v133, v90, v91
    v_mfma_f32_16x16x32_bf16 v[80:83], v[200:203], v[24:27], v[80:83]
    v_exp_f32 v93, v93
    v_mfma_f32_16x16x32_bf16 v[80:83], v[204:207], v[28:31], v[80:83]
    s_waitcnt lgkmcnt(1)
    ds_read_b64_tr_b16 v[216:217], v4 offset:17120
    ds_read_b64_tr_b16 v[218:219], v4 offset:17376
    v_mfma_f32_16x16x32_bf16 v[84:87], v[204:207], v[44:47], v[100:103]
    v_exp_f32 v94, v94
    v_mfma_f32_16x16x32_bf16 v[84:87], v[200:203], v[40:43], v[84:87]
    ds_read_b128 v[180:183], v5 offset:50752
    v_mfma_f32_16x16x32_bf16 v[84:87], v[196:199], v[36:39], v[84:87]
    v_exp_f32 v95, v95
    v_mfma_f32_16x16x32_bf16 v[84:87], v[192:195], v[32:35], v[84:87]
    v_mfma_f32_16x16x32_bf16 a[24:27], v[208:211], v[144:147], a[24:27]
    v_exp_f32 v80, v80
    v_mfma_f32_16x16x32_bf16 a[24:27], v[212:215], v[148:151], a[24:27]
    v_cvt_pk_bf16_f32 v140, v92, v93
    v_cvt_pk_bf16_f32 v141, v94, v95
    v_mfma_f32_16x16x32_bf16 a[56:59], v[208:211], v[152:155], a[56:59]
    v_exp_f32 v81, v81
    v_mfma_f32_16x16x32_bf16 a[56:59], v[212:215], v[156:159], a[56:59]
    ds_read_b64_tr_b16 v[220:221], v4 offset:17632
    ds_read_b64_tr_b16 v[222:223], v4 offset:17888
    v_mfma_f32_16x16x32_bf16 a[88:91], v[208:211], v[160:163], a[88:91]
    v_exp_f32 v82, v82
    v_mfma_f32_16x16x32_bf16 a[88:91], v[212:215], v[164:167], a[88:91]
    ds_read_b128 v[184:187], v5 offset:50816
    v_mfma_f32_16x16x32_bf16 a[120:123], v[208:211], v[168:171], a[120:123]
    s_add_u32 m0, s61, 16928
    v_exp_f32 v83, v83
    v_mfma_f32_16x16x32_bf16 a[120:123], v[212:215], v[172:175], a[120:123]
    buffer_load_dwordx4 v3, s[16:19], s63 offen offset:1024  lds
    v_mfma_f32_16x16x32_bf16 v[88:91], v[192:195], v[48:51], v[104:107]
    v_exp_f32 v84, v84
    v_mfma_f32_16x16x32_bf16 v[88:91], v[196:199], v[52:55], v[88:91]
    v_cvt_pk_bf16_f32 v118, v80, v81
    v_cvt_pk_bf16_f32 v119, v82, v83
    v_mfma_f32_16x16x32_bf16 v[88:91], v[200:203], v[56:59], v[88:91]
    v_exp_f32 v85, v85
    v_mfma_f32_16x16x32_bf16 v[88:91], v[204:207], v[60:63], v[88:91]
    s_waitcnt lgkmcnt(1)
    ds_read_b64_tr_b16 v[208:209], v4 offset:33792
    ds_read_b64_tr_b16 v[210:211], v4 offset:34048
    v_mfma_f32_16x16x32_bf16 v[92:95], v[204:207], v[76:79], v[108:111]
    v_exp_f32 v86, v86
    v_mfma_f32_16x16x32_bf16 v[92:95], v[200:203], v[72:75], v[92:95]
    ds_read_b128 v[188:191], v5 offset:50880
    v_mfma_f32_16x16x32_bf16 v[92:95], v[196:199], v[68:71], v[92:95]
    v_exp_f32 v87, v87
    v_mfma_f32_16x16x32_bf16 v[92:95], v[192:195], v[64:67], v[92:95]
    v_mfma_f32_16x16x32_bf16 a[28:31], v[216:219], v[144:147], a[28:31]
    v_exp_f32 v88, v88
    v_mfma_f32_16x16x32_bf16 a[28:31], v[220:223], v[148:151], a[28:31]
    v_cvt_pk_bf16_f32 v126, v84, v85
    v_cvt_pk_bf16_f32 v127, v86, v87
    v_mfma_f32_16x16x32_bf16 a[60:63], v[216:219], v[152:155], a[60:63]
    v_exp_f32 v89, v89
    v_mfma_f32_16x16x32_bf16 a[60:63], v[220:223], v[156:159], a[60:63]
    ds_read_b64_tr_b16 v[212:213], v4 offset:34304
    ds_read_b64_tr_b16 v[214:215], v4 offset:34560
    v_mfma_f32_16x16x32_bf16 a[92:95], v[216:219], v[160:163], a[92:95]
    v_exp_f32 v90, v90
    v_mfma_f32_16x16x32_bf16 a[92:95], v[220:223], v[164:167], a[92:95]
    ds_read_b128 v[192:195], v5 offset:50944
    v_mfma_f32_16x16x32_bf16 a[124:127], v[216:219], v[168:171], a[124:127]
    s_add_u32 m0, s61, 16960
    v_exp_f32 v91, v91
    v_mfma_f32_16x16x32_bf16 a[124:127], v[220:223], v[172:175], a[124:127]
    buffer_load_dwordx4 v3, s[16:19], s63 offen offset:2048  lds
    v_smfmac_f32_16x16x64_bf16 a[140:143], v[224:227], v[168:175], v228
    s_waitcnt lgkmcnt(3)
    v_mfma_f32_16x16x32_bf16 v[80:83], v[176:179], v[16:19], v[96:99]
    v_exp_f32 v92, v92
    v_mfma_f32_16x16x32_bf16 v[80:83], v[180:183], v[20:23], v[80:83]
    v_cvt_pk_bf16_f32 v134, v88, v89
    v_cvt_pk_bf16_f32 v135, v90, v91
    v_mfma_f32_16x16x32_bf16 v[80:83], v[184:187], v[24:27], v[80:83]
    v_exp_f32 v93, v93
    v_mfma_f32_16x16x32_bf16 v[80:83], v[188:191], v[28:31], v[80:83]
    s_waitcnt lgkmcnt(1)
    ds_read_b64_tr_b16 v[216:217], v4 offset:33824
    ds_read_b64_tr_b16 v[218:219], v4 offset:34080
    v_mfma_f32_16x16x32_bf16 v[84:87], v[188:191], v[44:47], v[100:103]
    v_exp_f32 v94, v94
    v_mfma_f32_16x16x32_bf16 v[84:87], v[184:187], v[40:43], v[84:87]
    ds_read_b128 v[196:199], v5 offset:51008
    v_mfma_f32_16x16x32_bf16 v[84:87], v[180:183], v[36:39], v[84:87]
    v_exp_f32 v95, v95
    v_mfma_f32_16x16x32_bf16 v[84:87], v[176:179], v[32:35], v[84:87]
    v_mfma_f32_16x16x32_bf16 a[0:3], v[208:211], v[112:115], a[0:3]
    v_exp_f32 v80, v80
    v_mfma_f32_16x16x32_bf16 a[0:3], v[212:215], v[116:119], a[0:3]
    v_cvt_pk_bf16_f32 v142, v92, v93
    v_cvt_pk_bf16_f32 v143, v94, v95
    v_mfma_f32_16x16x32_bf16 a[32:35], v[208:211], v[120:123], a[32:35]
    v_exp_f32 v81, v81
    v_mfma_f32_16x16x32_bf16 a[32:35], v[212:215], v[124:127], a[32:35]
    ds_read_b64_tr_b16 v[220:221], v4 offset:34336
    ds_read_b64_tr_b16 v[222:223], v4 offset:34592
    v_mfma_f32_16x16x32_bf16 a[64:67], v[208:211], v[128:131], a[64:67]
    v_exp_f32 v82, v82
    v_mfma_f32_16x16x32_bf16 a[64:67], v[212:215], v[132:135], a[64:67]
    ds_read_b128 v[200:203], v5 offset:51072
    v_mfma_f32_16x16x32_bf16 a[96:99], v[208:211], v[136:139], a[96:99]
    s_add_u32 m0, s61, 16992
    v_exp_f32 v83, v83
    v_mfma_f32_16x16x32_bf16 a[96:99], v[212:215], v[140:143], a[96:99]
    buffer_load_dwordx4 v3, s[16:19], s63 offen offset:3072  lds
    s_add_u32 s63, s63, 16384
    v_mfma_f32_16x16x32_bf16 v[88:91], v[176:179], v[48:51], v[104:107]
    v_exp_f32 v84, v84
    v_mfma_f32_16x16x32_bf16 v[88:91], v[180:183], v[52:55], v[88:91]
    v_cvt_pk_bf16_f32 v144, v80, v81
    v_cvt_pk_bf16_f32 v145, v82, v83
    v_mfma_f32_16x16x32_bf16 v[88:91], v[184:187], v[56:59], v[88:91]
    v_exp_f32 v85, v85
    v_mfma_f32_16x16x32_bf16 v[88:91], v[188:191], v[60:63], v[88:91]
    s_waitcnt lgkmcnt(1)
    ds_read_b64_tr_b16 v[208:209], v4 offset:33856
    ds_read_b64_tr_b16 v[210:211], v4 offset:34112
    v_mfma_f32_16x16x32_bf16 v[92:95], v[188:191], v[76:79], v[108:111]
    v_exp_f32 v86, v86
    v_mfma_f32_16x16x32_bf16 v[92:95], v[184:187], v[72:75], v[92:95]
    ds_read_b128 v[204:207], v5 offset:51136
    v_mfma_f32_16x16x32_bf16 v[92:95], v[180:183], v[68:71], v[92:95]
    v_exp_f32 v87, v87
    v_mfma_f32_16x16x32_bf16 v[92:95], v[176:179], v[64:67], v[92:95]
    v_mfma_f32_16x16x32_bf16 a[4:7], v[216:219], v[112:115], a[4:7]
    v_exp_f32 v88, v88
    v_mfma_f32_16x16x32_bf16 a[4:7], v[220:223], v[116:119], a[4:7]
    v_cvt_pk_bf16_f32 v152, v84, v85
    v_cvt_pk_bf16_f32 v153, v86, v87
    v_mfma_f32_16x16x32_bf16 a[36:39], v[216:219], v[120:123], a[36:39]
    v_exp_f32 v89, v89
    v_mfma_f32_16x16x32_bf16 a[36:39], v[220:223], v[124:127], a[36:39]
    ds_read_b64_tr_b16 v[212:213], v4 offset:34368
    ds_read_b64_tr_b16 v[214:215], v4 offset:34624
    v_mfma_f32_16x16x32_bf16 a[68:71], v[216:219], v[128:131], a[68:71]
    v_exp_f32 v90, v90
    v_mfma_f32_16x16x32_bf16 a[68:71], v[220:223], v[132:135], a[68:71]
    ds_read_b128 v[176:179], v5 offset:51200
    v_mfma_f32_16x16x32_bf16 a[100:103], v[216:219], v[136:139], a[100:103]
    s_add_u32 m0, s61, 67584
    v_exp_f32 v91, v91
    v_mfma_f32_16x16x32_bf16 a[100:103], v[220:223], v[140:143], a[100:103]
    buffer_load_dwordx4 v3, s[20:23], s64 offen offset:0  lds
    v_smfmac_f32_16x16x64_bf16 a[128:131], v[224:227], v[112:119], v228
    s_waitcnt lgkmcnt(3)
    v_mfma_f32_16x16x32_bf16 v[80:83], v[192:195], v[16:19], v[96:99]
    v_exp_f32 v92, v92
    v_mfma_f32_16x16x32_bf16 v[80:83], v[196:199], v[20:23], v[80:83]
    v_cvt_pk_bf16_f32 v160, v88, v89
    v_cvt_pk_bf16_f32 v161, v90, v91
    v_mfma_f32_16x16x32_bf16 v[80:83], v[200:203], v[24:27], v[80:83]
    v_exp_f32 v93, v93
    v_mfma_f32_16x16x32_bf16 v[80:83], v[204:207], v[28:31], v[80:83]
    s_waitcnt lgkmcnt(1)
    ds_read_b64_tr_b16 v[216:217], v4 offset:33888
    ds_read_b64_tr_b16 v[218:219], v4 offset:34144
    v_mfma_f32_16x16x32_bf16 v[84:87], v[204:207], v[44:47], v[100:103]
    v_exp_f32 v94, v94
    v_mfma_f32_16x16x32_bf16 v[84:87], v[200:203], v[40:43], v[84:87]
    ds_read_b128 v[180:183], v5 offset:51264
    v_mfma_f32_16x16x32_bf16 v[84:87], v[196:199], v[36:39], v[84:87]
    v_exp_f32 v95, v95
    v_mfma_f32_16x16x32_bf16 v[84:87], v[192:195], v[32:35], v[84:87]
    v_mfma_f32_16x16x32_bf16 a[8:11], v[208:211], v[112:115], a[8:11]
    v_exp_f32 v80, v80
    v_mfma_f32_16x16x32_bf16 a[8:11], v[212:215], v[116:119], a[8:11]
    v_cvt_pk_bf16_f32 v168, v92, v93
    v_cvt_pk_bf16_f32 v169, v94, v95
    v_mfma_f32_16x16x32_bf16 a[40:43], v[208:211], v[120:123], a[40:43]
    v_exp_f32 v81, v81
    v_mfma_f32_16x16x32_bf16 a[40:43], v[212:215], v[124:127], a[40:43]
    ds_read_b64_tr_b16 v[220:221], v4 offset:34400
    ds_read_b64_tr_b16 v[222:223], v4 offset:34656
    v_mfma_f32_16x16x32_bf16 a[72:75], v[208:211], v[128:131], a[72:75]
    v_exp_f32 v82, v82
    v_mfma_f32_16x16x32_bf16 a[72:75], v[212:215], v[132:135], a[72:75]
    ds_read_b128 v[184:187], v5 offset:51328
    v_mfma_f32_16x16x32_bf16 a[104:107], v[208:211], v[136:139], a[104:107]
    s_add_u32 m0, s61, 67616
    v_exp_f32 v83, v83
    v_mfma_f32_16x16x32_bf16 a[104:107], v[212:215], v[140:143], a[104:107]
    buffer_load_dwordx4 v3, s[20:23], s64 offen offset:1024  lds
    v_mfma_f32_16x16x32_bf16 v[88:91], v[192:195], v[48:51], v[104:107]
    v_exp_f32 v84, v84
    v_mfma_f32_16x16x32_bf16 v[88:91], v[196:199], v[52:55], v[88:91]
    v_cvt_pk_bf16_f32 v146, v80, v81
    v_cvt_pk_bf16_f32 v147, v82, v83
    v_mfma_f32_16x16x32_bf16 v[88:91], v[200:203], v[56:59], v[88:91]
    v_exp_f32 v85, v85
    v_mfma_f32_16x16x32_bf16 v[88:91], v[204:207], v[60:63], v[88:91]
    s_waitcnt lgkmcnt(1)
    ds_read_b64_tr_b16 v[208:209], v4 offset:33920
    ds_read_b64_tr_b16 v[210:211], v4 offset:34176
    v_mfma_f32_16x16x32_bf16 v[92:95], v[204:207], v[76:79], v[108:111]
    v_exp_f32 v86, v86
    v_mfma_f32_16x16x32_bf16 v[92:95], v[200:203], v[72:75], v[92:95]
    ds_read_b128 v[188:191], v5 offset:51392
    v_mfma_f32_16x16x32_bf16 v[92:95], v[196:199], v[68:71], v[92:95]
    v_exp_f32 v87, v87
    v_mfma_f32_16x16x32_bf16 v[92:95], v[192:195], v[64:67], v[92:95]
    v_mfma_f32_16x16x32_bf16 a[12:15], v[216:219], v[112:115], a[12:15]
    v_exp_f32 v88, v88
    v_mfma_f32_16x16x32_bf16 a[12:15], v[220:223], v[116:119], a[12:15]
    v_cvt_pk_bf16_f32 v154, v84, v85
    v_cvt_pk_bf16_f32 v155, v86, v87
    v_mfma_f32_16x16x32_bf16 a[44:47], v[216:219], v[120:123], a[44:47]
    v_exp_f32 v89, v89
    v_mfma_f32_16x16x32_bf16 a[44:47], v[220:223], v[124:127], a[44:47]
    ds_read_b64_tr_b16 v[212:213], v4 offset:34432
    ds_read_b64_tr_b16 v[214:215], v4 offset:34688
    v_mfma_f32_16x16x32_bf16 a[76:79], v[216:219], v[128:131], a[76:79]
    v_exp_f32 v90, v90
    v_mfma_f32_16x16x32_bf16 a[76:79], v[220:223], v[132:135], a[76:79]
    ds_read_b128 v[192:195], v5 offset:51456
    v_mfma_f32_16x16x32_bf16 a[108:111], v[216:219], v[136:139], a[108:111]
    s_add_u32 m0, s61, 67648
    v_exp_f32 v91, v91
    v_mfma_f32_16x16x32_bf16 a[108:111], v[220:223], v[140:143], a[108:111]
    buffer_load_dwordx4 v3, s[20:23], s64 offen offset:2048  lds
    v_smfmac_f32_16x16x64_bf16 a[132:135], v[224:227], v[120:127], v228
    s_waitcnt lgkmcnt(3)
    v_mfma_f32_16x16x32_bf16 v[80:83], v[176:179], v[16:19], v[96:99]
    v_exp_f32 v92, v92
    v_mfma_f32_16x16x32_bf16 v[80:83], v[180:183], v[20:23], v[80:83]
    v_cvt_pk_bf16_f32 v162, v88, v89
    v_cvt_pk_bf16_f32 v163, v90, v91
    v_mfma_f32_16x16x32_bf16 v[80:83], v[184:187], v[24:27], v[80:83]
    v_exp_f32 v93, v93
    v_mfma_f32_16x16x32_bf16 v[80:83], v[188:191], v[28:31], v[80:83]
    s_waitcnt lgkmcnt(1)
    ds_read_b64_tr_b16 v[216:217], v4 offset:33952
    ds_read_b64_tr_b16 v[218:219], v4 offset:34208
    v_mfma_f32_16x16x32_bf16 v[84:87], v[188:191], v[44:47], v[100:103]
    v_exp_f32 v94, v94
    v_mfma_f32_16x16x32_bf16 v[84:87], v[184:187], v[40:43], v[84:87]
    ds_read_b128 v[196:199], v5 offset:51520
    v_mfma_f32_16x16x32_bf16 v[84:87], v[180:183], v[36:39], v[84:87]
    v_exp_f32 v95, v95
    v_mfma_f32_16x16x32_bf16 v[84:87], v[176:179], v[32:35], v[84:87]
    v_mfma_f32_16x16x32_bf16 a[16:19], v[208:211], v[112:115], a[16:19]
    v_exp_f32 v80, v80
    v_mfma_f32_16x16x32_bf16 a[16:19], v[212:215], v[116:119], a[16:19]
    v_cvt_pk_bf16_f32 v170, v92, v93
    v_cvt_pk_bf16_f32 v171, v94, v95
    v_mfma_f32_16x16x32_bf16 a[48:51], v[208:211], v[120:123], a[48:51]
    v_exp_f32 v81, v81
    v_mfma_f32_16x16x32_bf16 a[48:51], v[212:215], v[124:127], a[48:51]
    ds_read_b64_tr_b16 v[220:221], v4 offset:34464
    ds_read_b64_tr_b16 v[222:223], v4 offset:34720
    v_mfma_f32_16x16x32_bf16 a[80:83], v[208:211], v[128:131], a[80:83]
    v_exp_f32 v82, v82
    v_mfma_f32_16x16x32_bf16 a[80:83], v[212:215], v[132:135], a[80:83]
    ds_read_b128 v[200:203], v5 offset:51584
    v_mfma_f32_16x16x32_bf16 a[112:115], v[208:211], v[136:139], a[112:115]
    s_add_u32 m0, s61, 67680
    v_exp_f32 v83, v83
    v_mfma_f32_16x16x32_bf16 a[112:115], v[212:215], v[140:143], a[112:115]
    buffer_load_dwordx4 v3, s[20:23], s64 offen offset:3072  lds
    s_add_u32 s64, s64, 16384
    v_mfma_f32_16x16x32_bf16 v[88:91], v[176:179], v[48:51], v[104:107]
    v_exp_f32 v84, v84
    v_mfma_f32_16x16x32_bf16 v[88:91], v[180:183], v[52:55], v[88:91]
    v_cvt_pk_bf16_f32 v148, v80, v81
    v_cvt_pk_bf16_f32 v149, v82, v83
    v_mfma_f32_16x16x32_bf16 v[88:91], v[184:187], v[56:59], v[88:91]
    v_exp_f32 v85, v85
    v_mfma_f32_16x16x32_bf16 v[88:91], v[188:191], v[60:63], v[88:91]
    s_waitcnt lgkmcnt(1)
    ds_read_b64_tr_b16 v[208:209], v4 offset:33984
    ds_read_b64_tr_b16 v[210:211], v4 offset:34240
    v_mfma_f32_16x16x32_bf16 v[92:95], v[188:191], v[76:79], v[108:111]
    v_exp_f32 v86, v86
    v_mfma_f32_16x16x32_bf16 v[92:95], v[184:187], v[72:75], v[92:95]
    ds_read_b128 v[204:207], v5 offset:51648
    v_mfma_f32_16x16x32_bf16 v[92:95], v[180:183], v[68:71], v[92:95]
    v_exp_f32 v87, v87
    v_mfma_f32_16x16x32_bf16 v[92:95], v[176:179], v[64:67], v[92:95]
    s_waitcnt vmcnt(8)
    s_barrier
    v_mfma_f32_16x16x32_bf16 a[20:23], v[216:219], v[112:115], a[20:23]
    v_exp_f32 v88, v88
    v_mfma_f32_16x16x32_bf16 a[20:23], v[220:223], v[116:119], a[20:23]
    v_cvt_pk_bf16_f32 v156, v84, v85
    v_cvt_pk_bf16_f32 v157, v86, v87
    v_mfma_f32_16x16x32_bf16 a[52:55], v[216:219], v[120:123], a[52:55]
    v_exp_f32 v89, v89
    v_mfma_f32_16x16x32_bf16 a[52:55], v[220:223], v[124:127], a[52:55]
    ds_read_b64_tr_b16 v[212:213], v4 offset:34496
    ds_read_b64_tr_b16 v[214:215], v4 offset:34752
    v_mfma_f32_16x16x32_bf16 a[84:87], v[216:219], v[128:131], a[84:87]
    v_exp_f32 v90, v90
    v_mfma_f32_16x16x32_bf16 a[84:87], v[220:223], v[132:135], a[84:87]
    ds_read_b128 v[176:179], v5 offset:0
    v_mfma_f32_16x16x32_bf16 a[116:119], v[216:219], v[136:139], a[116:119]
    s_add_u32 m0, s61, 33792
    v_exp_f32 v91, v91
    v_mfma_f32_16x16x32_bf16 a[116:119], v[220:223], v[140:143], a[116:119]
    buffer_load_dwordx4 v3, s[16:19], s63 offen offset:0  lds
    v_smfmac_f32_16x16x64_bf16 a[136:139], v[224:227], v[128:135], v228
    s_waitcnt lgkmcnt(3)
    v_mfma_f32_16x16x32_bf16 v[80:83], v[192:195], v[16:19], v[96:99]
    v_exp_f32 v92, v92
    v_mfma_f32_16x16x32_bf16 v[80:83], v[196:199], v[20:23], v[80:83]
    v_cvt_pk_bf16_f32 v164, v88, v89
    v_cvt_pk_bf16_f32 v165, v90, v91
    v_mfma_f32_16x16x32_bf16 v[80:83], v[200:203], v[24:27], v[80:83]
    v_exp_f32 v93, v93
    v_mfma_f32_16x16x32_bf16 v[80:83], v[204:207], v[28:31], v[80:83]
    s_waitcnt lgkmcnt(1)
    ds_read_b64_tr_b16 v[216:217], v4 offset:34016
    ds_read_b64_tr_b16 v[218:219], v4 offset:34272
    v_mfma_f32_16x16x32_bf16 v[84:87], v[204:207], v[44:47], v[100:103]
    v_exp_f32 v94, v94
    v_mfma_f32_16x16x32_bf16 v[84:87], v[200:203], v[40:43], v[84:87]
    ds_read_b128 v[180:183], v5 offset:64
    v_mfma_f32_16x16x32_bf16 v[84:87], v[196:199], v[36:39], v[84:87]
    v_exp_f32 v95, v95
    v_mfma_f32_16x16x32_bf16 v[84:87], v[192:195], v[32:35], v[84:87]
    v_mfma_f32_16x16x32_bf16 a[24:27], v[208:211], v[112:115], a[24:27]
    v_exp_f32 v80, v80
    v_mfma_f32_16x16x32_bf16 a[24:27], v[212:215], v[116:119], a[24:27]
    v_cvt_pk_bf16_f32 v172, v92, v93
    v_cvt_pk_bf16_f32 v173, v94, v95
    v_mfma_f32_16x16x32_bf16 a[56:59], v[208:211], v[120:123], a[56:59]
    v_exp_f32 v81, v81
    v_mfma_f32_16x16x32_bf16 a[56:59], v[212:215], v[124:127], a[56:59]
    ds_read_b64_tr_b16 v[220:221], v4 offset:34528
    ds_read_b64_tr_b16 v[222:223], v4 offset:34784
    v_mfma_f32_16x16x32_bf16 a[88:91], v[208:211], v[128:131], a[88:91]
    v_exp_f32 v82, v82
    v_mfma_f32_16x16x32_bf16 a[88:91], v[212:215], v[132:135], a[88:91]
    ds_read_b128 v[184:187], v5 offset:128
    v_mfma_f32_16x16x32_bf16 a[120:123], v[208:211], v[136:139], a[120:123]
    s_add_u32 m0, s61, 33824
    v_exp_f32 v83, v83
    v_mfma_f32_16x16x32_bf16 a[120:123], v[212:215], v[140:143], a[120:123]
    buffer_load_dwordx4 v3, s[16:19], s63 offen offset:1024  lds
    v_mfma_f32_16x16x32_bf16 v[88:91], v[192:195], v[48:51], v[104:107]
    v_exp_f32 v84, v84
    v_mfma_f32_16x16x32_bf16 v[88:91], v[196:199], v[52:55], v[88:91]
    v_cvt_pk_bf16_f32 v150, v80, v81
    v_cvt_pk_bf16_f32 v151, v82, v83
    v_mfma_f32_16x16x32_bf16 v[88:91], v[200:203], v[56:59], v[88:91]
    v_exp_f32 v85, v85
    v_mfma_f32_16x16x32_bf16 v[88:91], v[204:207], v[60:63], v[88:91]
    s_waitcnt lgkmcnt(1)
    ds_read_b64_tr_b16 v[208:209], v4 offset:50688
    ds_read_b64_tr_b16 v[210:211], v4 offset:50944
    v_mfma_f32_16x16x32_bf16 v[92:95], v[204:207], v[76:79], v[108:111]
    v_exp_f32 v86, v86
    v_mfma_f32_16x16x32_bf16 v[92:95], v[200:203], v[72:75], v[92:95]
    ds_read_b128 v[188:191], v5 offset:192
    v_mfma_f32_16x16x32_bf16 v[92:95], v[196:199], v[68:71], v[92:95]
    v_exp_f32 v87, v87
    v_mfma_f32_16x16x32_bf16 v[92:95], v[192:195], v[64:67], v[92:95]
    v_mfma_f32_16x16x32_bf16 a[28:31], v[216:219], v[112:115], a[28:31]
    v_exp_f32 v88, v88
    v_mfma_f32_16x16x32_bf16 a[28:31], v[220:223], v[116:119], a[28:31]
    v_cvt_pk_bf16_f32 v158, v84, v85
    v_cvt_pk_bf16_f32 v159, v86, v87
    v_mfma_f32_16x16x32_bf16 a[60:63], v[216:219], v[120:123], a[60:63]
    v_exp_f32 v89, v89
    v_mfma_f32_16x16x32_bf16 a[60:63], v[220:223], v[124:127], a[60:63]
    ds_read_b64_tr_b16 v[212:213], v4 offset:51200
    ds_read_b64_tr_b16 v[214:215], v4 offset:51456
    v_mfma_f32_16x16x32_bf16 a[92:95], v[216:219], v[128:131], a[92:95]
    v_exp_f32 v90, v90
    v_mfma_f32_16x16x32_bf16 a[92:95], v[220:223], v[132:135], a[92:95]
    ds_read_b128 v[192:195], v5 offset:256
    v_mfma_f32_16x16x32_bf16 a[124:127], v[216:219], v[136:139], a[124:127]
    s_add_u32 m0, s61, 33856
    v_exp_f32 v91, v91
    v_mfma_f32_16x16x32_bf16 a[124:127], v[220:223], v[140:143], a[124:127]
    buffer_load_dwordx4 v3, s[16:19], s63 offen offset:2048  lds
    v_smfmac_f32_16x16x64_bf16 a[140:143], v[224:227], v[136:143], v228
    s_waitcnt lgkmcnt(3)
    s_cmp_eq_u32 s49, 7
    s_cbranch_scc1 L_attn_done_61
    v_mfma_f32_16x16x32_bf16 v[80:83], v[176:179], v[16:19], v[96:99]
    v_exp_f32 v92, v92
    v_mfma_f32_16x16x32_bf16 v[80:83], v[180:183], v[20:23], v[80:83]
    v_cvt_pk_bf16_f32 v166, v88, v89
    v_cvt_pk_bf16_f32 v167, v90, v91
    v_mfma_f32_16x16x32_bf16 v[80:83], v[184:187], v[24:27], v[80:83]
    v_exp_f32 v93, v93
    v_mfma_f32_16x16x32_bf16 v[80:83], v[188:191], v[28:31], v[80:83]
    s_waitcnt lgkmcnt(1)
    ds_read_b64_tr_b16 v[216:217], v4 offset:50720
    ds_read_b64_tr_b16 v[218:219], v4 offset:50976
    v_mfma_f32_16x16x32_bf16 v[84:87], v[188:191], v[44:47], v[100:103]
    v_exp_f32 v94, v94
    v_mfma_f32_16x16x32_bf16 v[84:87], v[184:187], v[40:43], v[84:87]
    ds_read_b128 v[196:199], v5 offset:320
    v_mfma_f32_16x16x32_bf16 v[84:87], v[180:183], v[36:39], v[84:87]
    v_exp_f32 v95, v95
    v_mfma_f32_16x16x32_bf16 v[84:87], v[176:179], v[32:35], v[84:87]
    v_mfma_f32_16x16x32_bf16 a[0:3], v[208:211], v[144:147], a[0:3]
    v_exp_f32 v80, v80
    v_mfma_f32_16x16x32_bf16 a[0:3], v[212:215], v[148:151], a[0:3]
    v_cvt_pk_bf16_f32 v174, v92, v93
    v_cvt_pk_bf16_f32 v175, v94, v95
    v_mfma_f32_16x16x32_bf16 a[32:35], v[208:211], v[152:155], a[32:35]
    v_exp_f32 v81, v81
    v_mfma_f32_16x16x32_bf16 a[32:35], v[212:215], v[156:159], a[32:35]
    ds_read_b64_tr_b16 v[220:221], v4 offset:51232
    ds_read_b64_tr_b16 v[222:223], v4 offset:51488
    v_mfma_f32_16x16x32_bf16 a[64:67], v[208:211], v[160:163], a[64:67]
    v_exp_f32 v82, v82
    v_mfma_f32_16x16x32_bf16 a[64:67], v[212:215], v[164:167], a[64:67]
    ds_read_b128 v[200:203], v5 offset:384
    v_mfma_f32_16x16x32_bf16 a[96:99], v[208:211], v[168:171], a[96:99]
    s_add_u32 m0, s61, 33888
    v_exp_f32 v83, v83
    v_mfma_f32_16x16x32_bf16 a[96:99], v[212:215], v[172:175], a[96:99]
    buffer_load_dwordx4 v3, s[16:19], s63 offen offset:3072  lds
    s_add_u32 s63, s63, 16384
    v_mfma_f32_16x16x32_bf16 v[88:91], v[176:179], v[48:51], v[104:107]
    v_exp_f32 v84, v84
    v_mfma_f32_16x16x32_bf16 v[88:91], v[180:183], v[52:55], v[88:91]
    v_cvt_pk_bf16_f32 v112, v80, v81
    v_cvt_pk_bf16_f32 v113, v82, v83
    v_mfma_f32_16x16x32_bf16 v[88:91], v[184:187], v[56:59], v[88:91]
    v_exp_f32 v85, v85
    v_mfma_f32_16x16x32_bf16 v[88:91], v[188:191], v[60:63], v[88:91]
    s_waitcnt lgkmcnt(1)
    ds_read_b64_tr_b16 v[208:209], v4 offset:50752
    ds_read_b64_tr_b16 v[210:211], v4 offset:51008
    v_mfma_f32_16x16x32_bf16 v[92:95], v[188:191], v[76:79], v[108:111]
    v_exp_f32 v86, v86
    v_mfma_f32_16x16x32_bf16 v[92:95], v[184:187], v[72:75], v[92:95]
    ds_read_b128 v[204:207], v5 offset:448
    v_mfma_f32_16x16x32_bf16 v[92:95], v[180:183], v[68:71], v[92:95]
    v_exp_f32 v87, v87
    v_mfma_f32_16x16x32_bf16 v[92:95], v[176:179], v[64:67], v[92:95]
    v_mfma_f32_16x16x32_bf16 a[4:7], v[216:219], v[144:147], a[4:7]
    v_exp_f32 v88, v88
    v_mfma_f32_16x16x32_bf16 a[4:7], v[220:223], v[148:151], a[4:7]
    v_cvt_pk_bf16_f32 v120, v84, v85
    v_cvt_pk_bf16_f32 v121, v86, v87
    v_mfma_f32_16x16x32_bf16 a[36:39], v[216:219], v[152:155], a[36:39]
    v_exp_f32 v89, v89
    v_mfma_f32_16x16x32_bf16 a[36:39], v[220:223], v[156:159], a[36:39]
    ds_read_b64_tr_b16 v[212:213], v4 offset:51264
    ds_read_b64_tr_b16 v[214:215], v4 offset:51520
    v_mfma_f32_16x16x32_bf16 a[68:71], v[216:219], v[160:163], a[68:71]
    v_exp_f32 v90, v90
    v_mfma_f32_16x16x32_bf16 a[68:71], v[220:223], v[164:167], a[68:71]
    ds_read_b128 v[176:179], v5 offset:512
    v_mfma_f32_16x16x32_bf16 a[100:103], v[216:219], v[168:171], a[100:103]
    s_add_u32 m0, s61, 84480
    v_exp_f32 v91, v91
    v_mfma_f32_16x16x32_bf16 a[100:103], v[220:223], v[172:175], a[100:103]
    buffer_load_dwordx4 v3, s[20:23], s64 offen offset:0  lds
    v_smfmac_f32_16x16x64_bf16 a[128:131], v[224:227], v[144:151], v228
    s_waitcnt lgkmcnt(3)
    v_mfma_f32_16x16x32_bf16 v[80:83], v[192:195], v[16:19], v[96:99]
    v_exp_f32 v92, v92
    v_mfma_f32_16x16x32_bf16 v[80:83], v[196:199], v[20:23], v[80:83]
    v_cvt_pk_bf16_f32 v128, v88, v89
    v_cvt_pk_bf16_f32 v129, v90, v91
    v_mfma_f32_16x16x32_bf16 v[80:83], v[200:203], v[24:27], v[80:83]
    v_exp_f32 v93, v93
    v_mfma_f32_16x16x32_bf16 v[80:83], v[204:207], v[28:31], v[80:83]
    s_waitcnt lgkmcnt(1)
    ds_read_b64_tr_b16 v[216:217], v4 offset:50784
    ds_read_b64_tr_b16 v[218:219], v4 offset:51040
    v_mfma_f32_16x16x32_bf16 v[84:87], v[204:207], v[44:47], v[100:103]
    v_exp_f32 v94, v94
    v_mfma_f32_16x16x32_bf16 v[84:87], v[200:203], v[40:43], v[84:87]
    ds_read_b128 v[180:183], v5 offset:576
    v_mfma_f32_16x16x32_bf16 v[84:87], v[196:199], v[36:39], v[84:87]
    v_exp_f32 v95, v95
    v_mfma_f32_16x16x32_bf16 v[84:87], v[192:195], v[32:35], v[84:87]
    v_mfma_f32_16x16x32_bf16 a[8:11], v[208:211], v[144:147], a[8:11]
    v_exp_f32 v80, v80
    v_mfma_f32_16x16x32_bf16 a[8:11], v[212:215], v[148:151], a[8:11]
    v_cvt_pk_bf16_f32 v136, v92, v93
    v_cvt_pk_bf16_f32 v137, v94, v95
    v_mfma_f32_16x16x32_bf16 a[40:43], v[208:211], v[152:155], a[40:43]
    v_exp_f32 v81, v81
    v_mfma_f32_16x16x32_bf16 a[40:43], v[212:215], v[156:159], a[40:43]
    ds_read_b64_tr_b16 v[220:221], v4 offset:51296
    ds_read_b64_tr_b16 v[222:223], v4 offset:51552
    v_mfma_f32_16x16x32_bf16 a[72:75], v[208:211], v[160:163], a[72:75]
    v_exp_f32 v82, v82
    v_mfma_f32_16x16x32_bf16 a[72:75], v[212:215], v[164:167], a[72:75]
    ds_read_b128 v[184:187], v5 offset:640
    v_mfma_f32_16x16x32_bf16 a[104:107], v[208:211], v[168:171], a[104:107]
    s_add_u32 m0, s61, 84512
    v_exp_f32 v83, v83
    v_mfma_f32_16x16x32_bf16 a[104:107], v[212:215], v[172:175], a[104:107]
    buffer_load_dwordx4 v3, s[20:23], s64 offen offset:1024  lds
    v_mfma_f32_16x16x32_bf16 v[88:91], v[192:195], v[48:51], v[104:107]
    v_exp_f32 v84, v84
    v_mfma_f32_16x16x32_bf16 v[88:91], v[196:199], v[52:55], v[88:91]
    v_cvt_pk_bf16_f32 v114, v80, v81
    v_cvt_pk_bf16_f32 v115, v82, v83
    v_mfma_f32_16x16x32_bf16 v[88:91], v[200:203], v[56:59], v[88:91]
    v_exp_f32 v85, v85
    v_mfma_f32_16x16x32_bf16 v[88:91], v[204:207], v[60:63], v[88:91]
    s_waitcnt lgkmcnt(1)
    ds_read_b64_tr_b16 v[208:209], v4 offset:50816
    ds_read_b64_tr_b16 v[210:211], v4 offset:51072
    v_mfma_f32_16x16x32_bf16 v[92:95], v[204:207], v[76:79], v[108:111]
    v_exp_f32 v86, v86
    v_mfma_f32_16x16x32_bf16 v[92:95], v[200:203], v[72:75], v[92:95]
    ds_read_b128 v[188:191], v5 offset:704
    v_mfma_f32_16x16x32_bf16 v[92:95], v[196:199], v[68:71], v[92:95]
    v_exp_f32 v87, v87
    v_mfma_f32_16x16x32_bf16 v[92:95], v[192:195], v[64:67], v[92:95]
    v_mfma_f32_16x16x32_bf16 a[12:15], v[216:219], v[144:147], a[12:15]
    v_exp_f32 v88, v88
    v_mfma_f32_16x16x32_bf16 a[12:15], v[220:223], v[148:151], a[12:15]
    v_cvt_pk_bf16_f32 v122, v84, v85
    v_cvt_pk_bf16_f32 v123, v86, v87
    v_mfma_f32_16x16x32_bf16 a[44:47], v[216:219], v[152:155], a[44:47]
    v_exp_f32 v89, v89
    v_mfma_f32_16x16x32_bf16 a[44:47], v[220:223], v[156:159], a[44:47]
    ds_read_b64_tr_b16 v[212:213], v4 offset:51328
    ds_read_b64_tr_b16 v[214:215], v4 offset:51584
    v_mfma_f32_16x16x32_bf16 a[76:79], v[216:219], v[160:163], a[76:79]
    v_exp_f32 v90, v90
    v_mfma_f32_16x16x32_bf16 a[76:79], v[220:223], v[164:167], a[76:79]
    ds_read_b128 v[192:195], v5 offset:768
    v_mfma_f32_16x16x32_bf16 a[108:111], v[216:219], v[168:171], a[108:111]
    s_add_u32 m0, s61, 84544
    v_exp_f32 v91, v91
    v_mfma_f32_16x16x32_bf16 a[108:111], v[220:223], v[172:175], a[108:111]
    buffer_load_dwordx4 v3, s[20:23], s64 offen offset:2048  lds
    v_smfmac_f32_16x16x64_bf16 a[132:135], v[224:227], v[152:159], v228
    s_waitcnt lgkmcnt(3)
    v_mfma_f32_16x16x32_bf16 v[80:83], v[176:179], v[16:19], v[96:99]
    v_exp_f32 v92, v92
    v_mfma_f32_16x16x32_bf16 v[80:83], v[180:183], v[20:23], v[80:83]
    v_cvt_pk_bf16_f32 v130, v88, v89
    v_cvt_pk_bf16_f32 v131, v90, v91
    v_mfma_f32_16x16x32_bf16 v[80:83], v[184:187], v[24:27], v[80:83]
    v_exp_f32 v93, v93
    v_mfma_f32_16x16x32_bf16 v[80:83], v[188:191], v[28:31], v[80:83]
    s_waitcnt lgkmcnt(1)
    ds_read_b64_tr_b16 v[216:217], v4 offset:50848
    ds_read_b64_tr_b16 v[218:219], v4 offset:51104
    v_mfma_f32_16x16x32_bf16 v[84:87], v[188:191], v[44:47], v[100:103]
    v_exp_f32 v94, v94
    v_mfma_f32_16x16x32_bf16 v[84:87], v[184:187], v[40:43], v[84:87]
    ds_read_b128 v[196:199], v5 offset:832
    v_mfma_f32_16x16x32_bf16 v[84:87], v[180:183], v[36:39], v[84:87]
    v_exp_f32 v95, v95
    v_mfma_f32_16x16x32_bf16 v[84:87], v[176:179], v[32:35], v[84:87]
    v_mfma_f32_16x16x32_bf16 a[16:19], v[208:211], v[144:147], a[16:19]
    v_exp_f32 v80, v80
    v_mfma_f32_16x16x32_bf16 a[16:19], v[212:215], v[148:151], a[16:19]
    v_cvt_pk_bf16_f32 v138, v92, v93
    v_cvt_pk_bf16_f32 v139, v94, v95
    v_mfma_f32_16x16x32_bf16 a[48:51], v[208:211], v[152:155], a[48:51]
    v_exp_f32 v81, v81
    v_mfma_f32_16x16x32_bf16 a[48:51], v[212:215], v[156:159], a[48:51]
    ds_read_b64_tr_b16 v[220:221], v4 offset:51360
    ds_read_b64_tr_b16 v[222:223], v4 offset:51616
    v_mfma_f32_16x16x32_bf16 a[80:83], v[208:211], v[160:163], a[80:83]
    v_exp_f32 v82, v82
    v_mfma_f32_16x16x32_bf16 a[80:83], v[212:215], v[164:167], a[80:83]
    ds_read_b128 v[200:203], v5 offset:896
    v_mfma_f32_16x16x32_bf16 a[112:115], v[208:211], v[168:171], a[112:115]
    s_add_u32 m0, s61, 84576
    v_exp_f32 v83, v83
    v_mfma_f32_16x16x32_bf16 a[112:115], v[212:215], v[172:175], a[112:115]
    buffer_load_dwordx4 v3, s[20:23], s64 offen offset:3072  lds
    s_add_u32 s64, s64, 16384
    v_mfma_f32_16x16x32_bf16 v[88:91], v[176:179], v[48:51], v[104:107]
    v_exp_f32 v84, v84
    v_mfma_f32_16x16x32_bf16 v[88:91], v[180:183], v[52:55], v[88:91]
    v_cvt_pk_bf16_f32 v116, v80, v81
    v_cvt_pk_bf16_f32 v117, v82, v83
    v_mfma_f32_16x16x32_bf16 v[88:91], v[184:187], v[56:59], v[88:91]
    v_exp_f32 v85, v85
    v_mfma_f32_16x16x32_bf16 v[88:91], v[188:191], v[60:63], v[88:91]
    s_waitcnt lgkmcnt(1)
    ds_read_b64_tr_b16 v[208:209], v4 offset:50880
    ds_read_b64_tr_b16 v[210:211], v4 offset:51136
    v_mfma_f32_16x16x32_bf16 v[92:95], v[188:191], v[76:79], v[108:111]
    v_exp_f32 v86, v86
    v_mfma_f32_16x16x32_bf16 v[92:95], v[184:187], v[72:75], v[92:95]
    ds_read_b128 v[204:207], v5 offset:960
    v_mfma_f32_16x16x32_bf16 v[92:95], v[180:183], v[68:71], v[92:95]
    v_exp_f32 v87, v87
    v_mfma_f32_16x16x32_bf16 v[92:95], v[176:179], v[64:67], v[92:95]
    s_waitcnt vmcnt(8)
    s_barrier
    v_mfma_f32_16x16x32_bf16 a[20:23], v[216:219], v[144:147], a[20:23]
    v_exp_f32 v88, v88
    v_mfma_f32_16x16x32_bf16 a[20:23], v[220:223], v[148:151], a[20:23]
    v_cvt_pk_bf16_f32 v124, v84, v85
    v_cvt_pk_bf16_f32 v125, v86, v87
    v_mfma_f32_16x16x32_bf16 a[52:55], v[216:219], v[152:155], a[52:55]
    v_exp_f32 v89, v89
    v_mfma_f32_16x16x32_bf16 a[52:55], v[220:223], v[156:159], a[52:55]
    ds_read_b64_tr_b16 v[212:213], v4 offset:51392
    ds_read_b64_tr_b16 v[214:215], v4 offset:51648
    v_mfma_f32_16x16x32_bf16 a[84:87], v[216:219], v[160:163], a[84:87]
    v_exp_f32 v90, v90
    v_mfma_f32_16x16x32_bf16 a[84:87], v[220:223], v[164:167], a[84:87]
    ds_read_b128 v[176:179], v5 offset:16896
    v_mfma_f32_16x16x32_bf16 a[116:119], v[216:219], v[168:171], a[116:119]
    s_add_u32 m0, s61, 50688
    v_exp_f32 v91, v91
    v_mfma_f32_16x16x32_bf16 a[116:119], v[220:223], v[172:175], a[116:119]
    buffer_load_dwordx4 v3, s[16:19], s63 offen offset:0  lds
    v_smfmac_f32_16x16x64_bf16 a[136:139], v[224:227], v[160:167], v228
    s_waitcnt lgkmcnt(3)
    v_mfma_f32_16x16x32_bf16 v[80:83], v[192:195], v[16:19], v[96:99]
    v_exp_f32 v92, v92
    v_mfma_f32_16x16x32_bf16 v[80:83], v[196:199], v[20:23], v[80:83]
    v_cvt_pk_bf16_f32 v132, v88, v89
    v_cvt_pk_bf16_f32 v133, v90, v91
    v_mfma_f32_16x16x32_bf16 v[80:83], v[200:203], v[24:27], v[80:83]
    v_exp_f32 v93, v93
    v_mfma_f32_16x16x32_bf16 v[80:83], v[204:207], v[28:31], v[80:83]
    s_waitcnt lgkmcnt(1)
    ds_read_b64_tr_b16 v[216:217], v4 offset:50912
    ds_read_b64_tr_b16 v[218:219], v4 offset:51168
    v_mfma_f32_16x16x32_bf16 v[84:87], v[204:207], v[44:47], v[100:103]
    v_exp_f32 v94, v94
    v_mfma_f32_16x16x32_bf16 v[84:87], v[200:203], v[40:43], v[84:87]
    ds_read_b128 v[180:183], v5 offset:16960
    v_mfma_f32_16x16x32_bf16 v[84:87], v[196:199], v[36:39], v[84:87]
    v_exp_f32 v95, v95
    v_mfma_f32_16x16x32_bf16 v[84:87], v[192:195], v[32:35], v[84:87]
    v_mfma_f32_16x16x32_bf16 a[24:27], v[208:211], v[144:147], a[24:27]
    v_exp_f32 v80, v80
    v_mfma_f32_16x16x32_bf16 a[24:27], v[212:215], v[148:151], a[24:27]
    v_cvt_pk_bf16_f32 v140, v92, v93
    v_cvt_pk_bf16_f32 v141, v94, v95
    v_mfma_f32_16x16x32_bf16 a[56:59], v[208:211], v[152:155], a[56:59]
    v_exp_f32 v81, v81
    v_mfma_f32_16x16x32_bf16 a[56:59], v[212:215], v[156:159], a[56:59]
    ds_read_b64_tr_b16 v[220:221], v4 offset:51424
    ds_read_b64_tr_b16 v[222:223], v4 offset:51680
    v_mfma_f32_16x16x32_bf16 a[88:91], v[208:211], v[160:163], a[88:91]
    v_exp_f32 v82, v82
    v_mfma_f32_16x16x32_bf16 a[88:91], v[212:215], v[164:167], a[88:91]
    ds_read_b128 v[184:187], v5 offset:17024
    v_mfma_f32_16x16x32_bf16 a[120:123], v[208:211], v[168:171], a[120:123]
    s_add_u32 m0, s61, 50720
    v_exp_f32 v83, v83
    v_mfma_f32_16x16x32_bf16 a[120:123], v[212:215], v[172:175], a[120:123]
    buffer_load_dwordx4 v3, s[16:19], s63 offen offset:1024  lds
    v_mfma_f32_16x16x32_bf16 v[88:91], v[192:195], v[48:51], v[104:107]
    v_exp_f32 v84, v84
    v_mfma_f32_16x16x32_bf16 v[88:91], v[196:199], v[52:55], v[88:91]
    v_cvt_pk_bf16_f32 v118, v80, v81
    v_cvt_pk_bf16_f32 v119, v82, v83
    v_mfma_f32_16x16x32_bf16 v[88:91], v[200:203], v[56:59], v[88:91]
    v_exp_f32 v85, v85
    v_mfma_f32_16x16x32_bf16 v[88:91], v[204:207], v[60:63], v[88:91]
    s_waitcnt lgkmcnt(1)
    ds_read_b64_tr_b16 v[208:209], v4 offset:0
    ds_read_b64_tr_b16 v[210:211], v4 offset:256
    v_mfma_f32_16x16x32_bf16 v[92:95], v[204:207], v[76:79], v[108:111]
    v_exp_f32 v86, v86
    v_mfma_f32_16x16x32_bf16 v[92:95], v[200:203], v[72:75], v[92:95]
    ds_read_b128 v[188:191], v5 offset:17088
    v_mfma_f32_16x16x32_bf16 v[92:95], v[196:199], v[68:71], v[92:95]
    v_exp_f32 v87, v87
    v_mfma_f32_16x16x32_bf16 v[92:95], v[192:195], v[64:67], v[92:95]
    v_mfma_f32_16x16x32_bf16 a[28:31], v[216:219], v[144:147], a[28:31]
    v_exp_f32 v88, v88
    v_mfma_f32_16x16x32_bf16 a[28:31], v[220:223], v[148:151], a[28:31]
    v_cvt_pk_bf16_f32 v126, v84, v85
    v_cvt_pk_bf16_f32 v127, v86, v87
    v_mfma_f32_16x16x32_bf16 a[60:63], v[216:219], v[152:155], a[60:63]
    v_exp_f32 v89, v89
    v_mfma_f32_16x16x32_bf16 a[60:63], v[220:223], v[156:159], a[60:63]
    ds_read_b64_tr_b16 v[212:213], v4 offset:512
    ds_read_b64_tr_b16 v[214:215], v4 offset:768
    v_mfma_f32_16x16x32_bf16 a[92:95], v[216:219], v[160:163], a[92:95]
    v_exp_f32 v90, v90
    v_mfma_f32_16x16x32_bf16 a[92:95], v[220:223], v[164:167], a[92:95]
    ds_read_b128 v[192:195], v5 offset:17152
    v_mfma_f32_16x16x32_bf16 a[124:127], v[216:219], v[168:171], a[124:127]
    s_add_u32 m0, s61, 50752
    v_exp_f32 v91, v91
    v_mfma_f32_16x16x32_bf16 a[124:127], v[220:223], v[172:175], a[124:127]
    buffer_load_dwordx4 v3, s[16:19], s63 offen offset:2048  lds
    v_smfmac_f32_16x16x64_bf16 a[140:143], v[224:227], v[168:175], v228
    s_waitcnt lgkmcnt(3)
    s_add_u32 s49, s49, 1
    s_branch L_attn_60
L_attn_done_61:
    v_cvt_pk_bf16_f32 v166, v88, v89
    v_cvt_pk_bf16_f32 v167, v90, v91
    v_exp_f32 v92, v92
    v_exp_f32 v93, v93
    v_exp_f32 v94, v94
    v_exp_f32 v95, v95
    s_nop 1
    s_waitcnt lgkmcnt(0)
    v_mfma_f32_16x16x32_bf16 a[0:3], v[208:211], v[144:147], a[0:3]
    ds_read_b64_tr_b16 v[216:217], v4 offset:50720
    ds_read_b64_tr_b16 v[218:219], v4 offset:50976
    v_mfma_f32_16x16x32_bf16 a[0:3], v[212:215], v[148:151], a[0:3]
    v_mfma_f32_16x16x32_bf16 a[32:35], v[208:211], v[152:155], a[32:35]
    v_mfma_f32_16x16x32_bf16 a[32:35], v[212:215], v[156:159], a[32:35]
    v_cvt_pk_bf16_f32 v174, v92, v93
    v_cvt_pk_bf16_f32 v175, v94, v95
    s_nop 1
    v_mfma_f32_16x16x32_bf16 a[64:67], v[208:211], v[160:163], a[64:67]
    ds_read_b64_tr_b16 v[220:221], v4 offset:51232
    ds_read_b64_tr_b16 v[222:223], v4 offset:51488
    v_mfma_f32_16x16x32_bf16 a[64:67], v[212:215], v[164:167], a[64:67]
    v_mfma_f32_16x16x32_bf16 a[96:99], v[208:211], v[168:171], a[96:99]
    v_mfma_f32_16x16x32_bf16 a[96:99], v[212:215], v[172:175], a[96:99]
    s_waitcnt lgkmcnt(0)
    v_mfma_f32_16x16x32_bf16 a[4:7], v[216:219], v[144:147], a[4:7]
    ds_read_b64_tr_b16 v[208:209], v4 offset:50752
    ds_read_b64_tr_b16 v[210:211], v4 offset:51008
    v_mfma_f32_16x16x32_bf16 a[4:7], v[220:223], v[148:151], a[4:7]
    v_mfma_f32_16x16x32_bf16 a[36:39], v[216:219], v[152:155], a[36:39]
    v_mfma_f32_16x16x32_bf16 a[36:39], v[220:223], v[156:159], a[36:39]
    v_mfma_f32_16x16x32_bf16 a[68:71], v[216:219], v[160:163], a[68:71]
    ds_read_b64_tr_b16 v[212:213], v4 offset:51264
    ds_read_b64_tr_b16 v[214:215], v4 offset:51520
    v_mfma_f32_16x16x32_bf16 a[68:71], v[220:223], v[164:167], a[68:71]
    v_mfma_f32_16x16x32_bf16 a[100:103], v[216:219], v[168:171], a[100:103]
    v_mfma_f32_16x16x32_bf16 a[100:103], v[220:223], v[172:175], a[100:103]
    v_smfmac_f32_16x16x64_bf16 a[128:131], v[224:227], v[144:151], v228
    s_waitcnt lgkmcnt(0)
    v_mfma_f32_16x16x32_bf16 a[8:11], v[208:211], v[144:147], a[8:11]
    ds_read_b64_tr_b16 v[216:217], v4 offset:50784
    ds_read_b64_tr_b16 v[218:219], v4 offset:51040
    v_mfma_f32_16x16x32_bf16 a[8:11], v[212:215], v[148:151], a[8:11]
    v_mfma_f32_16x16x32_bf16 a[40:43], v[208:211], v[152:155], a[40:43]
    v_mfma_f32_16x16x32_bf16 a[40:43], v[212:215], v[156:159], a[40:43]
    v_mfma_f32_16x16x32_bf16 a[72:75], v[208:211], v[160:163], a[72:75]
    ds_read_b64_tr_b16 v[220:221], v4 offset:51296
    ds_read_b64_tr_b16 v[222:223], v4 offset:51552
    v_mfma_f32_16x16x32_bf16 a[72:75], v[212:215], v[164:167], a[72:75]
    v_mfma_f32_16x16x32_bf16 a[104:107], v[208:211], v[168:171], a[104:107]
    v_mfma_f32_16x16x32_bf16 a[104:107], v[212:215], v[172:175], a[104:107]
    s_waitcnt lgkmcnt(0)
    v_mfma_f32_16x16x32_bf16 a[12:15], v[216:219], v[144:147], a[12:15]
    ds_read_b64_tr_b16 v[208:209], v4 offset:50816
    ds_read_b64_tr_b16 v[210:211], v4 offset:51072
    v_mfma_f32_16x16x32_bf16 a[12:15], v[220:223], v[148:151], a[12:15]
    v_mfma_f32_16x16x32_bf16 a[44:47], v[216:219], v[152:155], a[44:47]
    v_mfma_f32_16x16x32_bf16 a[44:47], v[220:223], v[156:159], a[44:47]
    v_mfma_f32_16x16x32_bf16 a[76:79], v[216:219], v[160:163], a[76:79]
    ds_read_b64_tr_b16 v[212:213], v4 offset:51328
    ds_read_b64_tr_b16 v[214:215], v4 offset:51584
    v_mfma_f32_16x16x32_bf16 a[76:79], v[220:223], v[164:167], a[76:79]
    v_mfma_f32_16x16x32_bf16 a[108:111], v[216:219], v[168:171], a[108:111]
    v_mfma_f32_16x16x32_bf16 a[108:111], v[220:223], v[172:175], a[108:111]
    v_smfmac_f32_16x16x64_bf16 a[132:135], v[224:227], v[152:159], v228
    s_waitcnt lgkmcnt(0)
    v_mfma_f32_16x16x32_bf16 a[16:19], v[208:211], v[144:147], a[16:19]
    ds_read_b64_tr_b16 v[216:217], v4 offset:50848
    ds_read_b64_tr_b16 v[218:219], v4 offset:51104
    v_mfma_f32_16x16x32_bf16 a[16:19], v[212:215], v[148:151], a[16:19]
    v_mfma_f32_16x16x32_bf16 a[48:51], v[208:211], v[152:155], a[48:51]
    v_mfma_f32_16x16x32_bf16 a[48:51], v[212:215], v[156:159], a[48:51]
    v_mfma_f32_16x16x32_bf16 a[80:83], v[208:211], v[160:163], a[80:83]
    ds_read_b64_tr_b16 v[220:221], v4 offset:51360
    ds_read_b64_tr_b16 v[222:223], v4 offset:51616
    v_mfma_f32_16x16x32_bf16 a[80:83], v[212:215], v[164:167], a[80:83]
    v_mfma_f32_16x16x32_bf16 a[112:115], v[208:211], v[168:171], a[112:115]
    v_mfma_f32_16x16x32_bf16 a[112:115], v[212:215], v[172:175], a[112:115]
    s_waitcnt lgkmcnt(0)
    v_mfma_f32_16x16x32_bf16 a[20:23], v[216:219], v[144:147], a[20:23]
    ds_read_b64_tr_b16 v[208:209], v4 offset:50880
    ds_read_b64_tr_b16 v[210:211], v4 offset:51136
    v_mfma_f32_16x16x32_bf16 a[20:23], v[220:223], v[148:151], a[20:23]
    v_mfma_f32_16x16x32_bf16 a[52:55], v[216:219], v[152:155], a[52:55]
    v_mfma_f32_16x16x32_bf16 a[52:55], v[220:223], v[156:159], a[52:55]
    v_mfma_f32_16x16x32_bf16 a[84:87], v[216:219], v[160:163], a[84:87]
    ds_read_b64_tr_b16 v[212:213], v4 offset:51392
    ds_read_b64_tr_b16 v[214:215], v4 offset:51648
    v_mfma_f32_16x16x32_bf16 a[84:87], v[220:223], v[164:167], a[84:87]
    v_mfma_f32_16x16x32_bf16 a[116:119], v[216:219], v[168:171], a[116:119]
    v_mfma_f32_16x16x32_bf16 a[116:119], v[220:223], v[172:175], a[116:119]
    v_smfmac_f32_16x16x64_bf16 a[136:139], v[224:227], v[160:167], v228
    s_waitcnt lgkmcnt(0)
    v_mfma_f32_16x16x32_bf16 a[24:27], v[208:211], v[144:147], a[24:27]
    ds_read_b64_tr_b16 v[216:217], v4 offset:50912
    ds_read_b64_tr_b16 v[218:219], v4 offset:51168
    v_mfma_f32_16x16x32_bf16 a[24:27], v[212:215], v[148:151], a[24:27]
    v_mfma_f32_16x16x32_bf16 a[56:59], v[208:211], v[152:155], a[56:59]
    v_mfma_f32_16x16x32_bf16 a[56:59], v[212:215], v[156:159], a[56:59]
    v_mfma_f32_16x16x32_bf16 a[88:91], v[208:211], v[160:163], a[88:91]
    ds_read_b64_tr_b16 v[220:221], v4 offset:51424
    ds_read_b64_tr_b16 v[222:223], v4 offset:51680
    v_mfma_f32_16x16x32_bf16 a[88:91], v[212:215], v[164:167], a[88:91]
    v_mfma_f32_16x16x32_bf16 a[120:123], v[208:211], v[168:171], a[120:123]
    v_mfma_f32_16x16x32_bf16 a[120:123], v[212:215], v[172:175], a[120:123]
    s_waitcnt lgkmcnt(0)
    v_mfma_f32_16x16x32_bf16 a[28:31], v[216:219], v[144:147], a[28:31]
    v_mfma_f32_16x16x32_bf16 a[28:31], v[220:223], v[148:151], a[28:31]
    v_mfma_f32_16x16x32_bf16 a[60:63], v[216:219], v[152:155], a[60:63]
    v_mfma_f32_16x16x32_bf16 a[60:63], v[220:223], v[156:159], a[60:63]
    v_mfma_f32_16x16x32_bf16 a[92:95], v[216:219], v[160:163], a[92:95]
    v_mfma_f32_16x16x32_bf16 a[92:95], v[220:223], v[164:167], a[92:95]
    v_mfma_f32_16x16x32_bf16 a[124:127], v[216:219], v[168:171], a[124:127]
    v_mfma_f32_16x16x32_bf16 a[124:127], v[220:223], v[172:175], a[124:127]
    v_smfmac_f32_16x16x64_bf16 a[140:143], v[224:227], v[168:175], v228
    s_waitcnt vmcnt(0)
    s_barrier
    s_add_u32 m0, s61, 0
    s_nop 0
    buffer_load_dwordx4 v2, s[8:11], s67 offen  lds
    s_add_u32 s67, s67, 2048
    s_add_u32 m0, s61, 1032
    s_nop 0
    buffer_load_dwordx4 v2, s[8:11], s67 offen  lds
    s_add_u32 s67, s67, 2048
    s_add_u32 m0, s61, 2112
    s_nop 0
    buffer_load_dwordx4 v2, s[8:11], s67 offen  lds
    s_add_u32 s67, s67, 2048
    s_add_u32 m0, s61, 3144
    s_nop 0
    buffer_load_dwordx4 v2, s[8:11], s67 offen  lds
    s_add_u32 s67, s67, 256000
    s_add_u32 m0, s61, 16896
    s_nop 0
    buffer_load_dwordx4 v2, s[8:11], s67 offen  lds
    s_add_u32 s67, s67, 2048
    s_add_u32 m0, s61, 17928
    s_nop 0
    buffer_load_dwordx4 v2, s[8:11], s67 offen  lds
    s_add_u32 s67, s67, 2048
    s_add_u32 m0, s61, 19008
    s_nop 0
    buffer_load_dwordx4 v2, s[8:11], s67 offen  lds
    s_add_u32 s67, s67, 2048
    s_add_u32 m0, s61, 20040
    s_nop 0
    buffer_load_dwordx4 v2, s[8:11], s67 offen  lds
    s_add_u32 s67, s67, 256000
    s_add_u32 m0, s62, 0
    s_nop 0
    buffer_load_dwordx4 v2, s[8:11], s65 offen  lds
    s_add_u32 s65, s65, 2048
    s_add_u32 m0, s62, 1032
    s_nop 0
    buffer_load_dwordx4 v2, s[8:11], s65 offen  lds
    s_add_u32 s65, s65, 2048
    s_add_u32 m0, s62, 2112
    s_nop 0
    buffer_load_dwordx4 v2, s[8:11], s65 offen  lds
    s_add_u32 s65, s65, 2048
    s_add_u32 m0, s62, 3144
    s_nop 0
    buffer_load_dwordx4 v2, s[8:11], s65 offen  lds
    s_add_u32 s65, s65, 256000
    s_add_u32 m0, s61, 33792
    s_nop 0
    buffer_load_dwordx4 v2, s[8:11], s67 offen  lds
    s_add_u32 s67, s67, 2048
    s_add_u32 m0, s61, 34824
    s_nop 0
    buffer_load_dwordx4 v2, s[8:11], s67 offen  lds
    s_add_u32 s67, s67, 2048
    s_add_u32 m0, s61, 35904
    s_nop 0
    buffer_load_dwordx4 v2, s[8:11], s67 offen  lds
    s_add_u32 s67, s67, 2048
    s_add_u32 m0, s61, 36936
    s_nop 0
    buffer_load_dwordx4 v2, s[8:11], s67 offen  lds
    s_add_u32 s67, s67, 256000
    s_add_u32 m0, s62, 16896
    s_nop 0
    buffer_load_dwordx4 v2, s[8:11], s65 offen  lds
    s_add_u32 s65, s65, 2048
    s_add_u32 m0, s62, 17928
    s_nop 0
    buffer_load_dwordx4 v2, s[8:11], s65 offen  lds
    s_add_u32 s65, s65, 2048
    s_add_u32 m0, s62, 19008
    s_nop 0
    buffer_load_dwordx4 v2, s[8:11], s65 offen  lds
    s_add_u32 s65, s65, 2048
    s_add_u32 m0, s62, 20040
    s_nop 0
    buffer_load_dwordx4 v2, s[8:11], s65 offen  lds
    s_add_u32 s65, s65, 256000
    s_add_u32 m0, s61, 50688
    s_nop 0
    buffer_load_dwordx4 v2, s[8:11], s67 offen  lds
    s_add_u32 s67, s67, 2048
    s_add_u32 m0, s61, 51720
    s_nop 0
    buffer_load_dwordx4 v2, s[8:11], s67 offen  lds
    s_add_u32 s67, s67, 2048
    s_add_u32 m0, s61, 52800
    s_nop 0
    buffer_load_dwordx4 v2, s[8:11], s67 offen  lds
    s_add_u32 s67, s67, 2048
    s_add_u32 m0, s61, 53832
    s_nop 0
    buffer_load_dwordx4 v2, s[8:11], s67 offen  lds
    s_add_u32 s67, s67, s40
    s_nop 7
    v_accvgpr_read_b32 v80, a128
    v_accvgpr_read_b32 v81, a129
    v_accvgpr_read_b32 v82, a132
    v_accvgpr_read_b32 v83, a133
    v_accvgpr_read_b32 v84, a136
    v_accvgpr_read_b32 v85, a137
    v_accvgpr_read_b32 v86, a140
    v_accvgpr_read_b32 v87, a141
    v_add_f32 v80, v80, v81
    v_add_f32 v82, v82, v83
    v_add_f32 v84, v84, v85
    v_add_f32 v86, v86, v87
    v_rcp_f32 v80, v80
    v_rcp_f32 v82, v82
    v_rcp_f32 v84, v84
    v_rcp_f32 v86, v86
    v_mul_f32 v80, 0x41000000, v80
    v_mul_f32 v82, 0x41000000, v82
    v_mul_f32 v84, 0x41000000, v84
    v_mul_f32 v86, 0x41000000, v86
    v_accvgpr_read_b32 v176, a0
    v_accvgpr_read_b32 v177, a1
    v_accvgpr_read_b32 v178, a2
    v_accvgpr_read_b32 v179, a3
    v_accvgpr_read_b32 v180, a4
    v_accvgpr_read_b32 v181, a5
    v_accvgpr_read_b32 v182, a6
    v_accvgpr_read_b32 v183, a7
    v_pk_mul_f32 v[176:177], v[176:177], v[80:81] op_sel_hi:[1,0]
    v_pk_mul_f32 v[178:179], v[178:179], v[80:81] op_sel_hi:[1,0]
    v_pk_mul_f32 v[180:181], v[180:181], v[80:81] op_sel_hi:[1,0]
    v_pk_mul_f32 v[182:183], v[182:183], v[80:81] op_sel_hi:[1,0]
    v_cvt_pk_bf16_f32 v112, v176, v177
    v_cvt_pk_bf16_f32 v113, v178, v179
    v_cvt_pk_bf16_f32 v114, v180, v181
    v_cvt_pk_bf16_f32 v115, v182, v183
    buffer_store_dwordx4 v[112:115], v6, s[24:27], 0 offen offset:0 sc1
    v_accvgpr_read_b32 v184, a32
    v_accvgpr_read_b32 v185, a33
    v_accvgpr_read_b32 v186, a34
    v_accvgpr_read_b32 v187, a35
    v_accvgpr_read_b32 v188, a36
    v_accvgpr_read_b32 v189, a37
    v_accvgpr_read_b32 v190, a38
    v_accvgpr_read_b32 v191, a39
    v_pk_mul_f32 v[184:185], v[184:185], v[82:83] op_sel_hi:[1,0]
    v_pk_mul_f32 v[186:187], v[186:187], v[82:83] op_sel_hi:[1,0]
    v_pk_mul_f32 v[188:189], v[188:189], v[82:83] op_sel_hi:[1,0]
    v_pk_mul_f32 v[190:191], v[190:191], v[82:83] op_sel_hi:[1,0]
    v_cvt_pk_bf16_f32 v116, v184, v185
    v_cvt_pk_bf16_f32 v117, v186, v187
    v_cvt_pk_bf16_f32 v118, v188, v189
    v_cvt_pk_bf16_f32 v119, v190, v191
    buffer_store_dwordx4 v[116:119], v7, s[24:27], 0 offen offset:0 sc1
    v_accvgpr_read_b32 v176, a64
    v_accvgpr_read_b32 v177, a65
    v_accvgpr_read_b32 v178, a66
    v_accvgpr_read_b32 v179, a67
    v_accvgpr_read_b32 v180, a68
    v_accvgpr_read_b32 v181, a69
    v_accvgpr_read_b32 v182, a70
    v_accvgpr_read_b32 v183, a71
    v_pk_mul_f32 v[176:177], v[176:177], v[84:85] op_sel_hi:[1,0]
    v_pk_mul_f32 v[178:179], v[178:179], v[84:85] op_sel_hi:[1,0]
    v_pk_mul_f32 v[180:181], v[180:181], v[84:85] op_sel_hi:[1,0]
    v_pk_mul_f32 v[182:183], v[182:183], v[84:85] op_sel_hi:[1,0]
    v_cvt_pk_bf16_f32 v120, v176, v177
    v_cvt_pk_bf16_f32 v121, v178, v179
    v_cvt_pk_bf16_f32 v122, v180, v181
    v_cvt_pk_bf16_f32 v123, v182, v183
    buffer_store_dwordx4 v[120:123], v8, s[24:27], 0 offen offset:0 sc1
    v_accvgpr_read_b32 v184, a96
    v_accvgpr_read_b32 v185, a97
    v_accvgpr_read_b32 v186, a98
    v_accvgpr_read_b32 v187, a99
    v_accvgpr_read_b32 v188, a100
    v_accvgpr_read_b32 v189, a101
    v_accvgpr_read_b32 v190, a102
    v_accvgpr_read_b32 v191, a103
    v_pk_mul_f32 v[184:185], v[184:185], v[86:87] op_sel_hi:[1,0]
    v_pk_mul_f32 v[186:187], v[186:187], v[86:87] op_sel_hi:[1,0]
    v_pk_mul_f32 v[188:189], v[188:189], v[86:87] op_sel_hi:[1,0]
    v_pk_mul_f32 v[190:191], v[190:191], v[86:87] op_sel_hi:[1,0]
    v_cvt_pk_bf16_f32 v124, v184, v185
    v_cvt_pk_bf16_f32 v125, v186, v187
    v_cvt_pk_bf16_f32 v126, v188, v189
    v_cvt_pk_bf16_f32 v127, v190, v191
    buffer_store_dwordx4 v[124:127], v9, s[24:27], 0 offen offset:0 sc1
    v_accvgpr_read_b32 v176, a8
    v_accvgpr_read_b32 v177, a9
    v_accvgpr_read_b32 v178, a10
    v_accvgpr_read_b32 v179, a11
    v_accvgpr_read_b32 v180, a12
    v_accvgpr_read_b32 v181, a13
    v_accvgpr_read_b32 v182, a14
    v_accvgpr_read_b32 v183, a15
    v_pk_mul_f32 v[176:177], v[176:177], v[80:81] op_sel_hi:[1,0]
    v_pk_mul_f32 v[178:179], v[178:179], v[80:81] op_sel_hi:[1,0]
    v_pk_mul_f32 v[180:181], v[180:181], v[80:81] op_sel_hi:[1,0]
    v_pk_mul_f32 v[182:183], v[182:183], v[80:81] op_sel_hi:[1,0]
    v_cvt_pk_bf16_f32 v128, v176, v177
    v_cvt_pk_bf16_f32 v129, v178, v179
    v_cvt_pk_bf16_f32 v130, v180, v181
    v_cvt_pk_bf16_f32 v131, v182, v183
    buffer_store_dwordx4 v[128:131], v6, s[24:27], 0 offen offset:1024 sc1
    v_accvgpr_read_b32 v184, a40
    v_accvgpr_read_b32 v185, a41
    v_accvgpr_read_b32 v186, a42
    v_accvgpr_read_b32 v187, a43
    v_accvgpr_read_b32 v188, a44
    v_accvgpr_read_b32 v189, a45
    v_accvgpr_read_b32 v190, a46
    v_accvgpr_read_b32 v191, a47
    v_pk_mul_f32 v[184:185], v[184:185], v[82:83] op_sel_hi:[1,0]
    v_pk_mul_f32 v[186:187], v[186:187], v[82:83] op_sel_hi:[1,0]
    v_pk_mul_f32 v[188:189], v[188:189], v[82:83] op_sel_hi:[1,0]
    v_pk_mul_f32 v[190:191], v[190:191], v[82:83] op_sel_hi:[1,0]
    v_cvt_pk_bf16_f32 v132, v184, v185
    v_cvt_pk_bf16_f32 v133, v186, v187
    v_cvt_pk_bf16_f32 v134, v188, v189
    v_cvt_pk_bf16_f32 v135, v190, v191
    buffer_store_dwordx4 v[132:135], v7, s[24:27], 0 offen offset:1024 sc1
    v_accvgpr_read_b32 v176, a72
    v_accvgpr_read_b32 v177, a73
    v_accvgpr_read_b32 v178, a74
    v_accvgpr_read_b32 v179, a75
    v_accvgpr_read_b32 v180, a76
    v_accvgpr_read_b32 v181, a77
    v_accvgpr_read_b32 v182, a78
    v_accvgpr_read_b32 v183, a79
    v_pk_mul_f32 v[176:177], v[176:177], v[84:85] op_sel_hi:[1,0]
    v_pk_mul_f32 v[178:179], v[178:179], v[84:85] op_sel_hi:[1,0]
    v_pk_mul_f32 v[180:181], v[180:181], v[84:85] op_sel_hi:[1,0]
    v_pk_mul_f32 v[182:183], v[182:183], v[84:85] op_sel_hi:[1,0]
    v_cvt_pk_bf16_f32 v136, v176, v177
    v_cvt_pk_bf16_f32 v137, v178, v179
    v_cvt_pk_bf16_f32 v138, v180, v181
    v_cvt_pk_bf16_f32 v139, v182, v183
    buffer_store_dwordx4 v[136:139], v8, s[24:27], 0 offen offset:1024 sc1
    v_accvgpr_read_b32 v184, a104
    v_accvgpr_read_b32 v185, a105
    v_accvgpr_read_b32 v186, a106
    v_accvgpr_read_b32 v187, a107
    v_accvgpr_read_b32 v188, a108
    v_accvgpr_read_b32 v189, a109
    v_accvgpr_read_b32 v190, a110
    v_accvgpr_read_b32 v191, a111
    v_pk_mul_f32 v[184:185], v[184:185], v[86:87] op_sel_hi:[1,0]
    v_pk_mul_f32 v[186:187], v[186:187], v[86:87] op_sel_hi:[1,0]
    v_pk_mul_f32 v[188:189], v[188:189], v[86:87] op_sel_hi:[1,0]
    v_pk_mul_f32 v[190:191], v[190:191], v[86:87] op_sel_hi:[1,0]
    v_cvt_pk_bf16_f32 v140, v184, v185
    v_cvt_pk_bf16_f32 v141, v186, v187
    v_cvt_pk_bf16_f32 v142, v188, v189
    v_cvt_pk_bf16_f32 v143, v190, v191
    buffer_store_dwordx4 v[140:143], v9, s[24:27], 0 offen offset:1024 sc1
    v_accvgpr_read_b32 v176, a16
    v_accvgpr_read_b32 v177, a17
    v_accvgpr_read_b32 v178, a18
    v_accvgpr_read_b32 v179, a19
    v_accvgpr_read_b32 v180, a20
    v_accvgpr_read_b32 v181, a21
    v_accvgpr_read_b32 v182, a22
    v_accvgpr_read_b32 v183, a23
    v_pk_mul_f32 v[176:177], v[176:177], v[80:81] op_sel_hi:[1,0]
    v_pk_mul_f32 v[178:179], v[178:179], v[80:81] op_sel_hi:[1,0]
    v_pk_mul_f32 v[180:181], v[180:181], v[80:81] op_sel_hi:[1,0]
    v_pk_mul_f32 v[182:183], v[182:183], v[80:81] op_sel_hi:[1,0]
    v_cvt_pk_bf16_f32 v192, v176, v177
    v_cvt_pk_bf16_f32 v193, v178, v179
    v_cvt_pk_bf16_f32 v194, v180, v181
    v_cvt_pk_bf16_f32 v195, v182, v183
    v_accvgpr_read_b32 v184, a48
    v_accvgpr_read_b32 v185, a49
    v_accvgpr_read_b32 v186, a50
    v_accvgpr_read_b32 v187, a51
    v_accvgpr_read_b32 v188, a52
    v_accvgpr_read_b32 v189, a53
    v_accvgpr_read_b32 v190, a54
    v_accvgpr_read_b32 v191, a55
    v_pk_mul_f32 v[184:185], v[184:185], v[82:83] op_sel_hi:[1,0]
    v_pk_mul_f32 v[186:187], v[186:187], v[82:83] op_sel_hi:[1,0]
    v_pk_mul_f32 v[188:189], v[188:189], v[82:83] op_sel_hi:[1,0]
    v_pk_mul_f32 v[190:191], v[190:191], v[82:83] op_sel_hi:[1,0]
    v_cvt_pk_bf16_f32 v196, v184, v185
    v_cvt_pk_bf16_f32 v197, v186, v187
    v_cvt_pk_bf16_f32 v198, v188, v189
    v_cvt_pk_bf16_f32 v199, v190, v191
    v_accvgpr_read_b32 v176, a80
    v_accvgpr_read_b32 v177, a81
    v_accvgpr_read_b32 v178, a82
    v_accvgpr_read_b32 v179, a83
    v_accvgpr_read_b32 v180, a84
    v_accvgpr_read_b32 v181, a85
    v_accvgpr_read_b32 v182, a86
    v_accvgpr_read_b32 v183, a87
    v_pk_mul_f32 v[176:177], v[176:177], v[84:85] op_sel_hi:[1,0]
    v_pk_mul_f32 v[178:179], v[178:179], v[84:85] op_sel_hi:[1,0]
    v_pk_mul_f32 v[180:181], v[180:181], v[84:85] op_sel_hi:[1,0]
    v_pk_mul_f32 v[182:183], v[182:183], v[84:85] op_sel_hi:[1,0]
    v_cvt_pk_bf16_f32 v200, v176, v177
    v_cvt_pk_bf16_f32 v201, v178, v179
    v_cvt_pk_bf16_f32 v202, v180, v181
    v_cvt_pk_bf16_f32 v203, v182, v183
    v_accvgpr_read_b32 v184, a112
    v_accvgpr_read_b32 v185, a113
    v_accvgpr_read_b32 v186, a114
    v_accvgpr_read_b32 v187, a115
    v_accvgpr_read_b32 v188, a116
    v_accvgpr_read_b32 v189, a117
    v_accvgpr_read_b32 v190, a118
    v_accvgpr_read_b32 v191, a119
    v_pk_mul_f32 v[184:185], v[184:185], v[86:87] op_sel_hi:[1,0]
    v_pk_mul_f32 v[186:187], v[186:187], v[86:87] op_sel_hi:[1,0]
    v_pk_mul_f32 v[188:189], v[188:189], v[86:87] op_sel_hi:[1,0]
    v_pk_mul_f32 v[190:191], v[190:191], v[86:87] op_sel_hi:[1,0]
    v_cvt_pk_bf16_f32 v204, v184, v185
    v_cvt_pk_bf16_f32 v205, v186, v187
    v_cvt_pk_bf16_f32 v206, v188, v189
    v_cvt_pk_bf16_f32 v207, v190, v191
    v_accvgpr_read_b32 v176, a24
    v_accvgpr_read_b32 v177, a25
    v_accvgpr_read_b32 v178, a26
    v_accvgpr_read_b32 v179, a27
    v_accvgpr_read_b32 v180, a28
    v_accvgpr_read_b32 v181, a29
    v_accvgpr_read_b32 v182, a30
    v_accvgpr_read_b32 v183, a31
    v_pk_mul_f32 v[176:177], v[176:177], v[80:81] op_sel_hi:[1,0]
    v_pk_mul_f32 v[178:179], v[178:179], v[80:81] op_sel_hi:[1,0]
    v_pk_mul_f32 v[180:181], v[180:181], v[80:81] op_sel_hi:[1,0]
    v_pk_mul_f32 v[182:183], v[182:183], v[80:81] op_sel_hi:[1,0]
    v_cvt_pk_bf16_f32 v208, v176, v177
    v_cvt_pk_bf16_f32 v209, v178, v179
    v_cvt_pk_bf16_f32 v210, v180, v181
    v_cvt_pk_bf16_f32 v211, v182, v183
    v_accvgpr_read_b32 v184, a56
    v_accvgpr_read_b32 v185, a57
    v_accvgpr_read_b32 v186, a58
    v_accvgpr_read_b32 v187, a59
    v_accvgpr_read_b32 v188, a60
    v_accvgpr_read_b32 v189, a61
    v_accvgpr_read_b32 v190, a62
    v_accvgpr_read_b32 v191, a63
    v_pk_mul_f32 v[184:185], v[184:185], v[82:83] op_sel_hi:[1,0]
    v_pk_mul_f32 v[186:187], v[186:187], v[82:83] op_sel_hi:[1,0]
    v_pk_mul_f32 v[188:189], v[188:189], v[82:83] op_sel_hi:[1,0]
    v_pk_mul_f32 v[190:191], v[190:191], v[82:83] op_sel_hi:[1,0]
    v_cvt_pk_bf16_f32 v212, v184, v185
    v_cvt_pk_bf16_f32 v213, v186, v187
    v_cvt_pk_bf16_f32 v214, v188, v189
    v_cvt_pk_bf16_f32 v215, v190, v191
    v_accvgpr_read_b32 v176, a88
    v_accvgpr_read_b32 v177, a89
    v_accvgpr_read_b32 v178, a90
    v_accvgpr_read_b32 v179, a91
    v_accvgpr_read_b32 v180, a92
    v_accvgpr_read_b32 v181, a93
    v_accvgpr_read_b32 v182, a94
    v_accvgpr_read_b32 v183, a95
    v_pk_mul_f32 v[176:177], v[176:177], v[84:85] op_sel_hi:[1,0]
    v_pk_mul_f32 v[178:179], v[178:179], v[84:85] op_sel_hi:[1,0]
    v_pk_mul_f32 v[180:181], v[180:181], v[84:85] op_sel_hi:[1,0]
    v_pk_mul_f32 v[182:183], v[182:183], v[84:85] op_sel_hi:[1,0]
    v_cvt_pk_bf16_f32 v232, v176, v177
    v_cvt_pk_bf16_f32 v233, v178, v179
    v_cvt_pk_bf16_f32 v234, v180, v181
    v_cvt_pk_bf16_f32 v235, v182, v183
    buffer_store_dwordx4 v[232:235], v8, s[24:27], 0 offen offset:3072 sc1
    v_accvgpr_read_b32 v184, a120
    v_accvgpr_read_b32 v185, a121
    v_accvgpr_read_b32 v186, a122
    v_accvgpr_read_b32 v187, a123
    v_accvgpr_read_b32 v188, a124
    v_accvgpr_read_b32 v189, a125
    v_accvgpr_read_b32 v190, a126
    v_accvgpr_read_b32 v191, a127
    v_pk_mul_f32 v[184:185], v[184:185], v[86:87] op_sel_hi:[1,0]
    v_pk_mul_f32 v[186:187], v[186:187], v[86:87] op_sel_hi:[1,0]
    v_pk_mul_f32 v[188:189], v[188:189], v[86:87] op_sel_hi:[1,0]
    v_pk_mul_f32 v[190:191], v[190:191], v[86:87] op_sel_hi:[1,0]
    v_cvt_pk_bf16_f32 v236, v184, v185
    v_cvt_pk_bf16_f32 v237, v186, v187
    v_cvt_pk_bf16_f32 v238, v188, v189
    v_cvt_pk_bf16_f32 v239, v190, v191
    buffer_store_dwordx4 v[236:239], v9, s[24:27], 0 offen offset:3072 sc1
    s_branch L_cont_19
.section .rodata,"a"
.p2align 6
.amdhsa_kernel adaLN_cond__mha_block_cached__moe_arch_mod__prompt_kernel
  .amdhsa_next_free_vgpr 512
  .amdhsa_next_free_sgpr 102
  .amdhsa_accum_offset 256
  .amdhsa_group_segment_fixed_size 0
  .amdhsa_kernarg_size 120
  .amdhsa_user_sgpr_count 2
  .amdhsa_user_sgpr_kernarg_segment_ptr 1
  .amdhsa_system_sgpr_workgroup_id_x 1
  .amdhsa_float_denorm_mode_32 3
.end_amdhsa_kernel
```
